```python
import torch

def _softmax(x, axis=-1):
    return torch.softmax(x, dim=axis)
def _gelu(x):
    return torch.nn.functional.gelu(x, approximate="tanh")
def _silu(x):
    return torch.nn.functional.silu(x)
def _sigmoid(x):
    return torch.sigmoid(x)
def _layernorm(x, axis=-1, eps=1e-5):
    m = x.mean(dim=axis, keepdim=True)
    v = x.var(dim=axis, keepdim=True, unbiased=False)
    return (x - m) / torch.sqrt(v + eps)
def _scatter_add(tgt, idx, src, axis=0):
    return tgt.clone().index_add_(axis, idx, src)
def _segment_sum(src, seg, n):
    out = torch.zeros((n,) + src.shape[1:], dtype=src.dtype)
    return out.index_add_(0, seg, src)
def _pad(x, pw):
    flat = tuple(v for pair in reversed(pw) for v in pair)
    return torch.nn.functional.pad(x, flat)

kernel_name = 'sequential_preLN__ssm_conv_s4__swiglu_ffn__prompt'

def setup_inputs():

    _w = (lambda a: (lambda t: t.to(torch.bfloat16) if t.is_floating_point() else t)(torch.as_tensor(a)))
    def _A_setup():
        B, L, D, N = 1, 2048, 1024, 128
        A_re = -(lambda _x: torch.exp(torch.as_tensor(_x)))((lambda *s: torch.randn(*s, dtype=torch.bfloat16) * 6.4)(D, N))
        A_im = torch.pi * (lambda *s: torch.randn(*s, dtype=torch.bfloat16) * 0.05)(D, N)
        B_re = (lambda *s: torch.randn(*s, dtype=torch.bfloat16) * 0.05)(D, N)
        B_im = (lambda *s: torch.randn(*s, dtype=torch.bfloat16) * 0.05)(D, N)
        C_re = (lambda *s: torch.randn(*s, dtype=torch.bfloat16) * 0.05)(D, N)
        C_im = (lambda *s: torch.randn(*s, dtype=torch.bfloat16) * 0.05)(D, N)
        log_dt = (lambda *s: torch.randn(*s, dtype=torch.bfloat16) * 0.05)(D) * 0.5 - 4.0
        Dskip = (lambda *s: torch.randn(*s, dtype=torch.bfloat16) * 0.05)(D)
        return {
            "u": _w((lambda *s: torch.randn(*s, dtype=torch.bfloat16) * 0.05)(B, L, D)),
            "A_re": _w(A_re),
            "A_im": _w(A_im),
            "B_re": _w(B_re),
            "B_im": _w(B_im),
            "C_re": _w(C_re),
            "C_im": _w(C_im),
            "log_dt": _w(log_dt),
            "Dskip": _w(Dskip),
        }
    _A_in = _A_setup()

    def _B_setup():
        B, S, D, F = 1, 2048, 1024, 3584
        return {
            "x": _w((lambda *s: torch.randn(*s, dtype=torch.bfloat16) * 0.05)(B, S, D)),
            "w_gate": _w((lambda *s: torch.randn(*s, dtype=torch.bfloat16) * 0.05)(D, F)),
            "w_up": _w((lambda *s: torch.randn(*s, dtype=torch.bfloat16) * 0.05)(D, F)),
            "w_down": _w((lambda *s: torch.randn(*s, dtype=torch.bfloat16) * 0.05)(F, D)),
        }
    _B_in = _B_setup()

    return {
        "A_u": _A_in["u"],
        "A_A_re": _A_in["A_re"],
        "A_A_im": _A_in["A_im"],
        "A_B_re": _A_in["B_re"],
        "A_B_im": _A_in["B_im"],
        "A_C_re": _A_in["C_re"],
        "A_C_im": _A_in["C_im"],
        "A_log_dt": _A_in["log_dt"],
        "A_Dskip": _A_in["Dskip"],
        "B_x": _B_in["x"],
        "B_w_gate": _B_in["w_gate"],
        "B_w_up": _B_in["w_up"],
        "B_w_down": _B_in["w_down"],
    }

def reference(A_u, A_A_re, A_A_im, A_B_re, A_B_im, A_C_re, A_C_im, A_log_dt, A_Dskip, B_x, B_w_gate, B_w_up, B_w_down):
    def _A_ref(u, A_re, A_im, B_re, B_im, C_re, C_im, log_dt, Dskip):
        Bsz, L, D = u.shape
        dt = torch.exp(log_dt)[:, None]
        A = A_re + 1j * A_im
        Bc = B_re + 1j * B_im
        Cc = C_re + 1j * C_im
        logdA = dt * A
        dB = dt * Bc
        l = (lambda x, dt: x.to(dt))(torch.arange(L), A_re.dtype)
        P = torch.exp(logdA[:, :, None] * l[None, None, :])
        K = torch.einsum("dn,dnl,dn->dl", Cc, P, dB).real
        L2 = 2 * L
        Kp = _pad(K, ((0, 0), (0, L)))
        up = (lambda x, *d: x.permute(*d))(u, 0, 2, 1)
        up = _pad(up, ((0, 0), (0, 0), (0, L)))
        Kf = (lambda x, axes=(-2,-1): torch.fft.rfft2(x.float(), dim=axes))(Kp[:, None, :], axes=(-2, -1))
        Uf = (lambda x, axes=(-2,-1): torch.fft.rfft2(x.float(), dim=axes))(up[:, :, None, :], axes=(-2, -1))
        Yf = Uf * Kf[None, :, :, :]
        y = (lambda x, s, axes=(-2,-1): torch.fft.irfft2(x, s=s, dim=axes).to(torch.bfloat16))(Yf, (1, L2), axes=(-2, -1))[:, :, 0, :L]
        y = (lambda x, *d: x.permute(*d))(y, 0, 2, 1) + u * Dskip[None, None, :]
        return y

    def _B_ref(x, w_gate, w_up, w_down):
        g = _silu(x @ w_gate)
        u = x @ w_up
        return (g * u) @ w_down

    x = A_u
    h = x + _A_ref(_layernorm(x, axis=-1), A_A_re, A_A_im, A_B_re, A_B_im, A_C_re, A_C_im, A_log_dt, A_Dskip)
    h2 = h + _B_ref(_layernorm(h, axis=-1), B_w_gate, B_w_up, B_w_down)
    return h2
```

```asm
; @launch kernel=conv_kernel grid=(256,1,1) block=(256,1,1) lds=100176
; @launch kernel=ffn_kernel grid=(256,1,1) block=(256,1,1) lds=144512
.amdgcn_target "amdgcn-amd-amdhsa--gfx950"
.text
code_begin:
.globl conv_kernel
.p2align 8
.type conv_kernel,@function
conv_kernel:
  s_cmp_ge_u32 s2, 256
  s_cbranch_scc1 cv_end
  s_load_dwordx8 s[28:35], s[0:1], 0
  s_load_dwordx4 s[96:99], s[0:1], 112
  s_load_dwordx8 s[36:43], s[0:1], 32
  s_load_dwordx2 s[44:45], s[0:1], 64
  s_memrealtime s[56:57]
  v_lshrrev_b32 v2, 6, v0
  v_and_b32 v1, 63, v0
  v_readfirstlane_b32 s24, v2
  v_lshlrev_b32 v2, 4, v1
  s_lshl_b32 s46, s2, 2
  s_mov_b32 s6, 0x400000
  s_mov_b32 s7, 0x20000
  s_add_u32 s46, s46, s24
  s_lshl_b32 s46, s46, 1
  s_and_b32 s47, s46, 0x703
  s_bfe_u32 s58, s46, 0x40002
  s_lshl_b32 s58, s58, 4
  s_or_b32 s47, s47, s58
  s_bfe_u32 s58, s46, 0x20006
  s_lshl_b32 s58, s58, 2
  s_or_b32 s47, s47, s58
  s_lshl_b32 s47, s47, 11
  s_getpc_b64 s[92:93]
cp_here1:
  s_add_u32 s92, s92, code_begin - cp_here1
  s_addc_u32 s93, s93, ((code_begin - cp_here1) < 0)
  s_lshr_b32 s94, s2, 3
  s_mul_i32 s94, s94, 4
  s_add_u32 s94, s94, s24
  s_mul_i32 s94, s94, (((code_end - code_begin) / 128 + 128) / 128)
  v_min_u32 v25, (((code_end - code_begin) / 128 + 128) / 128) - 1, v1
  v_add_u32 v25, s94, v25
  v_lshlrev_b32 v25, 7, v25
  v_min_u32 v25, code_end - code_begin - 4, v25
  global_load_dword a192, v25, s[92:93]
  s_waitcnt lgkmcnt(0)
  s_mov_b64 s[4:5], s[28:29]
  buffer_load_dwordx4 v[64:67], v2, s[4:7], s47 offen offset:0
  buffer_load_dwordx4 v[68:71], v2, s[4:7], s47 offen offset:1024
  buffer_load_dwordx4 v[72:75], v2, s[4:7], s47 offen offset:2048
  buffer_load_dwordx4 v[76:79], v2, s[4:7], s47 offen offset:3072
  s_mov_b32 s16, s96
  s_mov_b32 s17, s97
  s_mov_b32 s18, 0x100
  s_mov_b32 s19, 0x20000
  v_lshlrev_b32 v61, 6, v1
  s_or_b32 s47, s2, s24
  s_cmp_lg_u32 s47, 0
  s_cbranch_scc1 cv_notag
  s_or_b32 s56, s56, 1
  v_mov_b32 v60, s56
  s_mov_b64 exec, 15
  buffer_store_dword v60, v61, s[16:19], 0 offen sc0 sc1
  s_mov_b64 exec, -1
cv_notag:
  s_and_b32 s27, s2, 7
  s_lshl_b32 s27, s27, 5
  s_lshr_b32 s52, s2, 3
  s_add_u32 s27, s27, s52
  s_lshl_b32 s53, s27, 3
  s_load_dwordx2 s[54:55], s[42:43], s53
  s_load_dwordx2 s[50:51], s[44:45], s53
  s_lshl_b32 s47, s27, 2
  s_add_u32 s47, s47, s24
  s_lshl_b32 s47, s47, 8
  v_lshlrev_b32 v3, 2, v1
  s_mov_b32 s22, 0x40000
  s_mov_b32 s23, 0x20000
  s_mov_b64 s[20:21], s[30:31]
  buffer_load_dword v154, v3, s[20:23], s47 offen
  s_mov_b64 s[20:21], s[32:33]
  buffer_load_dword v155, v3, s[20:23], s47 offen
  s_mov_b64 s[20:21], s[34:35]
  buffer_load_dword v156, v3, s[20:23], s47 offen
  s_mov_b64 s[20:21], s[36:37]
  buffer_load_dword v157, v3, s[20:23], s47 offen
  s_mov_b64 s[20:21], s[38:39]
  buffer_load_dword v158, v3, s[20:23], s47 offen
  s_mov_b64 s[20:21], s[40:41]
  buffer_load_dword v159, v3, s[20:23], s47 offen
  s_load_dwordx4 s[32:35], s[0:1], 80
  s_and_b32 s47, s2, 3
  s_lshl_b32 s59, s47, 6
  v_mov_b32 v61, 0
  s_cmp_lg_u32 s24, 0
  s_cbranch_scc1 cv_notag2
  buffer_load_dword v60, v61, s[16:19], s59 offen sc0 sc1
cv_notag2:
  v_bfe_u32 v26, v1, 1, 4
  v_and_b32 v27, 1, v1
  v_lshlrev_b32 v26, 11, v26
  v_lshl_add_u32 v26, v27, 7, v26
  s_lshr_b32 s47, s2, 3
  s_lshl_b32 s47, s47, 2
  s_add_u32 s47, s47, s24
  s_lshl_b32 s47, s47, 15
  s_and_b32 s58, s2, 7
  s_lshl_b32 s58, s58, 8
  s_add_u32 s47, s47, s58
  s_mov_b32 exec_hi, 0
  buffer_load_dword a192, v26, s[4:7], s47 offen
  s_mov_b64 exec, -1
  v_lshrrev_b32 v26, 2, v1
  v_and_b32 v27, 3, v1
  v_lshl_add_u32 v26, v26, 4, v27
  s_lshl_b32 s52, s24, 9
  v_add_lshl_u32 v2, s52, v26, 11
  v_add_lshl_u32 v3, s52, v1, 4
  s_movk_i32 s31, 0x1000
  s_mov_b32 s8, s98
  s_mov_b32 s9, s99
  s_mov_b32 s10, 0x8000
  s_mov_b32 s11, 0x20000
  s_add_u32 s12, s98, 0x100000
  s_addc_u32 s13, s99, 0
  s_mov_b32 s14, 0x400000
  s_mov_b32 s15, 0x20000
  s_add_u32 s60, s98, 0x3c000
  s_addc_u32 s61, s99, 0
  s_mov_b32 s62, 0x40000
  s_mov_b32 s63, 0x20000
  v_mov_b32 v24, 0
  v_mov_b32 v25, 0
  v_lshrrev_b32 v26, 3, v0
  v_and_b32 v27, 7, v0
  v_mul_u32_u24 v26, 1088, v26
  v_lshl_add_u32 v26, v27, 3, v26
  v_cmp_gt_u32 vcc, 128, v0
  s_and_saveexec_b64 s[56:57], vcc
  ds_write_b64 v26, v[24:25] offset:32768
  s_mov_b64 exec, s[56:57]
  v_lshrrev_b32 v26, 2, v0
  v_and_b32 v27, 3, v0
  v_mul_u32_u24 v26, 4160, v26
  v_lshl_add_u32 v26, v27, 3, v26
  v_add_u32 v26, 83456, v26
  v_cmp_gt_u32 vcc, 16, v0
  s_and_saveexec_b64 s[56:57], vcc
  ds_write_b64 v26, v[24:25]
  s_mov_b64 exec, s[56:57]
  s_lshl_b32 s46, s24, 13
  v_lshlrev_b32 v24, 6, v1
  v_add_u32 v24, s46, v24
  v_bfe_u32 v25, v1, 1, 2
  v_xor_b32 v26, 0, v25
  v_lshl_add_u32 v4, v26, 4, v24
  v_xor_b32 v26, 1, v25
  v_lshl_add_u32 v5, v26, 4, v24
  v_xor_b32 v26, 2, v25
  v_lshl_add_u32 v6, v26, 4, v24
  v_xor_b32 v26, 3, v25
  v_lshl_add_u32 v7, v26, 4, v24
  v_lshrrev_b32 v24, 2, v1
  v_lshlrev_b32 v24, 6, v24
  v_and_b32 v25, 1, v1
  v_lshl_add_u32 v24, v25, 3, v24
  v_add_u32 v24, s46, v24
  v_bfe_u32 v25, v1, 3, 2
  v_bfe_u32 v26, v1, 1, 1
  v_xor_b32 v25, v25, v26
  v_lshl_add_u32 v8, v25, 4, v24
  v_xor_b32 v25, 2, v25
  v_lshl_add_u32 v9, v25, 4, v24
  s_mul_i32 s47, s24, 4160
  s_add_u32 s47, s47, 83488
  v_and_b32 v27, 15, v1
  v_lshlrev_b32 v27, 4, v27
  v_add_u32 v27, s47, v27
  v_lshrrev_b32 v28, 4, v1
  v_lshl_add_u32 v148, v28, 8, v27
  v_lshl_add_u32 v149, v28, 9, v27
  v_subrev_u32 v149, 4, v149
  v_lshl_add_u32 v151, v28, 10, v27
  v_add_u32 v151, 2040, v151
  v_lshrrev_b32 v150, 1, v28
  v_lshl_add_u32 v150, v150, 8, v27
  v_and_b32 v28, 1, v28
  v_lshl_add_u32 v150, v28, 3, v150
  v_and_b32 v24, 3, v1
  v_lshrrev_b32 v25, 2, v1
  v_mul_u32_u24 v26, 1088, v24
  v_lshl_add_u32 v26, v25, 3, v26
  s_lshl_b32 s46, s24, 8
  s_add_u32 s46, s46, 32832
  v_add_u32 v152, s46, v26
  v_mul_u32_u24 v27, 2080, v24
  v_lshl_add_u32 v28, v25, 4, v27
  s_lshl_b32 s46, s24, 9
  s_add_u32 s46, s46, 50176
  v_add_u32 v153, s46, v28
  v_lshl_add_u32 v10, v25, 2, v27
  s_mul_i32 s46, s24, 8320
  s_add_u32 s46, s46, 50176
  v_add_u32 v10, s46, v10
  v_lshrrev_b32 v25, 4, v1
  v_bfe_u32 v29, v1, 2, 2
  v_lshlrev_b32 v30, 3, v25
  v_add_u32 v30, v30, v29
  v_sub_u32 v30, v24, v30
  s_mul_i32 s46, s24, 4160
  s_add_u32 s46, s46, 83680
  v_lshl_add_u32 v12, v30, 3, s46
  v_mul_u32_u24 v13, 1088, v24
  v_lshl_add_u32 v13, v29, 3, v13
  v_lshl_add_u32 v13, v25, 4, v13
  s_mul_i32 s46, s24, 4352
  s_add_u32 s46, s46, 32776
  v_add_u32 v13, s46, v13
  s_lshl_b32 s47, s24, 1
  v_lshl_add_u32 v11, v1, 3, s47
  v_min_u32 v30, 55, v1
  s_mul_i32 s46, s24, 56
  v_add_u32 v30, s46, v30
  v_mul_u32_u24 v31, 9363, v30
  v_lshrrev_b32 v31, 16, v31
  v_mul_u32_u24 v29, 7, v31
  v_sub_u32 v30, v30, v29
  v_mul_u32_u24 v31, 7168, v31
  v_lshl_add_u32 v14, v30, 7, v31
  s_bfe_u32 s46, s2, 0x40003
  s_mul_i32 s46, s46, 229376
  s_lshr_b32 s47, s2, 7
  s_mul_i32 s47, s47, 3670016
  s_add_u32 s46, s46, s47
  s_and_b32 s47, s2, 7
  s_mul_i32 s47, s47, 896
  s_add_u32 s30, s46, s47
  s_mov_b32 s47, 0x3f803f80
  s_waitcnt vmcnt(7)
  v_dot2_f32_bf16 v24, v64, s47, 0
  v_dot2_f32_bf16 v25, v64, v64, 0
  v_dot2_f32_bf16 v26, v65, s47, 0
  v_dot2_f32_bf16 v27, v65, v65, 0
  v_dot2_f32_bf16 v24, v66, s47, v24
  v_dot2_f32_bf16 v25, v66, v66, v25
  v_dot2_f32_bf16 v26, v67, s47, v26
  v_dot2_f32_bf16 v27, v67, v67, v27
  v_dot2_f32_bf16 v24, v68, s47, v24
  v_dot2_f32_bf16 v25, v68, v68, v25
  v_dot2_f32_bf16 v26, v69, s47, v26
  v_dot2_f32_bf16 v27, v69, v69, v27
  v_dot2_f32_bf16 v24, v70, s47, v24
  v_dot2_f32_bf16 v25, v70, v70, v25
  v_dot2_f32_bf16 v26, v71, s47, v26
  v_dot2_f32_bf16 v27, v71, v71, v27
  v_dot2_f32_bf16 v28, v72, s47, 0
  v_dot2_f32_bf16 v29, v72, v72, 0
  v_dot2_f32_bf16 v30, v73, s47, 0
  v_dot2_f32_bf16 v31, v73, v73, 0
  v_dot2_f32_bf16 v28, v74, s47, v28
  v_dot2_f32_bf16 v29, v74, v74, v29
  v_dot2_f32_bf16 v30, v75, s47, v30
  v_dot2_f32_bf16 v31, v75, v75, v31
  v_dot2_f32_bf16 v28, v76, s47, v28
  v_dot2_f32_bf16 v29, v76, v76, v29
  v_dot2_f32_bf16 v30, v77, s47, v30
  v_dot2_f32_bf16 v31, v77, v77, v31
  v_dot2_f32_bf16 v28, v78, s47, v28
  v_dot2_f32_bf16 v29, v78, v78, v29
  v_dot2_f32_bf16 v30, v79, s47, v30
  v_dot2_f32_bf16 v31, v79, v79, v31
  v_pk_add_f32 v[24:25], v[24:25], v[26:27]
  s_nop 1
  v_pk_add_f32 v[28:29], v[28:29], v[30:31]
  s_nop 1
  v_permlane32_swap_b32 v24, v28
  v_permlane32_swap_b32 v25, v29
  v_pk_add_f32 v[24:25], v[24:25], v[28:29]
  s_nop 1
  v_add_f32_dpp v24, v24, v24 quad_perm:[1,0,3,2] row_mask:0xf bank_mask:0xf
  v_add_f32_dpp v25, v25, v25 quad_perm:[1,0,3,2] row_mask:0xf bank_mask:0xf
  s_nop 0
  v_add_f32_dpp v24, v24, v24 quad_perm:[2,3,0,1] row_mask:0xf bank_mask:0xf
  v_add_f32_dpp v25, v25, v25 quad_perm:[2,3,0,1] row_mask:0xf bank_mask:0xf
  s_nop 0
  v_add_f32_dpp v24, v24, v24 row_half_mirror row_mask:0xf bank_mask:0xf
  v_add_f32_dpp v25, v25, v25 row_half_mirror row_mask:0xf bank_mask:0xf
  s_nop 0
  v_add_f32_dpp v24, v24, v24 row_mirror row_mask:0xf bank_mask:0xf
  v_add_f32_dpp v25, v25, v25 row_mirror row_mask:0xf bank_mask:0xf
  s_nop 0
  v_mov_b32 v26, v24
  v_mov_b32 v27, v25
  s_nop 0
  v_permlane16_swap_b32 v24, v26
  v_permlane16_swap_b32 v25, v27
  v_pk_add_f32 v[24:25], v[24:25], v[26:27]
  v_mul_f32 v24, 0xba800000, v24
  v_mov_b32 v26, 0x3727c5ac
  v_fmac_f32 v26, 0x3a800000, v25
  v_fma_f32 v26, -v24, v24, v26
  v_max_f32 v26, 0x3727c5ac, v26
  v_rsq_f32 v26, v26
  s_lshl_b32 s47, s24, 4
  s_add_u32 s47, s47, 100096
  v_lshrrev_b32 v28, 5, v1
  v_lshl_add_u32 v28, v28, 3, s47
  v_mul_f32 v27, v24, v26
  ds_write_b64 v28, v[26:27]
  s_waitcnt lgkmcnt(0)
  s_barrier
  s_waitcnt vmcnt(1)
  s_cmp_lg_u32 s24, 0
  s_cbranch_scc1 cv_nopub
  v_and_b32 v29, 7, v1
  v_mov_b32 v28, 100096
  v_lshl_add_u32 v30, v29, 3, v28
  ds_read_b64 v[26:27], v30
  s_mov_b32 s47, 0
cv_tagp:
  v_readfirstlane_b32 s58, v60
  s_cmp_lg_u32 s58, 0
  s_cbranch_scc1 cv_tagd
  buffer_load_dword v60, v61, s[16:19], s59 offen sc0 sc1
  s_add_u32 s47, s47, 1
  s_cmp_lt_u32 s47, 0x20000
  s_waitcnt vmcnt(0)
  s_cbranch_scc1 cv_tagp
cv_tagd:
  v_lshlrev_b32 v29, 4, v29
  s_lshl_b32 s47, s2, 7
  s_waitcnt lgkmcnt(0)
  v_mov_b32 v24, v26
  v_mov_b32 v25, v60
  v_mov_b32 v26, v27
  v_mov_b32 v27, v60
  s_mov_b64 exec, 0xff
  buffer_store_dwordx4 v[24:27], v29, s[8:11], s47 offen sc0 sc1
  s_mov_b64 exec, -1
  ds_write_b32 v28, v60 offset:64
cv_nopub:
  s_cmp_lg_u32 s24, 3
  s_cbranch_scc1 cv_nofill
  v_mov_b32 v24, -1
  v_mov_b32 v25, -1
  v_mov_b32 v26, -1
  v_mov_b32 v27, -1
  v_lshlrev_b32 v28, 4, v1
  s_lshl_b32 s47, s2, 10
  buffer_store_dwordx4 v[24:27], v28, s[60:63], s47 offen
cv_nofill:
  s_lshl_b32 s52, s24, 4
  s_lshr_b64 s[54:55], s[54:55], s52
  s_lshl_b32 s54, s54, 16
  s_lshl_b32 s48, s50, 16
  s_and_b32 s49, s50, 0xffff0000
  s_lshl_b32 s50, s51, 16
  s_and_b32 s51, s51, 0xffff0000
  v_mov_b32 v15, 0x3fb8aa3b
  v_mul_f32 v15, s54, v15
  v_exp_f32 v15, v15
  s_mov_b32 s54, 0x01000100
  s_mov_b32 s55, 0x03020302
  v_cvt_pk_bf16_f32 v15, v15, v15
  v_lshlrev_b32 v15, 16, v15
  buffer_load_dwordx2 v[224:225], v2, s[4:7], s53 offen
  s_add_u32 s53, s53, 8192
  v_lshlrev_b32 v32, 16, v154
  v_lshlrev_b32 v33, 16, v155
  v_lshlrev_b32 v34, 16, v156
  v_lshlrev_b32 v35, 16, v157
  v_lshlrev_b32 v36, 16, v158
  v_lshlrev_b32 v37, 16, v159
  v_mul_f32 v32, v32, v15
  v_mul_f32 v33, v33, v15
  v_mul_f32 v34, v34, v15
  v_mul_f32 v35, v35, v15
  v_mul_f32 v38, 0x3fb8aa3b, v32
  v_mul_f32 v39, 0x3e22f983, v33
  v_mul_f32 v26, 0x41000000, v38
  v_mul_f32 v27, 0x41000000, v39
  v_mul_f32 v28, 0x43000000, v38
  v_mul_f32 v29, 0x43000000, v39
  v_exp_f32 v24, v38
  v_fract_f32 v25, v39
  v_exp_f32 v26, v26
  v_fract_f32 v27, v27
  v_exp_f32 v28, v28
  v_fract_f32 v29, v29
  v_cos_f32 v40, v25
  v_sin_f32 v41, v25
  v_cos_f32 v42, v27
  v_sin_f32 v43, v27
  v_cos_f32 v44, v29
  v_sin_f32 v45, v29
  v_pk_mul_f32 v[64:65], v[36:37], v[34:35] op_sel_hi:[1,0]
  v_pk_fma_f32 v[64:65], v[36:37], v[34:35], v[64:65] op_sel:[1,1,0] op_sel_hi:[0,1,1] neg_lo:[0,1,0]
  v_pk_mul_f32 v[40:41], v[40:41], v[24:25] op_sel_hi:[1,0]
  v_pk_mul_f32 v[42:43], v[42:43], v[26:27] op_sel_hi:[1,0]
  v_pk_mul_f32 v[44:45], v[44:45], v[28:29] op_sel_hi:[1,0]
  v_mov_b32 v96, 1.0
  v_mov_b32 v97, 0
  v_mov_b32 v98, v42
  v_mov_b32 v99, v43
  v_pk_mul_f32 v[100:101], v[42:43], v[42:43] op_sel_hi:[1,0]
  v_pk_mul_f32 v[46:47], v[40:41], v[40:41] op_sel_hi:[1,0]
  v_pk_mul_f32 v[66:67], v[64:65], v[40:41] op_sel_hi:[1,0]
  v_pk_fma_f32 v[100:101], v[42:43], v[42:43], v[100:101] op_sel:[1,1,0] op_sel_hi:[0,1,1] neg_lo:[0,1,0]
  v_pk_fma_f32 v[46:47], v[40:41], v[40:41], v[46:47] op_sel:[1,1,0] op_sel_hi:[0,1,1] neg_lo:[0,1,0]
  v_pk_fma_f32 v[66:67], v[64:65], v[40:41], v[66:67] op_sel:[1,1,0] op_sel_hi:[0,1,1] neg_lo:[0,1,0]
  v_pk_mul_f32 v[102:103], v[100:101], v[42:43] op_sel_hi:[1,0]
  v_pk_mul_f32 v[104:105], v[100:101], v[100:101] op_sel_hi:[1,0]
  v_pk_mul_f32 v[48:49], v[46:47], v[46:47] op_sel_hi:[1,0]
  v_pk_mul_f32 v[68:69], v[64:65], v[46:47] op_sel_hi:[1,0]
  v_pk_mul_f32 v[70:71], v[66:67], v[46:47] op_sel_hi:[1,0]
  v_pk_fma_f32 v[102:103], v[100:101], v[42:43], v[102:103] op_sel:[1,1,0] op_sel_hi:[0,1,1] neg_lo:[0,1,0]
  v_pk_fma_f32 v[104:105], v[100:101], v[100:101], v[104:105] op_sel:[1,1,0] op_sel_hi:[0,1,1] neg_lo:[0,1,0]
  v_pk_fma_f32 v[48:49], v[46:47], v[46:47], v[48:49] op_sel:[1,1,0] op_sel_hi:[0,1,1] neg_lo:[0,1,0]
  v_pk_fma_f32 v[68:69], v[64:65], v[46:47], v[68:69] op_sel:[1,1,0] op_sel_hi:[0,1,1] neg_lo:[0,1,0]
  v_pk_fma_f32 v[70:71], v[66:67], v[46:47], v[70:71] op_sel:[1,1,0] op_sel_hi:[0,1,1] neg_lo:[0,1,0]
  v_pk_mul_f32 v[106:107], v[98:99], v[104:105] op_sel_hi:[1,0]
  v_pk_mul_f32 v[108:109], v[100:101], v[104:105] op_sel_hi:[1,0]
  v_pk_mul_f32 v[110:111], v[102:103], v[104:105] op_sel_hi:[1,0]
  v_pk_mul_f32 v[112:113], v[104:105], v[104:105] op_sel_hi:[1,0]
  v_pk_mul_f32 v[72:73], v[64:65], v[48:49] op_sel_hi:[1,0]
  v_pk_mul_f32 v[74:75], v[66:67], v[48:49] op_sel_hi:[1,0]
  v_pk_mul_f32 v[76:77], v[68:69], v[48:49] op_sel_hi:[1,0]
  v_pk_mul_f32 v[78:79], v[70:71], v[48:49] op_sel_hi:[1,0]
  v_pk_fma_f32 v[106:107], v[98:99], v[104:105], v[106:107] op_sel:[1,1,0] op_sel_hi:[0,1,1] neg_lo:[0,1,0]
  v_pk_fma_f32 v[108:109], v[100:101], v[104:105], v[108:109] op_sel:[1,1,0] op_sel_hi:[0,1,1] neg_lo:[0,1,0]
  v_pk_fma_f32 v[110:111], v[102:103], v[104:105], v[110:111] op_sel:[1,1,0] op_sel_hi:[0,1,1] neg_lo:[0,1,0]
  v_pk_fma_f32 v[112:113], v[104:105], v[104:105], v[112:113] op_sel:[1,1,0] op_sel_hi:[0,1,1] neg_lo:[0,1,0]
  v_pk_fma_f32 v[72:73], v[64:65], v[48:49], v[72:73] op_sel:[1,1,0] op_sel_hi:[0,1,1] neg_lo:[0,1,0]
  v_pk_fma_f32 v[74:75], v[66:67], v[48:49], v[74:75] op_sel:[1,1,0] op_sel_hi:[0,1,1] neg_lo:[0,1,0]
  v_pk_fma_f32 v[76:77], v[68:69], v[48:49], v[76:77] op_sel:[1,1,0] op_sel_hi:[0,1,1] neg_lo:[0,1,0]
  v_pk_fma_f32 v[78:79], v[70:71], v[48:49], v[78:79] op_sel:[1,1,0] op_sel_hi:[0,1,1] neg_lo:[0,1,0]
  v_cvt_pk_bf16_f32 v24, v96, v98
  v_cvt_pk_bf16_f32 v25, v100, v102
  v_cvt_pk_bf16_f32 v26, v104, v106
  v_cvt_pk_bf16_f32 v27, v108, v110
  v_cvt_pk_bf16_f32 v28, -v97, -v99
  v_cvt_pk_bf16_f32 v29, -v101, -v103
  v_cvt_pk_bf16_f32 v30, -v105, -v107
  v_cvt_pk_bf16_f32 v31, -v109, -v111
  ds_write_b128 v4, v[24:27]
  ds_write_b128 v4, v[28:31] offset:4096
  v_pk_mul_f32 v[114:115], v[98:99], v[112:113] op_sel_hi:[1,0]
  v_pk_mul_f32 v[116:117], v[100:101], v[112:113] op_sel_hi:[1,0]
  v_pk_mul_f32 v[118:119], v[102:103], v[112:113] op_sel_hi:[1,0]
  v_pk_mul_f32 v[120:121], v[104:105], v[112:113] op_sel_hi:[1,0]
  v_pk_mul_f32 v[122:123], v[106:107], v[112:113] op_sel_hi:[1,0]
  v_pk_mul_f32 v[124:125], v[108:109], v[112:113] op_sel_hi:[1,0]
  v_pk_mul_f32 v[126:127], v[110:111], v[112:113] op_sel_hi:[1,0]
  v_pk_fma_f32 v[114:115], v[98:99], v[112:113], v[114:115] op_sel:[1,1,0] op_sel_hi:[0,1,1] neg_lo:[0,1,0]
  v_pk_fma_f32 v[116:117], v[100:101], v[112:113], v[116:117] op_sel:[1,1,0] op_sel_hi:[0,1,1] neg_lo:[0,1,0]
  v_pk_fma_f32 v[118:119], v[102:103], v[112:113], v[118:119] op_sel:[1,1,0] op_sel_hi:[0,1,1] neg_lo:[0,1,0]
  v_pk_fma_f32 v[120:121], v[104:105], v[112:113], v[120:121] op_sel:[1,1,0] op_sel_hi:[0,1,1] neg_lo:[0,1,0]
  v_pk_fma_f32 v[122:123], v[106:107], v[112:113], v[122:123] op_sel:[1,1,0] op_sel_hi:[0,1,1] neg_lo:[0,1,0]
  v_pk_fma_f32 v[124:125], v[108:109], v[112:113], v[124:125] op_sel:[1,1,0] op_sel_hi:[0,1,1] neg_lo:[0,1,0]
  v_pk_fma_f32 v[126:127], v[110:111], v[112:113], v[126:127] op_sel:[1,1,0] op_sel_hi:[0,1,1] neg_lo:[0,1,0]
  v_cvt_pk_bf16_f32 v50, v64, v66
  v_cvt_pk_bf16_f32 v51, v68, v70
  v_cvt_pk_bf16_f32 v52, v72, v74
  v_cvt_pk_bf16_f32 v53, v76, v78
  v_cvt_pk_bf16_f32 v54, v65, v67
  v_cvt_pk_bf16_f32 v55, v69, v71
  v_cvt_pk_bf16_f32 v56, v73, v75
  v_cvt_pk_bf16_f32 v57, v77, v79
  ds_write_b128 v6, v[50:53]
  ds_write_b128 v6, v[54:57] offset:4096
  v_pk_mul_f32 v[80:81], v[64:65], v[44:45] op_sel_hi:[1,0]
  v_pk_mul_f32 v[82:83], v[66:67], v[44:45] op_sel_hi:[1,0]
  v_pk_mul_f32 v[84:85], v[68:69], v[44:45] op_sel_hi:[1,0]
  v_pk_mul_f32 v[86:87], v[70:71], v[44:45] op_sel_hi:[1,0]
  v_pk_mul_f32 v[88:89], v[72:73], v[44:45] op_sel_hi:[1,0]
  v_pk_mul_f32 v[90:91], v[74:75], v[44:45] op_sel_hi:[1,0]
  v_pk_mul_f32 v[92:93], v[76:77], v[44:45] op_sel_hi:[1,0]
  v_pk_mul_f32 v[94:95], v[78:79], v[44:45] op_sel_hi:[1,0]
  v_pk_fma_f32 v[80:81], v[64:65], v[44:45], v[80:81] op_sel:[1,1,0] op_sel_hi:[0,1,1] neg_lo:[0,1,0]
  v_pk_fma_f32 v[82:83], v[66:67], v[44:45], v[82:83] op_sel:[1,1,0] op_sel_hi:[0,1,1] neg_lo:[0,1,0]
  v_pk_fma_f32 v[84:85], v[68:69], v[44:45], v[84:85] op_sel:[1,1,0] op_sel_hi:[0,1,1] neg_lo:[0,1,0]
  v_pk_fma_f32 v[86:87], v[70:71], v[44:45], v[86:87] op_sel:[1,1,0] op_sel_hi:[0,1,1] neg_lo:[0,1,0]
  v_pk_fma_f32 v[88:89], v[72:73], v[44:45], v[88:89] op_sel:[1,1,0] op_sel_hi:[0,1,1] neg_lo:[0,1,0]
  v_pk_fma_f32 v[90:91], v[74:75], v[44:45], v[90:91] op_sel:[1,1,0] op_sel_hi:[0,1,1] neg_lo:[0,1,0]
  v_pk_fma_f32 v[92:93], v[76:77], v[44:45], v[92:93] op_sel:[1,1,0] op_sel_hi:[0,1,1] neg_lo:[0,1,0]
  v_pk_fma_f32 v[94:95], v[78:79], v[44:45], v[94:95] op_sel:[1,1,0] op_sel_hi:[0,1,1] neg_lo:[0,1,0]
  buffer_load_dwordx2 v[226:227], v2, s[4:7], s53 offen
  s_add_u32 s53, s53, 8192
  v_cvt_pk_bf16_f32 v24, v112, v114
  v_cvt_pk_bf16_f32 v25, v116, v118
  v_cvt_pk_bf16_f32 v26, v120, v122
  v_cvt_pk_bf16_f32 v27, v124, v126
  v_cvt_pk_bf16_f32 v28, -v113, -v115
  v_cvt_pk_bf16_f32 v29, -v117, -v119
  v_cvt_pk_bf16_f32 v30, -v121, -v123
  v_cvt_pk_bf16_f32 v31, -v125, -v127
  ds_write_b128 v5, v[24:27]
  ds_write_b128 v5, v[28:31] offset:4096
  v_pk_mul_f32 v[96:97], v[80:81], v[44:45] op_sel_hi:[1,0]
  v_pk_mul_f32 v[98:99], v[84:85], v[44:45] op_sel_hi:[1,0]
  v_pk_mul_f32 v[100:101], v[88:89], v[44:45] op_sel_hi:[1,0]
  v_pk_mul_f32 v[102:103], v[92:93], v[44:45] op_sel_hi:[1,0]
  v_pk_mul_f32 v[46:47], v[44:45], v[44:45] op_sel_hi:[1,0]
  v_pk_fma_f32 v[96:97], v[80:81], v[44:45], v[96:97] op_sel:[1,1,0] op_sel_hi:[0,1,1] neg_lo:[0,1,0]
  v_pk_fma_f32 v[98:99], v[84:85], v[44:45], v[98:99] op_sel:[1,1,0] op_sel_hi:[0,1,1] neg_lo:[0,1,0]
  v_pk_fma_f32 v[100:101], v[88:89], v[44:45], v[100:101] op_sel:[1,1,0] op_sel_hi:[0,1,1] neg_lo:[0,1,0]
  v_pk_fma_f32 v[102:103], v[92:93], v[44:45], v[102:103] op_sel:[1,1,0] op_sel_hi:[0,1,1] neg_lo:[0,1,0]
  v_pk_fma_f32 v[46:47], v[44:45], v[44:45], v[46:47] op_sel:[1,1,0] op_sel_hi:[0,1,1] neg_lo:[0,1,0]
  v_cvt_pk_bf16_f32 v50, v80, v82
  v_cvt_pk_bf16_f32 v51, v84, v86
  v_cvt_pk_bf16_f32 v52, v88, v90
  v_cvt_pk_bf16_f32 v53, v92, v94
  v_cvt_pk_bf16_f32 v54, v81, v83
  v_cvt_pk_bf16_f32 v55, v85, v87
  v_cvt_pk_bf16_f32 v56, v89, v91
  v_cvt_pk_bf16_f32 v57, v93, v95
  ds_write_b128 v7, v[50:53]
  ds_write_b128 v7, v[54:57] offset:4096
  v_pk_mul_f32 v[104:105], v[96:97], v[44:45] op_sel_hi:[1,0]
  v_pk_mul_f32 v[106:107], v[98:99], v[44:45] op_sel_hi:[1,0]
  v_pk_mul_f32 v[108:109], v[100:101], v[44:45] op_sel_hi:[1,0]
  v_pk_mul_f32 v[110:111], v[102:103], v[44:45] op_sel_hi:[1,0]
  v_pk_mul_f32 v[112:113], v[96:97], v[46:47] op_sel_hi:[1,0]
  v_pk_mul_f32 v[114:115], v[100:101], v[46:47] op_sel_hi:[1,0]
  v_pk_fma_f32 v[104:105], v[96:97], v[44:45], v[104:105] op_sel:[1,1,0] op_sel_hi:[0,1,1] neg_lo:[0,1,0]
  v_pk_fma_f32 v[106:107], v[98:99], v[44:45], v[106:107] op_sel:[1,1,0] op_sel_hi:[0,1,1] neg_lo:[0,1,0]
  v_pk_fma_f32 v[108:109], v[100:101], v[44:45], v[108:109] op_sel:[1,1,0] op_sel_hi:[0,1,1] neg_lo:[0,1,0]
  v_pk_fma_f32 v[110:111], v[102:103], v[44:45], v[110:111] op_sel:[1,1,0] op_sel_hi:[0,1,1] neg_lo:[0,1,0]
  v_pk_fma_f32 v[112:113], v[96:97], v[46:47], v[112:113] op_sel:[1,1,0] op_sel_hi:[0,1,1] neg_lo:[0,1,0]
  v_pk_fma_f32 v[114:115], v[100:101], v[46:47], v[114:115] op_sel:[1,1,0] op_sel_hi:[0,1,1] neg_lo:[0,1,0]
  ds_read_b64_tr_b16 a[0:1], v8 offset:0
  ds_read_b64_tr_b16 a[2:3], v8 offset:4096
  ds_read_b64_tr_b16 a[4:5], v8 offset:1024
  ds_read_b64_tr_b16 a[6:7], v8 offset:5120
  ds_read_b64_tr_b16 a[8:9], v8 offset:2048
  ds_read_b64_tr_b16 a[10:11], v8 offset:6144
  ds_read_b64_tr_b16 a[12:13], v8 offset:3072
  ds_read_b64_tr_b16 a[14:15], v8 offset:7168
  ds_read_b64_tr_b16 a[16:17], v9 offset:0
  ds_read_b64_tr_b16 a[18:19], v9 offset:4096
  ds_read_b64_tr_b16 a[20:21], v9 offset:1024
  ds_read_b64_tr_b16 a[22:23], v9 offset:5120
  ds_read_b64_tr_b16 a[24:25], v9 offset:2048
  ds_read_b64_tr_b16 a[26:27], v9 offset:6144
  ds_read_b64_tr_b16 a[28:29], v9 offset:3072
  ds_read_b64_tr_b16 a[30:31], v9 offset:7168
  v_pk_mul_f32 v[116:117], v[104:105], v[46:47] op_sel_hi:[1,0]
  v_pk_mul_f32 v[118:119], v[108:109], v[46:47] op_sel_hi:[1,0]
  v_pk_mul_f32 v[120:121], v[112:113], v[46:47] op_sel_hi:[1,0]
  v_pk_mul_f32 v[122:123], v[114:115], v[46:47] op_sel_hi:[1,0]
  v_pk_fma_f32 v[116:117], v[104:105], v[46:47], v[116:117] op_sel:[1,1,0] op_sel_hi:[0,1,1] neg_lo:[0,1,0]
  v_pk_fma_f32 v[118:119], v[108:109], v[46:47], v[118:119] op_sel:[1,1,0] op_sel_hi:[0,1,1] neg_lo:[0,1,0]
  v_pk_fma_f32 v[120:121], v[112:113], v[46:47], v[120:121] op_sel:[1,1,0] op_sel_hi:[0,1,1] neg_lo:[0,1,0]
  v_pk_fma_f32 v[122:123], v[114:115], v[46:47], v[122:123] op_sel:[1,1,0] op_sel_hi:[0,1,1] neg_lo:[0,1,0]
  v_cvt_pk_bf16_f32 v24, v96, v98
  v_cvt_pk_bf16_f32 v25, v100, v102
  v_cvt_pk_bf16_f32 v26, v104, v106
  v_cvt_pk_bf16_f32 v27, v108, v110
  v_cvt_pk_bf16_f32 v28, v97, v99
  v_cvt_pk_bf16_f32 v29, v101, v103
  v_cvt_pk_bf16_f32 v30, v105, v107
  v_cvt_pk_bf16_f32 v31, v109, v111
  ds_write_b128 v4, v[24:27]
  ds_write_b128 v4, v[28:31] offset:4096
  v_pk_mul_f32 v[124:125], v[116:117], v[46:47] op_sel_hi:[1,0]
  v_pk_mul_f32 v[126:127], v[118:119], v[46:47] op_sel_hi:[1,0]
  v_pk_mul_f32 v[128:129], v[120:121], v[46:47] op_sel_hi:[1,0]
  v_pk_fma_f32 v[124:125], v[116:117], v[46:47], v[124:125] op_sel:[1,1,0] op_sel_hi:[0,1,1] neg_lo:[0,1,0]
  v_pk_fma_f32 v[126:127], v[118:119], v[46:47], v[126:127] op_sel:[1,1,0] op_sel_hi:[0,1,1] neg_lo:[0,1,0]
  v_pk_fma_f32 v[128:129], v[120:121], v[46:47], v[128:129] op_sel:[1,1,0] op_sel_hi:[0,1,1] neg_lo:[0,1,0]
  v_pk_mul_f32 v[130:131], v[124:125], v[46:47] op_sel_hi:[1,0]
  v_pk_mul_f32 v[132:133], v[128:129], v[46:47] op_sel_hi:[1,0]
  v_pk_fma_f32 v[130:131], v[124:125], v[46:47], v[130:131] op_sel:[1,1,0] op_sel_hi:[0,1,1] neg_lo:[0,1,0]
  v_pk_fma_f32 v[132:133], v[128:129], v[46:47], v[132:133] op_sel:[1,1,0] op_sel_hi:[0,1,1] neg_lo:[0,1,0]
  v_cvt_pk_bf16_f32 v50, v112, v114
  v_cvt_pk_bf16_f32 v51, v116, v118
  v_cvt_pk_bf16_f32 v52, v120, v122
  v_cvt_pk_bf16_f32 v53, v124, v126
  v_cvt_pk_bf16_f32 v54, v113, v115
  v_cvt_pk_bf16_f32 v55, v117, v119
  v_cvt_pk_bf16_f32 v56, v121, v123
  v_cvt_pk_bf16_f32 v57, v125, v127
  ds_write_b128 v5, v[50:53]
  ds_write_b128 v5, v[54:57] offset:4096
  v_pk_mul_f32 v[134:135], v[130:131], v[46:47] op_sel_hi:[1,0]
  v_pk_mul_f32 v[136:137], v[132:133], v[46:47] op_sel_hi:[1,0]
  v_pk_fma_f32 v[134:135], v[130:131], v[46:47], v[134:135] op_sel:[1,1,0] op_sel_hi:[0,1,1] neg_lo:[0,1,0]
  v_pk_fma_f32 v[136:137], v[132:133], v[46:47], v[136:137] op_sel:[1,1,0] op_sel_hi:[0,1,1] neg_lo:[0,1,0]
  v_pk_mul_f32 v[138:139], v[134:135], v[46:47] op_sel_hi:[1,0]
  v_pk_mul_f32 v[140:141], v[136:137], v[46:47] op_sel_hi:[1,0]
  v_pk_fma_f32 v[138:139], v[134:135], v[46:47], v[138:139] op_sel:[1,1,0] op_sel_hi:[0,1,1] neg_lo:[0,1,0]
  v_pk_fma_f32 v[140:141], v[136:137], v[46:47], v[140:141] op_sel:[1,1,0] op_sel_hi:[0,1,1] neg_lo:[0,1,0]
  v_pk_mul_f32 v[142:143], v[138:139], v[46:47] op_sel_hi:[1,0]
  v_pk_mul_f32 v[144:145], v[140:141], v[46:47] op_sel_hi:[1,0]
  v_pk_fma_f32 v[142:143], v[138:139], v[46:47], v[142:143] op_sel:[1,1,0] op_sel_hi:[0,1,1] neg_lo:[0,1,0]
  v_pk_fma_f32 v[144:145], v[140:141], v[46:47], v[144:145] op_sel:[1,1,0] op_sel_hi:[0,1,1] neg_lo:[0,1,0]
  buffer_load_dwordx2 v[228:229], v2, s[4:7], s53 offen
  s_add_u32 s53, s53, 8192
  v_cvt_pk_bf16_f32 v24, v128, v130
  v_cvt_pk_bf16_f32 v25, v132, v134
  v_cvt_pk_bf16_f32 v26, v136, v138
  v_cvt_pk_bf16_f32 v27, v140, v142
  v_cvt_pk_bf16_f32 v28, v129, v131
  v_cvt_pk_bf16_f32 v29, v133, v135
  v_cvt_pk_bf16_f32 v30, v137, v139
  v_cvt_pk_bf16_f32 v31, v141, v143
  ds_write_b128 v6, v[24:27]
  ds_write_b128 v6, v[28:31] offset:4096
  v_cvt_pk_bf16_f32 v50, v144, v144
  v_cvt_pk_bf16_f32 v51, v145, v145
  ds_write_b32 v7, v50
  ds_write_b32 v7, v51 offset:4096
  ds_read_b64_tr_b16 a[32:33], v8 offset:0
  ds_read_b64_tr_b16 a[34:35], v8 offset:4096
  ds_read_b64_tr_b16 a[36:37], v8 offset:1024
  ds_read_b64_tr_b16 a[38:39], v8 offset:5120
  ds_read_b64_tr_b16 a[40:41], v8 offset:2048
  ds_read_b64_tr_b16 a[42:43], v8 offset:6144
  ds_read_b64_tr_b16 a[44:45], v8 offset:3072
  ds_read_b64_tr_b16 a[46:47], v8 offset:7168
  ds_read_b64_tr_b16 a[48:49], v9 offset:0
  ds_read_b64_tr_b16 a[50:51], v9 offset:4096
  ds_read_b64_tr_b16 a[52:53], v9 offset:1024
  ds_read_b64_tr_b16 a[54:55], v9 offset:5120
  ds_read_b64_tr_b16 a[56:57], v9 offset:2048
  ds_read_b64_tr_b16 a[58:59], v9 offset:6144
  ds_read_b64_tr_b16 a[60:61], v9 offset:3072
  ds_read_b64_tr_b16 a[62:63], v9 offset:7168
  buffer_load_dwordx2 v[230:231], v2, s[4:7], s53 offen
  s_add_u32 s53, s53, 499712
  v_and_b32 v32, 0xffff0000, v154
  v_and_b32 v33, 0xffff0000, v155
  v_and_b32 v34, 0xffff0000, v156
  v_and_b32 v35, 0xffff0000, v157
  v_and_b32 v36, 0xffff0000, v158
  v_and_b32 v37, 0xffff0000, v159
  v_mul_f32 v32, v32, v15
  v_mul_f32 v33, v33, v15
  v_mul_f32 v34, v34, v15
  v_mul_f32 v35, v35, v15
  v_mul_f32 v38, 0x3fb8aa3b, v32
  v_mul_f32 v39, 0x3e22f983, v33
  v_mul_f32 v26, 0x41000000, v38
  v_mul_f32 v27, 0x41000000, v39
  v_mul_f32 v28, 0x43000000, v38
  v_mul_f32 v29, 0x43000000, v39
  v_exp_f32 v24, v38
  v_fract_f32 v25, v39
  v_exp_f32 v26, v26
  v_fract_f32 v27, v27
  v_exp_f32 v28, v28
  v_fract_f32 v29, v29
  v_cos_f32 v40, v25
  v_sin_f32 v41, v25
  v_cos_f32 v42, v27
  v_sin_f32 v43, v27
  v_cos_f32 v44, v29
  v_sin_f32 v45, v29
  s_waitcnt lgkmcnt(0)
  v_mfma_f32_16x16x32_bf16 v[160:163], a[16:19], a[0:3], 0
  v_mfma_f32_16x16x32_bf16 v[164:167], a[32:35], a[0:3], 0
  v_mfma_f32_16x16x32_bf16 v[168:171], a[48:51], a[0:3], 0
  v_mfma_f32_16x16x32_bf16 v[160:163], a[20:23], a[4:7], v[160:163]
  v_mfma_f32_16x16x32_bf16 v[164:167], a[36:39], a[4:7], v[164:167]
  v_mfma_f32_16x16x32_bf16 v[168:171], a[52:55], a[4:7], v[168:171]
  v_mfma_f32_16x16x32_bf16 v[160:163], a[24:27], a[8:11], v[160:163]
  v_mfma_f32_16x16x32_bf16 v[164:167], a[40:43], a[8:11], v[164:167]
  v_mfma_f32_16x16x32_bf16 v[168:171], a[56:59], a[8:11], v[168:171]
  v_mfma_f32_16x16x32_bf16 v[160:163], a[28:31], a[12:15], v[160:163]
  v_mfma_f32_16x16x32_bf16 v[164:167], a[44:47], a[12:15], v[164:167]
  v_mfma_f32_16x16x32_bf16 v[168:171], a[60:63], a[12:15], v[168:171]
  v_pk_mul_f32 v[64:65], v[36:37], v[34:35] op_sel_hi:[1,0]
  v_pk_fma_f32 v[64:65], v[36:37], v[34:35], v[64:65] op_sel:[1,1,0] op_sel_hi:[0,1,1] neg_lo:[0,1,0]
  v_pk_mul_f32 v[40:41], v[40:41], v[24:25] op_sel_hi:[1,0]
  v_pk_mul_f32 v[42:43], v[42:43], v[26:27] op_sel_hi:[1,0]
  v_pk_mul_f32 v[44:45], v[44:45], v[28:29] op_sel_hi:[1,0]
  v_mov_b32 v96, 1.0
  v_mov_b32 v97, 0
  v_mov_b32 v98, v42
  v_mov_b32 v99, v43
  v_pk_mul_f32 v[100:101], v[42:43], v[42:43] op_sel_hi:[1,0]
  v_pk_mul_f32 v[46:47], v[40:41], v[40:41] op_sel_hi:[1,0]
  v_pk_mul_f32 v[66:67], v[64:65], v[40:41] op_sel_hi:[1,0]
  v_pk_fma_f32 v[100:101], v[42:43], v[42:43], v[100:101] op_sel:[1,1,0] op_sel_hi:[0,1,1] neg_lo:[0,1,0]
  v_pk_fma_f32 v[46:47], v[40:41], v[40:41], v[46:47] op_sel:[1,1,0] op_sel_hi:[0,1,1] neg_lo:[0,1,0]
  v_pk_fma_f32 v[66:67], v[64:65], v[40:41], v[66:67] op_sel:[1,1,0] op_sel_hi:[0,1,1] neg_lo:[0,1,0]
  v_pk_mul_f32 v[102:103], v[100:101], v[42:43] op_sel_hi:[1,0]
  v_pk_mul_f32 v[104:105], v[100:101], v[100:101] op_sel_hi:[1,0]
  v_pk_mul_f32 v[48:49], v[46:47], v[46:47] op_sel_hi:[1,0]
  v_pk_mul_f32 v[68:69], v[64:65], v[46:47] op_sel_hi:[1,0]
  v_pk_mul_f32 v[70:71], v[66:67], v[46:47] op_sel_hi:[1,0]
  v_pk_fma_f32 v[102:103], v[100:101], v[42:43], v[102:103] op_sel:[1,1,0] op_sel_hi:[0,1,1] neg_lo:[0,1,0]
  v_pk_fma_f32 v[104:105], v[100:101], v[100:101], v[104:105] op_sel:[1,1,0] op_sel_hi:[0,1,1] neg_lo:[0,1,0]
  v_pk_fma_f32 v[48:49], v[46:47], v[46:47], v[48:49] op_sel:[1,1,0] op_sel_hi:[0,1,1] neg_lo:[0,1,0]
  v_pk_fma_f32 v[68:69], v[64:65], v[46:47], v[68:69] op_sel:[1,1,0] op_sel_hi:[0,1,1] neg_lo:[0,1,0]
  v_pk_fma_f32 v[70:71], v[66:67], v[46:47], v[70:71] op_sel:[1,1,0] op_sel_hi:[0,1,1] neg_lo:[0,1,0]
  v_pk_mul_f32 v[106:107], v[98:99], v[104:105] op_sel_hi:[1,0]
  v_pk_mul_f32 v[108:109], v[100:101], v[104:105] op_sel_hi:[1,0]
  v_pk_mul_f32 v[110:111], v[102:103], v[104:105] op_sel_hi:[1,0]
  v_pk_mul_f32 v[112:113], v[104:105], v[104:105] op_sel_hi:[1,0]
  v_pk_mul_f32 v[72:73], v[64:65], v[48:49] op_sel_hi:[1,0]
  v_pk_mul_f32 v[74:75], v[66:67], v[48:49] op_sel_hi:[1,0]
  v_pk_mul_f32 v[76:77], v[68:69], v[48:49] op_sel_hi:[1,0]
  v_pk_mul_f32 v[78:79], v[70:71], v[48:49] op_sel_hi:[1,0]
  v_pk_fma_f32 v[106:107], v[98:99], v[104:105], v[106:107] op_sel:[1,1,0] op_sel_hi:[0,1,1] neg_lo:[0,1,0]
  v_pk_fma_f32 v[108:109], v[100:101], v[104:105], v[108:109] op_sel:[1,1,0] op_sel_hi:[0,1,1] neg_lo:[0,1,0]
  v_pk_fma_f32 v[110:111], v[102:103], v[104:105], v[110:111] op_sel:[1,1,0] op_sel_hi:[0,1,1] neg_lo:[0,1,0]
  v_pk_fma_f32 v[112:113], v[104:105], v[104:105], v[112:113] op_sel:[1,1,0] op_sel_hi:[0,1,1] neg_lo:[0,1,0]
  v_pk_fma_f32 v[72:73], v[64:65], v[48:49], v[72:73] op_sel:[1,1,0] op_sel_hi:[0,1,1] neg_lo:[0,1,0]
  v_pk_fma_f32 v[74:75], v[66:67], v[48:49], v[74:75] op_sel:[1,1,0] op_sel_hi:[0,1,1] neg_lo:[0,1,0]
  v_pk_fma_f32 v[76:77], v[68:69], v[48:49], v[76:77] op_sel:[1,1,0] op_sel_hi:[0,1,1] neg_lo:[0,1,0]
  v_pk_fma_f32 v[78:79], v[70:71], v[48:49], v[78:79] op_sel:[1,1,0] op_sel_hi:[0,1,1] neg_lo:[0,1,0]
  v_cvt_pk_bf16_f32 v24, v96, v98
  v_cvt_pk_bf16_f32 v25, v100, v102
  v_cvt_pk_bf16_f32 v26, v104, v106
  v_cvt_pk_bf16_f32 v27, v108, v110
  v_cvt_pk_bf16_f32 v28, -v97, -v99
  v_cvt_pk_bf16_f32 v29, -v101, -v103
  v_cvt_pk_bf16_f32 v30, -v105, -v107
  v_cvt_pk_bf16_f32 v31, -v109, -v111
  ds_write_b128 v4, v[24:27]
  ds_write_b128 v4, v[28:31] offset:4096
  v_pk_mul_f32 v[114:115], v[98:99], v[112:113] op_sel_hi:[1,0]
  v_pk_mul_f32 v[116:117], v[100:101], v[112:113] op_sel_hi:[1,0]
  v_pk_mul_f32 v[118:119], v[102:103], v[112:113] op_sel_hi:[1,0]
  v_pk_mul_f32 v[120:121], v[104:105], v[112:113] op_sel_hi:[1,0]
  v_pk_mul_f32 v[122:123], v[106:107], v[112:113] op_sel_hi:[1,0]
  v_pk_mul_f32 v[124:125], v[108:109], v[112:113] op_sel_hi:[1,0]
  v_pk_mul_f32 v[126:127], v[110:111], v[112:113] op_sel_hi:[1,0]
  v_pk_fma_f32 v[114:115], v[98:99], v[112:113], v[114:115] op_sel:[1,1,0] op_sel_hi:[0,1,1] neg_lo:[0,1,0]
  v_pk_fma_f32 v[116:117], v[100:101], v[112:113], v[116:117] op_sel:[1,1,0] op_sel_hi:[0,1,1] neg_lo:[0,1,0]
  v_pk_fma_f32 v[118:119], v[102:103], v[112:113], v[118:119] op_sel:[1,1,0] op_sel_hi:[0,1,1] neg_lo:[0,1,0]
  v_pk_fma_f32 v[120:121], v[104:105], v[112:113], v[120:121] op_sel:[1,1,0] op_sel_hi:[0,1,1] neg_lo:[0,1,0]
  v_pk_fma_f32 v[122:123], v[106:107], v[112:113], v[122:123] op_sel:[1,1,0] op_sel_hi:[0,1,1] neg_lo:[0,1,0]
  v_pk_fma_f32 v[124:125], v[108:109], v[112:113], v[124:125] op_sel:[1,1,0] op_sel_hi:[0,1,1] neg_lo:[0,1,0]
  v_pk_fma_f32 v[126:127], v[110:111], v[112:113], v[126:127] op_sel:[1,1,0] op_sel_hi:[0,1,1] neg_lo:[0,1,0]
  v_cvt_pk_bf16_f32 v50, v64, v66
  v_cvt_pk_bf16_f32 v51, v68, v70
  v_cvt_pk_bf16_f32 v52, v72, v74
  v_cvt_pk_bf16_f32 v53, v76, v78
  v_cvt_pk_bf16_f32 v54, v65, v67
  v_cvt_pk_bf16_f32 v55, v69, v71
  v_cvt_pk_bf16_f32 v56, v73, v75
  v_cvt_pk_bf16_f32 v57, v77, v79
  ds_write_b128 v6, v[50:53]
  ds_write_b128 v6, v[54:57] offset:4096
  v_pk_mul_f32 v[80:81], v[64:65], v[44:45] op_sel_hi:[1,0]
  v_pk_mul_f32 v[82:83], v[66:67], v[44:45] op_sel_hi:[1,0]
  v_pk_mul_f32 v[84:85], v[68:69], v[44:45] op_sel_hi:[1,0]
  v_pk_mul_f32 v[86:87], v[70:71], v[44:45] op_sel_hi:[1,0]
  v_pk_mul_f32 v[88:89], v[72:73], v[44:45] op_sel_hi:[1,0]
  v_pk_mul_f32 v[90:91], v[74:75], v[44:45] op_sel_hi:[1,0]
  v_pk_mul_f32 v[92:93], v[76:77], v[44:45] op_sel_hi:[1,0]
  v_pk_mul_f32 v[94:95], v[78:79], v[44:45] op_sel_hi:[1,0]
  v_pk_fma_f32 v[80:81], v[64:65], v[44:45], v[80:81] op_sel:[1,1,0] op_sel_hi:[0,1,1] neg_lo:[0,1,0]
  v_pk_fma_f32 v[82:83], v[66:67], v[44:45], v[82:83] op_sel:[1,1,0] op_sel_hi:[0,1,1] neg_lo:[0,1,0]
  v_pk_fma_f32 v[84:85], v[68:69], v[44:45], v[84:85] op_sel:[1,1,0] op_sel_hi:[0,1,1] neg_lo:[0,1,0]
  v_pk_fma_f32 v[86:87], v[70:71], v[44:45], v[86:87] op_sel:[1,1,0] op_sel_hi:[0,1,1] neg_lo:[0,1,0]
  v_pk_fma_f32 v[88:89], v[72:73], v[44:45], v[88:89] op_sel:[1,1,0] op_sel_hi:[0,1,1] neg_lo:[0,1,0]
  v_pk_fma_f32 v[90:91], v[74:75], v[44:45], v[90:91] op_sel:[1,1,0] op_sel_hi:[0,1,1] neg_lo:[0,1,0]
  v_pk_fma_f32 v[92:93], v[76:77], v[44:45], v[92:93] op_sel:[1,1,0] op_sel_hi:[0,1,1] neg_lo:[0,1,0]
  v_pk_fma_f32 v[94:95], v[78:79], v[44:45], v[94:95] op_sel:[1,1,0] op_sel_hi:[0,1,1] neg_lo:[0,1,0]
  buffer_load_dwordx2 v[232:233], v2, s[4:7], s53 offen
  s_add_u32 s53, s53, 8192
  v_cvt_pk_bf16_f32 v24, v112, v114
  v_cvt_pk_bf16_f32 v25, v116, v118
  v_cvt_pk_bf16_f32 v26, v120, v122
  v_cvt_pk_bf16_f32 v27, v124, v126
  v_cvt_pk_bf16_f32 v28, -v113, -v115
  v_cvt_pk_bf16_f32 v29, -v117, -v119
  v_cvt_pk_bf16_f32 v30, -v121, -v123
  v_cvt_pk_bf16_f32 v31, -v125, -v127
  ds_write_b128 v5, v[24:27]
  ds_write_b128 v5, v[28:31] offset:4096
  v_pk_mul_f32 v[96:97], v[80:81], v[44:45] op_sel_hi:[1,0]
  v_pk_mul_f32 v[98:99], v[84:85], v[44:45] op_sel_hi:[1,0]
  v_pk_mul_f32 v[100:101], v[88:89], v[44:45] op_sel_hi:[1,0]
  v_pk_mul_f32 v[102:103], v[92:93], v[44:45] op_sel_hi:[1,0]
  v_pk_mul_f32 v[46:47], v[44:45], v[44:45] op_sel_hi:[1,0]
  v_pk_fma_f32 v[96:97], v[80:81], v[44:45], v[96:97] op_sel:[1,1,0] op_sel_hi:[0,1,1] neg_lo:[0,1,0]
  v_pk_fma_f32 v[98:99], v[84:85], v[44:45], v[98:99] op_sel:[1,1,0] op_sel_hi:[0,1,1] neg_lo:[0,1,0]
  v_pk_fma_f32 v[100:101], v[88:89], v[44:45], v[100:101] op_sel:[1,1,0] op_sel_hi:[0,1,1] neg_lo:[0,1,0]
  v_pk_fma_f32 v[102:103], v[92:93], v[44:45], v[102:103] op_sel:[1,1,0] op_sel_hi:[0,1,1] neg_lo:[0,1,0]
  v_pk_fma_f32 v[46:47], v[44:45], v[44:45], v[46:47] op_sel:[1,1,0] op_sel_hi:[0,1,1] neg_lo:[0,1,0]
  v_cvt_pk_bf16_f32 v50, v80, v82
  v_cvt_pk_bf16_f32 v51, v84, v86
  v_cvt_pk_bf16_f32 v52, v88, v90
  v_cvt_pk_bf16_f32 v53, v92, v94
  v_cvt_pk_bf16_f32 v54, v81, v83
  v_cvt_pk_bf16_f32 v55, v85, v87
  v_cvt_pk_bf16_f32 v56, v89, v91
  v_cvt_pk_bf16_f32 v57, v93, v95
  ds_write_b128 v7, v[50:53]
  ds_write_b128 v7, v[54:57] offset:4096
  v_pk_mul_f32 v[104:105], v[96:97], v[44:45] op_sel_hi:[1,0]
  v_pk_mul_f32 v[106:107], v[98:99], v[44:45] op_sel_hi:[1,0]
  v_pk_mul_f32 v[108:109], v[100:101], v[44:45] op_sel_hi:[1,0]
  v_pk_mul_f32 v[110:111], v[102:103], v[44:45] op_sel_hi:[1,0]
  v_pk_mul_f32 v[112:113], v[96:97], v[46:47] op_sel_hi:[1,0]
  v_pk_mul_f32 v[114:115], v[100:101], v[46:47] op_sel_hi:[1,0]
  v_pk_fma_f32 v[104:105], v[96:97], v[44:45], v[104:105] op_sel:[1,1,0] op_sel_hi:[0,1,1] neg_lo:[0,1,0]
  v_pk_fma_f32 v[106:107], v[98:99], v[44:45], v[106:107] op_sel:[1,1,0] op_sel_hi:[0,1,1] neg_lo:[0,1,0]
  v_pk_fma_f32 v[108:109], v[100:101], v[44:45], v[108:109] op_sel:[1,1,0] op_sel_hi:[0,1,1] neg_lo:[0,1,0]
  v_pk_fma_f32 v[110:111], v[102:103], v[44:45], v[110:111] op_sel:[1,1,0] op_sel_hi:[0,1,1] neg_lo:[0,1,0]
  v_pk_fma_f32 v[112:113], v[96:97], v[46:47], v[112:113] op_sel:[1,1,0] op_sel_hi:[0,1,1] neg_lo:[0,1,0]
  v_pk_fma_f32 v[114:115], v[100:101], v[46:47], v[114:115] op_sel:[1,1,0] op_sel_hi:[0,1,1] neg_lo:[0,1,0]
  ds_read_b64_tr_b16 a[0:1], v8 offset:0
  ds_read_b64_tr_b16 a[2:3], v8 offset:4096
  ds_read_b64_tr_b16 a[4:5], v8 offset:1024
  ds_read_b64_tr_b16 a[6:7], v8 offset:5120
  ds_read_b64_tr_b16 a[8:9], v8 offset:2048
  ds_read_b64_tr_b16 a[10:11], v8 offset:6144
  ds_read_b64_tr_b16 a[12:13], v8 offset:3072
  ds_read_b64_tr_b16 a[14:15], v8 offset:7168
  ds_read_b64_tr_b16 a[16:17], v9 offset:0
  ds_read_b64_tr_b16 a[18:19], v9 offset:4096
  ds_read_b64_tr_b16 a[20:21], v9 offset:1024
  ds_read_b64_tr_b16 a[22:23], v9 offset:5120
  ds_read_b64_tr_b16 a[24:25], v9 offset:2048
  ds_read_b64_tr_b16 a[26:27], v9 offset:6144
  ds_read_b64_tr_b16 a[28:29], v9 offset:3072
  ds_read_b64_tr_b16 a[30:31], v9 offset:7168
  v_pk_mul_f32 v[116:117], v[104:105], v[46:47] op_sel_hi:[1,0]
  v_pk_mul_f32 v[118:119], v[108:109], v[46:47] op_sel_hi:[1,0]
  v_pk_mul_f32 v[120:121], v[112:113], v[46:47] op_sel_hi:[1,0]
  v_pk_mul_f32 v[122:123], v[114:115], v[46:47] op_sel_hi:[1,0]
  v_pk_fma_f32 v[116:117], v[104:105], v[46:47], v[116:117] op_sel:[1,1,0] op_sel_hi:[0,1,1] neg_lo:[0,1,0]
  v_pk_fma_f32 v[118:119], v[108:109], v[46:47], v[118:119] op_sel:[1,1,0] op_sel_hi:[0,1,1] neg_lo:[0,1,0]
  v_pk_fma_f32 v[120:121], v[112:113], v[46:47], v[120:121] op_sel:[1,1,0] op_sel_hi:[0,1,1] neg_lo:[0,1,0]
  v_pk_fma_f32 v[122:123], v[114:115], v[46:47], v[122:123] op_sel:[1,1,0] op_sel_hi:[0,1,1] neg_lo:[0,1,0]
  v_cvt_pk_bf16_f32 v24, v96, v98
  v_cvt_pk_bf16_f32 v25, v100, v102
  v_cvt_pk_bf16_f32 v26, v104, v106
  v_cvt_pk_bf16_f32 v27, v108, v110
  v_cvt_pk_bf16_f32 v28, v97, v99
  v_cvt_pk_bf16_f32 v29, v101, v103
  v_cvt_pk_bf16_f32 v30, v105, v107
  v_cvt_pk_bf16_f32 v31, v109, v111
  ds_write_b128 v4, v[24:27]
  ds_write_b128 v4, v[28:31] offset:4096
  v_pk_mul_f32 v[124:125], v[116:117], v[46:47] op_sel_hi:[1,0]
  v_pk_mul_f32 v[126:127], v[118:119], v[46:47] op_sel_hi:[1,0]
  v_pk_mul_f32 v[128:129], v[120:121], v[46:47] op_sel_hi:[1,0]
  v_pk_fma_f32 v[124:125], v[116:117], v[46:47], v[124:125] op_sel:[1,1,0] op_sel_hi:[0,1,1] neg_lo:[0,1,0]
  v_pk_fma_f32 v[126:127], v[118:119], v[46:47], v[126:127] op_sel:[1,1,0] op_sel_hi:[0,1,1] neg_lo:[0,1,0]
  v_pk_fma_f32 v[128:129], v[120:121], v[46:47], v[128:129] op_sel:[1,1,0] op_sel_hi:[0,1,1] neg_lo:[0,1,0]
  v_pk_mul_f32 v[130:131], v[124:125], v[46:47] op_sel_hi:[1,0]
  v_pk_mul_f32 v[132:133], v[128:129], v[46:47] op_sel_hi:[1,0]
  v_pk_fma_f32 v[130:131], v[124:125], v[46:47], v[130:131] op_sel:[1,1,0] op_sel_hi:[0,1,1] neg_lo:[0,1,0]
  v_pk_fma_f32 v[132:133], v[128:129], v[46:47], v[132:133] op_sel:[1,1,0] op_sel_hi:[0,1,1] neg_lo:[0,1,0]
  v_cvt_pk_bf16_f32 v50, v112, v114
  v_cvt_pk_bf16_f32 v51, v116, v118
  v_cvt_pk_bf16_f32 v52, v120, v122
  v_cvt_pk_bf16_f32 v53, v124, v126
  v_cvt_pk_bf16_f32 v54, v113, v115
  v_cvt_pk_bf16_f32 v55, v117, v119
  v_cvt_pk_bf16_f32 v56, v121, v123
  v_cvt_pk_bf16_f32 v57, v125, v127
  ds_write_b128 v5, v[50:53]
  ds_write_b128 v5, v[54:57] offset:4096
  v_pk_mul_f32 v[134:135], v[130:131], v[46:47] op_sel_hi:[1,0]
  v_pk_mul_f32 v[136:137], v[132:133], v[46:47] op_sel_hi:[1,0]
  v_pk_fma_f32 v[134:135], v[130:131], v[46:47], v[134:135] op_sel:[1,1,0] op_sel_hi:[0,1,1] neg_lo:[0,1,0]
  v_pk_fma_f32 v[136:137], v[132:133], v[46:47], v[136:137] op_sel:[1,1,0] op_sel_hi:[0,1,1] neg_lo:[0,1,0]
  v_pk_mul_f32 v[138:139], v[134:135], v[46:47] op_sel_hi:[1,0]
  v_pk_mul_f32 v[140:141], v[136:137], v[46:47] op_sel_hi:[1,0]
  v_pk_fma_f32 v[138:139], v[134:135], v[46:47], v[138:139] op_sel:[1,1,0] op_sel_hi:[0,1,1] neg_lo:[0,1,0]
  v_pk_fma_f32 v[140:141], v[136:137], v[46:47], v[140:141] op_sel:[1,1,0] op_sel_hi:[0,1,1] neg_lo:[0,1,0]
  v_pk_mul_f32 v[142:143], v[138:139], v[46:47] op_sel_hi:[1,0]
  v_pk_mul_f32 v[144:145], v[140:141], v[46:47] op_sel_hi:[1,0]
  v_pk_fma_f32 v[142:143], v[138:139], v[46:47], v[142:143] op_sel:[1,1,0] op_sel_hi:[0,1,1] neg_lo:[0,1,0]
  v_pk_fma_f32 v[144:145], v[140:141], v[46:47], v[144:145] op_sel:[1,1,0] op_sel_hi:[0,1,1] neg_lo:[0,1,0]
  buffer_load_dwordx2 v[234:235], v2, s[4:7], s53 offen
  s_add_u32 s53, s53, 8192
  v_cvt_pk_bf16_f32 v24, v128, v130
  v_cvt_pk_bf16_f32 v25, v132, v134
  v_cvt_pk_bf16_f32 v26, v136, v138
  v_cvt_pk_bf16_f32 v27, v140, v142
  v_cvt_pk_bf16_f32 v28, v129, v131
  v_cvt_pk_bf16_f32 v29, v133, v135
  v_cvt_pk_bf16_f32 v30, v137, v139
  v_cvt_pk_bf16_f32 v31, v141, v143
  ds_write_b128 v6, v[24:27]
  ds_write_b128 v6, v[28:31] offset:4096
  v_cvt_pk_bf16_f32 v50, v144, v144
  v_cvt_pk_bf16_f32 v51, v145, v145
  ds_write_b32 v7, v50
  ds_write_b32 v7, v51 offset:4096
  ds_read_b64_tr_b16 a[32:33], v8 offset:0
  ds_read_b64_tr_b16 a[34:35], v8 offset:4096
  ds_read_b64_tr_b16 a[36:37], v8 offset:1024
  ds_read_b64_tr_b16 a[38:39], v8 offset:5120
  ds_read_b64_tr_b16 a[40:41], v8 offset:2048
  ds_read_b64_tr_b16 a[42:43], v8 offset:6144
  ds_read_b64_tr_b16 a[44:45], v8 offset:3072
  ds_read_b64_tr_b16 a[46:47], v8 offset:7168
  ds_read_b64_tr_b16 a[48:49], v9 offset:0
  ds_read_b64_tr_b16 a[50:51], v9 offset:4096
  ds_read_b64_tr_b16 a[52:53], v9 offset:1024
  ds_read_b64_tr_b16 a[54:55], v9 offset:5120
  ds_read_b64_tr_b16 a[56:57], v9 offset:2048
  ds_read_b64_tr_b16 a[58:59], v9 offset:6144
  ds_read_b64_tr_b16 a[60:61], v9 offset:3072
  ds_read_b64_tr_b16 a[62:63], v9 offset:7168
  s_waitcnt lgkmcnt(0)
  v_mfma_f32_16x16x32_bf16 v[160:163], a[16:19], a[0:3], v[160:163]
  v_mfma_f32_16x16x32_bf16 v[164:167], a[32:35], a[0:3], v[164:167]
  v_mfma_f32_16x16x32_bf16 v[168:171], a[48:51], a[0:3], v[168:171]
  v_mfma_f32_16x16x32_bf16 v[160:163], a[20:23], a[4:7], v[160:163]
  v_mfma_f32_16x16x32_bf16 v[164:167], a[36:39], a[4:7], v[164:167]
  v_mfma_f32_16x16x32_bf16 v[168:171], a[52:55], a[4:7], v[168:171]
  v_mfma_f32_16x16x32_bf16 v[160:163], a[24:27], a[8:11], v[160:163]
  v_mfma_f32_16x16x32_bf16 v[164:167], a[40:43], a[8:11], v[164:167]
  v_mfma_f32_16x16x32_bf16 v[168:171], a[56:59], a[8:11], v[168:171]
  v_mfma_f32_16x16x32_bf16 v[160:163], a[28:31], a[12:15], v[160:163]
  v_mfma_f32_16x16x32_bf16 v[164:167], a[44:47], a[12:15], v[164:167]
  v_mfma_f32_16x16x32_bf16 v[168:171], a[60:63], a[12:15], v[168:171]
  buffer_load_dwordx2 v[236:237], v2, s[4:7], s53 offen
  s_add_u32 s53, s53, 8192
  v_mov_b32 v60, 100160
  s_nop 6
  v_cvt_pk_bf16_f32 v32, v168, v169
  v_cvt_pk_bf16_f32 v33, v170, v171
  v_cvt_pk_bf16_f32 v51, v164, v165
  v_cvt_pk_bf16_f32 v55, v166, v167
  v_cvt_pk_bf16_f32 v44, v160, v161
  v_cvt_pk_bf16_f32 v45, v162, v163
  v_perm_b32 v40, v32, v32, s54
  v_perm_b32 v41, v32, v32, s55
  v_perm_b32 v42, v33, v33, s54
  v_perm_b32 v43, v33, v33, s55
  v_perm_b32 v50, v51, v51, s54
  v_perm_b32 v54, v55, v55, s54
  v_perm_b32 v52, v51, v51, s55
  v_perm_b32 v56, v55, v55, s55
  v_mov_b32 v58, v50
  v_alignbit_b32 v59, v55, v51, 16
  s_mov_b32 exec_hi, 1
  ds_write_b32 v151, v40 offset:4
  ds_write2_b32 v151, v40, v40 offset0:2 offset1:3
  s_mov_b32 exec_lo, -2
  ds_write_b32 v151, v40
  s_mov_b32 exec_lo, -1
  s_mov_b32 exec_hi, 0
  ds_write2_b32 v151, v41, v41 offset0:64 offset1:65
  ds_write2_b32 v151, v41, v41 offset0:66 offset1:67
  ds_write2_b32 v151, v42, v42 offset0:128 offset1:129
  ds_write2_b32 v151, v42, v42 offset0:130 offset1:131
  ds_write2_b32 v151, v43, v43 offset0:192 offset1:193
  ds_write2_b32 v151, v43, v43 offset0:194 offset1:195
  s_mov_b32 exec_lo, 0x55555555
  ds_write_b16 v151, v40 offset:16
  ds_write_b16 v151, v41 offset:272
  ds_write_b16 v151, v42 offset:528
  ds_write_b16 v151, v43 offset:784
  s_mov_b32 exec_lo, 0
  s_mov_b32 exec_hi, -1
  ds_write_b32 v149, v50
  ds_write_b64 v149, v[50:51] offset:4
  ds_write_b32 v149, v52 offset:12
  ds_write_b32 v149, v54 offset:256
  ds_write_b64 v149, v[54:55] offset:260
  ds_write_b32 v149, v56 offset:268
  s_mov_b32 exec_lo, -1
  s_mov_b32 exec_hi, 0
  ds_write_b16 v148, v50 offset:510
  ds_write_b64 v148, v[58:59] offset:512
  ds_write_b32 v148, v54 offset:520
  ds_write_b16 v148, v56 offset:524
  s_mov_b64 exec, -1
  ds_write_b64 v150, v[44:45]
  buffer_load_dwordx2 v[238:239], v2, s[4:7], s53 offen
  buffer_load_dwordx4 v[192:195], v3, s[8:11], 0 offen offset:0 sc0 sc1
  buffer_load_dwordx4 v[196:199], v3, s[8:11], 0 offen offset:1024 sc0 sc1
  buffer_load_dwordx4 v[200:203], v3, s[8:11], 0 offen offset:2048 sc0 sc1
  buffer_load_dwordx4 v[204:207], v3, s[8:11], 0 offen offset:3072 sc0 sc1
  buffer_load_dwordx4 v[208:211], v3, s[8:11], s31 offen offset:0 sc0 sc1
  buffer_load_dwordx4 v[212:215], v3, s[8:11], s31 offen offset:1024 sc0 sc1
  buffer_load_dwordx4 v[216:219], v3, s[8:11], s31 offen offset:2048 sc0 sc1
  buffer_load_dwordx4 v[220:223], v3, s[8:11], s31 offen offset:3072 sc0 sc1
  s_waitcnt lgkmcnt(0)
  s_barrier
  ds_read_b32 v60, v60
  ds_read_b64_tr_b16 a[128:129], v12 offset:32
  ds_read_b64_tr_b16 a[130:131], v12 offset:0
  ds_read_b64_tr_b16 a[132:133], v12 offset:288
  ds_read_b64_tr_b16 a[134:135], v12 offset:256
  ds_read_b64_tr_b16 a[136:137], v12 offset:544
  ds_read_b64_tr_b16 a[138:139], v12 offset:512
  ds_read_b64_tr_b16 a[140:141], v12 offset:800
  ds_read_b64_tr_b16 a[142:143], v12 offset:768
  ds_read_b64_tr_b16 a[144:145], v12 offset:1056
  ds_read_b64_tr_b16 a[146:147], v12 offset:1024
  ds_read_b64_tr_b16 a[148:149], v12 offset:1312
  ds_read_b64_tr_b16 a[150:151], v12 offset:1280
  ds_read_b64_tr_b16 a[152:153], v12 offset:1568
  ds_read_b64_tr_b16 a[154:155], v12 offset:1536
  ds_read_b64_tr_b16 a[156:157], v12 offset:1824
  ds_read_b64_tr_b16 a[158:159], v12 offset:1792
  ds_read_b64_tr_b16 a[160:161], v12 offset:2080
  ds_read_b64_tr_b16 a[162:163], v12 offset:2048
  ds_read_b64_tr_b16 a[164:165], v12 offset:2336
  ds_read_b64_tr_b16 a[166:167], v12 offset:2304
  ds_read_b64_tr_b16 a[168:169], v12 offset:2592
  ds_read_b64_tr_b16 a[170:171], v12 offset:2560
  ds_read_b64_tr_b16 a[172:173], v12 offset:2848
  ds_read_b64_tr_b16 a[174:175], v12 offset:2816
  ds_read_b64_tr_b16 a[176:177], v12 offset:3104
  ds_read_b64_tr_b16 a[178:179], v12 offset:3072
  ds_read_b64_tr_b16 a[180:181], v12 offset:3360
  ds_read_b64_tr_b16 a[182:183], v12 offset:3328
  ds_read_b64_tr_b16 a[184:185], v12 offset:3616
  ds_read_b64_tr_b16 a[186:187], v12 offset:3584
  ds_read_b64_tr_b16 a[188:189], v12 offset:3872
  ds_read_b64_tr_b16 a[190:191], v12 offset:3840
  v_mov_b32 v49, 0
  v_mov_b32 v50, 0
  v_mov_b32 v51, 0
  v_mov_b32 v53, 0
  v_mov_b32 v54, 0
  v_mov_b32 v55, 0
  v_mov_b32 v57, 0
  v_mov_b32 v58, 0
  v_mov_b32 v59, 0
  v_mov_b32 v61, 0
  v_mov_b32 v62, 0
  v_mov_b32 v63, 0
  s_mov_b32 s46, 0
  s_waitcnt vmcnt(0) lgkmcnt(0)
cv_poll:
  v_xor_b32 v64, v193, v60
  v_xor_b32 v65, v195, v60
  v_xor_b32 v66, v197, v60
  v_xor_b32 v67, v199, v60
  v_xor_b32 v68, v201, v60
  v_xor_b32 v69, v203, v60
  v_xor_b32 v70, v205, v60
  v_xor_b32 v71, v207, v60
  v_xor_b32 v72, v209, v60
  v_xor_b32 v73, v211, v60
  v_xor_b32 v74, v213, v60
  v_xor_b32 v75, v215, v60
  v_xor_b32 v76, v217, v60
  v_xor_b32 v77, v219, v60
  v_xor_b32 v78, v221, v60
  v_xor_b32 v79, v223, v60
  v_or3_b32 v64, v64, v65, v66
  v_or3_b32 v67, v67, v68, v69
  v_or3_b32 v70, v70, v71, v72
  v_or3_b32 v73, v73, v74, v75
  v_or3_b32 v76, v76, v77, v78
  v_or3_b32 v64, v64, v67, v70
  v_or3_b32 v73, v73, v76, v79
  v_or_b32 v64, v64, v73
  v_cmp_ne_u32 vcc, 0, v64
  s_cbranch_vccz cv_polled
  buffer_load_dwordx4 v[192:195], v3, s[8:11], 0 offen offset:0 sc0 sc1
  buffer_load_dwordx4 v[196:199], v3, s[8:11], 0 offen offset:1024 sc0 sc1
  buffer_load_dwordx4 v[200:203], v3, s[8:11], 0 offen offset:2048 sc0 sc1
  buffer_load_dwordx4 v[204:207], v3, s[8:11], 0 offen offset:3072 sc0 sc1
  buffer_load_dwordx4 v[208:211], v3, s[8:11], s31 offen offset:0 sc0 sc1
  buffer_load_dwordx4 v[212:215], v3, s[8:11], s31 offen offset:1024 sc0 sc1
  buffer_load_dwordx4 v[216:219], v3, s[8:11], s31 offen offset:2048 sc0 sc1
  buffer_load_dwordx4 v[220:223], v3, s[8:11], s31 offen offset:3072 sc0 sc1
  s_add_u32 s46, s46, 1
  s_cmp_lt_u32 s46, 0x20000
  s_waitcnt vmcnt(0)
  s_cbranch_scc1 cv_poll
cv_polled:
  s_mov_b32 s22, 0x700000
  s_mov_b64 s[20:21], s[32:33]
  buffer_load_dword a192, v14, s[20:23], s30 offen
  v_lshlrev_b32 v64, 16, v224
  v_lshlrev_b32 v65, 16, v226
  v_lshlrev_b32 v66, 16, v228
  v_lshlrev_b32 v67, 16, v230
  v_fma_f32 v68, v64, v192, v194
  v_fma_f32 v69, v65, v196, v198
  v_fma_f32 v70, v66, v200, v202
  v_fma_f32 v71, v67, v204, v206
  v_fma_f32 v72, v68, s48, v64
  v_fma_f32 v73, v69, s48, v65
  v_fma_f32 v74, v70, s48, v66
  v_fma_f32 v75, v71, s48, v67
  v_cvt_pk_bf16_f32 v76, v68, v69
  v_cvt_pk_bf16_f32 v77, v70, v71
  ds_write_b128 v153, v[72:75] offset:0
  ds_write_b64 v152, v[76:77] offset:0
  v_and_b32 v80, 0xffff0000, v224
  v_and_b32 v81, 0xffff0000, v226
  v_and_b32 v82, 0xffff0000, v228
  v_and_b32 v83, 0xffff0000, v230
  v_fma_f32 v84, v80, v192, v194
  v_fma_f32 v85, v81, v196, v198
  v_fma_f32 v86, v82, v200, v202
  v_fma_f32 v87, v83, v204, v206
  v_fma_f32 v88, v84, s49, v80
  v_fma_f32 v89, v85, s49, v81
  v_fma_f32 v90, v86, s49, v82
  v_fma_f32 v91, v87, s49, v83
  v_cvt_pk_bf16_f32 v92, v84, v85
  v_cvt_pk_bf16_f32 v93, v86, v87
  ds_write_b128 v153, v[88:91] offset:8320
  ds_write_b64 v152, v[92:93] offset:4352
  v_lshlrev_b32 v96, 16, v225
  v_lshlrev_b32 v97, 16, v227
  v_lshlrev_b32 v98, 16, v229
  v_lshlrev_b32 v99, 16, v231
  v_fma_f32 v100, v96, v192, v194
  v_fma_f32 v101, v97, v196, v198
  v_fma_f32 v102, v98, v200, v202
  v_fma_f32 v103, v99, v204, v206
  v_fma_f32 v104, v100, s50, v96
  v_fma_f32 v105, v101, s50, v97
  v_fma_f32 v106, v102, s50, v98
  v_fma_f32 v107, v103, s50, v99
  v_cvt_pk_bf16_f32 v108, v100, v101
  v_cvt_pk_bf16_f32 v109, v102, v103
  ds_write_b128 v153, v[104:107] offset:16640
  ds_write_b64 v152, v[108:109] offset:8704
  v_and_b32 v112, 0xffff0000, v225
  v_and_b32 v113, 0xffff0000, v227
  v_and_b32 v114, 0xffff0000, v229
  v_and_b32 v115, 0xffff0000, v231
  v_fma_f32 v116, v112, v192, v194
  v_fma_f32 v117, v113, v196, v198
  v_fma_f32 v118, v114, v200, v202
  v_fma_f32 v119, v115, v204, v206
  v_fma_f32 v120, v116, s51, v112
  v_fma_f32 v121, v117, s51, v113
  v_fma_f32 v122, v118, s51, v114
  v_fma_f32 v123, v119, s51, v115
  v_cvt_pk_bf16_f32 v124, v116, v117
  v_cvt_pk_bf16_f32 v125, v118, v119
  ds_write_b128 v153, v[120:123] offset:24960
  ds_write_b64 v152, v[124:125] offset:13056
  v_lshlrev_b32 v64, 16, v232
  v_lshlrev_b32 v65, 16, v234
  v_lshlrev_b32 v66, 16, v236
  v_lshlrev_b32 v67, 16, v238
  v_fma_f32 v68, v64, v208, v210
  v_fma_f32 v69, v65, v212, v214
  v_fma_f32 v70, v66, v216, v218
  v_fma_f32 v71, v67, v220, v222
  v_fma_f32 v72, v68, s48, v64
  v_fma_f32 v73, v69, s48, v65
  v_fma_f32 v74, v70, s48, v66
  v_fma_f32 v75, v71, s48, v67
  v_cvt_pk_bf16_f32 v76, v68, v69
  v_cvt_pk_bf16_f32 v77, v70, v71
  ds_write_b128 v153, v[72:75] offset:256
  ds_write_b64 v152, v[76:77] offset:128
  v_and_b32 v80, 0xffff0000, v232
  v_and_b32 v81, 0xffff0000, v234
  v_and_b32 v82, 0xffff0000, v236
  v_and_b32 v83, 0xffff0000, v238
  v_fma_f32 v84, v80, v208, v210
  v_fma_f32 v85, v81, v212, v214
  v_fma_f32 v86, v82, v216, v218
  v_fma_f32 v87, v83, v220, v222
  v_fma_f32 v88, v84, s49, v80
  v_fma_f32 v89, v85, s49, v81
  v_fma_f32 v90, v86, s49, v82
  v_fma_f32 v91, v87, s49, v83
  v_cvt_pk_bf16_f32 v92, v84, v85
  v_cvt_pk_bf16_f32 v93, v86, v87
  ds_write_b128 v153, v[88:91] offset:8576
  ds_write_b64 v152, v[92:93] offset:4480
  v_lshlrev_b32 v96, 16, v233
  v_lshlrev_b32 v97, 16, v235
  v_lshlrev_b32 v98, 16, v237
  v_lshlrev_b32 v99, 16, v239
  v_fma_f32 v100, v96, v208, v210
  v_fma_f32 v101, v97, v212, v214
  v_fma_f32 v102, v98, v216, v218
  v_fma_f32 v103, v99, v220, v222
  v_fma_f32 v104, v100, s50, v96
  v_fma_f32 v105, v101, s50, v97
  v_fma_f32 v106, v102, s50, v98
  v_fma_f32 v107, v103, s50, v99
  v_cvt_pk_bf16_f32 v108, v100, v101
  v_cvt_pk_bf16_f32 v109, v102, v103
  ds_write_b128 v153, v[104:107] offset:16896
  ds_write_b64 v152, v[108:109] offset:8832
  v_and_b32 v112, 0xffff0000, v233
  v_and_b32 v113, 0xffff0000, v235
  v_and_b32 v114, 0xffff0000, v237
  v_and_b32 v115, 0xffff0000, v239
  v_fma_f32 v116, v112, v208, v210
  v_fma_f32 v117, v113, v212, v214
  v_fma_f32 v118, v114, v216, v218
  v_fma_f32 v119, v115, v220, v222
  v_fma_f32 v120, v116, s51, v112
  v_fma_f32 v121, v117, s51, v113
  v_fma_f32 v122, v118, s51, v114
  v_fma_f32 v123, v119, s51, v115
  v_cvt_pk_bf16_f32 v124, v116, v117
  v_cvt_pk_bf16_f32 v125, v118, v119
  ds_write_b128 v153, v[120:123] offset:25216
  ds_write_b64 v152, v[124:125] offset:13184
  s_waitcnt lgkmcnt(0)
  s_barrier
  v_lshlrev_b32 v24, 3, v0
  v_lshlrev_b32 v25, 4, v0
  s_lshr_b32 s46, s27, 1
  s_lshl_b32 s46, s46, 15
  s_and_b32 s47, s27, 1
  s_lshl_b32 s47, s47, 3
  s_add_u32 s46, s46, s47
  ds_read_b32 v48, v10 offset:0
  ds_read_b64 a[0:1], v13 offset:0
  ds_read_b64 a[2:3], v13 offset:8
  ds_read_b32 v52, v10 offset:64
  ds_read_b64 a[4:5], v13 offset:32
  ds_read_b64 a[6:7], v13 offset:40
  ds_read_b32 v56, v10 offset:128
  ds_read_b64 a[8:9], v13 offset:64
  ds_read_b64 a[10:11], v13 offset:72
  ds_read_b64 a[12:13], v13 offset:96
  ds_read_b64 a[14:15], v13 offset:104
  ds_read_b64 a[16:17], v13 offset:128
  s_waitcnt lgkmcnt(9)
  v_mfma_f32_16x16x32_bf16 v[128:131], a[0:3], a[128:131], v[48:51]
  s_mov_b64 s[20:21], s[34:35]
  buffer_load_dword a192, v14, s[20:23], s30 offen
  ds_read_b32 v60, v10 offset:192
  ds_read_b64 a[18:19], v13 offset:136
  s_waitcnt lgkmcnt(8)
  v_mfma_f32_16x16x32_bf16 v[132:135], a[4:7], a[128:131], v[52:55]
  ds_read_b32 v48, v10 offset:256
  ds_read_b64 a[20:21], v13 offset:160
  s_waitcnt lgkmcnt(9)
  v_mfma_f32_16x16x32_bf16 v[136:139], a[0:3], a[132:135], v[56:59]
  ds_read_b32 v52, v10 offset:320
  ds_read_b64 a[22:23], v13 offset:168
  s_waitcnt lgkmcnt(9)
  v_mfma_f32_16x16x32_bf16 v[136:139], a[8:11], a[128:131], v[136:139]
  ds_read_b64 a[24:25], v13 offset:192
  ds_read_b64 a[26:27], v13 offset:200
  s_waitcnt lgkmcnt(7)
  v_mfma_f32_16x16x32_bf16 v[140:143], a[4:7], a[132:135], v[60:63]
  ds_read_b32 v56, v10 offset:384
  ds_read_b64 a[28:29], v13 offset:224
  v_mfma_f32_16x16x32_bf16 v[140:143], a[12:15], a[128:131], v[140:143]
  ds_read_b64 a[30:31], v13 offset:232
  ds_read_b64 a[32:33], v13 offset:256
  s_waitcnt lgkmcnt(9)
  v_mfma_f32_16x16x32_bf16 v[144:147], a[0:3], a[136:139], v[48:51]
  ds_read_b32 v60, v10 offset:448
  ds_read_b64 a[34:35], v13 offset:264
  v_mfma_f32_16x16x32_bf16 v[144:147], a[8:11], a[132:135], v[144:147]
  ds_read_b64 a[36:37], v13 offset:288
  ds_read_b64 a[38:39], v13 offset:296
  v_mfma_f32_16x16x32_bf16 v[144:147], a[16:19], a[128:131], v[144:147]
  ds_read_b64 a[40:41], v13 offset:320
  ds_read_b64 a[42:43], v13 offset:328
  s_waitcnt lgkmcnt(13)
  v_mfma_f32_16x16x32_bf16 v[148:151], a[4:7], a[136:139], v[52:55]
  ds_read_b32 v48, v10 offset:512
  ds_read_b64 a[44:45], v13 offset:352
  v_mfma_f32_16x16x32_bf16 v[148:151], a[12:15], a[132:135], v[148:151]
  ds_read_b64 a[46:47], v13 offset:360
  ds_read_b64 a[48:49], v13 offset:384
  s_waitcnt lgkmcnt(15)
  v_mfma_f32_16x16x32_bf16 v[148:151], a[20:23], a[128:131], v[148:151]
  ds_read_b64 a[50:51], v13 offset:392
  ds_read_b64 a[52:53], v13 offset:416
  s_waitcnt lgkmcnt(15)
  v_mfma_f32_16x16x32_bf16 v[152:155], a[0:3], a[140:143], v[56:59]
  ds_read_b32 v52, v10 offset:576
  ds_read_b64 a[54:55], v13 offset:424
  v_mfma_f32_16x16x32_bf16 v[152:155], a[8:11], a[136:139], v[152:155]
  ds_read_b64 a[56:57], v13 offset:448
  ds_read_b64 a[58:59], v13 offset:456
  v_mfma_f32_16x16x32_bf16 v[152:155], a[16:19], a[132:135], v[152:155]
  ds_read_b64 a[60:61], v13 offset:480
  ds_read_b64 a[62:63], v13 offset:488
  v_mfma_f32_16x16x32_bf16 v[152:155], a[24:27], a[128:131], v[152:155]
  ds_read_b64 a[64:65], v13 offset:512
  ds_read_b64 a[66:67], v13 offset:520
  s_waitcnt lgkmcnt(15)
  v_mfma_f32_16x16x32_bf16 v[156:159], a[4:7], a[140:143], v[60:63]
  ds_read_b32 v56, v10 offset:640
  ds_read_b64 a[68:69], v13 offset:544
  v_mfma_f32_16x16x32_bf16 v[156:159], a[12:15], a[136:139], v[156:159]
  ds_read_b64 a[70:71], v13 offset:552
  ds_read_b64 a[72:73], v13 offset:576
  v_mfma_f32_16x16x32_bf16 v[156:159], a[20:23], a[132:135], v[156:159]
  ds_read_b64 a[74:75], v13 offset:584
  ds_read_b64 a[76:77], v13 offset:608
  v_mfma_f32_16x16x32_bf16 v[156:159], a[28:31], a[128:131], v[156:159]
  ds_read_b64 a[78:79], v13 offset:616
  ds_read_b64 a[80:81], v13 offset:640
  s_waitcnt lgkmcnt(15)
  v_mfma_f32_16x16x32_bf16 v[160:163], a[0:3], a[144:147], v[48:51]
  ds_read_b32 v60, v10 offset:704
  ds_read_b64 a[82:83], v13 offset:648
  v_mfma_f32_16x16x32_bf16 v[160:163], a[8:11], a[140:143], v[160:163]
  ds_read_b64 a[84:85], v13 offset:672
  ds_read_b64 a[86:87], v13 offset:680
  v_mfma_f32_16x16x32_bf16 v[160:163], a[16:19], a[136:139], v[160:163]
  ds_read_b64 a[88:89], v13 offset:704
  ds_read_b64 a[90:91], v13 offset:712
  v_mfma_f32_16x16x32_bf16 v[160:163], a[24:27], a[132:135], v[160:163]
  v_add_f32_dpp v16, v131, v130 wave_shr:1 row_mask:0xf bank_mask:0xf bound_ctrl:1
  v_mfma_f32_16x16x32_bf16 v[160:163], a[32:35], a[128:131], v[160:163]
  v_mfma_f32_16x16x32_bf16 v[164:167], a[4:7], a[144:147], v[52:55]
  ds_read_b32 v48, v10 offset:768
  ds_read_b64 a[92:93], v13 offset:736
  v_mfma_f32_16x16x32_bf16 v[164:167], a[12:15], a[140:143], v[164:167]
  ds_read_b64 a[94:95], v13 offset:744
  v_add_f32_dpp v17, v16, v129 wave_shr:1 row_mask:0xf bank_mask:0xf bound_ctrl:1
  v_mfma_f32_16x16x32_bf16 v[164:167], a[20:23], a[136:139], v[164:167]
  v_mfma_f32_16x16x32_bf16 v[164:167], a[28:31], a[132:135], v[164:167]
  v_add_f32_dpp v18, v17, v128 wave_shr:1 row_mask:0xf bank_mask:0xf bound_ctrl:1
  v_add_f32_dpp v20, v131, v134 wave_ror:1 row_mask:0x1 bank_mask:0x1
  v_mfma_f32_16x16x32_bf16 v[164:167], a[36:39], a[128:131], v[164:167]
  v_add_f32_dpp v20, v135, v134 wave_shr:1 row_mask:0xf bank_mask:0xf
  v_add_f32_dpp v21, v16, v133 wave_ror:1 row_mask:0x1 bank_mask:0x1
  s_waitcnt lgkmcnt(15)
  v_mfma_f32_16x16x32_bf16 v[168:171], a[0:3], a[148:151], v[56:59]
  ds_read_b32 v52, v10 offset:832
  ds_read_b64 a[96:97], v13 offset:768
  v_mfma_f32_16x16x32_bf16 v[168:171], a[8:11], a[144:147], v[168:171]
  ds_read_b64 a[98:99], v13 offset:776
  v_add_f32_dpp v21, v20, v133 wave_shr:1 row_mask:0xf bank_mask:0xf
  v_mfma_f32_16x16x32_bf16 v[168:171], a[16:19], a[140:143], v[168:171]
  v_add_f32_dpp v22, v17, v132 wave_ror:1 row_mask:0x1 bank_mask:0x1
  v_mfma_f32_16x16x32_bf16 v[168:171], a[24:27], a[136:139], v[168:171]
  v_add_f32_dpp v22, v21, v132 wave_shr:1 row_mask:0xf bank_mask:0xf
  v_cvt_pk_bf16_f32 v23, v22, v18
  v_mfma_f32_16x16x32_bf16 v[168:171], a[32:35], a[132:135], v[168:171]
  ds_write_b16 v11, v23 offset:512
  ds_write_b16_d16_hi v11, v23 offset:0
  v_mfma_f32_16x16x32_bf16 v[168:171], a[40:43], a[128:131], v[168:171]
  v_add_f32_dpp v16, v135, v138 wave_ror:1 row_mask:0x1 bank_mask:0x1
  v_add_f32_dpp v16, v139, v138 wave_shr:1 row_mask:0xf bank_mask:0xf
  s_waitcnt lgkmcnt(13)
  v_mfma_f32_16x16x32_bf16 v[172:175], a[4:7], a[148:151], v[60:63]
  ds_read_b32 v56, v10 offset:896
  ds_read_b64 a[100:101], v13 offset:800
  v_mfma_f32_16x16x32_bf16 v[172:175], a[12:15], a[144:147], v[172:175]
  ds_read_b64 a[102:103], v13 offset:808
  v_add_f32_dpp v17, v20, v137 wave_ror:1 row_mask:0x1 bank_mask:0x1
  v_mfma_f32_16x16x32_bf16 v[172:175], a[20:23], a[140:143], v[172:175]
  v_add_f32_dpp v17, v16, v137 wave_shr:1 row_mask:0xf bank_mask:0xf
  v_add_f32_dpp v18, v21, v136 wave_ror:1 row_mask:0x1 bank_mask:0x1
  v_mfma_f32_16x16x32_bf16 v[172:175], a[28:31], a[136:139], v[172:175]
  v_add_f32_dpp v18, v17, v136 wave_shr:1 row_mask:0xf bank_mask:0xf
  v_add_f32_dpp v20, v139, v142 wave_ror:1 row_mask:0x1 bank_mask:0x1
  v_mfma_f32_16x16x32_bf16 v[172:175], a[36:39], a[132:135], v[172:175]
  v_add_f32_dpp v20, v143, v142 wave_shr:1 row_mask:0xf bank_mask:0xf
  v_add_f32_dpp v21, v16, v141 wave_ror:1 row_mask:0x1 bank_mask:0x1
  v_mfma_f32_16x16x32_bf16 v[172:175], a[44:47], a[128:131], v[172:175]
  v_add_f32_dpp v21, v20, v141 wave_shr:1 row_mask:0xf bank_mask:0xf
  v_add_f32_dpp v22, v17, v140 wave_ror:1 row_mask:0x1 bank_mask:0x1
  s_waitcnt lgkmcnt(10)
  v_mfma_f32_16x16x32_bf16 v[176:179], a[0:3], a[152:155], v[48:51]
  ds_read_b32 v60, v10 offset:960
  ds_read_b64 a[104:105], v13 offset:832
  v_mfma_f32_16x16x32_bf16 v[176:179], a[8:11], a[148:151], v[176:179]
  ds_read_b64 a[106:107], v13 offset:840
  v_add_f32_dpp v22, v21, v140 wave_shr:1 row_mask:0xf bank_mask:0xf
  v_mfma_f32_16x16x32_bf16 v[176:179], a[16:19], a[144:147], v[176:179]
  v_cvt_pk_bf16_f32 v23, v22, v18
  ds_write_b16 v11, v23 offset:1536
  v_mfma_f32_16x16x32_bf16 v[176:179], a[24:27], a[140:143], v[176:179]
  ds_write_b16_d16_hi v11, v23 offset:1024
  v_add_f32_dpp v16, v143, v146 wave_ror:1 row_mask:0x1 bank_mask:0x1
  v_mfma_f32_16x16x32_bf16 v[176:179], a[32:35], a[136:139], v[176:179]
  v_add_f32_dpp v16, v147, v146 wave_shr:1 row_mask:0xf bank_mask:0xf
  v_add_f32_dpp v17, v20, v145 wave_ror:1 row_mask:0x1 bank_mask:0x1
  v_mfma_f32_16x16x32_bf16 v[176:179], a[40:43], a[132:135], v[176:179]
  v_add_f32_dpp v17, v16, v145 wave_shr:1 row_mask:0xf bank_mask:0xf
  v_add_f32_dpp v18, v21, v144 wave_ror:1 row_mask:0x1 bank_mask:0x1
  v_mfma_f32_16x16x32_bf16 v[176:179], a[48:51], a[128:131], v[176:179]
  v_add_f32_dpp v18, v17, v144 wave_shr:1 row_mask:0xf bank_mask:0xf
  v_add_f32_dpp v20, v147, v150 wave_ror:1 row_mask:0x1 bank_mask:0x1
  s_waitcnt lgkmcnt(12)
  v_mfma_f32_16x16x32_bf16 v[180:183], a[4:7], a[152:155], v[52:55]
  ds_read_b32 v48, v10 offset:1024
  ds_read_b64 a[108:109], v13 offset:864
  v_mfma_f32_16x16x32_bf16 v[180:183], a[12:15], a[148:151], v[180:183]
  ds_read_b64 a[110:111], v13 offset:872
  v_add_f32_dpp v20, v151, v150 wave_shr:1 row_mask:0xf bank_mask:0xf
  v_mfma_f32_16x16x32_bf16 v[180:183], a[20:23], a[144:147], v[180:183]
  v_add_f32_dpp v21, v16, v149 wave_ror:1 row_mask:0x1 bank_mask:0x1
  v_mfma_f32_16x16x32_bf16 v[180:183], a[28:31], a[140:143], v[180:183]
  v_add_f32_dpp v21, v20, v149 wave_shr:1 row_mask:0xf bank_mask:0xf
  v_add_f32_dpp v22, v17, v148 wave_ror:1 row_mask:0x1 bank_mask:0x1
  v_mfma_f32_16x16x32_bf16 v[180:183], a[36:39], a[136:139], v[180:183]
  v_add_f32_dpp v22, v21, v148 wave_shr:1 row_mask:0xf bank_mask:0xf
  v_cvt_pk_bf16_f32 v23, v22, v18
  v_mfma_f32_16x16x32_bf16 v[180:183], a[44:47], a[132:135], v[180:183]
  ds_write_b16 v11, v23 offset:2560
  ds_write_b16_d16_hi v11, v23 offset:2048
  v_mfma_f32_16x16x32_bf16 v[180:183], a[52:55], a[128:131], v[180:183]
  v_add_f32_dpp v16, v151, v154 wave_ror:1 row_mask:0x1 bank_mask:0x1
  v_add_f32_dpp v16, v155, v154 wave_shr:1 row_mask:0xf bank_mask:0xf
  s_waitcnt lgkmcnt(12)
  v_mfma_f32_16x16x32_bf16 v[184:187], a[0:3], a[156:159], v[56:59]
  ds_read_b32 v52, v10 offset:1088
  ds_read_b64 a[112:113], v13 offset:896
  v_mfma_f32_16x16x32_bf16 v[184:187], a[8:11], a[152:155], v[184:187]
  ds_read_b64 a[114:115], v13 offset:904
  v_add_f32_dpp v17, v20, v153 wave_ror:1 row_mask:0x1 bank_mask:0x1
  v_mfma_f32_16x16x32_bf16 v[184:187], a[16:19], a[148:151], v[184:187]
  v_add_f32_dpp v17, v16, v153 wave_shr:1 row_mask:0xf bank_mask:0xf
  v_add_f32_dpp v18, v21, v152 wave_ror:1 row_mask:0x1 bank_mask:0x1
  v_mfma_f32_16x16x32_bf16 v[184:187], a[24:27], a[144:147], v[184:187]
  v_add_f32_dpp v18, v17, v152 wave_shr:1 row_mask:0xf bank_mask:0xf
  v_add_f32_dpp v20, v155, v158 wave_ror:1 row_mask:0x1 bank_mask:0x1
  v_mfma_f32_16x16x32_bf16 v[184:187], a[32:35], a[140:143], v[184:187]
  v_add_f32_dpp v20, v159, v158 wave_shr:1 row_mask:0xf bank_mask:0xf
  v_add_f32_dpp v21, v16, v157 wave_ror:1 row_mask:0x1 bank_mask:0x1
  v_mfma_f32_16x16x32_bf16 v[184:187], a[40:43], a[136:139], v[184:187]
  v_add_f32_dpp v21, v20, v157 wave_shr:1 row_mask:0xf bank_mask:0xf
  v_add_f32_dpp v22, v17, v156 wave_ror:1 row_mask:0x1 bank_mask:0x1
  v_mfma_f32_16x16x32_bf16 v[184:187], a[48:51], a[132:135], v[184:187]
  v_add_f32_dpp v22, v21, v156 wave_shr:1 row_mask:0xf bank_mask:0xf
  v_cvt_pk_bf16_f32 v23, v22, v18
  v_mfma_f32_16x16x32_bf16 v[184:187], a[56:59], a[128:131], v[184:187]
  ds_write_b16 v11, v23 offset:3584
  ds_write_b16_d16_hi v11, v23 offset:3072
  s_waitcnt lgkmcnt(14)
  v_mfma_f32_16x16x32_bf16 v[188:191], a[4:7], a[156:159], v[60:63]
  ds_read_b32 v56, v10 offset:1152
  ds_read_b64 a[116:117], v13 offset:928
  v_mfma_f32_16x16x32_bf16 v[188:191], a[12:15], a[152:155], v[188:191]
  ds_read_b64 a[118:119], v13 offset:936
  v_add_f32_dpp v16, v159, v162 wave_ror:1 row_mask:0x1 bank_mask:0x1
  v_mfma_f32_16x16x32_bf16 v[188:191], a[20:23], a[148:151], v[188:191]
  v_add_f32_dpp v16, v163, v162 wave_shr:1 row_mask:0xf bank_mask:0xf
  v_add_f32_dpp v17, v20, v161 wave_ror:1 row_mask:0x1 bank_mask:0x1
  v_mfma_f32_16x16x32_bf16 v[188:191], a[28:31], a[144:147], v[188:191]
  v_add_f32_dpp v17, v16, v161 wave_shr:1 row_mask:0xf bank_mask:0xf
  v_add_f32_dpp v18, v21, v160 wave_ror:1 row_mask:0x1 bank_mask:0x1
  v_mfma_f32_16x16x32_bf16 v[188:191], a[36:39], a[140:143], v[188:191]
  v_add_f32_dpp v18, v17, v160 wave_shr:1 row_mask:0xf bank_mask:0xf
  v_add_f32_dpp v20, v163, v166 wave_ror:1 row_mask:0x1 bank_mask:0x1
  v_mfma_f32_16x16x32_bf16 v[188:191], a[44:47], a[136:139], v[188:191]
  v_add_f32_dpp v20, v167, v166 wave_shr:1 row_mask:0xf bank_mask:0xf
  v_add_f32_dpp v21, v16, v165 wave_ror:1 row_mask:0x1 bank_mask:0x1
  v_mfma_f32_16x16x32_bf16 v[188:191], a[52:55], a[132:135], v[188:191]
  v_add_f32_dpp v21, v20, v165 wave_shr:1 row_mask:0xf bank_mask:0xf
  v_add_f32_dpp v22, v17, v164 wave_ror:1 row_mask:0x1 bank_mask:0x1
  v_mfma_f32_16x16x32_bf16 v[188:191], a[60:63], a[128:131], v[188:191]
  v_add_f32_dpp v22, v21, v164 wave_shr:1 row_mask:0xf bank_mask:0xf
  v_cvt_pk_bf16_f32 v23, v22, v18
  s_waitcnt lgkmcnt(12)
  v_mfma_f32_16x16x32_bf16 v[192:195], a[0:3], a[160:163], v[48:51]
  ds_read_b32 v60, v10 offset:1216
  ds_read_b64 a[120:121], v13 offset:960
  v_mfma_f32_16x16x32_bf16 v[192:195], a[8:11], a[156:159], v[192:195]
  ds_read_b64 a[122:123], v13 offset:968
  ds_write_b16 v11, v23 offset:4608
  v_mfma_f32_16x16x32_bf16 v[192:195], a[16:19], a[152:155], v[192:195]
  ds_write_b16_d16_hi v11, v23 offset:4096
  v_add_f32_dpp v16, v167, v170 wave_ror:1 row_mask:0x1 bank_mask:0x1
  v_mfma_f32_16x16x32_bf16 v[192:195], a[24:27], a[148:151], v[192:195]
  v_add_f32_dpp v16, v171, v170 wave_shr:1 row_mask:0xf bank_mask:0xf
  v_add_f32_dpp v17, v20, v169 wave_ror:1 row_mask:0x1 bank_mask:0x1
  v_mfma_f32_16x16x32_bf16 v[192:195], a[32:35], a[144:147], v[192:195]
  v_add_f32_dpp v17, v16, v169 wave_shr:1 row_mask:0xf bank_mask:0xf
  v_add_f32_dpp v18, v21, v168 wave_ror:1 row_mask:0x1 bank_mask:0x1
  v_mfma_f32_16x16x32_bf16 v[192:195], a[40:43], a[140:143], v[192:195]
  v_add_f32_dpp v18, v17, v168 wave_shr:1 row_mask:0xf bank_mask:0xf
  v_add_f32_dpp v20, v171, v174 wave_ror:1 row_mask:0x1 bank_mask:0x1
  v_mfma_f32_16x16x32_bf16 v[192:195], a[48:51], a[136:139], v[192:195]
  v_add_f32_dpp v20, v175, v174 wave_shr:1 row_mask:0xf bank_mask:0xf
  v_add_f32_dpp v21, v16, v173 wave_ror:1 row_mask:0x1 bank_mask:0x1
  v_mfma_f32_16x16x32_bf16 v[192:195], a[56:59], a[132:135], v[192:195]
  v_add_f32_dpp v21, v20, v173 wave_shr:1 row_mask:0xf bank_mask:0xf
  v_add_f32_dpp v22, v17, v172 wave_ror:1 row_mask:0x1 bank_mask:0x1
  v_mfma_f32_16x16x32_bf16 v[192:195], a[64:67], a[128:131], v[192:195]
  v_add_f32_dpp v22, v21, v172 wave_shr:1 row_mask:0xf bank_mask:0xf
  v_cvt_pk_bf16_f32 v23, v22, v18
  s_waitcnt lgkmcnt(12)
  v_mfma_f32_16x16x32_bf16 v[196:199], a[4:7], a[160:163], v[52:55]
  ds_read_b32 v48, v10 offset:1280
  ds_read_b64 a[124:125], v13 offset:992
  v_mfma_f32_16x16x32_bf16 v[196:199], a[12:15], a[156:159], v[196:199]
  ds_read_b64 a[126:127], v13 offset:1000
  ds_write_b16 v11, v23 offset:5632
  v_mfma_f32_16x16x32_bf16 v[196:199], a[20:23], a[152:155], v[196:199]
  ds_write_b16_d16_hi v11, v23 offset:5120
  v_add_f32_dpp v16, v175, v178 wave_ror:1 row_mask:0x1 bank_mask:0x1
  v_mfma_f32_16x16x32_bf16 v[196:199], a[28:31], a[148:151], v[196:199]
  v_add_f32_dpp v16, v179, v178 wave_shr:1 row_mask:0xf bank_mask:0xf
  v_add_f32_dpp v17, v20, v177 wave_ror:1 row_mask:0x1 bank_mask:0x1
  v_mfma_f32_16x16x32_bf16 v[196:199], a[36:39], a[144:147], v[196:199]
  v_add_f32_dpp v17, v16, v177 wave_shr:1 row_mask:0xf bank_mask:0xf
  v_add_f32_dpp v18, v21, v176 wave_ror:1 row_mask:0x1 bank_mask:0x1
  v_mfma_f32_16x16x32_bf16 v[196:199], a[44:47], a[140:143], v[196:199]
  v_add_f32_dpp v18, v17, v176 wave_shr:1 row_mask:0xf bank_mask:0xf
  v_add_f32_dpp v20, v179, v182 wave_ror:1 row_mask:0x1 bank_mask:0x1
  v_mfma_f32_16x16x32_bf16 v[196:199], a[52:55], a[136:139], v[196:199]
  v_add_f32_dpp v20, v183, v182 wave_shr:1 row_mask:0xf bank_mask:0xf
  v_add_f32_dpp v21, v16, v181 wave_ror:1 row_mask:0x1 bank_mask:0x1
  v_mfma_f32_16x16x32_bf16 v[196:199], a[60:63], a[132:135], v[196:199]
  v_add_f32_dpp v21, v20, v181 wave_shr:1 row_mask:0xf bank_mask:0xf
  v_add_f32_dpp v22, v17, v180 wave_ror:1 row_mask:0x1 bank_mask:0x1
  v_mfma_f32_16x16x32_bf16 v[196:199], a[68:71], a[128:131], v[196:199]
  v_add_f32_dpp v22, v21, v180 wave_shr:1 row_mask:0xf bank_mask:0xf
  v_cvt_pk_bf16_f32 v23, v22, v18
  s_waitcnt lgkmcnt(12)
  v_mfma_f32_16x16x32_bf16 v[200:203], a[0:3], a[164:167], v[56:59]
  ds_read_b32 v52, v10 offset:1344
  ds_write_b16 v11, v23 offset:6656
  v_mfma_f32_16x16x32_bf16 v[200:203], a[8:11], a[160:163], v[200:203]
  ds_write_b16_d16_hi v11, v23 offset:6144
  v_add_f32_dpp v16, v183, v186 wave_ror:1 row_mask:0x1 bank_mask:0x1
  v_mfma_f32_16x16x32_bf16 v[200:203], a[16:19], a[156:159], v[200:203]
  v_add_f32_dpp v16, v187, v186 wave_shr:1 row_mask:0xf bank_mask:0xf
  v_add_f32_dpp v17, v20, v185 wave_ror:1 row_mask:0x1 bank_mask:0x1
  v_mfma_f32_16x16x32_bf16 v[200:203], a[24:27], a[152:155], v[200:203]
  v_add_f32_dpp v17, v16, v185 wave_shr:1 row_mask:0xf bank_mask:0xf
  v_add_f32_dpp v18, v21, v184 wave_ror:1 row_mask:0x1 bank_mask:0x1
  v_mfma_f32_16x16x32_bf16 v[200:203], a[32:35], a[148:151], v[200:203]
  v_add_f32_dpp v18, v17, v184 wave_shr:1 row_mask:0xf bank_mask:0xf
  v_add_f32_dpp v20, v187, v190 wave_ror:1 row_mask:0x1 bank_mask:0x1
  v_mfma_f32_16x16x32_bf16 v[200:203], a[40:43], a[144:147], v[200:203]
  v_add_f32_dpp v20, v191, v190 wave_shr:1 row_mask:0xf bank_mask:0xf
  v_add_f32_dpp v21, v16, v189 wave_ror:1 row_mask:0x1 bank_mask:0x1
  v_mfma_f32_16x16x32_bf16 v[200:203], a[48:51], a[140:143], v[200:203]
  v_add_f32_dpp v21, v20, v189 wave_shr:1 row_mask:0xf bank_mask:0xf
  v_add_f32_dpp v22, v17, v188 wave_ror:1 row_mask:0x1 bank_mask:0x1
  v_mfma_f32_16x16x32_bf16 v[200:203], a[56:59], a[136:139], v[200:203]
  v_add_f32_dpp v22, v21, v188 wave_shr:1 row_mask:0xf bank_mask:0xf
  v_cvt_pk_bf16_f32 v23, v22, v18
  v_mfma_f32_16x16x32_bf16 v[200:203], a[64:67], a[132:135], v[200:203]
  ds_write_b16 v11, v23 offset:7680
  ds_write_b16_d16_hi v11, v23 offset:7168
  v_mfma_f32_16x16x32_bf16 v[200:203], a[72:75], a[128:131], v[200:203]
  s_waitcnt lgkmcnt(0)
  s_barrier
  ds_read_b64 v[64:65], v24 offset:0
  ds_read_b64 v[66:67], v24 offset:2048
  ds_read_b64 v[68:69], v24 offset:4096
  ds_read_b64 v[70:71], v24 offset:6144
  v_add_f32_dpp v16, v191, v194 wave_ror:1 row_mask:0x1 bank_mask:0x1
  v_add_f32_dpp v16, v195, v194 wave_shr:1 row_mask:0xf bank_mask:0xf
  v_mfma_f32_16x16x32_bf16 v[204:207], a[4:7], a[164:167], v[60:63]
  ds_read_b32 v56, v10 offset:1408
  v_add_f32_dpp v17, v20, v193 wave_ror:1 row_mask:0x1 bank_mask:0x1
  v_mfma_f32_16x16x32_bf16 v[204:207], a[12:15], a[160:163], v[204:207]
  v_add_f32_dpp v17, v16, v193 wave_shr:1 row_mask:0xf bank_mask:0xf
  v_add_f32_dpp v18, v21, v192 wave_ror:1 row_mask:0x1 bank_mask:0x1
  v_mfma_f32_16x16x32_bf16 v[204:207], a[20:23], a[156:159], v[204:207]
  v_add_f32_dpp v18, v17, v192 wave_shr:1 row_mask:0xf bank_mask:0xf
  v_add_f32_dpp v20, v195, v198 wave_ror:1 row_mask:0x1 bank_mask:0x1
  v_mfma_f32_16x16x32_bf16 v[204:207], a[28:31], a[152:155], v[204:207]
  s_waitcnt lgkmcnt(4)
  buffer_store_dwordx2 v[64:65], v25, s[12:15], s46 offen sc1
  s_add_u32 s46, s46, 4096
  v_add_f32_dpp v20, v199, v198 wave_shr:1 row_mask:0xf bank_mask:0xf
  v_add_f32_dpp v21, v16, v197 wave_ror:1 row_mask:0x1 bank_mask:0x1
  v_mfma_f32_16x16x32_bf16 v[204:207], a[36:39], a[148:151], v[204:207]
  s_waitcnt lgkmcnt(3)
  buffer_store_dwordx2 v[66:67], v25, s[12:15], s46 offen sc1
  s_add_u32 s46, s46, 4096
  v_add_f32_dpp v21, v20, v197 wave_shr:1 row_mask:0xf bank_mask:0xf
  v_add_f32_dpp v22, v17, v196 wave_ror:1 row_mask:0x1 bank_mask:0x1
  v_mfma_f32_16x16x32_bf16 v[204:207], a[44:47], a[144:147], v[204:207]
  s_waitcnt lgkmcnt(2)
  buffer_store_dwordx2 v[68:69], v25, s[12:15], s46 offen sc1
  s_add_u32 s46, s46, 4096
  v_add_f32_dpp v22, v21, v196 wave_shr:1 row_mask:0xf bank_mask:0xf
  v_cvt_pk_bf16_f32 v23, v22, v18
  v_mfma_f32_16x16x32_bf16 v[204:207], a[52:55], a[140:143], v[204:207]
  s_waitcnt lgkmcnt(1)
  buffer_store_dwordx2 v[70:71], v25, s[12:15], s46 offen sc1
  s_add_u32 s46, s46, 4096
  ds_write_b16 v11, v23 offset:8704
  ds_write_b16_d16_hi v11, v23 offset:8192
  v_mfma_f32_16x16x32_bf16 v[204:207], a[60:63], a[136:139], v[204:207]
  v_add_f32_dpp v16, v199, v202 wave_ror:1 row_mask:0x1 bank_mask:0x1
  v_add_f32_dpp v16, v203, v202 wave_shr:1 row_mask:0xf bank_mask:0xf
  v_mfma_f32_16x16x32_bf16 v[204:207], a[68:71], a[132:135], v[204:207]
  v_add_f32_dpp v17, v20, v201 wave_ror:1 row_mask:0x1 bank_mask:0x1
  v_mfma_f32_16x16x32_bf16 v[204:207], a[76:79], a[128:131], v[204:207]
  v_add_f32_dpp v17, v16, v201 wave_shr:1 row_mask:0xf bank_mask:0xf
  v_add_f32_dpp v18, v21, v200 wave_ror:1 row_mask:0x1 bank_mask:0x1
  v_mfma_f32_16x16x32_bf16 v[208:211], a[0:3], a[168:171], v[48:51]
  ds_read_b32 v60, v10 offset:1472
  v_add_f32_dpp v18, v17, v200 wave_shr:1 row_mask:0xf bank_mask:0xf
  v_mfma_f32_16x16x32_bf16 v[208:211], a[8:11], a[164:167], v[208:211]
  v_mfma_f32_16x16x32_bf16 v[208:211], a[16:19], a[160:163], v[208:211]
  v_mfma_f32_16x16x32_bf16 v[208:211], a[24:27], a[156:159], v[208:211]
  v_add_f32_dpp v20, v203, v206 wave_ror:1 row_mask:0x1 bank_mask:0x1
  v_add_f32_dpp v20, v207, v206 wave_shr:1 row_mask:0xf bank_mask:0xf
  v_mfma_f32_16x16x32_bf16 v[208:211], a[32:35], a[152:155], v[208:211]
  v_add_f32_dpp v21, v16, v205 wave_ror:1 row_mask:0x1 bank_mask:0x1
  v_mfma_f32_16x16x32_bf16 v[208:211], a[40:43], a[148:151], v[208:211]
  v_add_f32_dpp v21, v20, v205 wave_shr:1 row_mask:0xf bank_mask:0xf
  v_add_f32_dpp v22, v17, v204 wave_ror:1 row_mask:0x1 bank_mask:0x1
  v_mfma_f32_16x16x32_bf16 v[208:211], a[48:51], a[144:147], v[208:211]
  v_add_f32_dpp v22, v21, v204 wave_shr:1 row_mask:0xf bank_mask:0xf
  v_cvt_pk_bf16_f32 v23, v22, v18
  v_mfma_f32_16x16x32_bf16 v[208:211], a[56:59], a[140:143], v[208:211]
  ds_write_b16 v11, v23 offset:9728
  ds_write_b16_d16_hi v11, v23 offset:9216
  v_mfma_f32_16x16x32_bf16 v[208:211], a[64:67], a[136:139], v[208:211]
  v_mfma_f32_16x16x32_bf16 v[208:211], a[72:75], a[132:135], v[208:211]
  v_mfma_f32_16x16x32_bf16 v[208:211], a[80:83], a[128:131], v[208:211]
  v_mfma_f32_16x16x32_bf16 v[212:215], a[4:7], a[168:171], v[52:55]
  ds_read_b32 v48, v10 offset:1536
  v_mfma_f32_16x16x32_bf16 v[212:215], a[12:15], a[164:167], v[212:215]
  v_mfma_f32_16x16x32_bf16 v[212:215], a[20:23], a[160:163], v[212:215]
  v_mfma_f32_16x16x32_bf16 v[212:215], a[28:31], a[156:159], v[212:215]
  v_mfma_f32_16x16x32_bf16 v[212:215], a[36:39], a[152:155], v[212:215]
  v_mfma_f32_16x16x32_bf16 v[212:215], a[44:47], a[148:151], v[212:215]
  v_mfma_f32_16x16x32_bf16 v[212:215], a[52:55], a[144:147], v[212:215]
  v_add_f32_dpp v16, v207, v210 wave_ror:1 row_mask:0x1 bank_mask:0x1
  v_add_f32_dpp v16, v211, v210 wave_shr:1 row_mask:0xf bank_mask:0xf
  v_mfma_f32_16x16x32_bf16 v[212:215], a[60:63], a[140:143], v[212:215]
  v_add_f32_dpp v17, v20, v209 wave_ror:1 row_mask:0x1 bank_mask:0x1
  v_mfma_f32_16x16x32_bf16 v[212:215], a[68:71], a[136:139], v[212:215]
  v_add_f32_dpp v17, v16, v209 wave_shr:1 row_mask:0xf bank_mask:0xf
  v_add_f32_dpp v18, v21, v208 wave_ror:1 row_mask:0x1 bank_mask:0x1
  v_mfma_f32_16x16x32_bf16 v[212:215], a[76:79], a[132:135], v[212:215]
  v_add_f32_dpp v18, v17, v208 wave_shr:1 row_mask:0xf bank_mask:0xf
  v_mfma_f32_16x16x32_bf16 v[212:215], a[84:87], a[128:131], v[212:215]
  s_waitcnt lgkmcnt(6)
  v_mfma_f32_16x16x32_bf16 v[216:219], a[0:3], a[172:175], v[56:59]
  ds_read_b32 v52, v10 offset:1600
  v_mfma_f32_16x16x32_bf16 v[216:219], a[8:11], a[168:171], v[216:219]
  v_mfma_f32_16x16x32_bf16 v[216:219], a[16:19], a[164:167], v[216:219]
  v_mfma_f32_16x16x32_bf16 v[216:219], a[24:27], a[160:163], v[216:219]
  v_mfma_f32_16x16x32_bf16 v[216:219], a[32:35], a[156:159], v[216:219]
  v_mfma_f32_16x16x32_bf16 v[216:219], a[40:43], a[152:155], v[216:219]
  v_add_f32_dpp v20, v211, v214 wave_ror:1 row_mask:0x1 bank_mask:0x1
  v_add_f32_dpp v20, v215, v214 wave_shr:1 row_mask:0xf bank_mask:0xf
  v_mfma_f32_16x16x32_bf16 v[216:219], a[48:51], a[148:151], v[216:219]
  v_add_f32_dpp v21, v16, v213 wave_ror:1 row_mask:0x1 bank_mask:0x1
  v_mfma_f32_16x16x32_bf16 v[216:219], a[56:59], a[144:147], v[216:219]
  v_add_f32_dpp v21, v20, v213 wave_shr:1 row_mask:0xf bank_mask:0xf
  v_add_f32_dpp v22, v17, v212 wave_ror:1 row_mask:0x1 bank_mask:0x1
  v_mfma_f32_16x16x32_bf16 v[216:219], a[64:67], a[140:143], v[216:219]
  v_add_f32_dpp v22, v21, v212 wave_shr:1 row_mask:0xf bank_mask:0xf
  v_cvt_pk_bf16_f32 v23, v22, v18
  v_mfma_f32_16x16x32_bf16 v[216:219], a[72:75], a[136:139], v[216:219]
  ds_write_b16 v11, v23 offset:10752
  ds_write_b16_d16_hi v11, v23 offset:10240
  v_mfma_f32_16x16x32_bf16 v[216:219], a[80:83], a[132:135], v[216:219]
  v_mfma_f32_16x16x32_bf16 v[216:219], a[88:91], a[128:131], v[216:219]
  s_waitcnt lgkmcnt(6)
  v_mfma_f32_16x16x32_bf16 v[220:223], a[4:7], a[172:175], v[60:63]
  ds_read_b32 v56, v10 offset:1664
  v_mfma_f32_16x16x32_bf16 v[220:223], a[12:15], a[168:171], v[220:223]
  v_mfma_f32_16x16x32_bf16 v[220:223], a[20:23], a[164:167], v[220:223]
  v_mfma_f32_16x16x32_bf16 v[220:223], a[28:31], a[160:163], v[220:223]
  v_mfma_f32_16x16x32_bf16 v[220:223], a[36:39], a[156:159], v[220:223]
  v_mfma_f32_16x16x32_bf16 v[220:223], a[44:47], a[152:155], v[220:223]
  v_add_f32_dpp v16, v215, v218 wave_ror:1 row_mask:0x1 bank_mask:0x1
  v_add_f32_dpp v16, v219, v218 wave_shr:1 row_mask:0xf bank_mask:0xf
  v_mfma_f32_16x16x32_bf16 v[220:223], a[52:55], a[148:151], v[220:223]
  v_add_f32_dpp v17, v20, v217 wave_ror:1 row_mask:0x1 bank_mask:0x1
  v_mfma_f32_16x16x32_bf16 v[220:223], a[60:63], a[144:147], v[220:223]
  v_add_f32_dpp v17, v16, v217 wave_shr:1 row_mask:0xf bank_mask:0xf
  v_add_f32_dpp v18, v21, v216 wave_ror:1 row_mask:0x1 bank_mask:0x1
  v_mfma_f32_16x16x32_bf16 v[220:223], a[68:71], a[140:143], v[220:223]
  v_add_f32_dpp v18, v17, v216 wave_shr:1 row_mask:0xf bank_mask:0xf
  v_mfma_f32_16x16x32_bf16 v[220:223], a[76:79], a[136:139], v[220:223]
  v_mfma_f32_16x16x32_bf16 v[220:223], a[84:87], a[132:135], v[220:223]
  v_mfma_f32_16x16x32_bf16 v[220:223], a[92:95], a[128:131], v[220:223]
  s_waitcnt lgkmcnt(4)
  v_mfma_f32_16x16x32_bf16 v[224:227], a[0:3], a[176:179], v[48:51]
  ds_read_b32 v60, v10 offset:1728
  v_mfma_f32_16x16x32_bf16 v[224:227], a[8:11], a[172:175], v[224:227]
  v_mfma_f32_16x16x32_bf16 v[224:227], a[16:19], a[168:171], v[224:227]
  v_mfma_f32_16x16x32_bf16 v[224:227], a[24:27], a[164:167], v[224:227]
  v_mfma_f32_16x16x32_bf16 v[224:227], a[32:35], a[160:163], v[224:227]
  v_mfma_f32_16x16x32_bf16 v[224:227], a[40:43], a[156:159], v[224:227]
  v_add_f32_dpp v20, v219, v222 wave_ror:1 row_mask:0x1 bank_mask:0x1
  v_add_f32_dpp v20, v223, v222 wave_shr:1 row_mask:0xf bank_mask:0xf
  v_mfma_f32_16x16x32_bf16 v[224:227], a[48:51], a[152:155], v[224:227]
  v_add_f32_dpp v21, v16, v221 wave_ror:1 row_mask:0x1 bank_mask:0x1
  v_mfma_f32_16x16x32_bf16 v[224:227], a[56:59], a[148:151], v[224:227]
  v_add_f32_dpp v21, v20, v221 wave_shr:1 row_mask:0xf bank_mask:0xf
  v_add_f32_dpp v22, v17, v220 wave_ror:1 row_mask:0x1 bank_mask:0x1
  v_mfma_f32_16x16x32_bf16 v[224:227], a[64:67], a[144:147], v[224:227]
  v_add_f32_dpp v22, v21, v220 wave_shr:1 row_mask:0xf bank_mask:0xf
  v_cvt_pk_bf16_f32 v23, v22, v18
  v_mfma_f32_16x16x32_bf16 v[224:227], a[72:75], a[140:143], v[224:227]
  ds_write_b16 v11, v23 offset:11776
  ds_write_b16_d16_hi v11, v23 offset:11264
  v_mfma_f32_16x16x32_bf16 v[224:227], a[80:83], a[136:139], v[224:227]
  s_waitcnt lgkmcnt(0)
  s_barrier
  ds_read_b64 v[72:73], v24 offset:8192
  ds_read_b64 v[74:75], v24 offset:10240
  v_mfma_f32_16x16x32_bf16 v[224:227], a[88:91], a[132:135], v[224:227]
  v_mfma_f32_16x16x32_bf16 v[224:227], a[96:99], a[128:131], v[224:227]
  v_mfma_f32_16x16x32_bf16 v[228:231], a[4:7], a[176:179], v[52:55]
  ds_read_b32 v48, v10 offset:1792
  v_mfma_f32_16x16x32_bf16 v[228:231], a[12:15], a[172:175], v[228:231]
  v_mfma_f32_16x16x32_bf16 v[228:231], a[20:23], a[168:171], v[228:231]
  v_mfma_f32_16x16x32_bf16 v[228:231], a[28:31], a[164:167], v[228:231]
  v_mfma_f32_16x16x32_bf16 v[228:231], a[36:39], a[160:163], v[228:231]
  v_mfma_f32_16x16x32_bf16 v[228:231], a[44:47], a[156:159], v[228:231]
  v_mfma_f32_16x16x32_bf16 v[228:231], a[52:55], a[152:155], v[228:231]
  v_add_f32_dpp v16, v223, v226 wave_ror:1 row_mask:0x1 bank_mask:0x1
  v_add_f32_dpp v16, v227, v226 wave_shr:1 row_mask:0xf bank_mask:0xf
  v_mfma_f32_16x16x32_bf16 v[228:231], a[60:63], a[148:151], v[228:231]
  s_waitcnt lgkmcnt(2)
  buffer_store_dwordx2 v[72:73], v25, s[12:15], s46 offen sc1
  s_add_u32 s46, s46, 4096
  v_add_f32_dpp v17, v20, v225 wave_ror:1 row_mask:0x1 bank_mask:0x1
  v_mfma_f32_16x16x32_bf16 v[228:231], a[68:71], a[144:147], v[228:231]
  s_waitcnt lgkmcnt(1)
  buffer_store_dwordx2 v[74:75], v25, s[12:15], s46 offen sc1
  s_add_u32 s46, s46, 4096
  v_add_f32_dpp v17, v16, v225 wave_shr:1 row_mask:0xf bank_mask:0xf
  v_add_f32_dpp v18, v21, v224 wave_ror:1 row_mask:0x1 bank_mask:0x1
  v_mfma_f32_16x16x32_bf16 v[228:231], a[76:79], a[140:143], v[228:231]
  v_add_f32_dpp v18, v17, v224 wave_shr:1 row_mask:0xf bank_mask:0xf
  v_mfma_f32_16x16x32_bf16 v[228:231], a[84:87], a[136:139], v[228:231]
  v_mfma_f32_16x16x32_bf16 v[228:231], a[92:95], a[132:135], v[228:231]
  v_mfma_f32_16x16x32_bf16 v[228:231], a[100:103], a[128:131], v[228:231]
  v_mfma_f32_16x16x32_bf16 v[232:235], a[0:3], a[180:183], v[56:59]
  ds_read_b32 v52, v10 offset:1856
  v_mfma_f32_16x16x32_bf16 v[232:235], a[8:11], a[176:179], v[232:235]
  v_mfma_f32_16x16x32_bf16 v[232:235], a[16:19], a[172:175], v[232:235]
  v_mfma_f32_16x16x32_bf16 v[232:235], a[24:27], a[168:171], v[232:235]
  v_mfma_f32_16x16x32_bf16 v[232:235], a[32:35], a[164:167], v[232:235]
  v_mfma_f32_16x16x32_bf16 v[232:235], a[40:43], a[160:163], v[232:235]
  v_mfma_f32_16x16x32_bf16 v[232:235], a[48:51], a[156:159], v[232:235]
  v_add_f32_dpp v20, v227, v230 wave_ror:1 row_mask:0x1 bank_mask:0x1
  v_add_f32_dpp v20, v231, v230 wave_shr:1 row_mask:0xf bank_mask:0xf
  v_mfma_f32_16x16x32_bf16 v[232:235], a[56:59], a[152:155], v[232:235]
  v_add_f32_dpp v21, v16, v229 wave_ror:1 row_mask:0x1 bank_mask:0x1
  v_mfma_f32_16x16x32_bf16 v[232:235], a[64:67], a[148:151], v[232:235]
  v_add_f32_dpp v21, v20, v229 wave_shr:1 row_mask:0xf bank_mask:0xf
  v_add_f32_dpp v22, v17, v228 wave_ror:1 row_mask:0x1 bank_mask:0x1
  v_mfma_f32_16x16x32_bf16 v[232:235], a[72:75], a[144:147], v[232:235]
  v_add_f32_dpp v22, v21, v228 wave_shr:1 row_mask:0xf bank_mask:0xf
  v_cvt_pk_bf16_f32 v23, v22, v18
  v_mfma_f32_16x16x32_bf16 v[232:235], a[80:83], a[140:143], v[232:235]
  ds_write_b16 v11, v23 offset:12800
  ds_write_b16_d16_hi v11, v23 offset:12288
  v_mfma_f32_16x16x32_bf16 v[232:235], a[88:91], a[136:139], v[232:235]
  v_mfma_f32_16x16x32_bf16 v[232:235], a[96:99], a[132:135], v[232:235]
  v_mfma_f32_16x16x32_bf16 v[232:235], a[104:107], a[128:131], v[232:235]
  v_mfma_f32_16x16x32_bf16 v[236:239], a[4:7], a[180:183], v[60:63]
  ds_read_b32 v56, v10 offset:1920
  v_mfma_f32_16x16x32_bf16 v[236:239], a[12:15], a[176:179], v[236:239]
  v_mfma_f32_16x16x32_bf16 v[236:239], a[20:23], a[172:175], v[236:239]
  v_mfma_f32_16x16x32_bf16 v[236:239], a[28:31], a[168:171], v[236:239]
  v_mfma_f32_16x16x32_bf16 v[236:239], a[36:39], a[164:167], v[236:239]
  v_mfma_f32_16x16x32_bf16 v[236:239], a[44:47], a[160:163], v[236:239]
  v_mfma_f32_16x16x32_bf16 v[236:239], a[52:55], a[156:159], v[236:239]
  v_add_f32_dpp v16, v231, v234 wave_ror:1 row_mask:0x1 bank_mask:0x1
  v_add_f32_dpp v16, v235, v234 wave_shr:1 row_mask:0xf bank_mask:0xf
  v_mfma_f32_16x16x32_bf16 v[236:239], a[60:63], a[152:155], v[236:239]
  v_add_f32_dpp v17, v20, v233 wave_ror:1 row_mask:0x1 bank_mask:0x1
  v_mfma_f32_16x16x32_bf16 v[236:239], a[68:71], a[148:151], v[236:239]
  v_add_f32_dpp v17, v16, v233 wave_shr:1 row_mask:0xf bank_mask:0xf
  v_add_f32_dpp v18, v21, v232 wave_ror:1 row_mask:0x1 bank_mask:0x1
  v_mfma_f32_16x16x32_bf16 v[236:239], a[76:79], a[144:147], v[236:239]
  v_add_f32_dpp v18, v17, v232 wave_shr:1 row_mask:0xf bank_mask:0xf
  v_mfma_f32_16x16x32_bf16 v[236:239], a[84:87], a[140:143], v[236:239]
  v_mfma_f32_16x16x32_bf16 v[236:239], a[92:95], a[136:139], v[236:239]
  v_mfma_f32_16x16x32_bf16 v[236:239], a[100:103], a[132:135], v[236:239]
  v_mfma_f32_16x16x32_bf16 v[236:239], a[108:111], a[128:131], v[236:239]
  s_waitcnt lgkmcnt(4)
  v_mfma_f32_16x16x32_bf16 v[240:243], a[0:3], a[184:187], v[48:51]
  ds_read_b32 v60, v10 offset:1984
  v_mfma_f32_16x16x32_bf16 v[240:243], a[8:11], a[180:183], v[240:243]
  v_mfma_f32_16x16x32_bf16 v[240:243], a[16:19], a[176:179], v[240:243]
  v_mfma_f32_16x16x32_bf16 v[240:243], a[24:27], a[172:175], v[240:243]
  v_mfma_f32_16x16x32_bf16 v[240:243], a[32:35], a[168:171], v[240:243]
  v_mfma_f32_16x16x32_bf16 v[240:243], a[40:43], a[164:167], v[240:243]
  v_add_f32_dpp v20, v235, v238 wave_ror:1 row_mask:0x1 bank_mask:0x1
  v_add_f32_dpp v20, v239, v238 wave_shr:1 row_mask:0xf bank_mask:0xf
  v_mfma_f32_16x16x32_bf16 v[240:243], a[48:51], a[160:163], v[240:243]
  v_add_f32_dpp v21, v16, v237 wave_ror:1 row_mask:0x1 bank_mask:0x1
  v_mfma_f32_16x16x32_bf16 v[240:243], a[56:59], a[156:159], v[240:243]
  v_add_f32_dpp v21, v20, v237 wave_shr:1 row_mask:0xf bank_mask:0xf
  v_add_f32_dpp v22, v17, v236 wave_ror:1 row_mask:0x1 bank_mask:0x1
  v_mfma_f32_16x16x32_bf16 v[240:243], a[64:67], a[152:155], v[240:243]
  v_add_f32_dpp v22, v21, v236 wave_shr:1 row_mask:0xf bank_mask:0xf
  v_cvt_pk_bf16_f32 v23, v22, v18
  v_mfma_f32_16x16x32_bf16 v[240:243], a[72:75], a[148:151], v[240:243]
  ds_write_b16 v11, v23 offset:13824
  ds_write_b16_d16_hi v11, v23 offset:13312
  v_mfma_f32_16x16x32_bf16 v[240:243], a[80:83], a[144:147], v[240:243]
  v_mfma_f32_16x16x32_bf16 v[240:243], a[88:91], a[140:143], v[240:243]
  v_mfma_f32_16x16x32_bf16 v[240:243], a[96:99], a[136:139], v[240:243]
  v_mfma_f32_16x16x32_bf16 v[240:243], a[104:107], a[132:135], v[240:243]
  v_mfma_f32_16x16x32_bf16 v[240:243], a[112:115], a[128:131], v[240:243]
  s_waitcnt lgkmcnt(6)
  v_mfma_f32_16x16x32_bf16 v[244:247], a[4:7], a[184:187], v[52:55]
  v_mfma_f32_16x16x32_bf16 v[244:247], a[12:15], a[180:183], v[244:247]
  v_mfma_f32_16x16x32_bf16 v[244:247], a[20:23], a[176:179], v[244:247]
  v_mfma_f32_16x16x32_bf16 v[244:247], a[28:31], a[172:175], v[244:247]
  v_mfma_f32_16x16x32_bf16 v[244:247], a[36:39], a[168:171], v[244:247]
  v_mfma_f32_16x16x32_bf16 v[244:247], a[44:47], a[164:167], v[244:247]
  v_mfma_f32_16x16x32_bf16 v[244:247], a[52:55], a[160:163], v[244:247]
  v_add_f32_dpp v16, v239, v242 wave_ror:1 row_mask:0x1 bank_mask:0x1
  v_add_f32_dpp v16, v243, v242 wave_shr:1 row_mask:0xf bank_mask:0xf
  v_mfma_f32_16x16x32_bf16 v[244:247], a[60:63], a[156:159], v[244:247]
  v_add_f32_dpp v17, v20, v241 wave_ror:1 row_mask:0x1 bank_mask:0x1
  v_mfma_f32_16x16x32_bf16 v[244:247], a[68:71], a[152:155], v[244:247]
  v_add_f32_dpp v17, v16, v241 wave_shr:1 row_mask:0xf bank_mask:0xf
  v_add_f32_dpp v18, v21, v240 wave_ror:1 row_mask:0x1 bank_mask:0x1
  v_mfma_f32_16x16x32_bf16 v[244:247], a[76:79], a[148:151], v[244:247]
  v_add_f32_dpp v18, v17, v240 wave_shr:1 row_mask:0xf bank_mask:0xf
  v_mfma_f32_16x16x32_bf16 v[244:247], a[84:87], a[144:147], v[244:247]
  v_mfma_f32_16x16x32_bf16 v[244:247], a[92:95], a[140:143], v[244:247]
  v_mfma_f32_16x16x32_bf16 v[244:247], a[100:103], a[136:139], v[244:247]
  v_mfma_f32_16x16x32_bf16 v[244:247], a[108:111], a[132:135], v[244:247]
  v_mfma_f32_16x16x32_bf16 v[244:247], a[116:119], a[128:131], v[244:247]
  s_waitcnt lgkmcnt(3)
  v_mfma_f32_16x16x32_bf16 v[248:251], a[0:3], a[188:191], v[56:59]
  v_mfma_f32_16x16x32_bf16 v[248:251], a[8:11], a[184:187], v[248:251]
  v_mfma_f32_16x16x32_bf16 v[248:251], a[16:19], a[180:183], v[248:251]
  v_mfma_f32_16x16x32_bf16 v[248:251], a[24:27], a[176:179], v[248:251]
  v_mfma_f32_16x16x32_bf16 v[248:251], a[32:35], a[172:175], v[248:251]
  v_mfma_f32_16x16x32_bf16 v[248:251], a[40:43], a[168:171], v[248:251]
  v_mfma_f32_16x16x32_bf16 v[248:251], a[48:51], a[164:167], v[248:251]
  v_add_f32_dpp v20, v243, v246 wave_ror:1 row_mask:0x1 bank_mask:0x1
  v_add_f32_dpp v20, v247, v246 wave_shr:1 row_mask:0xf bank_mask:0xf
  v_mfma_f32_16x16x32_bf16 v[248:251], a[56:59], a[160:163], v[248:251]
  v_add_f32_dpp v21, v16, v245 wave_ror:1 row_mask:0x1 bank_mask:0x1
  v_mfma_f32_16x16x32_bf16 v[248:251], a[64:67], a[156:159], v[248:251]
  v_add_f32_dpp v21, v20, v245 wave_shr:1 row_mask:0xf bank_mask:0xf
  v_add_f32_dpp v22, v17, v244 wave_ror:1 row_mask:0x1 bank_mask:0x1
  v_mfma_f32_16x16x32_bf16 v[248:251], a[72:75], a[152:155], v[248:251]
  v_add_f32_dpp v22, v21, v244 wave_shr:1 row_mask:0xf bank_mask:0xf
  v_cvt_pk_bf16_f32 v23, v22, v18
  v_mfma_f32_16x16x32_bf16 v[248:251], a[80:83], a[148:151], v[248:251]
  ds_write_b16 v11, v23 offset:14848
  ds_write_b16_d16_hi v11, v23 offset:14336
  v_mfma_f32_16x16x32_bf16 v[248:251], a[88:91], a[144:147], v[248:251]
  v_mfma_f32_16x16x32_bf16 v[248:251], a[96:99], a[140:143], v[248:251]
  v_mfma_f32_16x16x32_bf16 v[248:251], a[104:107], a[136:139], v[248:251]
  v_mfma_f32_16x16x32_bf16 v[248:251], a[112:115], a[132:135], v[248:251]
  v_mfma_f32_16x16x32_bf16 v[248:251], a[120:123], a[128:131], v[248:251]
  s_waitcnt lgkmcnt(4)
  v_mfma_f32_16x16x32_bf16 v[252:255], a[4:7], a[188:191], v[60:63]
  v_mfma_f32_16x16x32_bf16 v[252:255], a[12:15], a[184:187], v[252:255]
  v_mfma_f32_16x16x32_bf16 v[252:255], a[20:23], a[180:183], v[252:255]
  v_mfma_f32_16x16x32_bf16 v[252:255], a[28:31], a[176:179], v[252:255]
  v_mfma_f32_16x16x32_bf16 v[252:255], a[36:39], a[172:175], v[252:255]
  v_mfma_f32_16x16x32_bf16 v[252:255], a[44:47], a[168:171], v[252:255]
  v_mfma_f32_16x16x32_bf16 v[252:255], a[52:55], a[164:167], v[252:255]
  v_add_f32_dpp v16, v247, v250 wave_ror:1 row_mask:0x1 bank_mask:0x1
  v_add_f32_dpp v16, v251, v250 wave_shr:1 row_mask:0xf bank_mask:0xf
  v_mfma_f32_16x16x32_bf16 v[252:255], a[60:63], a[160:163], v[252:255]
  v_add_f32_dpp v17, v20, v249 wave_ror:1 row_mask:0x1 bank_mask:0x1
  v_mfma_f32_16x16x32_bf16 v[252:255], a[68:71], a[156:159], v[252:255]
  v_add_f32_dpp v17, v16, v249 wave_shr:1 row_mask:0xf bank_mask:0xf
  v_add_f32_dpp v18, v21, v248 wave_ror:1 row_mask:0x1 bank_mask:0x1
  v_mfma_f32_16x16x32_bf16 v[252:255], a[76:79], a[152:155], v[252:255]
  v_add_f32_dpp v18, v17, v248 wave_shr:1 row_mask:0xf bank_mask:0xf
  v_mfma_f32_16x16x32_bf16 v[252:255], a[84:87], a[148:151], v[252:255]
  v_mfma_f32_16x16x32_bf16 v[252:255], a[92:95], a[144:147], v[252:255]
  v_mfma_f32_16x16x32_bf16 v[252:255], a[100:103], a[140:143], v[252:255]
  v_mfma_f32_16x16x32_bf16 v[252:255], a[108:111], a[136:139], v[252:255]
  v_mfma_f32_16x16x32_bf16 v[252:255], a[116:119], a[132:135], v[252:255]
  v_mfma_f32_16x16x32_bf16 v[252:255], a[124:127], a[128:131], v[252:255]
  s_nop 0
  s_nop 0
  s_nop 0
  s_nop 0
  s_nop 0
  s_nop 0
  s_nop 0
  s_nop 0
  v_add_f32_dpp v20, v251, v254 wave_ror:1 row_mask:0x1 bank_mask:0x1
  v_add_f32_dpp v20, v255, v254 wave_shr:1 row_mask:0xf bank_mask:0xf
  v_add_f32_dpp v21, v16, v253 wave_ror:1 row_mask:0x1 bank_mask:0x1
  s_nop 0
  v_add_f32_dpp v21, v20, v253 wave_shr:1 row_mask:0xf bank_mask:0xf
  v_add_f32_dpp v22, v17, v252 wave_ror:1 row_mask:0x1 bank_mask:0x1
  s_nop 0
  v_add_f32_dpp v22, v21, v252 wave_shr:1 row_mask:0xf bank_mask:0xf
  v_cvt_pk_bf16_f32 v23, v22, v18
  ds_write_b16 v11, v23 offset:15872
  ds_write_b16_d16_hi v11, v23 offset:15360
  s_waitcnt lgkmcnt(0)
  s_barrier
  ds_read_b64 v[76:77], v24 offset:12288
  ds_read_b64 v[78:79], v24 offset:14336
  s_waitcnt lgkmcnt(1)
  buffer_store_dwordx2 v[76:77], v25, s[12:15], s46 offen
  s_add_u32 s46, s46, 4096
  s_waitcnt lgkmcnt(0)
  buffer_store_dwordx2 v[78:79], v25, s[12:15], s46 offen
cv_end:
  s_endpgm
.globl ffn_kernel
.p2align 8
.type ffn_kernel,@function
ffn_kernel:
  s_cmp_ge_u32 s2, 256
  s_cbranch_scc1 g1_end
  s_load_dwordx2 s[32:33], s[0:1], 120
  s_load_dwordx4 s[28:31], s[0:1], 80
  s_load_dwordx2 s[44:45], s[0:1], 96
  v_lshrrev_b32 v10, 6, v0
  v_and_b32 v12, 63, v0
  v_readfirstlane_b32 s16, v10
  s_and_b32 s18, s2, 7
  s_lshl_b32 s18, s18, 2
  s_bfe_u32 s27, s2, 0x20003
  s_add_u32 s18, s18, s27
  s_lshr_b32 s17, s2, 5
  s_lshr_b32 s34, s2, 7
  s_and_b32 s35, s16, 1
  s_lshr_b32 s36, s16, 1
  v_lshrrev_b32 v13, 3, v0
  v_and_b32 v15, 7, v0
  v_lshlrev_b32 v13, 15, v13
  v_lshl_add_u32 v13, v15, 4, v13
  s_lshl_b32 s37, s17, 5
  s_add_u32 s37, s37, s18
  s_lshl_b32 s53, s37, 7
  s_lshl_b32 s20, s16, 10
  s_lshl_b32 s27, s17, 12
  s_add_u32 s27, s20, s27
  v_lshrrev_b32 v16, 4, v12
  v_and_b32 v17, 15, v12
  v_lshlrev_b32 v16, 15, v16
  v_lshl_add_u32 v16, v17, 4, v16
  v_add_u32 v1, s27, v16
  s_lshl_b32 s20, s17, 19
  s_mul_i32 s21, s17, 917504
  s_mul_i32 s25, s36, 14336
  s_mul_i32 s27, s35, 7168
  s_add_u32 s25, s25, s27
  s_mul_i32 s39, s18, 224
  s_mul_i32 s27, s36, 229376
  s_add_u32 s39, s39, s27
  v_mov_b32 v40, v12
  v_mul_u32_u24 v41, 4682, v40
  v_lshrrev_b32 v41, 16, v41
  v_mul_u32_u24 v42, 14, v41
  v_sub_u32 v42, v40, v42
  v_bfe_u32 v43, v41, 2, 2
  v_lshrrev_b32 v44, 4, v41
  v_lshl_add_u32 v43, v43, 1, v44
  v_and_b32 v44, 3, v41
  v_lshl_add_u32 v43, v43, 2, v44
  v_mul_u32_u24 v43, 7168, v43
  v_lshl_add_u32 v43, v42, 4, v43
  v_add_u32 v2, s39, v43
  v_add_u32 v40, 64, v12
  v_mul_u32_u24 v41, 4682, v40
  v_lshrrev_b32 v41, 16, v41
  v_mul_u32_u24 v42, 14, v41
  v_sub_u32 v42, v40, v42
  v_bfe_u32 v43, v41, 2, 2
  v_lshrrev_b32 v44, 4, v41
  v_lshl_add_u32 v43, v43, 1, v44
  v_and_b32 v44, 3, v41
  v_lshl_add_u32 v43, v43, 2, v44
  v_mul_u32_u24 v43, 7168, v43
  v_lshl_add_u32 v43, v42, 4, v43
  v_subrev_u32 v43, 1024, v43
  v_add_u32 v3, s39, v43
  v_add_u32 v40, 128, v12
  v_mul_u32_u24 v41, 4682, v40
  v_lshrrev_b32 v41, 16, v41
  v_mul_u32_u24 v42, 14, v41
  v_sub_u32 v42, v40, v42
  v_bfe_u32 v43, v41, 2, 2
  v_lshrrev_b32 v44, 4, v41
  v_lshl_add_u32 v43, v43, 1, v44
  v_and_b32 v44, 3, v41
  v_lshl_add_u32 v43, v43, 2, v44
  v_mul_u32_u24 v43, 7168, v43
  v_lshl_add_u32 v43, v42, 4, v43
  v_subrev_u32 v43, 2048, v43
  v_add_u32 v4, s39, v43
  v_add_u32 v40, 192, v12
  v_mul_u32_u24 v41, 4682, v40
  v_lshrrev_b32 v41, 16, v41
  v_mul_u32_u24 v42, 14, v41
  v_sub_u32 v42, v40, v42
  v_bfe_u32 v43, v41, 2, 2
  v_lshrrev_b32 v44, 4, v41
  v_lshl_add_u32 v43, v43, 1, v44
  v_and_b32 v44, 3, v41
  v_lshl_add_u32 v43, v43, 2, v44
  v_mul_u32_u24 v43, 7168, v43
  v_lshl_add_u32 v43, v42, 4, v43
  v_subrev_u32 v43, 3072, v43
  v_add_u32 v5, s39, v43
  v_add_u32 v40, 256, v12
  v_mul_u32_u24 v41, 4682, v40
  v_lshrrev_b32 v41, 16, v41
  v_mul_u32_u24 v42, 14, v41
  v_sub_u32 v42, v40, v42
  v_bfe_u32 v43, v41, 2, 2
  v_lshrrev_b32 v44, 4, v41
  v_lshl_add_u32 v43, v43, 1, v44
  v_and_b32 v44, 3, v41
  v_lshl_add_u32 v43, v43, 2, v44
  v_mul_u32_u24 v43, 7168, v43
  v_lshl_add_u32 v43, v42, 4, v43
  v_add_u32 v6, s39, v43
  v_add_u32 v40, 320, v12
  v_mul_u32_u24 v41, 4682, v40
  v_lshrrev_b32 v41, 16, v41
  v_mul_u32_u24 v42, 14, v41
  v_sub_u32 v42, v40, v42
  v_bfe_u32 v43, v41, 2, 2
  v_lshrrev_b32 v44, 4, v41
  v_lshl_add_u32 v43, v43, 1, v44
  v_and_b32 v44, 3, v41
  v_lshl_add_u32 v43, v43, 2, v44
  v_mul_u32_u24 v43, 7168, v43
  v_lshl_add_u32 v43, v42, 4, v43
  v_subrev_u32 v43, 1024, v43
  v_add_u32 v7, s39, v43
  v_add_u32 v40, 384, v12
  v_mul_u32_u24 v41, 4682, v40
  v_lshrrev_b32 v41, 16, v41
  v_mul_u32_u24 v42, 14, v41
  v_sub_u32 v42, v40, v42
  v_bfe_u32 v43, v41, 2, 2
  v_lshrrev_b32 v44, 4, v41
  v_lshl_add_u32 v43, v43, 1, v44
  v_and_b32 v44, 3, v41
  v_lshl_add_u32 v43, v43, 2, v44
  v_mul_u32_u24 v43, 7168, v43
  v_lshl_add_u32 v43, v42, 4, v43
  v_subrev_u32 v43, 2048, v43
  v_add_u32 v8, s39, v43
  v_lshrrev_b32 v40, 2, v12
  v_mul_u32_u24 v9, 224, v40
  v_and_b32 v41, 3, v12
  v_lshl_add_u32 v9, v41, 3, v9
  v_add_u32 v10, 57344, v9
  v_add_u32 v11, 114688, v9
  v_mov_b32 v40, 0x3f803f80
  v_accvgpr_write_b32 a208, v40
  v_accvgpr_write_b32 a209, v40
  v_accvgpr_write_b32 a210, v40
  v_accvgpr_write_b32 a211, v40
  s_waitcnt lgkmcnt(0)
  s_add_u32 s4, s32, 0x100000
  s_addc_u32 s5, s33, 0
  s_mov_b32 s6, 0x400000
  s_mov_b32 s7, 0x20000
  s_cmp_eq_u32 s35, 0
  s_cselect_b32 s8, s28, s30
  s_cselect_b32 s9, s29, s31
  s_mov_b32 s10, 0x700000
  s_mov_b32 s11, 0x20000
  s_add_u32 m0, s25, 0
  s_nop 0
  buffer_load_dwordx4 v2, s[8:11], s21 offen offset:0  lds
  buffer_load_dwordx4 v3, s[8:11], s21 offen offset:1024  lds
  buffer_load_dwordx4 v4, s[8:11], s21 offen offset:2048  lds
  buffer_load_dwordx4 v5, s[8:11], s21 offen offset:3072  lds
  s_add_u32 m0, s25, 4096
  s_nop 0
  buffer_load_dwordx4 v6, s[8:11], s21 offen offset:0  lds
  buffer_load_dwordx4 v7, s[8:11], s21 offen offset:1024  lds
  buffer_load_dwordx4 v8, s[8:11], s21 offen offset:2048  lds
  s_add_u32 s21, s21, 458752
  buffer_load_dwordx4 a[112:115], v1, s[4:7], s20 offen offset:0
  buffer_load_dwordx4 a[116:119], v1, s[4:7], s20 offen offset:256
  buffer_load_dwordx4 a[120:123], v1, s[4:7], s20 offen offset:512
  buffer_load_dwordx4 a[124:127], v1, s[4:7], s20 offen offset:768
  s_add_u32 s20, s20, 0x20000
  buffer_load_dwordx4 a[128:131], v1, s[4:7], s20 offen offset:0
  buffer_load_dwordx4 a[132:135], v1, s[4:7], s20 offen offset:256
  buffer_load_dwordx4 a[136:139], v1, s[4:7], s20 offen offset:512
  buffer_load_dwordx4 a[140:143], v1, s[4:7], s20 offen offset:768
  s_add_u32 s20, s20, 0x20000
  s_add_u32 m0, s25, 28672
  s_nop 0
  buffer_load_dwordx4 v2, s[8:11], s21 offen offset:0  lds
  buffer_load_dwordx4 v3, s[8:11], s21 offen offset:1024  lds
  buffer_load_dwordx4 v4, s[8:11], s21 offen offset:2048  lds
  buffer_load_dwordx4 v5, s[8:11], s21 offen offset:3072  lds
  s_add_u32 m0, s25, 32768
  s_nop 0
  buffer_load_dwordx4 v6, s[8:11], s21 offen offset:0  lds
  buffer_load_dwordx4 v7, s[8:11], s21 offen offset:1024  lds
  buffer_load_dwordx4 v8, s[8:11], s21 offen offset:2048  lds
  s_add_u32 s21, s21, 458752
  s_cmp_eq_u32 s21, 7340032
  s_cselect_b32 s21, 0, s21
  buffer_load_dwordx4 v[16:19], v13, s[4:7], s53 offen
  s_add_u32 s53, s53, 0x100000
  buffer_load_dwordx4 v[20:23], v13, s[4:7], s53 offen
  s_add_u32 s53, s53, 0x100000
  buffer_load_dwordx4 v[24:27], v13, s[4:7], s53 offen
  s_add_u32 s53, s53, 0x100000
  buffer_load_dwordx4 v[28:31], v13, s[4:7], s53 offen
  s_add_u32 s12, s32, 0x1000000
  s_addc_u32 s13, s33, 0
  s_mov_b32 s14, 0xe00000
  s_mov_b32 s15, 0x20000
  s_mov_b32 s40, s32
  s_mov_b32 s41, s33
  s_mov_b32 s42, 0x3000000
  s_mov_b32 s43, 0x20000
  s_lshl_b32 s54, s37, 6
  s_add_u32 s54, s54, 245760
  s_and_b32 s22, s17, 3
  s_getpc_b64 s[48:49]
g1_pc:
  s_lshr_b32 s50, s2, 3
  s_lshl_b32 s50, s50, 2
  s_add_u32 s50, s50, s16
  s_lshl_b32 s50, s50, 7
  s_waitcnt vmcnt(19)
  s_barrier
  ds_read_b64_tr_b16 a[0:1], v9 offset:0
  ds_read_b64_tr_b16 a[2:3], v9 offset:3584
  ds_read_b64_tr_b16 a[4:5], v9 offset:7168
  ds_read_b64_tr_b16 a[6:7], v9 offset:10752
  ds_read_b64_tr_b16 a[8:9], v9 offset:32
  ds_read_b64_tr_b16 a[10:11], v9 offset:3616
  ds_read_b64_tr_b16 a[12:13], v9 offset:7200
  ds_read_b64_tr_b16 a[14:15], v9 offset:10784
  ds_read_b64_tr_b16 a[16:17], v9 offset:64
  ds_read_b64_tr_b16 a[18:19], v9 offset:3648
  ds_read_b64_tr_b16 a[20:21], v9 offset:7232
  ds_read_b64_tr_b16 a[22:23], v9 offset:10816
  ds_read_b64_tr_b16 a[24:25], v9 offset:96
  ds_read_b64_tr_b16 a[26:27], v9 offset:3680
  ds_read_b64_tr_b16 a[28:29], v9 offset:7264
  ds_read_b64_tr_b16 a[30:31], v9 offset:10848
  ds_read_b64_tr_b16 a[32:33], v9 offset:128
  ds_read_b64_tr_b16 a[34:35], v9 offset:3712
  ds_read_b64_tr_b16 a[36:37], v9 offset:7296
  ds_read_b64_tr_b16 a[38:39], v9 offset:10880
  ds_read_b64_tr_b16 a[40:41], v9 offset:160
  ds_read_b64_tr_b16 a[42:43], v9 offset:3744
  ds_read_b64_tr_b16 a[44:45], v9 offset:7328
  ds_read_b64_tr_b16 a[46:47], v9 offset:10912
  ds_read_b64_tr_b16 a[48:49], v9 offset:192
  ds_read_b64_tr_b16 a[50:51], v9 offset:3776
  ds_read_b64_tr_b16 a[52:53], v9 offset:7360
  ds_read_b64_tr_b16 a[54:55], v9 offset:10944
g1_s0:
  s_waitcnt vmcnt(15) lgkmcnt(0)
  v_mfma_f32_16x16x32_bf16 v[32:35], a[0:3], a[112:115], 0
  ds_read_b64_tr_b16 a[56:57], v9 offset:14336
  v_mfma_f32_16x16x32_bf16 v[36:39], a[0:3], a[116:119], 0
  ds_read_b64_tr_b16 a[58:59], v9 offset:17920
  v_mfma_f32_16x16x32_bf16 v[40:43], a[0:3], a[120:123], 0
  buffer_load_dwordx4 a[144:147], v1, s[4:7], s20 offen offset:0
  v_mfma_f32_16x16x32_bf16 v[44:47], a[0:3], a[124:127], 0
  ds_read_b64_tr_b16 a[60:61], v9 offset:21504
  v_mfma_f32_16x16x32_bf16 v[60:63], a[4:7], a[124:127], 0
  s_add_u32 m0, s25, 57344
  v_mfma_f32_16x16x32_bf16 v[56:59], a[4:7], a[120:123], 0
  ds_read_b64_tr_b16 a[62:63], v9 offset:25088
  v_mfma_f32_16x16x32_bf16 v[52:55], a[4:7], a[116:119], 0
  buffer_load_dwordx4 v2, s[8:11], s21 offen offset:0  lds
  v_mfma_f32_16x16x32_bf16 v[48:51], a[4:7], a[112:115], 0
  ds_read_b64_tr_b16 a[64:65], v9 offset:14368
  v_mfma_f32_16x16x32_bf16 v[64:67], a[8:11], a[112:115], 0
  ds_read_b64_tr_b16 a[66:67], v9 offset:17952
  v_mfma_f32_16x16x32_bf16 v[68:71], a[8:11], a[116:119], 0
  buffer_load_dwordx4 a[148:151], v1, s[4:7], s20 offen offset:256
  v_mfma_f32_16x16x32_bf16 v[72:75], a[8:11], a[120:123], 0
  ds_read_b64_tr_b16 a[68:69], v9 offset:21536
  v_mfma_f32_16x16x32_bf16 v[76:79], a[8:11], a[124:127], 0
  ds_read_b64_tr_b16 a[70:71], v9 offset:25120
  v_mfma_f32_16x16x32_bf16 v[92:95], a[12:15], a[124:127], 0
  ds_read_b64_tr_b16 a[72:73], v9 offset:14400
  v_mfma_f32_16x16x32_bf16 v[88:91], a[12:15], a[120:123], 0
  buffer_load_dwordx4 v3, s[8:11], s21 offen offset:1024  lds
  v_mfma_f32_16x16x32_bf16 v[84:87], a[12:15], a[116:119], 0
  ds_read_b64_tr_b16 a[74:75], v9 offset:17984
  v_mfma_f32_16x16x32_bf16 v[80:83], a[12:15], a[112:115], 0
  ds_read_b64_tr_b16 a[76:77], v9 offset:21568
  v_mfma_f32_16x16x32_bf16 v[96:99], a[16:19], a[112:115], 0
  ds_read_b64_tr_b16 a[78:79], v9 offset:25152
  v_mfma_f32_16x16x32_bf16 v[100:103], a[16:19], a[116:119], 0
  buffer_load_dwordx4 a[152:155], v1, s[4:7], s20 offen offset:512
  v_mfma_f32_16x16x32_bf16 v[104:107], a[16:19], a[120:123], 0
  ds_read_b64_tr_b16 a[80:81], v9 offset:14432
  v_mfma_f32_16x16x32_bf16 v[108:111], a[16:19], a[124:127], 0
  ds_read_b64_tr_b16 a[82:83], v9 offset:18016
  v_mfma_f32_16x16x32_bf16 v[124:127], a[20:23], a[124:127], 0
  buffer_load_dwordx4 v4, s[8:11], s21 offen offset:2048  lds
  v_mfma_f32_16x16x32_bf16 v[120:123], a[20:23], a[120:123], 0
  ds_read_b64_tr_b16 a[84:85], v9 offset:21600
  v_mfma_f32_16x16x32_bf16 v[116:119], a[20:23], a[116:119], 0
  ds_read_b64_tr_b16 a[86:87], v9 offset:25184
  v_mfma_f32_16x16x32_bf16 v[112:115], a[20:23], a[112:115], 0
  ds_read_b64_tr_b16 a[88:89], v9 offset:14464
  v_mfma_f32_16x16x32_bf16 v[128:131], a[24:27], a[112:115], 0
  buffer_load_dwordx4 a[156:159], v1, s[4:7], s20 offen offset:768
  v_mfma_f32_16x16x32_bf16 v[132:135], a[24:27], a[116:119], 0
  s_add_u32 s20, s20, 0x20000
  v_mfma_f32_16x16x32_bf16 v[136:139], a[24:27], a[120:123], 0
  ds_read_b64_tr_b16 a[90:91], v9 offset:18048
  v_mfma_f32_16x16x32_bf16 v[140:143], a[24:27], a[124:127], 0
  ds_read_b64_tr_b16 a[92:93], v9 offset:21632
  v_mfma_f32_16x16x32_bf16 v[156:159], a[28:31], a[124:127], 0
  ds_read_b64_tr_b16 a[94:95], v9 offset:25216
  v_mfma_f32_16x16x32_bf16 v[152:155], a[28:31], a[120:123], 0
  buffer_load_dwordx4 v5, s[8:11], s21 offen offset:3072  lds
  v_mfma_f32_16x16x32_bf16 v[148:151], a[28:31], a[116:119], 0
  ds_read_b64_tr_b16 a[96:97], v9 offset:14496
  v_mfma_f32_16x16x32_bf16 v[144:147], a[28:31], a[112:115], 0
  ds_read_b64_tr_b16 a[98:99], v9 offset:18080
  v_mfma_f32_16x16x32_bf16 v[160:163], a[32:35], a[112:115], 0
  buffer_load_dwordx4 a[160:163], v1, s[4:7], s20 offen offset:0
  v_mfma_f32_16x16x32_bf16 v[164:167], a[32:35], a[116:119], 0
  ds_read_b64_tr_b16 a[100:101], v9 offset:21664
  v_mfma_f32_16x16x32_bf16 v[168:171], a[32:35], a[120:123], 0
  ds_read_b64_tr_b16 a[102:103], v9 offset:25248
  v_mfma_f32_16x16x32_bf16 v[172:175], a[32:35], a[124:127], 0
  s_add_u32 m0, s25, 61440
  v_mfma_f32_16x16x32_bf16 v[188:191], a[36:39], a[124:127], 0
  ds_read_b64_tr_b16 a[104:105], v9 offset:14528
  v_mfma_f32_16x16x32_bf16 v[184:187], a[36:39], a[120:123], 0
  buffer_load_dwordx4 v6, s[8:11], s21 offen offset:0  lds
  v_mfma_f32_16x16x32_bf16 v[180:183], a[36:39], a[116:119], 0
  ds_read_b64_tr_b16 a[106:107], v9 offset:18112
  v_mfma_f32_16x16x32_bf16 v[176:179], a[36:39], a[112:115], 0
  ds_read_b64_tr_b16 a[108:109], v9 offset:21696
  v_mfma_f32_16x16x32_bf16 v[192:195], a[40:43], a[112:115], 0
  buffer_load_dwordx4 a[164:167], v1, s[4:7], s20 offen offset:256
  v_mfma_f32_16x16x32_bf16 v[196:199], a[40:43], a[116:119], 0
  ds_read_b64_tr_b16 a[110:111], v9 offset:25280
  v_mfma_f32_16x16x32_bf16 v[200:203], a[40:43], a[120:123], 0
  buffer_load_dwordx4 v7, s[8:11], s21 offen offset:1024  lds
  v_mfma_f32_16x16x32_bf16 v[204:207], a[40:43], a[124:127], 0
  s_add_u32 s51, s50, g1_s2 - g1_pc
  v_mfma_f32_16x16x32_bf16 v[220:223], a[44:47], a[124:127], 0
  s_min_u32 s51, s51, code_end - g1_pc - 4
  v_mfma_f32_16x16x32_bf16 v[216:219], a[44:47], a[120:123], 0
  v_mov_b32 v14, s51
  v_mfma_f32_16x16x32_bf16 v[212:215], a[44:47], a[116:119], 0
  s_cmp_lg_u32 s16, 0
  s_cbranch_scc1 g1_cs0_0
  v_mfma_f32_16x16x32_bf16 a[192:195], a[0:3], a[208:211], 0
  v_mfma_f32_16x16x32_bf16 a[196:199], a[16:19], a[208:211], 0
  v_mfma_f32_16x16x32_bf16 a[200:203], a[32:35], a[208:211], 0
  v_mfma_f32_16x16x32_bf16 a[204:207], a[48:51], a[208:211], 0
  s_branch g1_cs0_e
g1_cs0_0:
  s_cmp_lg_u32 s16, 1
  s_cbranch_scc1 g1_cs0_1
  v_mfma_f32_16x16x32_bf16 a[192:195], a[4:7], a[208:211], 0
  v_mfma_f32_16x16x32_bf16 a[196:199], a[20:23], a[208:211], 0
  v_mfma_f32_16x16x32_bf16 a[200:203], a[36:39], a[208:211], 0
  v_mfma_f32_16x16x32_bf16 a[204:207], a[52:55], a[208:211], 0
  s_branch g1_cs0_e
g1_cs0_1:
  s_cmp_lg_u32 s16, 2
  s_cbranch_scc1 g1_cs0_2
  v_mfma_f32_16x16x32_bf16 a[192:195], a[8:11], a[208:211], 0
  v_mfma_f32_16x16x32_bf16 a[196:199], a[24:27], a[208:211], 0
  v_mfma_f32_16x16x32_bf16 a[200:203], a[40:43], a[208:211], 0
  s_branch g1_cs0_e
g1_cs0_2:
  v_mfma_f32_16x16x32_bf16 a[192:195], a[12:15], a[208:211], 0
  v_mfma_f32_16x16x32_bf16 a[196:199], a[28:31], a[208:211], 0
  v_mfma_f32_16x16x32_bf16 a[200:203], a[44:47], a[208:211], 0
g1_cs0_e:
  v_mfma_f32_16x16x32_bf16 v[208:211], a[44:47], a[112:115], 0
  v_mfma_f32_16x16x32_bf16 v[224:227], a[48:51], a[112:115], 0
  global_load_dword a212, v14, s[48:49]
  v_mfma_f32_16x16x32_bf16 v[228:231], a[48:51], a[116:119], 0
  v_mfma_f32_16x16x32_bf16 v[232:235], a[48:51], a[120:123], 0
  v_mfma_f32_16x16x32_bf16 v[236:239], a[48:51], a[124:127], 0
  v_mfma_f32_16x16x32_bf16 v[252:255], a[52:55], a[124:127], 0
  v_mfma_f32_16x16x32_bf16 v[248:251], a[52:55], a[120:123], 0
  v_mfma_f32_16x16x32_bf16 v[244:247], a[52:55], a[116:119], 0
  v_mfma_f32_16x16x32_bf16 v[240:243], a[52:55], a[112:115], 0
g1_s1:
  s_waitcnt vmcnt(17) lgkmcnt(0)
  v_mfma_f32_16x16x32_bf16 v[32:35], a[56:59], a[128:131], v[32:35]
  s_barrier
  ds_read_b64_tr_b16 a[0:1], v9 offset:28672
  v_mfma_f32_16x16x32_bf16 v[36:39], a[56:59], a[132:135], v[36:39]
  s_waitcnt vmcnt(13)
  ds_read_b64_tr_b16 a[2:3], v9 offset:32256
  v_mfma_f32_16x16x32_bf16 v[40:43], a[56:59], a[136:139], v[40:43]
  buffer_load_dwordx4 a[168:171], v1, s[4:7], s20 offen offset:512
  v_mov_b32 v13, 0
  v_mfma_f32_16x16x32_bf16 v[44:47], a[56:59], a[140:143], v[44:47]
  v_mov_b32 v14, 0
  ds_read_b64_tr_b16 a[4:5], v9 offset:35840
  v_mfma_f32_16x16x32_bf16 v[60:63], a[60:63], a[140:143], v[60:63]
  v_lshlrev_b32 v15, 16, v16
  v_and_b32 v16, 0xffff0000, v16
  v_mfma_f32_16x16x32_bf16 v[56:59], a[60:63], a[136:139], v[56:59]
  ds_read_b64_tr_b16 a[6:7], v9 offset:39424
  v_mfma_f32_16x16x32_bf16 v[52:55], a[60:63], a[132:135], v[52:55]
  buffer_load_dwordx4 v8, s[8:11], s21 offen offset:2048  lds
  s_add_u32 s21, s21, 458752
  v_mfma_f32_16x16x32_bf16 v[48:51], a[60:63], a[128:131], v[48:51]
  v_add_f32 v13, v13, v15
  ds_read_b64_tr_b16 a[8:9], v9 offset:28704
  v_mfma_f32_16x16x32_bf16 v[64:67], a[64:67], a[128:131], v[64:67]
  v_fmac_f32 v14, v15, v15
  v_add_f32 v13, v13, v16
  v_mfma_f32_16x16x32_bf16 v[68:71], a[64:67], a[132:135], v[68:71]
  ds_read_b64_tr_b16 a[10:11], v9 offset:32288
  v_fmac_f32 v14, v16, v16
  v_mfma_f32_16x16x32_bf16 v[72:75], a[64:67], a[136:139], v[72:75]
  buffer_load_dwordx4 a[172:175], v1, s[4:7], s20 offen offset:768
  s_add_u32 s20, s20, 0x20000
  v_mfma_f32_16x16x32_bf16 v[76:79], a[64:67], a[140:143], v[76:79]
  s_and_b32 s20, s20, 0x3fffff
  v_mfma_f32_16x16x32_bf16 v[92:95], a[68:71], a[140:143], v[92:95]
  v_lshlrev_b32 v15, 16, v17
  ds_read_b64_tr_b16 a[12:13], v9 offset:35872
  v_mfma_f32_16x16x32_bf16 v[88:91], a[68:71], a[136:139], v[88:91]
  v_and_b32 v17, 0xffff0000, v17
  ds_read_b64_tr_b16 a[14:15], v9 offset:39456
  v_mfma_f32_16x16x32_bf16 v[84:87], a[68:71], a[132:135], v[84:87]
  v_add_f32 v13, v13, v15
  v_fmac_f32 v14, v15, v15
  v_mfma_f32_16x16x32_bf16 v[80:83], a[68:71], a[128:131], v[80:83]
  ds_read_b64_tr_b16 a[16:17], v9 offset:28736
  v_add_f32 v13, v13, v17
  v_mfma_f32_16x16x32_bf16 v[96:99], a[72:75], a[128:131], v[96:99]
  buffer_load_dwordx4 a[176:179], v1, s[4:7], s20 offen offset:0
  v_fmac_f32 v14, v17, v17
  v_mfma_f32_16x16x32_bf16 v[100:103], a[72:75], a[132:135], v[100:103]
  ds_read_b64_tr_b16 a[18:19], v9 offset:32320
  v_mfma_f32_16x16x32_bf16 v[104:107], a[72:75], a[136:139], v[104:107]
  v_lshlrev_b32 v15, 16, v18
  ds_read_b64_tr_b16 a[20:21], v9 offset:35904
  v_mfma_f32_16x16x32_bf16 v[108:111], a[72:75], a[140:143], v[108:111]
  v_and_b32 v18, 0xffff0000, v18
  s_add_u32 m0, s25, 86016
  v_mfma_f32_16x16x32_bf16 v[124:127], a[76:79], a[140:143], v[124:127]
  v_add_f32 v13, v13, v15
  ds_read_b64_tr_b16 a[22:23], v9 offset:39488
  v_mfma_f32_16x16x32_bf16 v[120:123], a[76:79], a[136:139], v[120:123]
  buffer_load_dwordx4 v2, s[8:11], s21 offen offset:0  lds
  v_fmac_f32 v14, v15, v15
  v_mfma_f32_16x16x32_bf16 v[116:119], a[76:79], a[132:135], v[116:119]
  v_add_f32 v13, v13, v18
  ds_read_b64_tr_b16 a[24:25], v9 offset:28768
  v_mfma_f32_16x16x32_bf16 v[112:115], a[76:79], a[128:131], v[112:115]
  v_fmac_f32 v14, v18, v18
  v_mfma_f32_16x16x32_bf16 v[128:131], a[80:83], a[128:131], v[128:131]
  ds_read_b64_tr_b16 a[26:27], v9 offset:32352
  v_lshlrev_b32 v15, 16, v19
  v_mfma_f32_16x16x32_bf16 v[132:135], a[80:83], a[132:135], v[132:135]
  buffer_load_dwordx4 a[180:183], v1, s[4:7], s20 offen offset:256
  v_and_b32 v19, 0xffff0000, v19
  v_mfma_f32_16x16x32_bf16 v[136:139], a[80:83], a[136:139], v[136:139]
  ds_read_b64_tr_b16 a[28:29], v9 offset:35936
  v_add_f32 v13, v13, v15
  v_mfma_f32_16x16x32_bf16 v[140:143], a[80:83], a[140:143], v[140:143]
  v_fmac_f32 v14, v15, v15
  ds_read_b64_tr_b16 a[30:31], v9 offset:39520
  v_mfma_f32_16x16x32_bf16 v[156:159], a[84:87], a[140:143], v[156:159]
  v_add_f32 v13, v13, v19
  ds_read_b64_tr_b16 a[32:33], v9 offset:28800
  v_mfma_f32_16x16x32_bf16 v[152:155], a[84:87], a[136:139], v[152:155]
  v_fmac_f32 v14, v19, v19
  v_mfma_f32_16x16x32_bf16 v[148:151], a[84:87], a[132:135], v[148:151]
  buffer_load_dwordx4 v3, s[8:11], s21 offen offset:1024  lds
  v_lshlrev_b32 v15, 16, v20
  v_mfma_f32_16x16x32_bf16 v[144:147], a[84:87], a[128:131], v[144:147]
  ds_read_b64_tr_b16 a[34:35], v9 offset:32384
  v_and_b32 v20, 0xffff0000, v20
  v_mfma_f32_16x16x32_bf16 v[160:163], a[88:91], a[128:131], v[160:163]
  v_add_f32 v13, v13, v15
  ds_read_b64_tr_b16 a[36:37], v9 offset:35968
  v_mfma_f32_16x16x32_bf16 v[164:167], a[88:91], a[132:135], v[164:167]
  v_fmac_f32 v14, v15, v15
  ds_read_b64_tr_b16 a[38:39], v9 offset:39552
  v_mfma_f32_16x16x32_bf16 v[168:171], a[88:91], a[136:139], v[168:171]
  buffer_load_dwordx4 a[184:187], v1, s[4:7], s20 offen offset:512
  v_add_f32 v13, v13, v20
  v_mfma_f32_16x16x32_bf16 v[172:175], a[88:91], a[140:143], v[172:175]
  v_fmac_f32 v14, v20, v20
  v_mfma_f32_16x16x32_bf16 v[188:191], a[92:95], a[140:143], v[188:191]
  ds_read_b64_tr_b16 a[40:41], v9 offset:28832
  v_lshlrev_b32 v15, 16, v21
  v_mfma_f32_16x16x32_bf16 v[184:187], a[92:95], a[136:139], v[184:187]
  v_and_b32 v21, 0xffff0000, v21
  ds_read_b64_tr_b16 a[42:43], v9 offset:32416
  v_mfma_f32_16x16x32_bf16 v[180:183], a[92:95], a[132:135], v[180:183]
  buffer_load_dwordx4 v4, s[8:11], s21 offen offset:2048  lds
  v_add_f32 v13, v13, v15
  v_mfma_f32_16x16x32_bf16 v[176:179], a[92:95], a[128:131], v[176:179]
  ds_read_b64_tr_b16 a[44:45], v9 offset:36000
  v_fmac_f32 v14, v15, v15
  v_mfma_f32_16x16x32_bf16 v[192:195], a[96:99], a[128:131], v[192:195]
  v_add_f32 v13, v13, v21
  ds_read_b64_tr_b16 a[46:47], v9 offset:39584
  v_mfma_f32_16x16x32_bf16 v[196:199], a[96:99], a[132:135], v[196:199]
  v_fmac_f32 v14, v21, v21
  v_mfma_f32_16x16x32_bf16 v[200:203], a[96:99], a[136:139], v[200:203]
  v_lshlrev_b32 v15, 16, v22
  ds_read_b64_tr_b16 a[48:49], v9 offset:28864
  v_mfma_f32_16x16x32_bf16 v[204:207], a[96:99], a[140:143], v[204:207]
  buffer_load_dwordx4 a[188:191], v1, s[4:7], s20 offen offset:768
  s_add_u32 s20, s20, 0x20000
  v_mfma_f32_16x16x32_bf16 v[220:223], a[100:103], a[140:143], v[220:223]
  v_and_b32 v22, 0xffff0000, v22
  ds_read_b64_tr_b16 a[50:51], v9 offset:32448
  v_mfma_f32_16x16x32_bf16 v[216:219], a[100:103], a[136:139], v[216:219]
  v_add_f32 v13, v13, v15
  v_fmac_f32 v14, v15, v15
  v_mfma_f32_16x16x32_bf16 v[212:215], a[100:103], a[132:135], v[212:215]
  ds_read_b64_tr_b16 a[52:53], v9 offset:36032
  v_add_f32 v13, v13, v22
  v_mfma_f32_16x16x32_bf16 v[208:211], a[100:103], a[128:131], v[208:211]
  buffer_load_dwordx4 v5, s[8:11], s21 offen offset:3072  lds
  v_mfma_f32_16x16x32_bf16 v[224:227], a[104:107], a[128:131], v[224:227]
  v_fmac_f32 v14, v22, v22
  ds_read_b64_tr_b16 a[54:55], v9 offset:39616
  v_mfma_f32_16x16x32_bf16 v[228:231], a[104:107], a[132:135], v[228:231]
  v_lshlrev_b32 v15, 16, v23
  v_and_b32 v23, 0xffff0000, v23
  v_mfma_f32_16x16x32_bf16 v[232:235], a[104:107], a[136:139], v[232:235]
  v_add_f32 v13, v13, v15
  buffer_load_dwordx4 a[112:115], v1, s[4:7], s20 offen offset:0
  v_mfma_f32_16x16x32_bf16 v[236:239], a[104:107], a[140:143], v[236:239]
  v_fmac_f32 v14, v15, v15
  v_add_f32 v13, v13, v23
  v_mfma_f32_16x16x32_bf16 v[252:255], a[108:111], a[140:143], v[252:255]
  v_fmac_f32 v14, v23, v23
  s_cmp_lg_u32 s16, 0
  s_cbranch_scc1 g1_cs1_0
  v_mfma_f32_16x16x32_bf16 a[192:195], a[56:59], a[208:211], a[192:195]
  v_mfma_f32_16x16x32_bf16 a[196:199], a[72:75], a[208:211], a[196:199]
  v_mfma_f32_16x16x32_bf16 a[200:203], a[88:91], a[208:211], a[200:203]
  v_mfma_f32_16x16x32_bf16 a[204:207], a[104:107], a[208:211], a[204:207]
  s_branch g1_cs1_e
g1_cs1_0:
  s_cmp_lg_u32 s16, 1
  s_cbranch_scc1 g1_cs1_1
  v_mfma_f32_16x16x32_bf16 a[192:195], a[60:63], a[208:211], a[192:195]
  v_mfma_f32_16x16x32_bf16 a[196:199], a[76:79], a[208:211], a[196:199]
  v_mfma_f32_16x16x32_bf16 a[200:203], a[92:95], a[208:211], a[200:203]
  v_mfma_f32_16x16x32_bf16 a[204:207], a[108:111], a[208:211], a[204:207]
  s_branch g1_cs1_e
g1_cs1_1:
  s_cmp_lg_u32 s16, 2
  s_cbranch_scc1 g1_cs1_2
  v_mfma_f32_16x16x32_bf16 a[192:195], a[64:67], a[208:211], a[192:195]
  v_mfma_f32_16x16x32_bf16 a[196:199], a[80:83], a[208:211], a[196:199]
  v_mfma_f32_16x16x32_bf16 a[200:203], a[96:99], a[208:211], a[200:203]
  s_branch g1_cs1_e
g1_cs1_2:
  v_mfma_f32_16x16x32_bf16 a[192:195], a[68:71], a[208:211], a[192:195]
  v_mfma_f32_16x16x32_bf16 a[196:199], a[84:87], a[208:211], a[196:199]
  v_mfma_f32_16x16x32_bf16 a[200:203], a[100:103], a[208:211], a[200:203]
g1_cs1_e:
  v_mfma_f32_16x16x32_bf16 v[248:251], a[108:111], a[136:139], v[248:251]
  v_mfma_f32_16x16x32_bf16 v[244:247], a[108:111], a[132:135], v[244:247]
  v_mfma_f32_16x16x32_bf16 v[240:243], a[108:111], a[128:131], v[240:243]
g1_s2:
  s_waitcnt vmcnt(18) lgkmcnt(0)
  v_mfma_f32_16x16x32_bf16 v[32:35], a[0:3], a[144:147], v[32:35]
  ds_read_b64_tr_b16 a[56:57], v9 offset:43008
  s_add_u32 m0, s25, 90112
  v_mfma_f32_16x16x32_bf16 v[36:39], a[0:3], a[148:151], v[36:39]
  v_lshlrev_b32 v15, 16, v24
  ds_read_b64_tr_b16 a[58:59], v9 offset:46592
  v_mfma_f32_16x16x32_bf16 v[40:43], a[0:3], a[152:155], v[40:43]
  buffer_load_dwordx4 v6, s[8:11], s21 offen offset:0  lds
  v_and_b32 v24, 0xffff0000, v24
  v_mfma_f32_16x16x32_bf16 v[44:47], a[0:3], a[156:159], v[44:47]
  v_add_f32 v13, v13, v15
  ds_read_b64_tr_b16 a[60:61], v9 offset:50176
  v_mfma_f32_16x16x32_bf16 v[60:63], a[4:7], a[156:159], v[60:63]
  v_fmac_f32 v14, v15, v15
  v_mfma_f32_16x16x32_bf16 v[56:59], a[4:7], a[152:155], v[56:59]
  v_add_f32 v13, v13, v24
  ds_read_b64_tr_b16 a[62:63], v9 offset:53760
  v_mfma_f32_16x16x32_bf16 v[52:55], a[4:7], a[148:151], v[52:55]
  buffer_load_dwordx4 a[116:119], v1, s[4:7], s20 offen offset:256
  v_fmac_f32 v14, v24, v24
  v_mfma_f32_16x16x32_bf16 v[48:51], a[4:7], a[144:147], v[48:51]
  ds_read_b64_tr_b16 a[64:65], v9 offset:43040
  v_lshlrev_b32 v15, 16, v25
  v_mfma_f32_16x16x32_bf16 v[64:67], a[8:11], a[144:147], v[64:67]
  v_and_b32 v25, 0xffff0000, v25
  v_mfma_f32_16x16x32_bf16 v[68:71], a[8:11], a[148:151], v[68:71]
  ds_read_b64_tr_b16 a[66:67], v9 offset:46624
  v_add_f32 v13, v13, v15
  v_mfma_f32_16x16x32_bf16 v[72:75], a[8:11], a[152:155], v[72:75]
  buffer_load_dwordx4 v7, s[8:11], s21 offen offset:1024  lds
  v_fmac_f32 v14, v15, v15
  v_mfma_f32_16x16x32_bf16 v[76:79], a[8:11], a[156:159], v[76:79]
  ds_read_b64_tr_b16 a[68:69], v9 offset:50208
  v_add_f32 v13, v13, v25
  v_mfma_f32_16x16x32_bf16 v[92:95], a[12:15], a[156:159], v[92:95]
  ds_read_b64_tr_b16 a[70:71], v9 offset:53792
  v_fmac_f32 v14, v25, v25
  v_mfma_f32_16x16x32_bf16 v[88:91], a[12:15], a[152:155], v[88:91]
  v_lshlrev_b32 v15, 16, v26
  v_mfma_f32_16x16x32_bf16 v[84:87], a[12:15], a[148:151], v[84:87]
  ds_read_b64_tr_b16 a[72:73], v9 offset:43072
  v_and_b32 v26, 0xffff0000, v26
  v_mfma_f32_16x16x32_bf16 v[80:83], a[12:15], a[144:147], v[80:83]
  buffer_load_dwordx4 a[120:123], v1, s[4:7], s20 offen offset:512
  v_add_f32 v13, v13, v15
  v_mfma_f32_16x16x32_bf16 v[96:99], a[16:19], a[144:147], v[96:99]
  ds_read_b64_tr_b16 a[74:75], v9 offset:46656
  v_fmac_f32 v14, v15, v15
  v_mfma_f32_16x16x32_bf16 v[100:103], a[16:19], a[148:151], v[100:103]
  ds_read_b64_tr_b16 a[76:77], v9 offset:50240
  v_mfma_f32_16x16x32_bf16 v[104:107], a[16:19], a[152:155], v[104:107]
  v_add_f32 v13, v13, v26
  v_fmac_f32 v14, v26, v26
  v_mfma_f32_16x16x32_bf16 v[108:111], a[16:19], a[156:159], v[108:111]
  ds_read_b64_tr_b16 a[78:79], v9 offset:53824
  buffer_load_dwordx4 v8, s[8:11], s21 offen offset:2048  lds
  v_mfma_f32_16x16x32_bf16 v[124:127], a[20:23], a[156:159], v[124:127]
  s_add_u32 s21, s21, 458752
  s_cmp_eq_u32 s21, 7340032
  s_cselect_b32 s21, 0, s21
  v_mfma_f32_16x16x32_bf16 v[120:123], a[20:23], a[152:155], v[120:123]
  v_lshlrev_b32 v15, 16, v27
  v_mfma_f32_16x16x32_bf16 v[116:119], a[20:23], a[148:151], v[116:119]
  v_and_b32 v27, 0xffff0000, v27
  v_mfma_f32_16x16x32_bf16 v[112:115], a[20:23], a[144:147], v[112:115]
  ds_read_b64_tr_b16 a[80:81], v9 offset:43104
  v_add_f32 v13, v13, v15
  v_mfma_f32_16x16x32_bf16 v[128:131], a[24:27], a[144:147], v[128:131]
  ds_read_b64_tr_b16 a[82:83], v9 offset:46688
  v_fmac_f32 v14, v15, v15
  v_mfma_f32_16x16x32_bf16 v[132:135], a[24:27], a[148:151], v[132:135]
  buffer_load_dwordx4 a[124:127], v1, s[4:7], s20 offen offset:768
  s_add_u32 s20, s20, 0x20000
  v_mfma_f32_16x16x32_bf16 v[136:139], a[24:27], a[152:155], v[136:139]
  v_add_f32 v13, v13, v27
  v_mfma_f32_16x16x32_bf16 v[140:143], a[24:27], a[156:159], v[140:143]
  ds_read_b64_tr_b16 a[84:85], v9 offset:50272
  v_fmac_f32 v14, v27, v27
  v_mfma_f32_16x16x32_bf16 v[156:159], a[28:31], a[156:159], v[156:159]
  v_lshlrev_b32 v15, 16, v28
  ds_read_b64_tr_b16 a[86:87], v9 offset:53856
  v_mfma_f32_16x16x32_bf16 v[152:155], a[28:31], a[152:155], v[152:155]
  v_and_b32 v28, 0xffff0000, v28
  ds_read_b64_tr_b16 a[88:89], v9 offset:43136
  v_mfma_f32_16x16x32_bf16 v[148:151], a[28:31], a[148:151], v[148:151]
  v_add_f32 v13, v13, v15
  buffer_load_dwordx4 a[128:131], v1, s[4:7], s20 offen offset:0
  v_mfma_f32_16x16x32_bf16 v[144:147], a[28:31], a[144:147], v[144:147]
  v_fmac_f32 v14, v15, v15
  v_mfma_f32_16x16x32_bf16 v[160:163], a[32:35], a[144:147], v[160:163]
  ds_read_b64_tr_b16 a[90:91], v9 offset:46720
  v_add_f32 v13, v13, v28
  v_mfma_f32_16x16x32_bf16 v[164:167], a[32:35], a[148:151], v[164:167]
  v_fmac_f32 v14, v28, v28
  ds_read_b64_tr_b16 a[92:93], v9 offset:50304
  v_mfma_f32_16x16x32_bf16 v[168:171], a[32:35], a[152:155], v[168:171]
  s_add_u32 m0, s25, 114688
  v_lshlrev_b32 v15, 16, v29
  v_mfma_f32_16x16x32_bf16 v[172:175], a[32:35], a[156:159], v[172:175]
  ds_read_b64_tr_b16 a[94:95], v9 offset:53888
  v_mfma_f32_16x16x32_bf16 v[188:191], a[36:39], a[156:159], v[188:191]
  buffer_load_dwordx4 v2, s[8:11], s21 offen offset:0  lds
  v_and_b32 v29, 0xffff0000, v29
  v_mfma_f32_16x16x32_bf16 v[184:187], a[36:39], a[152:155], v[184:187]
  v_add_f32 v13, v13, v15
  ds_read_b64_tr_b16 a[96:97], v9 offset:43168
  v_mfma_f32_16x16x32_bf16 v[180:183], a[36:39], a[148:151], v[180:183]
  v_fmac_f32 v14, v15, v15
  v_add_f32 v13, v13, v29
  v_mfma_f32_16x16x32_bf16 v[176:179], a[36:39], a[144:147], v[176:179]
  ds_read_b64_tr_b16 a[98:99], v9 offset:46752
  buffer_load_dwordx4 a[132:135], v1, s[4:7], s20 offen offset:256
  v_mfma_f32_16x16x32_bf16 v[192:195], a[40:43], a[144:147], v[192:195]
  v_fmac_f32 v14, v29, v29
  v_mfma_f32_16x16x32_bf16 v[196:199], a[40:43], a[148:151], v[196:199]
  ds_read_b64_tr_b16 a[100:101], v9 offset:50336
  v_lshlrev_b32 v15, 16, v30
  v_mfma_f32_16x16x32_bf16 v[200:203], a[40:43], a[152:155], v[200:203]
  v_and_b32 v30, 0xffff0000, v30
  ds_read_b64_tr_b16 a[102:103], v9 offset:53920
  v_mfma_f32_16x16x32_bf16 v[204:207], a[40:43], a[156:159], v[204:207]
  v_add_f32 v13, v13, v15
  v_fmac_f32 v14, v15, v15
  v_mfma_f32_16x16x32_bf16 v[220:223], a[44:47], a[156:159], v[220:223]
  ds_read_b64_tr_b16 a[104:105], v9 offset:43200
  v_mfma_f32_16x16x32_bf16 v[216:219], a[44:47], a[152:155], v[216:219]
  buffer_load_dwordx4 v3, s[8:11], s21 offen offset:1024  lds
  v_add_f32 v13, v13, v30
  v_mfma_f32_16x16x32_bf16 v[212:215], a[44:47], a[148:151], v[212:215]
  ds_read_b64_tr_b16 a[106:107], v9 offset:46784
  v_fmac_f32 v14, v30, v30
  v_mfma_f32_16x16x32_bf16 v[208:211], a[44:47], a[144:147], v[208:211]
  v_lshlrev_b32 v15, 16, v31
  ds_read_b64_tr_b16 a[108:109], v9 offset:50368
  v_mfma_f32_16x16x32_bf16 v[224:227], a[48:51], a[144:147], v[224:227]
  v_and_b32 v31, 0xffff0000, v31
  buffer_load_dwordx4 a[136:139], v1, s[4:7], s20 offen offset:512
  v_mfma_f32_16x16x32_bf16 v[228:231], a[48:51], a[148:151], v[228:231]
  v_add_f32 v13, v13, v15
  v_mfma_f32_16x16x32_bf16 v[232:235], a[48:51], a[152:155], v[232:235]
  ds_read_b64_tr_b16 a[110:111], v9 offset:53952
  v_fmac_f32 v14, v15, v15
  v_mfma_f32_16x16x32_bf16 v[236:239], a[48:51], a[156:159], v[236:239]
  v_add_f32 v13, v13, v31
  v_fmac_f32 v14, v31, v31
  v_mfma_f32_16x16x32_bf16 v[252:255], a[52:55], a[156:159], v[252:255]
  buffer_load_dwordx4 v4, s[8:11], s21 offen offset:2048  lds
  s_cmp_lg_u32 s16, 0
  s_cbranch_scc1 g1_cs2_0
  v_mfma_f32_16x16x32_bf16 a[192:195], a[0:3], a[208:211], a[192:195]
  v_mfma_f32_16x16x32_bf16 a[196:199], a[16:19], a[208:211], a[196:199]
  v_mfma_f32_16x16x32_bf16 a[200:203], a[32:35], a[208:211], a[200:203]
  v_mfma_f32_16x16x32_bf16 a[204:207], a[48:51], a[208:211], a[204:207]
  s_branch g1_cs2_e
g1_cs2_0:
  s_cmp_lg_u32 s16, 1
  s_cbranch_scc1 g1_cs2_1
  v_mfma_f32_16x16x32_bf16 a[192:195], a[4:7], a[208:211], a[192:195]
  v_mfma_f32_16x16x32_bf16 a[196:199], a[20:23], a[208:211], a[196:199]
  v_mfma_f32_16x16x32_bf16 a[200:203], a[36:39], a[208:211], a[200:203]
  v_mfma_f32_16x16x32_bf16 a[204:207], a[52:55], a[208:211], a[204:207]
  s_branch g1_cs2_e
g1_cs2_1:
  s_cmp_lg_u32 s16, 2
  s_cbranch_scc1 g1_cs2_2
  v_mfma_f32_16x16x32_bf16 a[192:195], a[8:11], a[208:211], a[192:195]
  v_mfma_f32_16x16x32_bf16 a[196:199], a[24:27], a[208:211], a[196:199]
  v_mfma_f32_16x16x32_bf16 a[200:203], a[40:43], a[208:211], a[200:203]
  s_branch g1_cs2_e
g1_cs2_2:
  v_mfma_f32_16x16x32_bf16 a[192:195], a[12:15], a[208:211], a[192:195]
  v_mfma_f32_16x16x32_bf16 a[196:199], a[28:31], a[208:211], a[196:199]
  v_mfma_f32_16x16x32_bf16 a[200:203], a[44:47], a[208:211], a[200:203]
g1_cs2_e:
  v_mfma_f32_16x16x32_bf16 v[248:251], a[52:55], a[152:155], v[248:251]
  v_mfma_f32_16x16x32_bf16 v[244:247], a[52:55], a[148:151], v[244:247]
  v_mfma_f32_16x16x32_bf16 v[240:243], a[52:55], a[144:147], v[240:243]
g1_s3:
  s_waitcnt vmcnt(21) lgkmcnt(0)
  v_mfma_f32_16x16x32_bf16 v[32:35], a[56:59], a[160:163], v[32:35]
  s_barrier
  ds_read_b64_tr_b16 a[0:1], v10 offset:0
  v_mfma_f32_16x16x32_bf16 v[36:39], a[56:59], a[164:167], v[36:39]
  v_and_b32 v15, 7, v0
  v_mfma_f32_16x16x32_bf16 v[40:43], a[56:59], a[168:171], v[40:43]
  ds_read_b64_tr_b16 a[2:3], v10 offset:3584
  v_mfma_f32_16x16x32_bf16 v[44:47], a[56:59], a[172:175], v[44:47]
  buffer_load_dwordx4 a[140:143], v1, s[4:7], s20 offen offset:768
  s_add_u32 s20, s20, 0x20000
  v_mfma_f32_16x16x32_bf16 v[60:63], a[60:63], a[172:175], v[60:63]
  v_lshlrev_b32 v15, 5, v15
  v_mfma_f32_16x16x32_bf16 v[56:59], a[60:63], a[168:171], v[56:59]
  v_add_u32 v15, 143360, v15
  v_mfma_f32_16x16x32_bf16 v[52:55], a[60:63], a[164:167], v[52:55]
  ds_read_b64_tr_b16 a[4:5], v10 offset:7168
  v_mfma_f32_16x16x32_bf16 v[48:51], a[60:63], a[160:163], v[48:51]
  v_lshl_add_u32 v16, s16, 2, v15
  v_add_f32_dpp v13, v13, v13 row_ror:8 row_mask:0xf bank_mask:0xf
  v_mfma_f32_16x16x32_bf16 v[64:67], a[64:67], a[160:163], v[64:67]
  ds_read_b64_tr_b16 a[6:7], v10 offset:10752
  v_mfma_f32_16x16x32_bf16 v[68:71], a[64:67], a[164:167], v[68:71]
  buffer_load_dwordx4 v5, s[8:11], s21 offen offset:3072  lds
  v_mfma_f32_16x16x32_bf16 v[72:75], a[64:67], a[168:171], v[72:75]
  v_add_f32_dpp v14, v14, v14 row_ror:8 row_mask:0xf bank_mask:0xf
  v_mfma_f32_16x16x32_bf16 v[76:79], a[64:67], a[172:175], v[76:79]
  ds_read_b64_tr_b16 a[8:9], v10 offset:32
  v_mov_b32 v17, v13
  v_mfma_f32_16x16x32_bf16 v[92:95], a[68:71], a[172:175], v[92:95]
  v_mov_b32 v18, v14
  v_mfma_f32_16x16x32_bf16 v[88:91], a[68:71], a[168:171], v[88:91]
  ds_read_b64_tr_b16 a[10:11], v10 offset:3616
  v_mfma_f32_16x16x32_bf16 v[84:87], a[68:71], a[164:167], v[84:87]
  v_permlane16_swap_b32 v13, v17
  v_mfma_f32_16x16x32_bf16 v[80:83], a[68:71], a[160:163], v[80:83]
  buffer_load_dwordx4 a[144:147], v1, s[4:7], s20 offen offset:0
  v_permlane16_swap_b32 v14, v18
  v_mfma_f32_16x16x32_bf16 v[96:99], a[72:75], a[160:163], v[96:99]
  ds_read_b64_tr_b16 a[12:13], v10 offset:7200
  v_mfma_f32_16x16x32_bf16 v[100:103], a[72:75], a[164:167], v[100:103]
  v_add_f32 v13, v13, v17
  v_mfma_f32_16x16x32_bf16 v[104:107], a[72:75], a[168:171], v[104:107]
  ds_read_b64_tr_b16 a[14:15], v10 offset:10784
  v_mfma_f32_16x16x32_bf16 v[108:111], a[72:75], a[172:175], v[108:111]
  v_add_f32 v14, v14, v18
  v_mov_b32 v17, v13
  v_mfma_f32_16x16x32_bf16 v[124:127], a[76:79], a[172:175], v[124:127]
  ds_read_b64_tr_b16 a[16:17], v10 offset:64
  v_mfma_f32_16x16x32_bf16 v[120:123], a[76:79], a[168:171], v[120:123]
  s_add_u32 m0, s25, 118784
  v_mfma_f32_16x16x32_bf16 v[116:119], a[76:79], a[164:167], v[116:119]
  v_mov_b32 v18, v14
  v_mfma_f32_16x16x32_bf16 v[112:115], a[76:79], a[160:163], v[112:115]
  buffer_load_dwordx4 v6, s[8:11], s21 offen offset:0  lds
  v_permlane32_swap_b32 v13, v17
  v_mfma_f32_16x16x32_bf16 v[128:131], a[80:83], a[160:163], v[128:131]
  ds_read_b64_tr_b16 a[18:19], v10 offset:3648
  v_mfma_f32_16x16x32_bf16 v[132:135], a[80:83], a[164:167], v[132:135]
  v_permlane32_swap_b32 v14, v18
  v_mfma_f32_16x16x32_bf16 v[136:139], a[80:83], a[168:171], v[136:139]
  ds_read_b64_tr_b16 a[20:21], v10 offset:7232
  v_mfma_f32_16x16x32_bf16 v[140:143], a[80:83], a[172:175], v[140:143]
  v_add_f32 v13, v13, v17
  v_add_f32 v14, v14, v18
  v_mfma_f32_16x16x32_bf16 v[156:159], a[84:87], a[172:175], v[156:159]
  ds_read_b64_tr_b16 a[22:23], v10 offset:10816
  v_mfma_f32_16x16x32_bf16 v[152:155], a[84:87], a[168:171], v[152:155]
  buffer_load_dwordx4 a[148:151], v1, s[4:7], s20 offen offset:256
  v_mfma_f32_16x16x32_bf16 v[148:151], a[84:87], a[164:167], v[148:151]
  ds_write2_b32 v16, v13, v14 offset0:0 offset1:4
  ds_read_b64_tr_b16 a[24:25], v10 offset:96
  v_mfma_f32_16x16x32_bf16 v[144:147], a[84:87], a[160:163], v[144:147]
  ds_read_b64_tr_b16 a[26:27], v10 offset:3680
  v_mfma_f32_16x16x32_bf16 v[160:163], a[88:91], a[160:163], v[160:163]
  buffer_load_dwordx4 v7, s[8:11], s21 offen offset:1024  lds
  v_mfma_f32_16x16x32_bf16 v[164:167], a[88:91], a[164:167], v[164:167]
  ds_read_b64_tr_b16 a[28:29], v10 offset:7264
  v_mfma_f32_16x16x32_bf16 v[168:171], a[88:91], a[168:171], v[168:171]
  ds_read_b64_tr_b16 a[30:31], v10 offset:10848
  ds_read_b64_tr_b16 a[32:33], v10 offset:128
  v_mfma_f32_16x16x32_bf16 v[172:175], a[88:91], a[172:175], v[172:175]
  buffer_load_dwordx4 a[152:155], v1, s[4:7], s20 offen offset:512
  v_mfma_f32_16x16x32_bf16 v[188:191], a[92:95], a[172:175], v[188:191]
  ds_read_b64_tr_b16 a[34:35], v10 offset:3712
  v_mfma_f32_16x16x32_bf16 v[184:187], a[92:95], a[168:171], v[184:187]
  ds_read_b64_tr_b16 a[36:37], v10 offset:7296
  v_mfma_f32_16x16x32_bf16 v[180:183], a[92:95], a[164:167], v[180:183]
  ds_read_b64_tr_b16 a[38:39], v10 offset:10880
  buffer_load_dwordx4 v8, s[8:11], s21 offen offset:2048  lds
  v_mfma_f32_16x16x32_bf16 v[176:179], a[92:95], a[160:163], v[176:179]
  s_add_u32 s21, s21, 458752
  v_mfma_f32_16x16x32_bf16 v[192:195], a[96:99], a[160:163], v[192:195]
  ds_read_b64_tr_b16 a[40:41], v10 offset:160
  v_mfma_f32_16x16x32_bf16 v[196:199], a[96:99], a[164:167], v[196:199]
  ds_read_b64_tr_b16 a[42:43], v10 offset:3744
  v_mfma_f32_16x16x32_bf16 v[200:203], a[96:99], a[168:171], v[200:203]
  buffer_load_dwordx4 a[156:159], v1, s[4:7], s20 offen offset:768
  s_add_u32 s20, s20, 0x20000
  v_mfma_f32_16x16x32_bf16 v[204:207], a[96:99], a[172:175], v[204:207]
  s_and_b32 s20, s20, 0x3fffff
  v_mfma_f32_16x16x32_bf16 v[220:223], a[100:103], a[172:175], v[220:223]
  ds_read_b64_tr_b16 a[44:45], v10 offset:7328
  v_mfma_f32_16x16x32_bf16 v[216:219], a[100:103], a[168:171], v[216:219]
  ds_read_b64_tr_b16 a[46:47], v10 offset:10912
  v_mfma_f32_16x16x32_bf16 v[212:215], a[100:103], a[164:167], v[212:215]
  s_add_u32 m0, s25, 0
  ds_read_b64_tr_b16 a[48:49], v10 offset:192
  v_mfma_f32_16x16x32_bf16 v[208:211], a[100:103], a[160:163], v[208:211]
  buffer_load_dwordx4 v2, s[8:11], s21 offen offset:0  lds
  v_mfma_f32_16x16x32_bf16 v[224:227], a[104:107], a[160:163], v[224:227]
  ds_read_b64_tr_b16 a[50:51], v10 offset:3776
  v_mfma_f32_16x16x32_bf16 v[228:231], a[104:107], a[164:167], v[228:231]
  ds_read_b64_tr_b16 a[52:53], v10 offset:7360
  v_mfma_f32_16x16x32_bf16 v[232:235], a[104:107], a[168:171], v[232:235]
  buffer_load_dwordx4 v3, s[8:11], s21 offen offset:1024  lds
  ds_read_b64_tr_b16 a[54:55], v10 offset:10944
  v_mfma_f32_16x16x32_bf16 v[236:239], a[104:107], a[172:175], v[236:239]
  buffer_load_dwordx4 v4, s[8:11], s21 offen offset:2048  lds
  v_mfma_f32_16x16x32_bf16 v[252:255], a[108:111], a[172:175], v[252:255]
  s_cmp_lg_u32 s16, 0
  s_cbranch_scc1 g1_cs3_0
  v_mfma_f32_16x16x32_bf16 a[192:195], a[56:59], a[208:211], a[192:195]
  v_mfma_f32_16x16x32_bf16 a[196:199], a[72:75], a[208:211], a[196:199]
  v_mfma_f32_16x16x32_bf16 a[200:203], a[88:91], a[208:211], a[200:203]
  v_mfma_f32_16x16x32_bf16 a[204:207], a[104:107], a[208:211], a[204:207]
  s_branch g1_cs3_e
g1_cs3_0:
  s_cmp_lg_u32 s16, 1
  s_cbranch_scc1 g1_cs3_1
  v_mfma_f32_16x16x32_bf16 a[192:195], a[60:63], a[208:211], a[192:195]
  v_mfma_f32_16x16x32_bf16 a[196:199], a[76:79], a[208:211], a[196:199]
  v_mfma_f32_16x16x32_bf16 a[200:203], a[92:95], a[208:211], a[200:203]
  v_mfma_f32_16x16x32_bf16 a[204:207], a[108:111], a[208:211], a[204:207]
  s_branch g1_cs3_e
g1_cs3_1:
  s_cmp_lg_u32 s16, 2
  s_cbranch_scc1 g1_cs3_2
  v_mfma_f32_16x16x32_bf16 a[192:195], a[64:67], a[208:211], a[192:195]
  v_mfma_f32_16x16x32_bf16 a[196:199], a[80:83], a[208:211], a[196:199]
  v_mfma_f32_16x16x32_bf16 a[200:203], a[96:99], a[208:211], a[200:203]
  s_branch g1_cs3_e
g1_cs3_2:
  v_mfma_f32_16x16x32_bf16 a[192:195], a[68:71], a[208:211], a[192:195]
  v_mfma_f32_16x16x32_bf16 a[196:199], a[84:87], a[208:211], a[196:199]
  v_mfma_f32_16x16x32_bf16 a[200:203], a[100:103], a[208:211], a[200:203]
g1_cs3_e:
  v_mfma_f32_16x16x32_bf16 v[248:251], a[108:111], a[168:171], v[248:251]
  v_mfma_f32_16x16x32_bf16 v[244:247], a[108:111], a[164:167], v[244:247]
  v_mfma_f32_16x16x32_bf16 v[240:243], a[108:111], a[160:163], v[240:243]
g1_s4:
  s_waitcnt vmcnt(26) lgkmcnt(0)
  v_mfma_f32_16x16x32_bf16 v[32:35], a[0:3], a[176:179], v[32:35]
  ds_read_b64_tr_b16 a[56:57], v10 offset:14336
  v_mfma_f32_16x16x32_bf16 v[36:39], a[0:3], a[180:183], v[36:39]
  s_lshl_b32 s37, s17, 5
  v_mfma_f32_16x16x32_bf16 v[40:43], a[0:3], a[184:187], v[40:43]
  ds_read_b64_tr_b16 a[58:59], v10 offset:17920
  v_mfma_f32_16x16x32_bf16 v[44:47], a[0:3], a[188:191], v[44:47]
  buffer_load_dwordx4 a[160:163], v1, s[4:7], s20 offen offset:0
  v_mfma_f32_16x16x32_bf16 v[60:63], a[4:7], a[188:191], v[60:63]
  s_add_u32 s37, s37, s18
  v_mfma_f32_16x16x32_bf16 v[56:59], a[4:7], a[184:187], v[56:59]
  s_mul_i32 s37, s37, 896
  v_mfma_f32_16x16x32_bf16 v[52:55], a[4:7], a[180:183], v[52:55]
  ds_read_b64_tr_b16 a[60:61], v10 offset:21504
  v_mfma_f32_16x16x32_bf16 v[48:51], a[4:7], a[176:179], v[48:51]
  s_lshl_b32 s27, s16, 6
  v_mfma_f32_16x16x32_bf16 v[64:67], a[8:11], a[176:179], v[64:67]
  s_add_u32 s37, s37, s27
  v_mfma_f32_16x16x32_bf16 v[68:71], a[8:11], a[180:183], v[68:71]
  ds_read_b64_tr_b16 a[62:63], v10 offset:25088
  v_mfma_f32_16x16x32_bf16 v[72:75], a[8:11], a[184:187], v[72:75]
  buffer_load_dwordx4 a[164:167], v1, s[4:7], s20 offen offset:256
  v_mfma_f32_16x16x32_bf16 v[76:79], a[8:11], a[188:191], v[76:79]
  s_add_u32 s37, s37, 262144
  v_mfma_f32_16x16x32_bf16 v[92:95], a[12:15], a[188:191], v[92:95]
  ds_read_b64_tr_b16 a[64:65], v10 offset:14368
  v_mfma_f32_16x16x32_bf16 v[88:91], a[12:15], a[184:187], v[88:91]
  ds_read_b64_tr_b16 a[66:67], v10 offset:17952
  v_mfma_f32_16x16x32_bf16 v[84:87], a[12:15], a[180:183], v[84:87]
  buffer_load_dwordx4 a[168:171], v1, s[4:7], s20 offen offset:512
  v_mfma_f32_16x16x32_bf16 v[80:83], a[12:15], a[176:179], v[80:83]
  ds_read_b64_tr_b16 a[68:69], v10 offset:21536
  v_mfma_f32_16x16x32_bf16 v[96:99], a[16:19], a[176:179], v[96:99]
  ds_read_b64_tr_b16 a[70:71], v10 offset:25120
  v_mfma_f32_16x16x32_bf16 v[100:103], a[16:19], a[180:183], v[100:103]
  ds_read_b64_tr_b16 a[72:73], v10 offset:14400
  v_mfma_f32_16x16x32_bf16 v[104:107], a[16:19], a[184:187], v[104:107]
  buffer_load_dwordx4 a[172:175], v1, s[4:7], s20 offen offset:768
  v_mfma_f32_16x16x32_bf16 v[108:111], a[16:19], a[188:191], v[108:111]
  s_add_u32 s20, s20, 0x20000
  v_mfma_f32_16x16x32_bf16 v[124:127], a[20:23], a[188:191], v[124:127]
  ds_read_b64_tr_b16 a[74:75], v10 offset:17984
  v_mfma_f32_16x16x32_bf16 v[120:123], a[20:23], a[184:187], v[120:123]
  ds_read_b64_tr_b16 a[76:77], v10 offset:21568
  v_mfma_f32_16x16x32_bf16 v[116:119], a[20:23], a[180:183], v[116:119]
  ds_read_b64_tr_b16 a[78:79], v10 offset:25152
  v_mfma_f32_16x16x32_bf16 v[112:115], a[20:23], a[176:179], v[112:115]
  buffer_load_dwordx4 v5, s[8:11], s21 offen offset:3072  lds
  v_mfma_f32_16x16x32_bf16 v[128:131], a[24:27], a[176:179], v[128:131]
  ds_read_b64_tr_b16 a[80:81], v10 offset:14432
  v_mfma_f32_16x16x32_bf16 v[132:135], a[24:27], a[180:183], v[132:135]
  ds_read_b64_tr_b16 a[82:83], v10 offset:18016
  v_mfma_f32_16x16x32_bf16 v[136:139], a[24:27], a[184:187], v[136:139]
  s_add_u32 m0, s25, 4096
  v_mfma_f32_16x16x32_bf16 v[140:143], a[24:27], a[188:191], v[140:143]
  buffer_load_dwordx4 v6, s[8:11], s21 offen offset:0  lds
  v_mfma_f32_16x16x32_bf16 v[156:159], a[28:31], a[188:191], v[156:159]
  ds_read_b64_tr_b16 a[84:85], v10 offset:21600
  v_mfma_f32_16x16x32_bf16 v[152:155], a[28:31], a[184:187], v[152:155]
  ds_read_b64_tr_b16 a[86:87], v10 offset:25184
  v_mfma_f32_16x16x32_bf16 v[148:151], a[28:31], a[180:183], v[148:151]
  ds_read_b64_tr_b16 a[88:89], v10 offset:14464
  v_mfma_f32_16x16x32_bf16 v[144:147], a[28:31], a[176:179], v[144:147]
  buffer_load_dwordx4 v7, s[8:11], s21 offen offset:1024  lds
  v_mfma_f32_16x16x32_bf16 v[160:163], a[32:35], a[176:179], v[160:163]
  ds_read_b64_tr_b16 a[90:91], v10 offset:18048
  v_mfma_f32_16x16x32_bf16 v[164:167], a[32:35], a[180:183], v[164:167]
  ds_read_b64_tr_b16 a[92:93], v10 offset:21632
  v_mfma_f32_16x16x32_bf16 v[168:171], a[32:35], a[184:187], v[168:171]
  ds_read_b64_tr_b16 a[94:95], v10 offset:25216
  v_mfma_f32_16x16x32_bf16 v[172:175], a[32:35], a[188:191], v[172:175]
  buffer_load_dwordx4 v8, s[8:11], s21 offen offset:2048  lds
  v_mfma_f32_16x16x32_bf16 v[188:191], a[36:39], a[188:191], v[188:191]
  s_add_u32 s21, s21, 458752
  s_cmp_eq_u32 s21, 7340032
  s_cselect_b32 s21, 0, s21
  v_mfma_f32_16x16x32_bf16 v[184:187], a[36:39], a[184:187], v[184:187]
  v_mfma_f32_16x16x32_bf16 v[180:183], a[36:39], a[180:183], v[180:183]
  v_mfma_f32_16x16x32_bf16 v[176:179], a[36:39], a[176:179], v[176:179]
  ds_read_b64_tr_b16 a[96:97], v10 offset:14496
  v_mfma_f32_16x16x32_bf16 v[192:195], a[40:43], a[176:179], v[192:195]
  ds_read_b64_tr_b16 a[98:99], v10 offset:18080
  v_mfma_f32_16x16x32_bf16 v[196:199], a[40:43], a[180:183], v[196:199]
  ds_read_b64_tr_b16 a[100:101], v10 offset:21664
  v_mfma_f32_16x16x32_bf16 v[200:203], a[40:43], a[184:187], v[200:203]
  ds_read_b64_tr_b16 a[102:103], v10 offset:25248
  v_mfma_f32_16x16x32_bf16 v[204:207], a[40:43], a[188:191], v[204:207]
  ds_read_b64_tr_b16 a[104:105], v10 offset:14528
  v_mfma_f32_16x16x32_bf16 v[220:223], a[44:47], a[188:191], v[220:223]
  ds_read_b64_tr_b16 a[106:107], v10 offset:18112
  v_mfma_f32_16x16x32_bf16 v[216:219], a[44:47], a[184:187], v[216:219]
  ds_read_b64_tr_b16 a[108:109], v10 offset:21696
  v_mfma_f32_16x16x32_bf16 v[212:215], a[44:47], a[180:183], v[212:215]
  ds_read_b64_tr_b16 a[110:111], v10 offset:25280
  v_mfma_f32_16x16x32_bf16 v[208:211], a[44:47], a[176:179], v[208:211]
  s_add_u32 s51, s50, g1_s7 - g1_pc
  v_mfma_f32_16x16x32_bf16 v[224:227], a[48:51], a[176:179], v[224:227]
  s_min_u32 s51, s51, code_end - g1_pc - 4
  v_mfma_f32_16x16x32_bf16 v[228:231], a[48:51], a[180:183], v[228:231]
  v_mov_b32 v23, s51
  v_mfma_f32_16x16x32_bf16 v[232:235], a[48:51], a[184:187], v[232:235]
  s_mov_b32 exec_lo, 0x00010001
  s_mov_b32 exec_hi, 0x00010001
  buffer_store_dwordx4 a[192:195], v12, s[40:43], s37 offen offset:0 sc0 sc1
  buffer_store_dwordx4 a[196:199], v12, s[40:43], s37 offen offset:256 sc0 sc1
  buffer_store_dwordx4 a[200:203], v12, s[40:43], s37 offen offset:512 sc0 sc1
  s_cmp_lg_u32 s36, 0
  s_cbranch_scc1 g1_nocs
  buffer_store_dwordx4 a[204:207], v12, s[40:43], s37 offen offset:768 sc0 sc1
g1_nocs:
  s_mov_b64 exec, -1
  v_mfma_f32_16x16x32_bf16 v[236:239], a[48:51], a[188:191], v[236:239]
  v_mfma_f32_16x16x32_bf16 v[252:255], a[52:55], a[188:191], v[252:255]
  global_load_dword a212, v23, s[48:49]
  v_mfma_f32_16x16x32_bf16 v[248:251], a[52:55], a[184:187], v[248:251]
  v_mfma_f32_16x16x32_bf16 v[244:247], a[52:55], a[180:183], v[244:247]
  v_mfma_f32_16x16x32_bf16 v[240:243], a[52:55], a[176:179], v[240:243]
g1_s5:
  s_waitcnt vmcnt(30) lgkmcnt(0)
  v_mfma_f32_16x16x32_bf16 v[32:35], a[56:59], a[112:115], v[32:35]
  s_barrier
  v_mfma_f32_16x16x32_bf16 v[36:39], a[56:59], a[116:119], v[36:39]
  ds_read_b64_tr_b16 a[0:1], v10 offset:28672
  v_mfma_f32_16x16x32_bf16 v[40:43], a[56:59], a[120:123], v[40:43]
  ds_read_b64_tr_b16 a[2:3], v10 offset:32256
  v_mfma_f32_16x16x32_bf16 v[44:47], a[56:59], a[124:127], v[44:47]
  buffer_load_dwordx4 a[176:179], v1, s[4:7], s20 offen offset:0
  v_mfma_f32_16x16x32_bf16 v[60:63], a[60:63], a[124:127], v[60:63]
  ds_read_b128 v[16:19], v15
  ds_read_b128 v[20:23], v15 offset:16
  v_mfma_f32_16x16x32_bf16 v[56:59], a[60:63], a[120:123], v[56:59]
  v_mfma_f32_16x16x32_bf16 v[52:55], a[60:63], a[116:119], v[52:55]
  ds_read_b64_tr_b16 a[4:5], v10 offset:35840
  v_mfma_f32_16x16x32_bf16 v[48:51], a[60:63], a[112:115], v[48:51]
  ds_read_b64_tr_b16 a[6:7], v10 offset:39424
  v_mfma_f32_16x16x32_bf16 v[64:67], a[64:67], a[112:115], v[64:67]
  buffer_load_dwordx4 a[180:183], v1, s[4:7], s20 offen offset:256
  v_mfma_f32_16x16x32_bf16 v[68:71], a[64:67], a[116:119], v[68:71]
  ds_read_b64_tr_b16 a[8:9], v10 offset:28704
  v_mfma_f32_16x16x32_bf16 v[72:75], a[64:67], a[120:123], v[72:75]
  ds_read_b64_tr_b16 a[10:11], v10 offset:32288
  v_mfma_f32_16x16x32_bf16 v[76:79], a[64:67], a[124:127], v[76:79]
  buffer_load_dwordx4 a[184:187], v1, s[4:7], s20 offen offset:512
  v_mfma_f32_16x16x32_bf16 v[92:95], a[68:71], a[124:127], v[92:95]
  ds_read_b64_tr_b16 a[12:13], v10 offset:35872
  v_mfma_f32_16x16x32_bf16 v[88:91], a[68:71], a[120:123], v[88:91]
  ds_read_b64_tr_b16 a[14:15], v10 offset:39456
  v_mfma_f32_16x16x32_bf16 v[84:87], a[68:71], a[116:119], v[84:87]
  ds_read_b64_tr_b16 a[16:17], v10 offset:28736
  v_mfma_f32_16x16x32_bf16 v[80:83], a[68:71], a[112:115], v[80:83]
  buffer_load_dwordx4 a[188:191], v1, s[4:7], s20 offen offset:768
  v_mfma_f32_16x16x32_bf16 v[96:99], a[72:75], a[112:115], v[96:99]
  s_add_u32 s20, s20, 0x20000
  v_mfma_f32_16x16x32_bf16 v[100:103], a[72:75], a[116:119], v[100:103]
  ds_read_b64_tr_b16 a[18:19], v10 offset:32320
  v_mfma_f32_16x16x32_bf16 v[104:107], a[72:75], a[120:123], v[104:107]
  ds_read_b64_tr_b16 a[20:21], v10 offset:35904
  v_mfma_f32_16x16x32_bf16 v[108:111], a[72:75], a[124:127], v[108:111]
  s_add_u32 m0, s25, 28672
  v_mfma_f32_16x16x32_bf16 v[124:127], a[76:79], a[124:127], v[124:127]
  ds_read_b64_tr_b16 a[22:23], v10 offset:39488
  v_mfma_f32_16x16x32_bf16 v[120:123], a[76:79], a[120:123], v[120:123]
  buffer_load_dwordx4 v2, s[8:11], s21 offen offset:0  lds
  v_mfma_f32_16x16x32_bf16 v[116:119], a[76:79], a[116:119], v[116:119]
  ds_read_b64_tr_b16 a[24:25], v10 offset:28768
  v_mfma_f32_16x16x32_bf16 v[112:115], a[76:79], a[112:115], v[112:115]
  ds_read_b64_tr_b16 a[26:27], v10 offset:32352
  v_mfma_f32_16x16x32_bf16 v[128:131], a[80:83], a[112:115], v[128:131]
  buffer_load_dwordx4 v3, s[8:11], s21 offen offset:1024  lds
  v_mfma_f32_16x16x32_bf16 v[132:135], a[80:83], a[116:119], v[132:135]
  ds_read_b64_tr_b16 a[28:29], v10 offset:35936
  v_mfma_f32_16x16x32_bf16 v[136:139], a[80:83], a[120:123], v[136:139]
  ds_read_b64_tr_b16 a[30:31], v10 offset:39520
  v_mfma_f32_16x16x32_bf16 v[140:143], a[80:83], a[124:127], v[140:143]
  ds_read_b64_tr_b16 a[32:33], v10 offset:28800
  v_mfma_f32_16x16x32_bf16 v[156:159], a[84:87], a[124:127], v[156:159]
  buffer_load_dwordx4 v4, s[8:11], s21 offen offset:2048  lds
  v_mfma_f32_16x16x32_bf16 v[152:155], a[84:87], a[120:123], v[152:155]
  ds_read_b64_tr_b16 a[34:35], v10 offset:32384
  v_mfma_f32_16x16x32_bf16 v[148:151], a[84:87], a[116:119], v[148:151]
  ds_read_b64_tr_b16 a[36:37], v10 offset:35968
  v_mfma_f32_16x16x32_bf16 v[144:147], a[84:87], a[112:115], v[144:147]
  ds_read_b64_tr_b16 a[38:39], v10 offset:39552
  v_mfma_f32_16x16x32_bf16 v[160:163], a[88:91], a[112:115], v[160:163]
  ds_read_b64_tr_b16 a[40:41], v10 offset:28832
  v_mfma_f32_16x16x32_bf16 v[164:167], a[88:91], a[116:119], v[164:167]
  ds_read_b64_tr_b16 a[42:43], v10 offset:32416
  v_mfma_f32_16x16x32_bf16 v[168:171], a[88:91], a[120:123], v[168:171]
  ds_read_b64_tr_b16 a[44:45], v10 offset:36000
  v_mfma_f32_16x16x32_bf16 v[172:175], a[88:91], a[124:127], v[172:175]
  ds_read_b64_tr_b16 a[46:47], v10 offset:39584
  v_mfma_f32_16x16x32_bf16 v[188:191], a[92:95], a[124:127], v[188:191]
  ds_read_b64_tr_b16 a[48:49], v10 offset:28864
  v_mfma_f32_16x16x32_bf16 v[184:187], a[92:95], a[120:123], v[184:187]
  ds_read_b64_tr_b16 a[50:51], v10 offset:32448
  v_mfma_f32_16x16x32_bf16 v[180:183], a[92:95], a[116:119], v[180:183]
  ds_read_b64_tr_b16 a[52:53], v10 offset:36032
  v_mfma_f32_16x16x32_bf16 v[176:179], a[92:95], a[112:115], v[176:179]
  ds_read_b64_tr_b16 a[54:55], v10 offset:39616
  v_mfma_f32_16x16x32_bf16 v[192:195], a[96:99], a[112:115], v[192:195]
  v_mfma_f32_16x16x32_bf16 v[196:199], a[96:99], a[116:119], v[196:199]
  v_mfma_f32_16x16x32_bf16 v[200:203], a[96:99], a[120:123], v[200:203]
  v_mfma_f32_16x16x32_bf16 v[204:207], a[96:99], a[124:127], v[204:207]
  v_mfma_f32_16x16x32_bf16 v[220:223], a[100:103], a[124:127], v[220:223]
  v_mfma_f32_16x16x32_bf16 v[216:219], a[100:103], a[120:123], v[216:219]
  v_mfma_f32_16x16x32_bf16 v[212:215], a[100:103], a[116:119], v[212:215]
  v_mfma_f32_16x16x32_bf16 v[208:211], a[100:103], a[112:115], v[208:211]
  v_mfma_f32_16x16x32_bf16 v[224:227], a[104:107], a[112:115], v[224:227]
  v_mfma_f32_16x16x32_bf16 v[228:231], a[104:107], a[116:119], v[228:231]
  v_mfma_f32_16x16x32_bf16 v[232:235], a[104:107], a[120:123], v[232:235]
  v_mfma_f32_16x16x32_bf16 v[236:239], a[104:107], a[124:127], v[236:239]
  v_mfma_f32_16x16x32_bf16 v[252:255], a[108:111], a[124:127], v[252:255]
  v_mfma_f32_16x16x32_bf16 v[248:251], a[108:111], a[120:123], v[248:251]
  v_mfma_f32_16x16x32_bf16 v[244:247], a[108:111], a[116:119], v[244:247]
  v_mfma_f32_16x16x32_bf16 v[240:243], a[108:111], a[112:115], v[240:243]
g1_s6:
  s_waitcnt vmcnt(30) lgkmcnt(0)
  v_mfma_f32_16x16x32_bf16 v[32:35], a[0:3], a[128:131], v[32:35]
  ds_read_b64_tr_b16 a[56:57], v10 offset:43008
  v_mfma_f32_16x16x32_bf16 v[36:39], a[0:3], a[132:135], v[36:39]
  v_add_f32 v16, v16, v17
  v_mfma_f32_16x16x32_bf16 v[40:43], a[0:3], a[136:139], v[40:43]
  ds_read_b64_tr_b16 a[58:59], v10 offset:46592
  v_mfma_f32_16x16x32_bf16 v[44:47], a[0:3], a[140:143], v[44:47]
  buffer_load_dwordx4 a[112:115], v1, s[4:7], s20 offen offset:0
  v_mfma_f32_16x16x32_bf16 v[60:63], a[4:7], a[140:143], v[60:63]
  v_add_f32 v18, v18, v19
  v_mfma_f32_16x16x32_bf16 v[56:59], a[4:7], a[136:139], v[56:59]
  v_add_f32 v20, v20, v21
  v_mfma_f32_16x16x32_bf16 v[52:55], a[4:7], a[132:135], v[52:55]
  ds_read_b64_tr_b16 a[60:61], v10 offset:50176
  v_mfma_f32_16x16x32_bf16 v[48:51], a[4:7], a[128:131], v[48:51]
  v_add_f32 v22, v22, v23
  v_mfma_f32_16x16x32_bf16 v[64:67], a[8:11], a[128:131], v[64:67]
  v_add_f32 v16, v16, v18
  v_mfma_f32_16x16x32_bf16 v[68:71], a[8:11], a[132:135], v[68:71]
  ds_read_b64_tr_b16 a[62:63], v10 offset:53760
  v_mfma_f32_16x16x32_bf16 v[72:75], a[8:11], a[136:139], v[72:75]
  buffer_load_dwordx4 a[116:119], v1, s[4:7], s20 offen offset:256
  v_mfma_f32_16x16x32_bf16 v[76:79], a[8:11], a[140:143], v[76:79]
  v_add_f32 v20, v20, v22
  v_mfma_f32_16x16x32_bf16 v[92:95], a[12:15], a[140:143], v[92:95]
  ds_read_b64_tr_b16 a[64:65], v10 offset:43040
  v_mfma_f32_16x16x32_bf16 v[88:91], a[12:15], a[136:139], v[88:91]
  v_mul_f32 v16, 0xba800000, v16
  v_mfma_f32_16x16x32_bf16 v[84:87], a[12:15], a[132:135], v[84:87]
  v_mov_b32 v17, 0x3727c5ac
  v_mfma_f32_16x16x32_bf16 v[80:83], a[12:15], a[128:131], v[80:83]
  ds_read_b64_tr_b16 a[66:67], v10 offset:46624
  v_mfma_f32_16x16x32_bf16 v[96:99], a[16:19], a[128:131], v[96:99]
  v_fmac_f32 v17, 0x3a800000, v20
  v_mfma_f32_16x16x32_bf16 v[100:103], a[16:19], a[132:135], v[100:103]
  buffer_load_dwordx4 a[120:123], v1, s[4:7], s20 offen offset:512
  v_mfma_f32_16x16x32_bf16 v[104:107], a[16:19], a[136:139], v[104:107]
  v_fma_f32 v17, -v16, v16, v17
  v_mfma_f32_16x16x32_bf16 v[108:111], a[16:19], a[140:143], v[108:111]
  ds_read_b64_tr_b16 a[68:69], v10 offset:50208
  v_mfma_f32_16x16x32_bf16 v[124:127], a[20:23], a[140:143], v[124:127]
  v_lshlrev_b32 v18, 3, v12
  v_mfma_f32_16x16x32_bf16 v[120:123], a[20:23], a[136:139], v[120:123]
  ds_read_b64_tr_b16 a[70:71], v10 offset:53792
  v_mfma_f32_16x16x32_bf16 v[116:119], a[20:23], a[132:135], v[116:119]
  v_max_f32 v17, 0x3727c5ac, v17
  v_mfma_f32_16x16x32_bf16 v[112:115], a[20:23], a[128:131], v[112:115]
  ds_read_b64_tr_b16 a[72:73], v10 offset:43072
  v_mfma_f32_16x16x32_bf16 v[128:131], a[24:27], a[128:131], v[128:131]
  buffer_load_dwordx4 a[124:127], v1, s[4:7], s20 offen offset:768
  v_mfma_f32_16x16x32_bf16 v[132:135], a[24:27], a[132:135], v[132:135]
  s_add_u32 s20, s20, 0x20000
  v_mfma_f32_16x16x32_bf16 v[136:139], a[24:27], a[136:139], v[136:139]
  ds_read_b64_tr_b16 a[74:75], v10 offset:46656
  v_mfma_f32_16x16x32_bf16 v[140:143], a[24:27], a[140:143], v[140:143]
  ds_read_b64_tr_b16 a[76:77], v10 offset:50240
  v_mfma_f32_16x16x32_bf16 v[156:159], a[28:31], a[140:143], v[156:159]
  ds_read_b64_tr_b16 a[78:79], v10 offset:53824
  v_mfma_f32_16x16x32_bf16 v[152:155], a[28:31], a[136:139], v[152:155]
  buffer_load_dwordx4 v5, s[8:11], s21 offen offset:3072  lds
  v_mfma_f32_16x16x32_bf16 v[148:151], a[28:31], a[132:135], v[148:151]
  ds_read_b64_tr_b16 a[80:81], v10 offset:43104
  v_mfma_f32_16x16x32_bf16 v[144:147], a[28:31], a[128:131], v[144:147]
  ds_read_b64_tr_b16 a[82:83], v10 offset:46688
  v_mfma_f32_16x16x32_bf16 v[160:163], a[32:35], a[128:131], v[160:163]
  s_add_u32 m0, s25, 32768
  v_mfma_f32_16x16x32_bf16 v[164:167], a[32:35], a[132:135], v[164:167]
  buffer_load_dwordx4 v6, s[8:11], s21 offen offset:0  lds
  v_mfma_f32_16x16x32_bf16 v[168:171], a[32:35], a[136:139], v[168:171]
  ds_read_b64_tr_b16 a[84:85], v10 offset:50272
  v_mfma_f32_16x16x32_bf16 v[172:175], a[32:35], a[140:143], v[172:175]
  ds_read_b64_tr_b16 a[86:87], v10 offset:53856
  v_mfma_f32_16x16x32_bf16 v[188:191], a[36:39], a[140:143], v[188:191]
  ds_read_b64_tr_b16 a[88:89], v10 offset:43136
  v_mfma_f32_16x16x32_bf16 v[184:187], a[36:39], a[136:139], v[184:187]
  buffer_load_dwordx4 v7, s[8:11], s21 offen offset:1024  lds
  v_mfma_f32_16x16x32_bf16 v[180:183], a[36:39], a[132:135], v[180:183]
  ds_read_b64_tr_b16 a[90:91], v10 offset:46720
  v_mfma_f32_16x16x32_bf16 v[176:179], a[36:39], a[128:131], v[176:179]
  ds_read_b64_tr_b16 a[92:93], v10 offset:50304
  v_mfma_f32_16x16x32_bf16 v[192:195], a[40:43], a[128:131], v[192:195]
  ds_read_b64_tr_b16 a[94:95], v10 offset:53888
  v_mfma_f32_16x16x32_bf16 v[196:199], a[40:43], a[132:135], v[196:199]
  buffer_load_dwordx4 v8, s[8:11], s21 offen offset:2048  lds
  v_mfma_f32_16x16x32_bf16 v[200:203], a[40:43], a[136:139], v[200:203]
  s_add_u32 s21, s21, 458752
  v_mfma_f32_16x16x32_bf16 v[204:207], a[40:43], a[140:143], v[204:207]
  ds_read_b64_tr_b16 a[96:97], v10 offset:43168
  v_mfma_f32_16x16x32_bf16 v[220:223], a[44:47], a[140:143], v[220:223]
  ds_read_b64_tr_b16 a[98:99], v10 offset:46752
  v_mfma_f32_16x16x32_bf16 v[216:219], a[44:47], a[136:139], v[216:219]
  ds_read_b64_tr_b16 a[100:101], v10 offset:50336
  v_mfma_f32_16x16x32_bf16 v[212:215], a[44:47], a[132:135], v[212:215]
  ds_read_b64_tr_b16 a[102:103], v10 offset:53920
  v_mfma_f32_16x16x32_bf16 v[208:211], a[44:47], a[128:131], v[208:211]
  ds_read_b64_tr_b16 a[104:105], v10 offset:43200
  v_mfma_f32_16x16x32_bf16 v[224:227], a[48:51], a[128:131], v[224:227]
  ds_read_b64_tr_b16 a[106:107], v10 offset:46784
  v_mfma_f32_16x16x32_bf16 v[228:231], a[48:51], a[132:135], v[228:231]
  ds_read_b64_tr_b16 a[108:109], v10 offset:50368
  v_mfma_f32_16x16x32_bf16 v[232:235], a[48:51], a[136:139], v[232:235]
  ds_read_b64_tr_b16 a[110:111], v10 offset:53952
  v_mfma_f32_16x16x32_bf16 v[236:239], a[48:51], a[140:143], v[236:239]
  s_cmp_lg_u32 s16, 0
  s_cbranch_scc1 g1_nost
  s_mov_b64 exec, 0xff
  buffer_store_dwordx2 v[16:17], v18, s[40:43], s54 offen sc0 sc1
  s_mov_b64 exec, -1
g1_nost:
  v_mfma_f32_16x16x32_bf16 v[252:255], a[52:55], a[140:143], v[252:255]
  v_mfma_f32_16x16x32_bf16 v[248:251], a[52:55], a[136:139], v[248:251]
  v_mfma_f32_16x16x32_bf16 v[244:247], a[52:55], a[132:135], v[244:247]
  v_mfma_f32_16x16x32_bf16 v[240:243], a[52:55], a[128:131], v[240:243]
g1_s7:
  s_waitcnt vmcnt(30) lgkmcnt(0)
  v_mfma_f32_16x16x32_bf16 v[32:35], a[56:59], a[144:147], v[32:35]
  s_barrier
  v_mfma_f32_16x16x32_bf16 v[36:39], a[56:59], a[148:151], v[36:39]
  ds_read_b64_tr_b16 a[0:1], v11 offset:0
  v_mfma_f32_16x16x32_bf16 v[40:43], a[56:59], a[152:155], v[40:43]
  ds_read_b64_tr_b16 a[2:3], v11 offset:3584
  v_mfma_f32_16x16x32_bf16 v[44:47], a[56:59], a[156:159], v[44:47]
  buffer_load_dwordx4 a[128:131], v1, s[4:7], s20 offen offset:0
  v_mfma_f32_16x16x32_bf16 v[60:63], a[60:63], a[156:159], v[60:63]
  ds_read_b64_tr_b16 a[4:5], v11 offset:7168
  v_mfma_f32_16x16x32_bf16 v[56:59], a[60:63], a[152:155], v[56:59]
  ds_read_b64_tr_b16 a[6:7], v11 offset:10752
  v_mfma_f32_16x16x32_bf16 v[52:55], a[60:63], a[148:151], v[52:55]
  buffer_load_dwordx4 a[132:135], v1, s[4:7], s20 offen offset:256
  v_mfma_f32_16x16x32_bf16 v[48:51], a[60:63], a[144:147], v[48:51]
  ds_read_b64_tr_b16 a[8:9], v11 offset:32
  v_mfma_f32_16x16x32_bf16 v[64:67], a[64:67], a[144:147], v[64:67]
  ds_read_b64_tr_b16 a[10:11], v11 offset:3616
  v_mfma_f32_16x16x32_bf16 v[68:71], a[64:67], a[148:151], v[68:71]
  buffer_load_dwordx4 a[136:139], v1, s[4:7], s20 offen offset:512
  v_mfma_f32_16x16x32_bf16 v[72:75], a[64:67], a[152:155], v[72:75]
  ds_read_b64_tr_b16 a[12:13], v11 offset:7200
  v_mfma_f32_16x16x32_bf16 v[76:79], a[64:67], a[156:159], v[76:79]
  ds_read_b64_tr_b16 a[14:15], v11 offset:10784
  v_mfma_f32_16x16x32_bf16 v[92:95], a[68:71], a[156:159], v[92:95]
  ds_read_b64_tr_b16 a[16:17], v11 offset:64
  v_mfma_f32_16x16x32_bf16 v[88:91], a[68:71], a[152:155], v[88:91]
  buffer_load_dwordx4 a[140:143], v1, s[4:7], s20 offen offset:768
  v_mfma_f32_16x16x32_bf16 v[84:87], a[68:71], a[148:151], v[84:87]
  s_add_u32 s20, s20, 0x20000
  v_mfma_f32_16x16x32_bf16 v[80:83], a[68:71], a[144:147], v[80:83]
  s_and_b32 s20, s20, 0x3fffff
  v_mfma_f32_16x16x32_bf16 v[96:99], a[72:75], a[144:147], v[96:99]
  ds_read_b64_tr_b16 a[18:19], v11 offset:3648
  v_mfma_f32_16x16x32_bf16 v[100:103], a[72:75], a[148:151], v[100:103]
  ds_read_b64_tr_b16 a[20:21], v11 offset:7232
  v_mfma_f32_16x16x32_bf16 v[104:107], a[72:75], a[152:155], v[104:107]
  s_add_u32 m0, s25, 57344
  v_mfma_f32_16x16x32_bf16 v[108:111], a[72:75], a[156:159], v[108:111]
  ds_read_b64_tr_b16 a[22:23], v11 offset:10816
  v_mfma_f32_16x16x32_bf16 v[124:127], a[76:79], a[156:159], v[124:127]
  buffer_load_dwordx4 v2, s[8:11], s21 offen offset:0  lds
  v_mfma_f32_16x16x32_bf16 v[120:123], a[76:79], a[152:155], v[120:123]
  ds_read_b64_tr_b16 a[24:25], v11 offset:96
  v_mfma_f32_16x16x32_bf16 v[116:119], a[76:79], a[148:151], v[116:119]
  ds_read_b64_tr_b16 a[26:27], v11 offset:3680
  v_mfma_f32_16x16x32_bf16 v[112:115], a[76:79], a[144:147], v[112:115]
  buffer_load_dwordx4 v3, s[8:11], s21 offen offset:1024  lds
  v_mfma_f32_16x16x32_bf16 v[128:131], a[80:83], a[144:147], v[128:131]
  ds_read_b64_tr_b16 a[28:29], v11 offset:7264
  v_mfma_f32_16x16x32_bf16 v[132:135], a[80:83], a[148:151], v[132:135]
  ds_read_b64_tr_b16 a[30:31], v11 offset:10848
  v_mfma_f32_16x16x32_bf16 v[136:139], a[80:83], a[152:155], v[136:139]
  ds_read_b64_tr_b16 a[32:33], v11 offset:128
  v_mfma_f32_16x16x32_bf16 v[140:143], a[80:83], a[156:159], v[140:143]
  buffer_load_dwordx4 v4, s[8:11], s21 offen offset:2048  lds
  v_mfma_f32_16x16x32_bf16 v[156:159], a[84:87], a[156:159], v[156:159]
  ds_read_b64_tr_b16 a[34:35], v11 offset:3712
  v_mfma_f32_16x16x32_bf16 v[152:155], a[84:87], a[152:155], v[152:155]
  ds_read_b64_tr_b16 a[36:37], v11 offset:7296
  v_mfma_f32_16x16x32_bf16 v[148:151], a[84:87], a[148:151], v[148:151]
  ds_read_b64_tr_b16 a[38:39], v11 offset:10880
  v_mfma_f32_16x16x32_bf16 v[144:147], a[84:87], a[144:147], v[144:147]
  ds_read_b64_tr_b16 a[40:41], v11 offset:160
  v_mfma_f32_16x16x32_bf16 v[160:163], a[88:91], a[144:147], v[160:163]
  ds_read_b64_tr_b16 a[42:43], v11 offset:3744
  v_mfma_f32_16x16x32_bf16 v[164:167], a[88:91], a[148:151], v[164:167]
  ds_read_b64_tr_b16 a[44:45], v11 offset:7328
  v_mfma_f32_16x16x32_bf16 v[168:171], a[88:91], a[152:155], v[168:171]
  ds_read_b64_tr_b16 a[46:47], v11 offset:10912
  v_mfma_f32_16x16x32_bf16 v[172:175], a[88:91], a[156:159], v[172:175]
  ds_read_b64_tr_b16 a[48:49], v11 offset:192
  v_mfma_f32_16x16x32_bf16 v[188:191], a[92:95], a[156:159], v[188:191]
  ds_read_b64_tr_b16 a[50:51], v11 offset:3776
  v_mfma_f32_16x16x32_bf16 v[184:187], a[92:95], a[152:155], v[184:187]
  ds_read_b64_tr_b16 a[52:53], v11 offset:7360
  v_mfma_f32_16x16x32_bf16 v[180:183], a[92:95], a[148:151], v[180:183]
  ds_read_b64_tr_b16 a[54:55], v11 offset:10944
  v_mfma_f32_16x16x32_bf16 v[176:179], a[92:95], a[144:147], v[176:179]
  v_mfma_f32_16x16x32_bf16 v[192:195], a[96:99], a[144:147], v[192:195]
  v_mfma_f32_16x16x32_bf16 v[196:199], a[96:99], a[148:151], v[196:199]
  v_mfma_f32_16x16x32_bf16 v[200:203], a[96:99], a[152:155], v[200:203]
  v_mfma_f32_16x16x32_bf16 v[204:207], a[96:99], a[156:159], v[204:207]
  v_mfma_f32_16x16x32_bf16 v[220:223], a[100:103], a[156:159], v[220:223]
  v_mfma_f32_16x16x32_bf16 v[216:219], a[100:103], a[152:155], v[216:219]
  v_mfma_f32_16x16x32_bf16 v[212:215], a[100:103], a[148:151], v[212:215]
  v_mfma_f32_16x16x32_bf16 v[208:211], a[100:103], a[144:147], v[208:211]
  v_mfma_f32_16x16x32_bf16 v[224:227], a[104:107], a[144:147], v[224:227]
  v_mfma_f32_16x16x32_bf16 v[228:231], a[104:107], a[148:151], v[228:231]
  v_mfma_f32_16x16x32_bf16 v[232:235], a[104:107], a[152:155], v[232:235]
  v_mfma_f32_16x16x32_bf16 v[236:239], a[104:107], a[156:159], v[236:239]
  v_mfma_f32_16x16x32_bf16 v[252:255], a[108:111], a[156:159], v[252:255]
  v_mfma_f32_16x16x32_bf16 v[248:251], a[108:111], a[152:155], v[248:251]
  v_mfma_f32_16x16x32_bf16 v[244:247], a[108:111], a[148:151], v[244:247]
  v_mfma_f32_16x16x32_bf16 v[240:243], a[108:111], a[144:147], v[240:243]
g1_s8:
  s_waitcnt vmcnt(30) lgkmcnt(0)
  v_mfma_f32_16x16x32_bf16 v[32:35], a[0:3], a[160:163], v[32:35]
  ds_read_b64_tr_b16 a[56:57], v11 offset:14336
  v_mfma_f32_16x16x32_bf16 v[36:39], a[0:3], a[164:167], v[36:39]
  ds_read_b64_tr_b16 a[58:59], v11 offset:17920
  v_mfma_f32_16x16x32_bf16 v[40:43], a[0:3], a[168:171], v[40:43]
  buffer_load_dwordx4 a[144:147], v1, s[4:7], s20 offen offset:0
  v_mfma_f32_16x16x32_bf16 v[44:47], a[0:3], a[172:175], v[44:47]
  ds_read_b64_tr_b16 a[60:61], v11 offset:21504
  v_mfma_f32_16x16x32_bf16 v[60:63], a[4:7], a[172:175], v[60:63]
  ds_read_b64_tr_b16 a[62:63], v11 offset:25088
  v_mfma_f32_16x16x32_bf16 v[56:59], a[4:7], a[168:171], v[56:59]
  buffer_load_dwordx4 a[148:151], v1, s[4:7], s20 offen offset:256
  v_mfma_f32_16x16x32_bf16 v[52:55], a[4:7], a[164:167], v[52:55]
  ds_read_b64_tr_b16 a[64:65], v11 offset:14368
  v_mfma_f32_16x16x32_bf16 v[48:51], a[4:7], a[160:163], v[48:51]
  ds_read_b64_tr_b16 a[66:67], v11 offset:17952
  v_mfma_f32_16x16x32_bf16 v[64:67], a[8:11], a[160:163], v[64:67]
  buffer_load_dwordx4 a[152:155], v1, s[4:7], s20 offen offset:512
  v_mfma_f32_16x16x32_bf16 v[68:71], a[8:11], a[164:167], v[68:71]
  ds_read_b64_tr_b16 a[68:69], v11 offset:21536
  v_mfma_f32_16x16x32_bf16 v[72:75], a[8:11], a[168:171], v[72:75]
  ds_read_b64_tr_b16 a[70:71], v11 offset:25120
  v_mfma_f32_16x16x32_bf16 v[76:79], a[8:11], a[172:175], v[76:79]
  ds_read_b64_tr_b16 a[72:73], v11 offset:14400
  v_mfma_f32_16x16x32_bf16 v[92:95], a[12:15], a[172:175], v[92:95]
  buffer_load_dwordx4 a[156:159], v1, s[4:7], s20 offen offset:768
  v_mfma_f32_16x16x32_bf16 v[88:91], a[12:15], a[168:171], v[88:91]
  s_add_u32 s20, s20, 0x20000
  v_mfma_f32_16x16x32_bf16 v[84:87], a[12:15], a[164:167], v[84:87]
  ds_read_b64_tr_b16 a[74:75], v11 offset:17984
  v_mfma_f32_16x16x32_bf16 v[80:83], a[12:15], a[160:163], v[80:83]
  ds_read_b64_tr_b16 a[76:77], v11 offset:21568
  v_mfma_f32_16x16x32_bf16 v[96:99], a[16:19], a[160:163], v[96:99]
  ds_read_b64_tr_b16 a[78:79], v11 offset:25152
  v_mfma_f32_16x16x32_bf16 v[100:103], a[16:19], a[164:167], v[100:103]
  buffer_load_dwordx4 v5, s[8:11], s21 offen offset:3072  lds
  v_mfma_f32_16x16x32_bf16 v[104:107], a[16:19], a[168:171], v[104:107]
  ds_read_b64_tr_b16 a[80:81], v11 offset:14432
  v_mfma_f32_16x16x32_bf16 v[108:111], a[16:19], a[172:175], v[108:111]
  ds_read_b64_tr_b16 a[82:83], v11 offset:18016
  v_mfma_f32_16x16x32_bf16 v[124:127], a[20:23], a[172:175], v[124:127]
  s_add_u32 m0, s25, 61440
  v_mfma_f32_16x16x32_bf16 v[120:123], a[20:23], a[168:171], v[120:123]
  buffer_load_dwordx4 v6, s[8:11], s21 offen offset:0  lds
  v_mfma_f32_16x16x32_bf16 v[116:119], a[20:23], a[164:167], v[116:119]
  ds_read_b64_tr_b16 a[84:85], v11 offset:21600
  v_mfma_f32_16x16x32_bf16 v[112:115], a[20:23], a[160:163], v[112:115]
  ds_read_b64_tr_b16 a[86:87], v11 offset:25184
  v_mfma_f32_16x16x32_bf16 v[128:131], a[24:27], a[160:163], v[128:131]
  ds_read_b64_tr_b16 a[88:89], v11 offset:14464
  v_mfma_f32_16x16x32_bf16 v[132:135], a[24:27], a[164:167], v[132:135]
  buffer_load_dwordx4 v7, s[8:11], s21 offen offset:1024  lds
  v_mfma_f32_16x16x32_bf16 v[136:139], a[24:27], a[168:171], v[136:139]
  ds_read_b64_tr_b16 a[90:91], v11 offset:18048
  v_mfma_f32_16x16x32_bf16 v[140:143], a[24:27], a[172:175], v[140:143]
  ds_read_b64_tr_b16 a[92:93], v11 offset:21632
  v_mfma_f32_16x16x32_bf16 v[156:159], a[28:31], a[172:175], v[156:159]
  ds_read_b64_tr_b16 a[94:95], v11 offset:25216
  v_mfma_f32_16x16x32_bf16 v[152:155], a[28:31], a[168:171], v[152:155]
  buffer_load_dwordx4 v8, s[8:11], s21 offen offset:2048  lds
  v_mfma_f32_16x16x32_bf16 v[148:151], a[28:31], a[164:167], v[148:151]
  s_add_u32 s21, s21, 458752
  s_cmp_eq_u32 s21, 7340032
  s_cselect_b32 s21, 0, s21
  v_mfma_f32_16x16x32_bf16 v[144:147], a[28:31], a[160:163], v[144:147]
  v_mfma_f32_16x16x32_bf16 v[160:163], a[32:35], a[160:163], v[160:163]
  v_mfma_f32_16x16x32_bf16 v[164:167], a[32:35], a[164:167], v[164:167]
  ds_read_b64_tr_b16 a[96:97], v11 offset:14496
  v_mfma_f32_16x16x32_bf16 v[168:171], a[32:35], a[168:171], v[168:171]
  ds_read_b64_tr_b16 a[98:99], v11 offset:18080
  v_mfma_f32_16x16x32_bf16 v[172:175], a[32:35], a[172:175], v[172:175]
  ds_read_b64_tr_b16 a[100:101], v11 offset:21664
  v_mfma_f32_16x16x32_bf16 v[188:191], a[36:39], a[172:175], v[188:191]
  ds_read_b64_tr_b16 a[102:103], v11 offset:25248
  v_mfma_f32_16x16x32_bf16 v[184:187], a[36:39], a[168:171], v[184:187]
  ds_read_b64_tr_b16 a[104:105], v11 offset:14528
  v_mfma_f32_16x16x32_bf16 v[180:183], a[36:39], a[164:167], v[180:183]
  ds_read_b64_tr_b16 a[106:107], v11 offset:18112
  v_mfma_f32_16x16x32_bf16 v[176:179], a[36:39], a[160:163], v[176:179]
  ds_read_b64_tr_b16 a[108:109], v11 offset:21696
  v_mfma_f32_16x16x32_bf16 v[192:195], a[40:43], a[160:163], v[192:195]
  ds_read_b64_tr_b16 a[110:111], v11 offset:25280
  v_mfma_f32_16x16x32_bf16 v[196:199], a[40:43], a[164:167], v[196:199]
  v_mfma_f32_16x16x32_bf16 v[200:203], a[40:43], a[168:171], v[200:203]
  v_mfma_f32_16x16x32_bf16 v[204:207], a[40:43], a[172:175], v[204:207]
  v_mfma_f32_16x16x32_bf16 v[220:223], a[44:47], a[172:175], v[220:223]
  v_mfma_f32_16x16x32_bf16 v[216:219], a[44:47], a[168:171], v[216:219]
  v_mfma_f32_16x16x32_bf16 v[212:215], a[44:47], a[164:167], v[212:215]
  v_mfma_f32_16x16x32_bf16 v[208:211], a[44:47], a[160:163], v[208:211]
  v_mfma_f32_16x16x32_bf16 v[224:227], a[48:51], a[160:163], v[224:227]
  v_mfma_f32_16x16x32_bf16 v[228:231], a[48:51], a[164:167], v[228:231]
  v_mfma_f32_16x16x32_bf16 v[232:235], a[48:51], a[168:171], v[232:235]
  v_mfma_f32_16x16x32_bf16 v[236:239], a[48:51], a[172:175], v[236:239]
  v_mfma_f32_16x16x32_bf16 v[252:255], a[52:55], a[172:175], v[252:255]
  v_mfma_f32_16x16x32_bf16 v[248:251], a[52:55], a[168:171], v[248:251]
  v_mfma_f32_16x16x32_bf16 v[244:247], a[52:55], a[164:167], v[244:247]
  v_mfma_f32_16x16x32_bf16 v[240:243], a[52:55], a[160:163], v[240:243]
g1_s9:
  s_waitcnt vmcnt(26) lgkmcnt(0)
  v_mfma_f32_16x16x32_bf16 v[32:35], a[56:59], a[176:179], v[32:35]
  s_barrier
  v_mfma_f32_16x16x32_bf16 v[36:39], a[56:59], a[180:183], v[36:39]
  ds_read_b64_tr_b16 a[0:1], v9 offset:0
  v_mfma_f32_16x16x32_bf16 v[40:43], a[56:59], a[184:187], v[40:43]
  ds_read_b64_tr_b16 a[2:3], v9 offset:3584
  v_mfma_f32_16x16x32_bf16 v[44:47], a[56:59], a[188:191], v[44:47]
  buffer_load_dwordx4 a[160:163], v1, s[4:7], s20 offen offset:0
  v_mfma_f32_16x16x32_bf16 v[60:63], a[60:63], a[188:191], v[60:63]
  ds_read_b64_tr_b16 a[4:5], v9 offset:7168
  v_mfma_f32_16x16x32_bf16 v[56:59], a[60:63], a[184:187], v[56:59]
  ds_read_b64_tr_b16 a[6:7], v9 offset:10752
  v_mfma_f32_16x16x32_bf16 v[52:55], a[60:63], a[180:183], v[52:55]
  buffer_load_dwordx4 a[164:167], v1, s[4:7], s20 offen offset:256
  v_mfma_f32_16x16x32_bf16 v[48:51], a[60:63], a[176:179], v[48:51]
  ds_read_b64_tr_b16 a[8:9], v9 offset:32
  v_mfma_f32_16x16x32_bf16 v[64:67], a[64:67], a[176:179], v[64:67]
  ds_read_b64_tr_b16 a[10:11], v9 offset:3616
  v_mfma_f32_16x16x32_bf16 v[68:71], a[64:67], a[180:183], v[68:71]
  buffer_load_dwordx4 a[168:171], v1, s[4:7], s20 offen offset:512
  v_mfma_f32_16x16x32_bf16 v[72:75], a[64:67], a[184:187], v[72:75]
  ds_read_b64_tr_b16 a[12:13], v9 offset:7200
  v_mfma_f32_16x16x32_bf16 v[76:79], a[64:67], a[188:191], v[76:79]
  ds_read_b64_tr_b16 a[14:15], v9 offset:10784
  v_mfma_f32_16x16x32_bf16 v[92:95], a[68:71], a[188:191], v[92:95]
  ds_read_b64_tr_b16 a[16:17], v9 offset:64
  v_mfma_f32_16x16x32_bf16 v[88:91], a[68:71], a[184:187], v[88:91]
  buffer_load_dwordx4 a[172:175], v1, s[4:7], s20 offen offset:768
  v_mfma_f32_16x16x32_bf16 v[84:87], a[68:71], a[180:183], v[84:87]
  s_add_u32 s20, s20, 0x20000
  v_mfma_f32_16x16x32_bf16 v[80:83], a[68:71], a[176:179], v[80:83]
  ds_read_b64_tr_b16 a[18:19], v9 offset:3648
  v_mfma_f32_16x16x32_bf16 v[96:99], a[72:75], a[176:179], v[96:99]
  ds_read_b64_tr_b16 a[20:21], v9 offset:7232
  v_mfma_f32_16x16x32_bf16 v[100:103], a[72:75], a[180:183], v[100:103]
  s_add_u32 m0, s25, 86016
  v_mfma_f32_16x16x32_bf16 v[104:107], a[72:75], a[184:187], v[104:107]
  ds_read_b64_tr_b16 a[22:23], v9 offset:10816
  v_mfma_f32_16x16x32_bf16 v[108:111], a[72:75], a[188:191], v[108:111]
  buffer_load_dwordx4 v2, s[8:11], s21 offen offset:0  lds
  v_mfma_f32_16x16x32_bf16 v[124:127], a[76:79], a[188:191], v[124:127]
  ds_read_b64_tr_b16 a[24:25], v9 offset:96
  v_mfma_f32_16x16x32_bf16 v[120:123], a[76:79], a[184:187], v[120:123]
  ds_read_b64_tr_b16 a[26:27], v9 offset:3680
  v_mfma_f32_16x16x32_bf16 v[116:119], a[76:79], a[180:183], v[116:119]
  buffer_load_dwordx4 v3, s[8:11], s21 offen offset:1024  lds
  v_mfma_f32_16x16x32_bf16 v[112:115], a[76:79], a[176:179], v[112:115]
  ds_read_b64_tr_b16 a[28:29], v9 offset:7264
  v_mfma_f32_16x16x32_bf16 v[128:131], a[80:83], a[176:179], v[128:131]
  ds_read_b64_tr_b16 a[30:31], v9 offset:10848
  v_mfma_f32_16x16x32_bf16 v[132:135], a[80:83], a[180:183], v[132:135]
  ds_read_b64_tr_b16 a[32:33], v9 offset:128
  v_mfma_f32_16x16x32_bf16 v[136:139], a[80:83], a[184:187], v[136:139]
  buffer_load_dwordx4 v4, s[8:11], s21 offen offset:2048  lds
  v_mfma_f32_16x16x32_bf16 v[140:143], a[80:83], a[188:191], v[140:143]
  ds_read_b64_tr_b16 a[34:35], v9 offset:3712
  v_mfma_f32_16x16x32_bf16 v[156:159], a[84:87], a[188:191], v[156:159]
  ds_read_b64_tr_b16 a[36:37], v9 offset:7296
  v_mfma_f32_16x16x32_bf16 v[152:155], a[84:87], a[184:187], v[152:155]
  ds_read_b64_tr_b16 a[38:39], v9 offset:10880
  v_mfma_f32_16x16x32_bf16 v[148:151], a[84:87], a[180:183], v[148:151]
  ds_read_b64_tr_b16 a[40:41], v9 offset:160
  v_mfma_f32_16x16x32_bf16 v[144:147], a[84:87], a[176:179], v[144:147]
  ds_read_b64_tr_b16 a[42:43], v9 offset:3744
  v_mfma_f32_16x16x32_bf16 v[160:163], a[88:91], a[176:179], v[160:163]
  ds_read_b64_tr_b16 a[44:45], v9 offset:7328
  v_mfma_f32_16x16x32_bf16 v[164:167], a[88:91], a[180:183], v[164:167]
  ds_read_b64_tr_b16 a[46:47], v9 offset:10912
  v_mfma_f32_16x16x32_bf16 v[168:171], a[88:91], a[184:187], v[168:171]
  ds_read_b64_tr_b16 a[48:49], v9 offset:192
  v_mfma_f32_16x16x32_bf16 v[172:175], a[88:91], a[188:191], v[172:175]
  ds_read_b64_tr_b16 a[50:51], v9 offset:3776
  v_mfma_f32_16x16x32_bf16 v[188:191], a[92:95], a[188:191], v[188:191]
  ds_read_b64_tr_b16 a[52:53], v9 offset:7360
  v_mfma_f32_16x16x32_bf16 v[184:187], a[92:95], a[184:187], v[184:187]
  ds_read_b64_tr_b16 a[54:55], v9 offset:10944
  v_mfma_f32_16x16x32_bf16 v[180:183], a[92:95], a[180:183], v[180:183]
  s_add_u32 s51, s50, g1_s12 - g1_pc
  v_mfma_f32_16x16x32_bf16 v[176:179], a[92:95], a[176:179], v[176:179]
  s_min_u32 s51, s51, code_end - g1_pc - 4
  v_mfma_f32_16x16x32_bf16 v[192:195], a[96:99], a[176:179], v[192:195]
  v_mov_b32 v23, s51
  v_mfma_f32_16x16x32_bf16 v[196:199], a[96:99], a[180:183], v[196:199]
  global_load_dword a212, v23, s[48:49]
  v_mfma_f32_16x16x32_bf16 v[200:203], a[96:99], a[184:187], v[200:203]
  v_mfma_f32_16x16x32_bf16 v[204:207], a[96:99], a[188:191], v[204:207]
  v_mfma_f32_16x16x32_bf16 v[220:223], a[100:103], a[188:191], v[220:223]
  v_mfma_f32_16x16x32_bf16 v[216:219], a[100:103], a[184:187], v[216:219]
  v_mfma_f32_16x16x32_bf16 v[212:215], a[100:103], a[180:183], v[212:215]
  v_mfma_f32_16x16x32_bf16 v[208:211], a[100:103], a[176:179], v[208:211]
  v_mfma_f32_16x16x32_bf16 v[224:227], a[104:107], a[176:179], v[224:227]
  v_mfma_f32_16x16x32_bf16 v[228:231], a[104:107], a[180:183], v[228:231]
  v_mfma_f32_16x16x32_bf16 v[232:235], a[104:107], a[184:187], v[232:235]
  v_mfma_f32_16x16x32_bf16 v[236:239], a[104:107], a[188:191], v[236:239]
  v_mfma_f32_16x16x32_bf16 v[252:255], a[108:111], a[188:191], v[252:255]
  v_mfma_f32_16x16x32_bf16 v[248:251], a[108:111], a[184:187], v[248:251]
  v_mfma_f32_16x16x32_bf16 v[244:247], a[108:111], a[180:183], v[244:247]
  v_mfma_f32_16x16x32_bf16 v[240:243], a[108:111], a[176:179], v[240:243]
g1_s10:
  s_waitcnt vmcnt(27) lgkmcnt(0)
  v_mfma_f32_16x16x32_bf16 v[32:35], a[0:3], a[112:115], v[32:35]
  ds_read_b64_tr_b16 a[56:57], v9 offset:14336
  v_mfma_f32_16x16x32_bf16 v[36:39], a[0:3], a[116:119], v[36:39]
  ds_read_b64_tr_b16 a[58:59], v9 offset:17920
  v_mfma_f32_16x16x32_bf16 v[40:43], a[0:3], a[120:123], v[40:43]
  buffer_load_dwordx4 a[176:179], v1, s[4:7], s20 offen offset:0
  v_mfma_f32_16x16x32_bf16 v[44:47], a[0:3], a[124:127], v[44:47]
  ds_read_b64_tr_b16 a[60:61], v9 offset:21504
  v_mfma_f32_16x16x32_bf16 v[60:63], a[4:7], a[124:127], v[60:63]
  ds_read_b64_tr_b16 a[62:63], v9 offset:25088
  v_mfma_f32_16x16x32_bf16 v[56:59], a[4:7], a[120:123], v[56:59]
  buffer_load_dwordx4 a[180:183], v1, s[4:7], s20 offen offset:256
  v_mfma_f32_16x16x32_bf16 v[52:55], a[4:7], a[116:119], v[52:55]
  ds_read_b64_tr_b16 a[64:65], v9 offset:14368
  v_mfma_f32_16x16x32_bf16 v[48:51], a[4:7], a[112:115], v[48:51]
  ds_read_b64_tr_b16 a[66:67], v9 offset:17952
  v_mfma_f32_16x16x32_bf16 v[64:67], a[8:11], a[112:115], v[64:67]
  buffer_load_dwordx4 a[184:187], v1, s[4:7], s20 offen offset:512
  v_mfma_f32_16x16x32_bf16 v[68:71], a[8:11], a[116:119], v[68:71]
  ds_read_b64_tr_b16 a[68:69], v9 offset:21536
  v_mfma_f32_16x16x32_bf16 v[72:75], a[8:11], a[120:123], v[72:75]
  ds_read_b64_tr_b16 a[70:71], v9 offset:25120
  v_mfma_f32_16x16x32_bf16 v[76:79], a[8:11], a[124:127], v[76:79]
  ds_read_b64_tr_b16 a[72:73], v9 offset:14400
  v_mfma_f32_16x16x32_bf16 v[92:95], a[12:15], a[124:127], v[92:95]
  buffer_load_dwordx4 a[188:191], v1, s[4:7], s20 offen offset:768
  v_mfma_f32_16x16x32_bf16 v[88:91], a[12:15], a[120:123], v[88:91]
  s_add_u32 s20, s20, 0x20000
  v_mfma_f32_16x16x32_bf16 v[84:87], a[12:15], a[116:119], v[84:87]
  ds_read_b64_tr_b16 a[74:75], v9 offset:17984
  v_mfma_f32_16x16x32_bf16 v[80:83], a[12:15], a[112:115], v[80:83]
  ds_read_b64_tr_b16 a[76:77], v9 offset:21568
  v_mfma_f32_16x16x32_bf16 v[96:99], a[16:19], a[112:115], v[96:99]
  ds_read_b64_tr_b16 a[78:79], v9 offset:25152
  v_mfma_f32_16x16x32_bf16 v[100:103], a[16:19], a[116:119], v[100:103]
  buffer_load_dwordx4 v5, s[8:11], s21 offen offset:3072  lds
  v_mfma_f32_16x16x32_bf16 v[104:107], a[16:19], a[120:123], v[104:107]
  ds_read_b64_tr_b16 a[80:81], v9 offset:14432
  v_mfma_f32_16x16x32_bf16 v[108:111], a[16:19], a[124:127], v[108:111]
  ds_read_b64_tr_b16 a[82:83], v9 offset:18016
  v_mfma_f32_16x16x32_bf16 v[124:127], a[20:23], a[124:127], v[124:127]
  s_add_u32 m0, s25, 90112
  v_mfma_f32_16x16x32_bf16 v[120:123], a[20:23], a[120:123], v[120:123]
  buffer_load_dwordx4 v6, s[8:11], s21 offen offset:0  lds
  v_mfma_f32_16x16x32_bf16 v[116:119], a[20:23], a[116:119], v[116:119]
  ds_read_b64_tr_b16 a[84:85], v9 offset:21600
  v_mfma_f32_16x16x32_bf16 v[112:115], a[20:23], a[112:115], v[112:115]
  ds_read_b64_tr_b16 a[86:87], v9 offset:25184
  v_mfma_f32_16x16x32_bf16 v[128:131], a[24:27], a[112:115], v[128:131]
  ds_read_b64_tr_b16 a[88:89], v9 offset:14464
  v_mfma_f32_16x16x32_bf16 v[132:135], a[24:27], a[116:119], v[132:135]
  buffer_load_dwordx4 v7, s[8:11], s21 offen offset:1024  lds
  v_mfma_f32_16x16x32_bf16 v[136:139], a[24:27], a[120:123], v[136:139]
  ds_read_b64_tr_b16 a[90:91], v9 offset:18048
  v_mfma_f32_16x16x32_bf16 v[140:143], a[24:27], a[124:127], v[140:143]
  ds_read_b64_tr_b16 a[92:93], v9 offset:21632
  v_mfma_f32_16x16x32_bf16 v[156:159], a[28:31], a[124:127], v[156:159]
  ds_read_b64_tr_b16 a[94:95], v9 offset:25216
  v_mfma_f32_16x16x32_bf16 v[152:155], a[28:31], a[120:123], v[152:155]
  buffer_load_dwordx4 v8, s[8:11], s21 offen offset:2048  lds
  v_mfma_f32_16x16x32_bf16 v[148:151], a[28:31], a[116:119], v[148:151]
  s_add_u32 s21, s21, 458752
  v_mfma_f32_16x16x32_bf16 v[144:147], a[28:31], a[112:115], v[144:147]
  ds_read_b64_tr_b16 a[96:97], v9 offset:14496
  v_mfma_f32_16x16x32_bf16 v[160:163], a[32:35], a[112:115], v[160:163]
  ds_read_b64_tr_b16 a[98:99], v9 offset:18080
  v_mfma_f32_16x16x32_bf16 v[164:167], a[32:35], a[116:119], v[164:167]
  ds_read_b64_tr_b16 a[100:101], v9 offset:21664
  v_mfma_f32_16x16x32_bf16 v[168:171], a[32:35], a[120:123], v[168:171]
  ds_read_b64_tr_b16 a[102:103], v9 offset:25248
  v_mfma_f32_16x16x32_bf16 v[172:175], a[32:35], a[124:127], v[172:175]
  ds_read_b64_tr_b16 a[104:105], v9 offset:14528
  v_mfma_f32_16x16x32_bf16 v[188:191], a[36:39], a[124:127], v[188:191]
  ds_read_b64_tr_b16 a[106:107], v9 offset:18112
  v_mfma_f32_16x16x32_bf16 v[184:187], a[36:39], a[120:123], v[184:187]
  ds_read_b64_tr_b16 a[108:109], v9 offset:21696
  v_mfma_f32_16x16x32_bf16 v[180:183], a[36:39], a[116:119], v[180:183]
  ds_read_b64_tr_b16 a[110:111], v9 offset:25280
  v_mfma_f32_16x16x32_bf16 v[176:179], a[36:39], a[112:115], v[176:179]
  v_mfma_f32_16x16x32_bf16 v[192:195], a[40:43], a[112:115], v[192:195]
  v_mfma_f32_16x16x32_bf16 v[196:199], a[40:43], a[116:119], v[196:199]
  v_mfma_f32_16x16x32_bf16 v[200:203], a[40:43], a[120:123], v[200:203]
  v_mfma_f32_16x16x32_bf16 v[204:207], a[40:43], a[124:127], v[204:207]
  v_mfma_f32_16x16x32_bf16 v[220:223], a[44:47], a[124:127], v[220:223]
  v_mfma_f32_16x16x32_bf16 v[216:219], a[44:47], a[120:123], v[216:219]
  v_mfma_f32_16x16x32_bf16 v[212:215], a[44:47], a[116:119], v[212:215]
  v_mfma_f32_16x16x32_bf16 v[208:211], a[44:47], a[112:115], v[208:211]
  v_mfma_f32_16x16x32_bf16 v[224:227], a[48:51], a[112:115], v[224:227]
  v_mfma_f32_16x16x32_bf16 v[228:231], a[48:51], a[116:119], v[228:231]
  v_mfma_f32_16x16x32_bf16 v[232:235], a[48:51], a[120:123], v[232:235]
  v_mfma_f32_16x16x32_bf16 v[236:239], a[48:51], a[124:127], v[236:239]
  v_mfma_f32_16x16x32_bf16 v[252:255], a[52:55], a[124:127], v[252:255]
  v_mfma_f32_16x16x32_bf16 v[248:251], a[52:55], a[120:123], v[248:251]
  v_mfma_f32_16x16x32_bf16 v[244:247], a[52:55], a[116:119], v[244:247]
  v_mfma_f32_16x16x32_bf16 v[240:243], a[52:55], a[112:115], v[240:243]
g1_s11:
  s_waitcnt vmcnt(27) lgkmcnt(0)
  v_mfma_f32_16x16x32_bf16 v[32:35], a[56:59], a[128:131], v[32:35]
  s_barrier
  v_mfma_f32_16x16x32_bf16 v[36:39], a[56:59], a[132:135], v[36:39]
  ds_read_b64_tr_b16 a[0:1], v9 offset:28672
  v_mfma_f32_16x16x32_bf16 v[40:43], a[56:59], a[136:139], v[40:43]
  ds_read_b64_tr_b16 a[2:3], v9 offset:32256
  v_mfma_f32_16x16x32_bf16 v[44:47], a[56:59], a[140:143], v[44:47]
  buffer_load_dwordx4 a[112:115], v1, s[4:7], s20 offen offset:0
  v_mfma_f32_16x16x32_bf16 v[60:63], a[60:63], a[140:143], v[60:63]
  ds_read_b64_tr_b16 a[4:5], v9 offset:35840
  v_mfma_f32_16x16x32_bf16 v[56:59], a[60:63], a[136:139], v[56:59]
  ds_read_b64_tr_b16 a[6:7], v9 offset:39424
  v_mfma_f32_16x16x32_bf16 v[52:55], a[60:63], a[132:135], v[52:55]
  buffer_load_dwordx4 a[116:119], v1, s[4:7], s20 offen offset:256
  v_mfma_f32_16x16x32_bf16 v[48:51], a[60:63], a[128:131], v[48:51]
  ds_read_b64_tr_b16 a[8:9], v9 offset:28704
  v_mfma_f32_16x16x32_bf16 v[64:67], a[64:67], a[128:131], v[64:67]
  ds_read_b64_tr_b16 a[10:11], v9 offset:32288
  v_mfma_f32_16x16x32_bf16 v[68:71], a[64:67], a[132:135], v[68:71]
  buffer_load_dwordx4 a[120:123], v1, s[4:7], s20 offen offset:512
  v_mfma_f32_16x16x32_bf16 v[72:75], a[64:67], a[136:139], v[72:75]
  ds_read_b64_tr_b16 a[12:13], v9 offset:35872
  v_mfma_f32_16x16x32_bf16 v[76:79], a[64:67], a[140:143], v[76:79]
  ds_read_b64_tr_b16 a[14:15], v9 offset:39456
  v_mfma_f32_16x16x32_bf16 v[92:95], a[68:71], a[140:143], v[92:95]
  ds_read_b64_tr_b16 a[16:17], v9 offset:28736
  v_mfma_f32_16x16x32_bf16 v[88:91], a[68:71], a[136:139], v[88:91]
  buffer_load_dwordx4 a[124:127], v1, s[4:7], s20 offen offset:768
  v_mfma_f32_16x16x32_bf16 v[84:87], a[68:71], a[132:135], v[84:87]
  s_add_u32 s20, s20, 0x20000
  v_mfma_f32_16x16x32_bf16 v[80:83], a[68:71], a[128:131], v[80:83]
  s_and_b32 s20, s20, 0x3fffff
  v_mfma_f32_16x16x32_bf16 v[96:99], a[72:75], a[128:131], v[96:99]
  ds_read_b64_tr_b16 a[18:19], v9 offset:32320
  v_mfma_f32_16x16x32_bf16 v[100:103], a[72:75], a[132:135], v[100:103]
  ds_read_b64_tr_b16 a[20:21], v9 offset:35904
  v_mfma_f32_16x16x32_bf16 v[104:107], a[72:75], a[136:139], v[104:107]
  s_add_u32 m0, s25, 114688
  v_mfma_f32_16x16x32_bf16 v[108:111], a[72:75], a[140:143], v[108:111]
  ds_read_b64_tr_b16 a[22:23], v9 offset:39488
  v_mfma_f32_16x16x32_bf16 v[124:127], a[76:79], a[140:143], v[124:127]
  buffer_load_dwordx4 v2, s[8:11], s21 offen offset:0  lds
  v_mfma_f32_16x16x32_bf16 v[120:123], a[76:79], a[136:139], v[120:123]
  ds_read_b64_tr_b16 a[24:25], v9 offset:28768
  v_mfma_f32_16x16x32_bf16 v[116:119], a[76:79], a[132:135], v[116:119]
  ds_read_b64_tr_b16 a[26:27], v9 offset:32352
  v_mfma_f32_16x16x32_bf16 v[112:115], a[76:79], a[128:131], v[112:115]
  buffer_load_dwordx4 v3, s[8:11], s21 offen offset:1024  lds
  v_mfma_f32_16x16x32_bf16 v[128:131], a[80:83], a[128:131], v[128:131]
  ds_read_b64_tr_b16 a[28:29], v9 offset:35936
  v_mfma_f32_16x16x32_bf16 v[132:135], a[80:83], a[132:135], v[132:135]
  ds_read_b64_tr_b16 a[30:31], v9 offset:39520
  v_mfma_f32_16x16x32_bf16 v[136:139], a[80:83], a[136:139], v[136:139]
  ds_read_b64_tr_b16 a[32:33], v9 offset:28800
  v_mfma_f32_16x16x32_bf16 v[140:143], a[80:83], a[140:143], v[140:143]
  buffer_load_dwordx4 v4, s[8:11], s21 offen offset:2048  lds
  v_mfma_f32_16x16x32_bf16 v[156:159], a[84:87], a[140:143], v[156:159]
  ds_read_b64_tr_b16 a[34:35], v9 offset:32384
  v_mfma_f32_16x16x32_bf16 v[152:155], a[84:87], a[136:139], v[152:155]
  ds_read_b64_tr_b16 a[36:37], v9 offset:35968
  v_mfma_f32_16x16x32_bf16 v[148:151], a[84:87], a[132:135], v[148:151]
  ds_read_b64_tr_b16 a[38:39], v9 offset:39552
  v_mfma_f32_16x16x32_bf16 v[144:147], a[84:87], a[128:131], v[144:147]
  ds_read_b64_tr_b16 a[40:41], v9 offset:28832
  v_mfma_f32_16x16x32_bf16 v[160:163], a[88:91], a[128:131], v[160:163]
  ds_read_b64_tr_b16 a[42:43], v9 offset:32416
  v_mfma_f32_16x16x32_bf16 v[164:167], a[88:91], a[132:135], v[164:167]
  ds_read_b64_tr_b16 a[44:45], v9 offset:36000
  v_mfma_f32_16x16x32_bf16 v[168:171], a[88:91], a[136:139], v[168:171]
  ds_read_b64_tr_b16 a[46:47], v9 offset:39584
  v_mfma_f32_16x16x32_bf16 v[172:175], a[88:91], a[140:143], v[172:175]
  ds_read_b64_tr_b16 a[48:49], v9 offset:28864
  v_mfma_f32_16x16x32_bf16 v[188:191], a[92:95], a[140:143], v[188:191]
  ds_read_b64_tr_b16 a[50:51], v9 offset:32448
  v_mfma_f32_16x16x32_bf16 v[184:187], a[92:95], a[136:139], v[184:187]
  ds_read_b64_tr_b16 a[52:53], v9 offset:36032
  v_mfma_f32_16x16x32_bf16 v[180:183], a[92:95], a[132:135], v[180:183]
  ds_read_b64_tr_b16 a[54:55], v9 offset:39616
  v_mfma_f32_16x16x32_bf16 v[176:179], a[92:95], a[128:131], v[176:179]
  v_mfma_f32_16x16x32_bf16 v[192:195], a[96:99], a[128:131], v[192:195]
  v_mfma_f32_16x16x32_bf16 v[196:199], a[96:99], a[132:135], v[196:199]
  v_mfma_f32_16x16x32_bf16 v[200:203], a[96:99], a[136:139], v[200:203]
  v_mfma_f32_16x16x32_bf16 v[204:207], a[96:99], a[140:143], v[204:207]
  v_mfma_f32_16x16x32_bf16 v[220:223], a[100:103], a[140:143], v[220:223]
  v_mfma_f32_16x16x32_bf16 v[216:219], a[100:103], a[136:139], v[216:219]
  v_mfma_f32_16x16x32_bf16 v[212:215], a[100:103], a[132:135], v[212:215]
  v_mfma_f32_16x16x32_bf16 v[208:211], a[100:103], a[128:131], v[208:211]
  v_mfma_f32_16x16x32_bf16 v[224:227], a[104:107], a[128:131], v[224:227]
  v_mfma_f32_16x16x32_bf16 v[228:231], a[104:107], a[132:135], v[228:231]
  v_mfma_f32_16x16x32_bf16 v[232:235], a[104:107], a[136:139], v[232:235]
  v_mfma_f32_16x16x32_bf16 v[236:239], a[104:107], a[140:143], v[236:239]
  v_mfma_f32_16x16x32_bf16 v[252:255], a[108:111], a[140:143], v[252:255]
  v_mfma_f32_16x16x32_bf16 v[248:251], a[108:111], a[136:139], v[248:251]
  v_mfma_f32_16x16x32_bf16 v[244:247], a[108:111], a[132:135], v[244:247]
  v_mfma_f32_16x16x32_bf16 v[240:243], a[108:111], a[128:131], v[240:243]
g1_s12:
  s_waitcnt vmcnt(27) lgkmcnt(0)
  v_mfma_f32_16x16x32_bf16 v[32:35], a[0:3], a[144:147], v[32:35]
  ds_read_b64_tr_b16 a[56:57], v9 offset:43008
  v_mfma_f32_16x16x32_bf16 v[36:39], a[0:3], a[148:151], v[36:39]
  ds_read_b64_tr_b16 a[58:59], v9 offset:46592
  v_mfma_f32_16x16x32_bf16 v[40:43], a[0:3], a[152:155], v[40:43]
  buffer_load_dwordx4 a[128:131], v1, s[4:7], s20 offen offset:0
  v_mfma_f32_16x16x32_bf16 v[44:47], a[0:3], a[156:159], v[44:47]
  ds_read_b64_tr_b16 a[60:61], v9 offset:50176
  v_mfma_f32_16x16x32_bf16 v[60:63], a[4:7], a[156:159], v[60:63]
  ds_read_b64_tr_b16 a[62:63], v9 offset:53760
  v_mfma_f32_16x16x32_bf16 v[56:59], a[4:7], a[152:155], v[56:59]
  buffer_load_dwordx4 a[132:135], v1, s[4:7], s20 offen offset:256
  v_mfma_f32_16x16x32_bf16 v[52:55], a[4:7], a[148:151], v[52:55]
  ds_read_b64_tr_b16 a[64:65], v9 offset:43040
  v_mfma_f32_16x16x32_bf16 v[48:51], a[4:7], a[144:147], v[48:51]
  ds_read_b64_tr_b16 a[66:67], v9 offset:46624
  v_mfma_f32_16x16x32_bf16 v[64:67], a[8:11], a[144:147], v[64:67]
  buffer_load_dwordx4 a[136:139], v1, s[4:7], s20 offen offset:512
  v_mfma_f32_16x16x32_bf16 v[68:71], a[8:11], a[148:151], v[68:71]
  ds_read_b64_tr_b16 a[68:69], v9 offset:50208
  v_mfma_f32_16x16x32_bf16 v[72:75], a[8:11], a[152:155], v[72:75]
  ds_read_b64_tr_b16 a[70:71], v9 offset:53792
  v_mfma_f32_16x16x32_bf16 v[76:79], a[8:11], a[156:159], v[76:79]
  ds_read_b64_tr_b16 a[72:73], v9 offset:43072
  v_mfma_f32_16x16x32_bf16 v[92:95], a[12:15], a[156:159], v[92:95]
  buffer_load_dwordx4 a[140:143], v1, s[4:7], s20 offen offset:768
  v_mfma_f32_16x16x32_bf16 v[88:91], a[12:15], a[152:155], v[88:91]
  s_add_u32 s20, s20, 0x20000
  v_mfma_f32_16x16x32_bf16 v[84:87], a[12:15], a[148:151], v[84:87]
  ds_read_b64_tr_b16 a[74:75], v9 offset:46656
  v_mfma_f32_16x16x32_bf16 v[80:83], a[12:15], a[144:147], v[80:83]
  ds_read_b64_tr_b16 a[76:77], v9 offset:50240
  v_mfma_f32_16x16x32_bf16 v[96:99], a[16:19], a[144:147], v[96:99]
  ds_read_b64_tr_b16 a[78:79], v9 offset:53824
  v_mfma_f32_16x16x32_bf16 v[100:103], a[16:19], a[148:151], v[100:103]
  buffer_load_dwordx4 v5, s[8:11], s21 offen offset:3072  lds
  v_mfma_f32_16x16x32_bf16 v[104:107], a[16:19], a[152:155], v[104:107]
  ds_read_b64_tr_b16 a[80:81], v9 offset:43104
  v_mfma_f32_16x16x32_bf16 v[108:111], a[16:19], a[156:159], v[108:111]
  ds_read_b64_tr_b16 a[82:83], v9 offset:46688
  v_mfma_f32_16x16x32_bf16 v[124:127], a[20:23], a[156:159], v[124:127]
  s_add_u32 m0, s25, 118784
  v_mfma_f32_16x16x32_bf16 v[120:123], a[20:23], a[152:155], v[120:123]
  buffer_load_dwordx4 v6, s[8:11], s21 offen offset:0  lds
  v_mfma_f32_16x16x32_bf16 v[116:119], a[20:23], a[148:151], v[116:119]
  ds_read_b64_tr_b16 a[84:85], v9 offset:50272
  v_mfma_f32_16x16x32_bf16 v[112:115], a[20:23], a[144:147], v[112:115]
  ds_read_b64_tr_b16 a[86:87], v9 offset:53856
  v_mfma_f32_16x16x32_bf16 v[128:131], a[24:27], a[144:147], v[128:131]
  ds_read_b64_tr_b16 a[88:89], v9 offset:43136
  v_mfma_f32_16x16x32_bf16 v[132:135], a[24:27], a[148:151], v[132:135]
  buffer_load_dwordx4 v7, s[8:11], s21 offen offset:1024  lds
  v_mfma_f32_16x16x32_bf16 v[136:139], a[24:27], a[152:155], v[136:139]
  ds_read_b64_tr_b16 a[90:91], v9 offset:46720
  v_mfma_f32_16x16x32_bf16 v[140:143], a[24:27], a[156:159], v[140:143]
  ds_read_b64_tr_b16 a[92:93], v9 offset:50304
  v_mfma_f32_16x16x32_bf16 v[156:159], a[28:31], a[156:159], v[156:159]
  ds_read_b64_tr_b16 a[94:95], v9 offset:53888
  v_mfma_f32_16x16x32_bf16 v[152:155], a[28:31], a[152:155], v[152:155]
  buffer_load_dwordx4 v8, s[8:11], s21 offen offset:2048  lds
  v_mfma_f32_16x16x32_bf16 v[148:151], a[28:31], a[148:151], v[148:151]
  s_add_u32 s21, s21, 458752
  s_cmp_eq_u32 s21, 7340032
  s_cselect_b32 s21, 0, s21
  v_mfma_f32_16x16x32_bf16 v[144:147], a[28:31], a[144:147], v[144:147]
  v_mfma_f32_16x16x32_bf16 v[160:163], a[32:35], a[144:147], v[160:163]
  v_mfma_f32_16x16x32_bf16 v[164:167], a[32:35], a[148:151], v[164:167]
  ds_read_b64_tr_b16 a[96:97], v9 offset:43168
  v_mfma_f32_16x16x32_bf16 v[168:171], a[32:35], a[152:155], v[168:171]
  ds_read_b64_tr_b16 a[98:99], v9 offset:46752
  v_mfma_f32_16x16x32_bf16 v[172:175], a[32:35], a[156:159], v[172:175]
  ds_read_b64_tr_b16 a[100:101], v9 offset:50336
  v_mfma_f32_16x16x32_bf16 v[188:191], a[36:39], a[156:159], v[188:191]
  ds_read_b64_tr_b16 a[102:103], v9 offset:53920
  v_mfma_f32_16x16x32_bf16 v[184:187], a[36:39], a[152:155], v[184:187]
  ds_read_b64_tr_b16 a[104:105], v9 offset:43200
  v_mfma_f32_16x16x32_bf16 v[180:183], a[36:39], a[148:151], v[180:183]
  ds_read_b64_tr_b16 a[106:107], v9 offset:46784
  v_mfma_f32_16x16x32_bf16 v[176:179], a[36:39], a[144:147], v[176:179]
  ds_read_b64_tr_b16 a[108:109], v9 offset:50368
  v_mfma_f32_16x16x32_bf16 v[192:195], a[40:43], a[144:147], v[192:195]
  ds_read_b64_tr_b16 a[110:111], v9 offset:53952
  v_mfma_f32_16x16x32_bf16 v[196:199], a[40:43], a[148:151], v[196:199]
  v_mfma_f32_16x16x32_bf16 v[200:203], a[40:43], a[152:155], v[200:203]
  v_mfma_f32_16x16x32_bf16 v[204:207], a[40:43], a[156:159], v[204:207]
  v_mfma_f32_16x16x32_bf16 v[220:223], a[44:47], a[156:159], v[220:223]
  v_mfma_f32_16x16x32_bf16 v[216:219], a[44:47], a[152:155], v[216:219]
  v_mfma_f32_16x16x32_bf16 v[212:215], a[44:47], a[148:151], v[212:215]
  v_mfma_f32_16x16x32_bf16 v[208:211], a[44:47], a[144:147], v[208:211]
  v_mfma_f32_16x16x32_bf16 v[224:227], a[48:51], a[144:147], v[224:227]
  v_mfma_f32_16x16x32_bf16 v[228:231], a[48:51], a[148:151], v[228:231]
  v_mfma_f32_16x16x32_bf16 v[232:235], a[48:51], a[152:155], v[232:235]
  v_mfma_f32_16x16x32_bf16 v[236:239], a[48:51], a[156:159], v[236:239]
  v_mfma_f32_16x16x32_bf16 v[252:255], a[52:55], a[156:159], v[252:255]
  v_mfma_f32_16x16x32_bf16 v[248:251], a[52:55], a[152:155], v[248:251]
  v_mfma_f32_16x16x32_bf16 v[244:247], a[52:55], a[148:151], v[244:247]
  v_mfma_f32_16x16x32_bf16 v[240:243], a[52:55], a[144:147], v[240:243]
g1_s13:
  s_waitcnt vmcnt(27) lgkmcnt(0)
  v_mfma_f32_16x16x32_bf16 v[32:35], a[56:59], a[160:163], v[32:35]
  s_barrier
  v_mfma_f32_16x16x32_bf16 v[36:39], a[56:59], a[164:167], v[36:39]
  ds_read_b64_tr_b16 a[0:1], v10 offset:0
  v_mfma_f32_16x16x32_bf16 v[40:43], a[56:59], a[168:171], v[40:43]
  ds_read_b64_tr_b16 a[2:3], v10 offset:3584
  v_mfma_f32_16x16x32_bf16 v[44:47], a[56:59], a[172:175], v[44:47]
  buffer_load_dwordx4 a[144:147], v1, s[4:7], s20 offen offset:0
  v_mfma_f32_16x16x32_bf16 v[60:63], a[60:63], a[172:175], v[60:63]
  ds_read_b64_tr_b16 a[4:5], v10 offset:7168
  v_mfma_f32_16x16x32_bf16 v[56:59], a[60:63], a[168:171], v[56:59]
  ds_read_b64_tr_b16 a[6:7], v10 offset:10752
  v_mfma_f32_16x16x32_bf16 v[52:55], a[60:63], a[164:167], v[52:55]
  buffer_load_dwordx4 a[148:151], v1, s[4:7], s20 offen offset:256
  v_mfma_f32_16x16x32_bf16 v[48:51], a[60:63], a[160:163], v[48:51]
  ds_read_b64_tr_b16 a[8:9], v10 offset:32
  v_mfma_f32_16x16x32_bf16 v[64:67], a[64:67], a[160:163], v[64:67]
  ds_read_b64_tr_b16 a[10:11], v10 offset:3616
  v_mfma_f32_16x16x32_bf16 v[68:71], a[64:67], a[164:167], v[68:71]
  buffer_load_dwordx4 a[152:155], v1, s[4:7], s20 offen offset:512
  v_mfma_f32_16x16x32_bf16 v[72:75], a[64:67], a[168:171], v[72:75]
  ds_read_b64_tr_b16 a[12:13], v10 offset:7200
  v_mfma_f32_16x16x32_bf16 v[76:79], a[64:67], a[172:175], v[76:79]
  ds_read_b64_tr_b16 a[14:15], v10 offset:10784
  v_mfma_f32_16x16x32_bf16 v[92:95], a[68:71], a[172:175], v[92:95]
  ds_read_b64_tr_b16 a[16:17], v10 offset:64
  v_mfma_f32_16x16x32_bf16 v[88:91], a[68:71], a[168:171], v[88:91]
  buffer_load_dwordx4 a[156:159], v1, s[4:7], s20 offen offset:768
  v_mfma_f32_16x16x32_bf16 v[84:87], a[68:71], a[164:167], v[84:87]
  s_add_u32 s20, s20, 0x20000
  v_mfma_f32_16x16x32_bf16 v[80:83], a[68:71], a[160:163], v[80:83]
  ds_read_b64_tr_b16 a[18:19], v10 offset:3648
  v_mfma_f32_16x16x32_bf16 v[96:99], a[72:75], a[160:163], v[96:99]
  ds_read_b64_tr_b16 a[20:21], v10 offset:7232
  v_mfma_f32_16x16x32_bf16 v[100:103], a[72:75], a[164:167], v[100:103]
  s_add_u32 m0, s25, 0
  v_mfma_f32_16x16x32_bf16 v[104:107], a[72:75], a[168:171], v[104:107]
  ds_read_b64_tr_b16 a[22:23], v10 offset:10816
  v_mfma_f32_16x16x32_bf16 v[108:111], a[72:75], a[172:175], v[108:111]
  buffer_load_dwordx4 v2, s[8:11], s21 offen offset:0  lds
  v_mfma_f32_16x16x32_bf16 v[124:127], a[76:79], a[172:175], v[124:127]
  ds_read_b64_tr_b16 a[24:25], v10 offset:96
  v_mfma_f32_16x16x32_bf16 v[120:123], a[76:79], a[168:171], v[120:123]
  ds_read_b64_tr_b16 a[26:27], v10 offset:3680
  v_mfma_f32_16x16x32_bf16 v[116:119], a[76:79], a[164:167], v[116:119]
  buffer_load_dwordx4 v3, s[8:11], s21 offen offset:1024  lds
  v_mfma_f32_16x16x32_bf16 v[112:115], a[76:79], a[160:163], v[112:115]
  ds_read_b64_tr_b16 a[28:29], v10 offset:7264
  v_mfma_f32_16x16x32_bf16 v[128:131], a[80:83], a[160:163], v[128:131]
  ds_read_b64_tr_b16 a[30:31], v10 offset:10848
  v_mfma_f32_16x16x32_bf16 v[132:135], a[80:83], a[164:167], v[132:135]
  ds_read_b64_tr_b16 a[32:33], v10 offset:128
  v_mfma_f32_16x16x32_bf16 v[136:139], a[80:83], a[168:171], v[136:139]
  buffer_load_dwordx4 v4, s[8:11], s21 offen offset:2048  lds
  v_mfma_f32_16x16x32_bf16 v[140:143], a[80:83], a[172:175], v[140:143]
  ds_read_b64_tr_b16 a[34:35], v10 offset:3712
  v_mfma_f32_16x16x32_bf16 v[156:159], a[84:87], a[172:175], v[156:159]
  ds_read_b64_tr_b16 a[36:37], v10 offset:7296
  v_mfma_f32_16x16x32_bf16 v[152:155], a[84:87], a[168:171], v[152:155]
  ds_read_b64_tr_b16 a[38:39], v10 offset:10880
  v_mfma_f32_16x16x32_bf16 v[148:151], a[84:87], a[164:167], v[148:151]
  ds_read_b64_tr_b16 a[40:41], v10 offset:160
  v_mfma_f32_16x16x32_bf16 v[144:147], a[84:87], a[160:163], v[144:147]
  ds_read_b64_tr_b16 a[42:43], v10 offset:3744
  v_mfma_f32_16x16x32_bf16 v[160:163], a[88:91], a[160:163], v[160:163]
  ds_read_b64_tr_b16 a[44:45], v10 offset:7328
  v_mfma_f32_16x16x32_bf16 v[164:167], a[88:91], a[164:167], v[164:167]
  ds_read_b64_tr_b16 a[46:47], v10 offset:10912
  v_mfma_f32_16x16x32_bf16 v[168:171], a[88:91], a[168:171], v[168:171]
  ds_read_b64_tr_b16 a[48:49], v10 offset:192
  v_mfma_f32_16x16x32_bf16 v[172:175], a[88:91], a[172:175], v[172:175]
  ds_read_b64_tr_b16 a[50:51], v10 offset:3776
  v_mfma_f32_16x16x32_bf16 v[188:191], a[92:95], a[172:175], v[188:191]
  ds_read_b64_tr_b16 a[52:53], v10 offset:7360
  v_mfma_f32_16x16x32_bf16 v[184:187], a[92:95], a[168:171], v[184:187]
  ds_read_b64_tr_b16 a[54:55], v10 offset:10944
  v_mfma_f32_16x16x32_bf16 v[180:183], a[92:95], a[164:167], v[180:183]
  v_mfma_f32_16x16x32_bf16 v[176:179], a[92:95], a[160:163], v[176:179]
  v_mfma_f32_16x16x32_bf16 v[192:195], a[96:99], a[160:163], v[192:195]
  v_mfma_f32_16x16x32_bf16 v[196:199], a[96:99], a[164:167], v[196:199]
  v_mfma_f32_16x16x32_bf16 v[200:203], a[96:99], a[168:171], v[200:203]
  v_mfma_f32_16x16x32_bf16 v[204:207], a[96:99], a[172:175], v[204:207]
  v_mfma_f32_16x16x32_bf16 v[220:223], a[100:103], a[172:175], v[220:223]
  v_mfma_f32_16x16x32_bf16 v[216:219], a[100:103], a[168:171], v[216:219]
  v_mfma_f32_16x16x32_bf16 v[212:215], a[100:103], a[164:167], v[212:215]
  v_mfma_f32_16x16x32_bf16 v[208:211], a[100:103], a[160:163], v[208:211]
  v_mfma_f32_16x16x32_bf16 v[224:227], a[104:107], a[160:163], v[224:227]
  v_mfma_f32_16x16x32_bf16 v[228:231], a[104:107], a[164:167], v[228:231]
  v_mfma_f32_16x16x32_bf16 v[232:235], a[104:107], a[168:171], v[232:235]
  v_mfma_f32_16x16x32_bf16 v[236:239], a[104:107], a[172:175], v[236:239]
  v_mfma_f32_16x16x32_bf16 v[252:255], a[108:111], a[172:175], v[252:255]
  v_mfma_f32_16x16x32_bf16 v[248:251], a[108:111], a[168:171], v[248:251]
  v_mfma_f32_16x16x32_bf16 v[244:247], a[108:111], a[164:167], v[244:247]
  v_mfma_f32_16x16x32_bf16 v[240:243], a[108:111], a[160:163], v[240:243]
g1_s14:
  s_waitcnt vmcnt(26) lgkmcnt(0)
  v_mfma_f32_16x16x32_bf16 v[32:35], a[0:3], a[176:179], v[32:35]
  ds_read_b64_tr_b16 a[56:57], v10 offset:14336
  v_mfma_f32_16x16x32_bf16 v[36:39], a[0:3], a[180:183], v[36:39]
  ds_read_b64_tr_b16 a[58:59], v10 offset:17920
  v_mfma_f32_16x16x32_bf16 v[40:43], a[0:3], a[184:187], v[40:43]
  buffer_load_dwordx4 a[160:163], v1, s[4:7], s20 offen offset:0
  v_mfma_f32_16x16x32_bf16 v[44:47], a[0:3], a[188:191], v[44:47]
  ds_read_b64_tr_b16 a[60:61], v10 offset:21504
  v_mfma_f32_16x16x32_bf16 v[60:63], a[4:7], a[188:191], v[60:63]
  ds_read_b64_tr_b16 a[62:63], v10 offset:25088
  v_mfma_f32_16x16x32_bf16 v[56:59], a[4:7], a[184:187], v[56:59]
  buffer_load_dwordx4 a[164:167], v1, s[4:7], s20 offen offset:256
  v_mfma_f32_16x16x32_bf16 v[52:55], a[4:7], a[180:183], v[52:55]
  ds_read_b64_tr_b16 a[64:65], v10 offset:14368
  v_mfma_f32_16x16x32_bf16 v[48:51], a[4:7], a[176:179], v[48:51]
  s_mov_b32 s46, 0x700000
  v_mfma_f32_16x16x32_bf16 v[64:67], a[8:11], a[176:179], v[64:67]
  ds_read_b64_tr_b16 a[66:67], v10 offset:17952
  v_mfma_f32_16x16x32_bf16 v[68:71], a[8:11], a[180:183], v[68:71]
  s_mov_b32 s47, 0x20000
  v_mfma_f32_16x16x32_bf16 v[72:75], a[8:11], a[184:187], v[72:75]
  buffer_load_dwordx4 a[168:171], v1, s[4:7], s20 offen offset:512
  v_mfma_f32_16x16x32_bf16 v[76:79], a[8:11], a[188:191], v[76:79]
  s_mul_i32 s52, s2, 28672
  v_mfma_f32_16x16x32_bf16 v[92:95], a[12:15], a[188:191], v[92:95]
  ds_read_b64_tr_b16 a[68:69], v10 offset:21536
  v_mfma_f32_16x16x32_bf16 v[88:91], a[12:15], a[184:187], v[88:91]
  s_mul_i32 s27, s16, 1792
  v_mfma_f32_16x16x32_bf16 v[84:87], a[12:15], a[180:183], v[84:87]
  ds_read_b64_tr_b16 a[70:71], v10 offset:25120
  v_mfma_f32_16x16x32_bf16 v[80:83], a[12:15], a[176:179], v[80:83]
  s_add_u32 s52, s52, s27
  v_mfma_f32_16x16x32_bf16 v[96:99], a[16:19], a[176:179], v[96:99]
  v_min_u32 v21, 13, v12
  v_mfma_f32_16x16x32_bf16 v[100:103], a[16:19], a[180:183], v[100:103]
  ds_read_b64_tr_b16 a[72:73], v10 offset:14400
  v_mfma_f32_16x16x32_bf16 v[104:107], a[16:19], a[184:187], v[104:107]
  v_lshlrev_b32 v21, 7, v21
  v_mfma_f32_16x16x32_bf16 v[108:111], a[16:19], a[188:191], v[108:111]
  buffer_load_dwordx4 a[172:175], v1, s[4:7], s20 offen offset:768
  v_mfma_f32_16x16x32_bf16 v[124:127], a[20:23], a[188:191], v[124:127]
  s_add_u32 s20, s20, 0x20000
  v_mfma_f32_16x16x32_bf16 v[120:123], a[20:23], a[184:187], v[120:123]
  ds_read_b64_tr_b16 a[74:75], v10 offset:17984
  v_mfma_f32_16x16x32_bf16 v[116:119], a[20:23], a[180:183], v[116:119]
  ds_read_b64_tr_b16 a[76:77], v10 offset:21568
  v_mfma_f32_16x16x32_bf16 v[112:115], a[20:23], a[176:179], v[112:115]
  ds_read_b64_tr_b16 a[78:79], v10 offset:25152
  v_mfma_f32_16x16x32_bf16 v[128:131], a[24:27], a[176:179], v[128:131]
  buffer_load_dwordx4 v5, s[8:11], s21 offen offset:3072  lds
  v_mfma_f32_16x16x32_bf16 v[132:135], a[24:27], a[180:183], v[132:135]
  ds_read_b64_tr_b16 a[80:81], v10 offset:14432
  v_mfma_f32_16x16x32_bf16 v[136:139], a[24:27], a[184:187], v[136:139]
  ds_read_b64_tr_b16 a[82:83], v10 offset:18016
  v_mfma_f32_16x16x32_bf16 v[140:143], a[24:27], a[188:191], v[140:143]
  s_add_u32 m0, s25, 4096
  v_mfma_f32_16x16x32_bf16 v[156:159], a[28:31], a[188:191], v[156:159]
  buffer_load_dwordx4 v6, s[8:11], s21 offen offset:0  lds
  v_mfma_f32_16x16x32_bf16 v[152:155], a[28:31], a[184:187], v[152:155]
  ds_read_b64_tr_b16 a[84:85], v10 offset:21600
  v_mfma_f32_16x16x32_bf16 v[148:151], a[28:31], a[180:183], v[148:151]
  ds_read_b64_tr_b16 a[86:87], v10 offset:25184
  v_mfma_f32_16x16x32_bf16 v[144:147], a[28:31], a[176:179], v[144:147]
  ds_read_b64_tr_b16 a[88:89], v10 offset:14464
  v_mfma_f32_16x16x32_bf16 v[160:163], a[32:35], a[176:179], v[160:163]
  buffer_load_dwordx4 v7, s[8:11], s21 offen offset:1024  lds
  v_mfma_f32_16x16x32_bf16 v[164:167], a[32:35], a[180:183], v[164:167]
  ds_read_b64_tr_b16 a[90:91], v10 offset:18048
  v_mfma_f32_16x16x32_bf16 v[168:171], a[32:35], a[184:187], v[168:171]
  ds_read_b64_tr_b16 a[92:93], v10 offset:21632
  v_mfma_f32_16x16x32_bf16 v[172:175], a[32:35], a[188:191], v[172:175]
  ds_read_b64_tr_b16 a[94:95], v10 offset:25216
  v_mfma_f32_16x16x32_bf16 v[188:191], a[36:39], a[188:191], v[188:191]
  buffer_load_dwordx4 v8, s[8:11], s21 offen offset:2048  lds
  v_mfma_f32_16x16x32_bf16 v[184:187], a[36:39], a[184:187], v[184:187]
  s_add_u32 s21, s21, 458752
  v_mfma_f32_16x16x32_bf16 v[180:183], a[36:39], a[180:183], v[180:183]
  ds_read_b64_tr_b16 a[96:97], v10 offset:14496
  v_mfma_f32_16x16x32_bf16 v[176:179], a[36:39], a[176:179], v[176:179]
  ds_read_b64_tr_b16 a[98:99], v10 offset:18080
  v_mfma_f32_16x16x32_bf16 v[192:195], a[40:43], a[176:179], v[192:195]
  ds_read_b64_tr_b16 a[100:101], v10 offset:21664
  v_mfma_f32_16x16x32_bf16 v[196:199], a[40:43], a[180:183], v[196:199]
  ds_read_b64_tr_b16 a[102:103], v10 offset:25248
  v_mfma_f32_16x16x32_bf16 v[200:203], a[40:43], a[184:187], v[200:203]
  ds_read_b64_tr_b16 a[104:105], v10 offset:14528
  v_mfma_f32_16x16x32_bf16 v[204:207], a[40:43], a[188:191], v[204:207]
  ds_read_b64_tr_b16 a[106:107], v10 offset:18112
  v_mfma_f32_16x16x32_bf16 v[220:223], a[44:47], a[188:191], v[220:223]
  ds_read_b64_tr_b16 a[108:109], v10 offset:21696
  v_mfma_f32_16x16x32_bf16 v[216:219], a[44:47], a[184:187], v[216:219]
  ds_read_b64_tr_b16 a[110:111], v10 offset:25280
  v_mfma_f32_16x16x32_bf16 v[212:215], a[44:47], a[180:183], v[212:215]
  buffer_load_dword a212, v21, s[44:47], s52 offen
  s_add_u32 s52, s52, 7168
  v_mfma_f32_16x16x32_bf16 v[208:211], a[44:47], a[176:179], v[208:211]
  v_mfma_f32_16x16x32_bf16 v[224:227], a[48:51], a[176:179], v[224:227]
  v_mfma_f32_16x16x32_bf16 v[228:231], a[48:51], a[180:183], v[228:231]
  v_mfma_f32_16x16x32_bf16 v[232:235], a[48:51], a[184:187], v[232:235]
  v_mfma_f32_16x16x32_bf16 v[236:239], a[48:51], a[188:191], v[236:239]
  v_mfma_f32_16x16x32_bf16 v[252:255], a[52:55], a[188:191], v[252:255]
  v_mfma_f32_16x16x32_bf16 v[248:251], a[52:55], a[184:187], v[248:251]
  v_mfma_f32_16x16x32_bf16 v[244:247], a[52:55], a[180:183], v[244:247]
  v_mfma_f32_16x16x32_bf16 v[240:243], a[52:55], a[176:179], v[240:243]
g1_s15:
  s_waitcnt vmcnt(27) lgkmcnt(0)
  v_mfma_f32_16x16x32_bf16 v[32:35], a[56:59], a[112:115], v[32:35]
  s_barrier
  v_mfma_f32_16x16x32_bf16 v[36:39], a[56:59], a[116:119], v[36:39]
  ds_read_b64_tr_b16 a[0:1], v10 offset:28672
  v_mfma_f32_16x16x32_bf16 v[40:43], a[56:59], a[120:123], v[40:43]
  ds_read_b64_tr_b16 a[2:3], v10 offset:32256
  v_mfma_f32_16x16x32_bf16 v[44:47], a[56:59], a[124:127], v[44:47]
  buffer_load_dwordx4 a[176:179], v1, s[4:7], s20 offen offset:0
  v_mfma_f32_16x16x32_bf16 v[60:63], a[60:63], a[124:127], v[60:63]
  ds_read_b64_tr_b16 a[4:5], v10 offset:35840
  v_mfma_f32_16x16x32_bf16 v[56:59], a[60:63], a[120:123], v[56:59]
  ds_read_b64_tr_b16 a[6:7], v10 offset:39424
  v_mfma_f32_16x16x32_bf16 v[52:55], a[60:63], a[116:119], v[52:55]
  buffer_load_dwordx4 a[180:183], v1, s[4:7], s20 offen offset:256
  v_mfma_f32_16x16x32_bf16 v[48:51], a[60:63], a[112:115], v[48:51]
  ds_read_b64_tr_b16 a[8:9], v10 offset:28704
  v_mfma_f32_16x16x32_bf16 v[64:67], a[64:67], a[112:115], v[64:67]
  ds_read_b64_tr_b16 a[10:11], v10 offset:32288
  v_mfma_f32_16x16x32_bf16 v[68:71], a[64:67], a[116:119], v[68:71]
  buffer_load_dwordx4 a[184:187], v1, s[4:7], s20 offen offset:512
  v_mfma_f32_16x16x32_bf16 v[72:75], a[64:67], a[120:123], v[72:75]
  ds_read_b64_tr_b16 a[12:13], v10 offset:35872
  v_mfma_f32_16x16x32_bf16 v[76:79], a[64:67], a[124:127], v[76:79]
  ds_read_b64_tr_b16 a[14:15], v10 offset:39456
  v_mfma_f32_16x16x32_bf16 v[92:95], a[68:71], a[124:127], v[92:95]
  ds_read_b64_tr_b16 a[16:17], v10 offset:28736
  v_mfma_f32_16x16x32_bf16 v[88:91], a[68:71], a[120:123], v[88:91]
  buffer_load_dwordx4 a[188:191], v1, s[4:7], s20 offen offset:768
  v_mfma_f32_16x16x32_bf16 v[84:87], a[68:71], a[116:119], v[84:87]
  s_add_u32 s20, s20, 0x20000
  v_mfma_f32_16x16x32_bf16 v[80:83], a[68:71], a[112:115], v[80:83]
  s_and_b32 s20, s20, 0x3fffff
  v_mfma_f32_16x16x32_bf16 v[96:99], a[72:75], a[112:115], v[96:99]
  ds_read_b64_tr_b16 a[18:19], v10 offset:32320
  v_mfma_f32_16x16x32_bf16 v[100:103], a[72:75], a[116:119], v[100:103]
  ds_read_b64_tr_b16 a[20:21], v10 offset:35904
  v_mfma_f32_16x16x32_bf16 v[104:107], a[72:75], a[120:123], v[104:107]
  s_add_u32 m0, s25, 28672
  v_mfma_f32_16x16x32_bf16 v[108:111], a[72:75], a[124:127], v[108:111]
  ds_read_b64_tr_b16 a[22:23], v10 offset:39488
  v_mfma_f32_16x16x32_bf16 v[124:127], a[76:79], a[124:127], v[124:127]
  buffer_load_dwordx4 v2, s[8:11], s21 offen offset:0  lds
  v_mfma_f32_16x16x32_bf16 v[120:123], a[76:79], a[120:123], v[120:123]
  ds_read_b64_tr_b16 a[24:25], v10 offset:28768
  v_mfma_f32_16x16x32_bf16 v[116:119], a[76:79], a[116:119], v[116:119]
  ds_read_b64_tr_b16 a[26:27], v10 offset:32352
  v_mfma_f32_16x16x32_bf16 v[112:115], a[76:79], a[112:115], v[112:115]
  buffer_load_dwordx4 v3, s[8:11], s21 offen offset:1024  lds
  v_mfma_f32_16x16x32_bf16 v[128:131], a[80:83], a[112:115], v[128:131]
  ds_read_b64_tr_b16 a[28:29], v10 offset:35936
  v_mfma_f32_16x16x32_bf16 v[132:135], a[80:83], a[116:119], v[132:135]
  ds_read_b64_tr_b16 a[30:31], v10 offset:39520
  v_mfma_f32_16x16x32_bf16 v[136:139], a[80:83], a[120:123], v[136:139]
  ds_read_b64_tr_b16 a[32:33], v10 offset:28800
  v_mfma_f32_16x16x32_bf16 v[140:143], a[80:83], a[124:127], v[140:143]
  buffer_load_dwordx4 v4, s[8:11], s21 offen offset:2048  lds
  v_mfma_f32_16x16x32_bf16 v[156:159], a[84:87], a[124:127], v[156:159]
  ds_read_b64_tr_b16 a[34:35], v10 offset:32384
  v_mfma_f32_16x16x32_bf16 v[152:155], a[84:87], a[120:123], v[152:155]
  ds_read_b64_tr_b16 a[36:37], v10 offset:35968
  v_mfma_f32_16x16x32_bf16 v[148:151], a[84:87], a[116:119], v[148:151]
  ds_read_b64_tr_b16 a[38:39], v10 offset:39552
  v_mfma_f32_16x16x32_bf16 v[144:147], a[84:87], a[112:115], v[144:147]
  ds_read_b64_tr_b16 a[40:41], v10 offset:28832
  v_mfma_f32_16x16x32_bf16 v[160:163], a[88:91], a[112:115], v[160:163]
  ds_read_b64_tr_b16 a[42:43], v10 offset:32416
  v_mfma_f32_16x16x32_bf16 v[164:167], a[88:91], a[116:119], v[164:167]
  ds_read_b64_tr_b16 a[44:45], v10 offset:36000
  v_mfma_f32_16x16x32_bf16 v[168:171], a[88:91], a[120:123], v[168:171]
  ds_read_b64_tr_b16 a[46:47], v10 offset:39584
  v_mfma_f32_16x16x32_bf16 v[172:175], a[88:91], a[124:127], v[172:175]
  ds_read_b64_tr_b16 a[48:49], v10 offset:28864
  v_mfma_f32_16x16x32_bf16 v[188:191], a[92:95], a[124:127], v[188:191]
  ds_read_b64_tr_b16 a[50:51], v10 offset:32448
  v_mfma_f32_16x16x32_bf16 v[184:187], a[92:95], a[120:123], v[184:187]
  ds_read_b64_tr_b16 a[52:53], v10 offset:36032
  v_mfma_f32_16x16x32_bf16 v[180:183], a[92:95], a[116:119], v[180:183]
  ds_read_b64_tr_b16 a[54:55], v10 offset:39616
  v_mfma_f32_16x16x32_bf16 v[176:179], a[92:95], a[112:115], v[176:179]
  s_add_u32 s51, s50, g1_s18 - g1_pc
  v_mfma_f32_16x16x32_bf16 v[192:195], a[96:99], a[112:115], v[192:195]
  s_min_u32 s51, s51, code_end - g1_pc - 4
  v_mfma_f32_16x16x32_bf16 v[196:199], a[96:99], a[116:119], v[196:199]
  v_mov_b32 v23, s51
  v_mfma_f32_16x16x32_bf16 v[200:203], a[96:99], a[120:123], v[200:203]
  global_load_dword a212, v23, s[48:49]
  v_mfma_f32_16x16x32_bf16 v[204:207], a[96:99], a[124:127], v[204:207]
  v_mfma_f32_16x16x32_bf16 v[220:223], a[100:103], a[124:127], v[220:223]
  v_mfma_f32_16x16x32_bf16 v[216:219], a[100:103], a[120:123], v[216:219]
  v_mfma_f32_16x16x32_bf16 v[212:215], a[100:103], a[116:119], v[212:215]
  v_mfma_f32_16x16x32_bf16 v[208:211], a[100:103], a[112:115], v[208:211]
  v_mfma_f32_16x16x32_bf16 v[224:227], a[104:107], a[112:115], v[224:227]
  v_mfma_f32_16x16x32_bf16 v[228:231], a[104:107], a[116:119], v[228:231]
  v_mfma_f32_16x16x32_bf16 v[232:235], a[104:107], a[120:123], v[232:235]
  v_mfma_f32_16x16x32_bf16 v[236:239], a[104:107], a[124:127], v[236:239]
  v_mfma_f32_16x16x32_bf16 v[252:255], a[108:111], a[124:127], v[252:255]
  v_mfma_f32_16x16x32_bf16 v[248:251], a[108:111], a[120:123], v[248:251]
  v_mfma_f32_16x16x32_bf16 v[244:247], a[108:111], a[116:119], v[244:247]
  v_mfma_f32_16x16x32_bf16 v[240:243], a[108:111], a[112:115], v[240:243]
g1_s16:
  s_waitcnt vmcnt(28) lgkmcnt(0)
  v_mfma_f32_16x16x32_bf16 v[32:35], a[0:3], a[128:131], v[32:35]
  ds_read_b64_tr_b16 a[56:57], v10 offset:43008
  v_mfma_f32_16x16x32_bf16 v[36:39], a[0:3], a[132:135], v[36:39]
  ds_read_b64_tr_b16 a[58:59], v10 offset:46592
  v_mfma_f32_16x16x32_bf16 v[40:43], a[0:3], a[136:139], v[40:43]
  buffer_load_dwordx4 a[112:115], v1, s[4:7], s20 offen offset:0
  v_mfma_f32_16x16x32_bf16 v[44:47], a[0:3], a[140:143], v[44:47]
  ds_read_b64_tr_b16 a[60:61], v10 offset:50176
  v_mfma_f32_16x16x32_bf16 v[60:63], a[4:7], a[140:143], v[60:63]
  ds_read_b64_tr_b16 a[62:63], v10 offset:53760
  v_mfma_f32_16x16x32_bf16 v[56:59], a[4:7], a[136:139], v[56:59]
  buffer_load_dwordx4 a[116:119], v1, s[4:7], s20 offen offset:256
  v_mfma_f32_16x16x32_bf16 v[52:55], a[4:7], a[132:135], v[52:55]
  ds_read_b64_tr_b16 a[64:65], v10 offset:43040
  v_mfma_f32_16x16x32_bf16 v[48:51], a[4:7], a[128:131], v[48:51]
  ds_read_b64_tr_b16 a[66:67], v10 offset:46624
  v_mfma_f32_16x16x32_bf16 v[64:67], a[8:11], a[128:131], v[64:67]
  buffer_load_dwordx4 a[120:123], v1, s[4:7], s20 offen offset:512
  v_mfma_f32_16x16x32_bf16 v[68:71], a[8:11], a[132:135], v[68:71]
  ds_read_b64_tr_b16 a[68:69], v10 offset:50208
  v_mfma_f32_16x16x32_bf16 v[72:75], a[8:11], a[136:139], v[72:75]
  ds_read_b64_tr_b16 a[70:71], v10 offset:53792
  v_mfma_f32_16x16x32_bf16 v[76:79], a[8:11], a[140:143], v[76:79]
  ds_read_b64_tr_b16 a[72:73], v10 offset:43072
  v_mfma_f32_16x16x32_bf16 v[92:95], a[12:15], a[140:143], v[92:95]
  buffer_load_dwordx4 a[124:127], v1, s[4:7], s20 offen offset:768
  v_mfma_f32_16x16x32_bf16 v[88:91], a[12:15], a[136:139], v[88:91]
  s_add_u32 s20, s20, 0x20000
  v_mfma_f32_16x16x32_bf16 v[84:87], a[12:15], a[132:135], v[84:87]
  ds_read_b64_tr_b16 a[74:75], v10 offset:46656
  v_mfma_f32_16x16x32_bf16 v[80:83], a[12:15], a[128:131], v[80:83]
  ds_read_b64_tr_b16 a[76:77], v10 offset:50240
  v_mfma_f32_16x16x32_bf16 v[96:99], a[16:19], a[128:131], v[96:99]
  ds_read_b64_tr_b16 a[78:79], v10 offset:53824
  v_mfma_f32_16x16x32_bf16 v[100:103], a[16:19], a[132:135], v[100:103]
  buffer_load_dwordx4 v5, s[8:11], s21 offen offset:3072  lds
  v_mfma_f32_16x16x32_bf16 v[104:107], a[16:19], a[136:139], v[104:107]
  ds_read_b64_tr_b16 a[80:81], v10 offset:43104
  v_mfma_f32_16x16x32_bf16 v[108:111], a[16:19], a[140:143], v[108:111]
  ds_read_b64_tr_b16 a[82:83], v10 offset:46688
  v_mfma_f32_16x16x32_bf16 v[124:127], a[20:23], a[140:143], v[124:127]
  s_add_u32 m0, s25, 32768
  v_mfma_f32_16x16x32_bf16 v[120:123], a[20:23], a[136:139], v[120:123]
  buffer_load_dwordx4 v6, s[8:11], s21 offen offset:0  lds
  v_mfma_f32_16x16x32_bf16 v[116:119], a[20:23], a[132:135], v[116:119]
  ds_read_b64_tr_b16 a[84:85], v10 offset:50272
  v_mfma_f32_16x16x32_bf16 v[112:115], a[20:23], a[128:131], v[112:115]
  ds_read_b64_tr_b16 a[86:87], v10 offset:53856
  v_mfma_f32_16x16x32_bf16 v[128:131], a[24:27], a[128:131], v[128:131]
  ds_read_b64_tr_b16 a[88:89], v10 offset:43136
  v_mfma_f32_16x16x32_bf16 v[132:135], a[24:27], a[132:135], v[132:135]
  buffer_load_dwordx4 v7, s[8:11], s21 offen offset:1024  lds
  v_mfma_f32_16x16x32_bf16 v[136:139], a[24:27], a[136:139], v[136:139]
  ds_read_b64_tr_b16 a[90:91], v10 offset:46720
  v_mfma_f32_16x16x32_bf16 v[140:143], a[24:27], a[140:143], v[140:143]
  ds_read_b64_tr_b16 a[92:93], v10 offset:50304
  v_mfma_f32_16x16x32_bf16 v[156:159], a[28:31], a[140:143], v[156:159]
  ds_read_b64_tr_b16 a[94:95], v10 offset:53888
  v_mfma_f32_16x16x32_bf16 v[152:155], a[28:31], a[136:139], v[152:155]
  buffer_load_dwordx4 v8, s[8:11], s21 offen offset:2048  lds
  v_mfma_f32_16x16x32_bf16 v[148:151], a[28:31], a[132:135], v[148:151]
  s_add_u32 s21, s21, 458752
  s_cmp_eq_u32 s21, 7340032
  s_cselect_b32 s21, 0, s21
  v_mfma_f32_16x16x32_bf16 v[144:147], a[28:31], a[128:131], v[144:147]
  v_mfma_f32_16x16x32_bf16 v[160:163], a[32:35], a[128:131], v[160:163]
  v_mfma_f32_16x16x32_bf16 v[164:167], a[32:35], a[132:135], v[164:167]
  ds_read_b64_tr_b16 a[96:97], v10 offset:43168
  v_mfma_f32_16x16x32_bf16 v[168:171], a[32:35], a[136:139], v[168:171]
  ds_read_b64_tr_b16 a[98:99], v10 offset:46752
  v_mfma_f32_16x16x32_bf16 v[172:175], a[32:35], a[140:143], v[172:175]
  ds_read_b64_tr_b16 a[100:101], v10 offset:50336
  v_mfma_f32_16x16x32_bf16 v[188:191], a[36:39], a[140:143], v[188:191]
  ds_read_b64_tr_b16 a[102:103], v10 offset:53920
  v_mfma_f32_16x16x32_bf16 v[184:187], a[36:39], a[136:139], v[184:187]
  ds_read_b64_tr_b16 a[104:105], v10 offset:43200
  v_mfma_f32_16x16x32_bf16 v[180:183], a[36:39], a[132:135], v[180:183]
  ds_read_b64_tr_b16 a[106:107], v10 offset:46784
  v_mfma_f32_16x16x32_bf16 v[176:179], a[36:39], a[128:131], v[176:179]
  ds_read_b64_tr_b16 a[108:109], v10 offset:50368
  v_mfma_f32_16x16x32_bf16 v[192:195], a[40:43], a[128:131], v[192:195]
  ds_read_b64_tr_b16 a[110:111], v10 offset:53952
  v_mfma_f32_16x16x32_bf16 v[196:199], a[40:43], a[132:135], v[196:199]
  v_mfma_f32_16x16x32_bf16 v[200:203], a[40:43], a[136:139], v[200:203]
  v_mfma_f32_16x16x32_bf16 v[204:207], a[40:43], a[140:143], v[204:207]
  v_mfma_f32_16x16x32_bf16 v[220:223], a[44:47], a[140:143], v[220:223]
  v_mfma_f32_16x16x32_bf16 v[216:219], a[44:47], a[136:139], v[216:219]
  v_mfma_f32_16x16x32_bf16 v[212:215], a[44:47], a[132:135], v[212:215]
  v_mfma_f32_16x16x32_bf16 v[208:211], a[44:47], a[128:131], v[208:211]
  v_mfma_f32_16x16x32_bf16 v[224:227], a[48:51], a[128:131], v[224:227]
  v_mfma_f32_16x16x32_bf16 v[228:231], a[48:51], a[132:135], v[228:231]
  v_mfma_f32_16x16x32_bf16 v[232:235], a[48:51], a[136:139], v[232:235]
  v_mfma_f32_16x16x32_bf16 v[236:239], a[48:51], a[140:143], v[236:239]
  v_mfma_f32_16x16x32_bf16 v[252:255], a[52:55], a[140:143], v[252:255]
  v_mfma_f32_16x16x32_bf16 v[248:251], a[52:55], a[136:139], v[248:251]
  v_mfma_f32_16x16x32_bf16 v[244:247], a[52:55], a[132:135], v[244:247]
  v_mfma_f32_16x16x32_bf16 v[240:243], a[52:55], a[128:131], v[240:243]
g1_s17:
  s_waitcnt vmcnt(28) lgkmcnt(0)
  v_mfma_f32_16x16x32_bf16 v[32:35], a[56:59], a[144:147], v[32:35]
  s_barrier
  v_mfma_f32_16x16x32_bf16 v[36:39], a[56:59], a[148:151], v[36:39]
  ds_read_b64_tr_b16 a[0:1], v11 offset:0
  v_mfma_f32_16x16x32_bf16 v[40:43], a[56:59], a[152:155], v[40:43]
  ds_read_b64_tr_b16 a[2:3], v11 offset:3584
  v_mfma_f32_16x16x32_bf16 v[44:47], a[56:59], a[156:159], v[44:47]
  buffer_load_dwordx4 a[128:131], v1, s[4:7], s20 offen offset:0
  v_mfma_f32_16x16x32_bf16 v[60:63], a[60:63], a[156:159], v[60:63]
  ds_read_b64_tr_b16 a[4:5], v11 offset:7168
  v_mfma_f32_16x16x32_bf16 v[56:59], a[60:63], a[152:155], v[56:59]
  ds_read_b64_tr_b16 a[6:7], v11 offset:10752
  v_mfma_f32_16x16x32_bf16 v[52:55], a[60:63], a[148:151], v[52:55]
  buffer_load_dwordx4 a[132:135], v1, s[4:7], s20 offen offset:256
  v_mfma_f32_16x16x32_bf16 v[48:51], a[60:63], a[144:147], v[48:51]
  ds_read_b64_tr_b16 a[8:9], v11 offset:32
  v_mfma_f32_16x16x32_bf16 v[64:67], a[64:67], a[144:147], v[64:67]
  ds_read_b64_tr_b16 a[10:11], v11 offset:3616
  v_mfma_f32_16x16x32_bf16 v[68:71], a[64:67], a[148:151], v[68:71]
  buffer_load_dwordx4 a[136:139], v1, s[4:7], s20 offen offset:512
  v_mfma_f32_16x16x32_bf16 v[72:75], a[64:67], a[152:155], v[72:75]
  ds_read_b64_tr_b16 a[12:13], v11 offset:7200
  v_mfma_f32_16x16x32_bf16 v[76:79], a[64:67], a[156:159], v[76:79]
  ds_read_b64_tr_b16 a[14:15], v11 offset:10784
  v_mfma_f32_16x16x32_bf16 v[92:95], a[68:71], a[156:159], v[92:95]
  ds_read_b64_tr_b16 a[16:17], v11 offset:64
  v_mfma_f32_16x16x32_bf16 v[88:91], a[68:71], a[152:155], v[88:91]
  buffer_load_dwordx4 a[140:143], v1, s[4:7], s20 offen offset:768
  v_mfma_f32_16x16x32_bf16 v[84:87], a[68:71], a[148:151], v[84:87]
  s_add_u32 s20, s20, 0x20000
  v_mfma_f32_16x16x32_bf16 v[80:83], a[68:71], a[144:147], v[80:83]
  ds_read_b64_tr_b16 a[18:19], v11 offset:3648
  v_mfma_f32_16x16x32_bf16 v[96:99], a[72:75], a[144:147], v[96:99]
  ds_read_b64_tr_b16 a[20:21], v11 offset:7232
  v_mfma_f32_16x16x32_bf16 v[100:103], a[72:75], a[148:151], v[100:103]
  s_add_u32 m0, s25, 57344
  v_mfma_f32_16x16x32_bf16 v[104:107], a[72:75], a[152:155], v[104:107]
  ds_read_b64_tr_b16 a[22:23], v11 offset:10816
  v_mfma_f32_16x16x32_bf16 v[108:111], a[72:75], a[156:159], v[108:111]
  buffer_load_dwordx4 v2, s[8:11], s21 offen offset:0  lds
  v_mfma_f32_16x16x32_bf16 v[124:127], a[76:79], a[156:159], v[124:127]
  ds_read_b64_tr_b16 a[24:25], v11 offset:96
  v_mfma_f32_16x16x32_bf16 v[120:123], a[76:79], a[152:155], v[120:123]
  ds_read_b64_tr_b16 a[26:27], v11 offset:3680
  v_mfma_f32_16x16x32_bf16 v[116:119], a[76:79], a[148:151], v[116:119]
  buffer_load_dwordx4 v3, s[8:11], s21 offen offset:1024  lds
  v_mfma_f32_16x16x32_bf16 v[112:115], a[76:79], a[144:147], v[112:115]
  ds_read_b64_tr_b16 a[28:29], v11 offset:7264
  v_mfma_f32_16x16x32_bf16 v[128:131], a[80:83], a[144:147], v[128:131]
  ds_read_b64_tr_b16 a[30:31], v11 offset:10848
  v_mfma_f32_16x16x32_bf16 v[132:135], a[80:83], a[148:151], v[132:135]
  ds_read_b64_tr_b16 a[32:33], v11 offset:128
  v_mfma_f32_16x16x32_bf16 v[136:139], a[80:83], a[152:155], v[136:139]
  buffer_load_dwordx4 v4, s[8:11], s21 offen offset:2048  lds
  v_mfma_f32_16x16x32_bf16 v[140:143], a[80:83], a[156:159], v[140:143]
  ds_read_b64_tr_b16 a[34:35], v11 offset:3712
  v_mfma_f32_16x16x32_bf16 v[156:159], a[84:87], a[156:159], v[156:159]
  ds_read_b64_tr_b16 a[36:37], v11 offset:7296
  v_mfma_f32_16x16x32_bf16 v[152:155], a[84:87], a[152:155], v[152:155]
  ds_read_b64_tr_b16 a[38:39], v11 offset:10880
  v_mfma_f32_16x16x32_bf16 v[148:151], a[84:87], a[148:151], v[148:151]
  ds_read_b64_tr_b16 a[40:41], v11 offset:160
  v_mfma_f32_16x16x32_bf16 v[144:147], a[84:87], a[144:147], v[144:147]
  ds_read_b64_tr_b16 a[42:43], v11 offset:3744
  v_mfma_f32_16x16x32_bf16 v[160:163], a[88:91], a[144:147], v[160:163]
  ds_read_b64_tr_b16 a[44:45], v11 offset:7328
  v_mfma_f32_16x16x32_bf16 v[164:167], a[88:91], a[148:151], v[164:167]
  ds_read_b64_tr_b16 a[46:47], v11 offset:10912
  v_mfma_f32_16x16x32_bf16 v[168:171], a[88:91], a[152:155], v[168:171]
  ds_read_b64_tr_b16 a[48:49], v11 offset:192
  v_mfma_f32_16x16x32_bf16 v[172:175], a[88:91], a[156:159], v[172:175]
  ds_read_b64_tr_b16 a[50:51], v11 offset:3776
  v_mfma_f32_16x16x32_bf16 v[188:191], a[92:95], a[156:159], v[188:191]
  ds_read_b64_tr_b16 a[52:53], v11 offset:7360
  v_mfma_f32_16x16x32_bf16 v[184:187], a[92:95], a[152:155], v[184:187]
  ds_read_b64_tr_b16 a[54:55], v11 offset:10944
  v_mfma_f32_16x16x32_bf16 v[180:183], a[92:95], a[148:151], v[180:183]
  buffer_load_dword a212, v21, s[44:47], s52 offen
  s_add_u32 s52, s52, 7168
  v_mfma_f32_16x16x32_bf16 v[176:179], a[92:95], a[144:147], v[176:179]
  v_mfma_f32_16x16x32_bf16 v[192:195], a[96:99], a[144:147], v[192:195]
  v_mfma_f32_16x16x32_bf16 v[196:199], a[96:99], a[148:151], v[196:199]
  v_mfma_f32_16x16x32_bf16 v[200:203], a[96:99], a[152:155], v[200:203]
  v_mfma_f32_16x16x32_bf16 v[204:207], a[96:99], a[156:159], v[204:207]
  v_mfma_f32_16x16x32_bf16 v[220:223], a[100:103], a[156:159], v[220:223]
  v_mfma_f32_16x16x32_bf16 v[216:219], a[100:103], a[152:155], v[216:219]
  v_mfma_f32_16x16x32_bf16 v[212:215], a[100:103], a[148:151], v[212:215]
  v_mfma_f32_16x16x32_bf16 v[208:211], a[100:103], a[144:147], v[208:211]
  v_mfma_f32_16x16x32_bf16 v[224:227], a[104:107], a[144:147], v[224:227]
  v_mfma_f32_16x16x32_bf16 v[228:231], a[104:107], a[148:151], v[228:231]
  v_mfma_f32_16x16x32_bf16 v[232:235], a[104:107], a[152:155], v[232:235]
  v_mfma_f32_16x16x32_bf16 v[236:239], a[104:107], a[156:159], v[236:239]
  v_mfma_f32_16x16x32_bf16 v[252:255], a[108:111], a[156:159], v[252:255]
  v_mfma_f32_16x16x32_bf16 v[248:251], a[108:111], a[152:155], v[248:251]
  v_mfma_f32_16x16x32_bf16 v[244:247], a[108:111], a[148:151], v[244:247]
  v_mfma_f32_16x16x32_bf16 v[240:243], a[108:111], a[144:147], v[240:243]
g1_s18:
  s_waitcnt vmcnt(29) lgkmcnt(0)
  v_mfma_f32_16x16x32_bf16 v[32:35], a[0:3], a[160:163], v[32:35]
  ds_read_b64_tr_b16 a[56:57], v11 offset:14336
  v_mfma_f32_16x16x32_bf16 v[36:39], a[0:3], a[164:167], v[36:39]
  ds_read_b64_tr_b16 a[58:59], v11 offset:17920
  v_mfma_f32_16x16x32_bf16 v[40:43], a[0:3], a[168:171], v[40:43]
  buffer_load_dwordx4 a[144:147], v1, s[4:7], s20 offen offset:0
  v_mfma_f32_16x16x32_bf16 v[44:47], a[0:3], a[172:175], v[44:47]
  ds_read_b64_tr_b16 a[60:61], v11 offset:21504
  v_mfma_f32_16x16x32_bf16 v[60:63], a[4:7], a[172:175], v[60:63]
  ds_read_b64_tr_b16 a[62:63], v11 offset:25088
  v_mfma_f32_16x16x32_bf16 v[56:59], a[4:7], a[168:171], v[56:59]
  buffer_load_dwordx4 a[148:151], v1, s[4:7], s20 offen offset:256
  v_mfma_f32_16x16x32_bf16 v[52:55], a[4:7], a[164:167], v[52:55]
  ds_read_b64_tr_b16 a[64:65], v11 offset:14368
  v_mfma_f32_16x16x32_bf16 v[48:51], a[4:7], a[160:163], v[48:51]
  ds_read_b64_tr_b16 a[66:67], v11 offset:17952
  v_mfma_f32_16x16x32_bf16 v[64:67], a[8:11], a[160:163], v[64:67]
  buffer_load_dwordx4 a[152:155], v1, s[4:7], s20 offen offset:512
  v_mfma_f32_16x16x32_bf16 v[68:71], a[8:11], a[164:167], v[68:71]
  ds_read_b64_tr_b16 a[68:69], v11 offset:21536
  v_mfma_f32_16x16x32_bf16 v[72:75], a[8:11], a[168:171], v[72:75]
  ds_read_b64_tr_b16 a[70:71], v11 offset:25120
  v_mfma_f32_16x16x32_bf16 v[76:79], a[8:11], a[172:175], v[76:79]
  ds_read_b64_tr_b16 a[72:73], v11 offset:14400
  v_mfma_f32_16x16x32_bf16 v[92:95], a[12:15], a[172:175], v[92:95]
  buffer_load_dwordx4 a[156:159], v1, s[4:7], s20 offen offset:768
  v_mfma_f32_16x16x32_bf16 v[88:91], a[12:15], a[168:171], v[88:91]
  s_add_u32 s20, s20, 0x20000
  v_mfma_f32_16x16x32_bf16 v[84:87], a[12:15], a[164:167], v[84:87]
  ds_read_b64_tr_b16 a[74:75], v11 offset:17984
  v_mfma_f32_16x16x32_bf16 v[80:83], a[12:15], a[160:163], v[80:83]
  ds_read_b64_tr_b16 a[76:77], v11 offset:21568
  v_mfma_f32_16x16x32_bf16 v[96:99], a[16:19], a[160:163], v[96:99]
  ds_read_b64_tr_b16 a[78:79], v11 offset:25152
  v_mfma_f32_16x16x32_bf16 v[100:103], a[16:19], a[164:167], v[100:103]
  buffer_load_dwordx4 v5, s[8:11], s21 offen offset:3072  lds
  v_mfma_f32_16x16x32_bf16 v[104:107], a[16:19], a[168:171], v[104:107]
  ds_read_b64_tr_b16 a[80:81], v11 offset:14432
  v_mfma_f32_16x16x32_bf16 v[108:111], a[16:19], a[172:175], v[108:111]
  ds_read_b64_tr_b16 a[82:83], v11 offset:18016
  v_mfma_f32_16x16x32_bf16 v[124:127], a[20:23], a[172:175], v[124:127]
  s_add_u32 m0, s25, 61440
  v_mfma_f32_16x16x32_bf16 v[120:123], a[20:23], a[168:171], v[120:123]
  buffer_load_dwordx4 v6, s[8:11], s21 offen offset:0  lds
  v_mfma_f32_16x16x32_bf16 v[116:119], a[20:23], a[164:167], v[116:119]
  ds_read_b64_tr_b16 a[84:85], v11 offset:21600
  v_mfma_f32_16x16x32_bf16 v[112:115], a[20:23], a[160:163], v[112:115]
  ds_read_b64_tr_b16 a[86:87], v11 offset:25184
  v_mfma_f32_16x16x32_bf16 v[128:131], a[24:27], a[160:163], v[128:131]
  ds_read_b64_tr_b16 a[88:89], v11 offset:14464
  v_mfma_f32_16x16x32_bf16 v[132:135], a[24:27], a[164:167], v[132:135]
  buffer_load_dwordx4 v7, s[8:11], s21 offen offset:1024  lds
  v_mfma_f32_16x16x32_bf16 v[136:139], a[24:27], a[168:171], v[136:139]
  ds_read_b64_tr_b16 a[90:91], v11 offset:18048
  v_mfma_f32_16x16x32_bf16 v[140:143], a[24:27], a[172:175], v[140:143]
  ds_read_b64_tr_b16 a[92:93], v11 offset:21632
  v_mfma_f32_16x16x32_bf16 v[156:159], a[28:31], a[172:175], v[156:159]
  ds_read_b64_tr_b16 a[94:95], v11 offset:25216
  v_mfma_f32_16x16x32_bf16 v[152:155], a[28:31], a[168:171], v[152:155]
  buffer_load_dwordx4 v8, s[8:11], s21 offen offset:2048  lds
  v_mfma_f32_16x16x32_bf16 v[148:151], a[28:31], a[164:167], v[148:151]
  s_add_u32 s21, s21, 458752
  v_mfma_f32_16x16x32_bf16 v[144:147], a[28:31], a[160:163], v[144:147]
  ds_read_b64_tr_b16 a[96:97], v11 offset:14496
  v_mfma_f32_16x16x32_bf16 v[160:163], a[32:35], a[160:163], v[160:163]
  ds_read_b64_tr_b16 a[98:99], v11 offset:18080
  v_mfma_f32_16x16x32_bf16 v[164:167], a[32:35], a[164:167], v[164:167]
  ds_read_b64_tr_b16 a[100:101], v11 offset:21664
  v_mfma_f32_16x16x32_bf16 v[168:171], a[32:35], a[168:171], v[168:171]
  ds_read_b64_tr_b16 a[102:103], v11 offset:25248
  v_mfma_f32_16x16x32_bf16 v[172:175], a[32:35], a[172:175], v[172:175]
  ds_read_b64_tr_b16 a[104:105], v11 offset:14528
  v_mfma_f32_16x16x32_bf16 v[188:191], a[36:39], a[172:175], v[188:191]
  ds_read_b64_tr_b16 a[106:107], v11 offset:18112
  v_mfma_f32_16x16x32_bf16 v[184:187], a[36:39], a[168:171], v[184:187]
  ds_read_b64_tr_b16 a[108:109], v11 offset:21696
  v_mfma_f32_16x16x32_bf16 v[180:183], a[36:39], a[164:167], v[180:183]
  ds_read_b64_tr_b16 a[110:111], v11 offset:25280
  v_mfma_f32_16x16x32_bf16 v[176:179], a[36:39], a[160:163], v[176:179]
  v_mfma_f32_16x16x32_bf16 v[192:195], a[40:43], a[160:163], v[192:195]
  v_mfma_f32_16x16x32_bf16 v[196:199], a[40:43], a[164:167], v[196:199]
  v_mfma_f32_16x16x32_bf16 v[200:203], a[40:43], a[168:171], v[200:203]
  v_mfma_f32_16x16x32_bf16 v[204:207], a[40:43], a[172:175], v[204:207]
  v_mfma_f32_16x16x32_bf16 v[220:223], a[44:47], a[172:175], v[220:223]
  v_mfma_f32_16x16x32_bf16 v[216:219], a[44:47], a[168:171], v[216:219]
  v_mfma_f32_16x16x32_bf16 v[212:215], a[44:47], a[164:167], v[212:215]
  v_mfma_f32_16x16x32_bf16 v[208:211], a[44:47], a[160:163], v[208:211]
  v_mfma_f32_16x16x32_bf16 v[224:227], a[48:51], a[160:163], v[224:227]
  v_mfma_f32_16x16x32_bf16 v[228:231], a[48:51], a[164:167], v[228:231]
  v_mfma_f32_16x16x32_bf16 v[232:235], a[48:51], a[168:171], v[232:235]
  v_mfma_f32_16x16x32_bf16 v[236:239], a[48:51], a[172:175], v[236:239]
  v_mfma_f32_16x16x32_bf16 v[252:255], a[52:55], a[172:175], v[252:255]
  v_mfma_f32_16x16x32_bf16 v[248:251], a[52:55], a[168:171], v[248:251]
  v_mfma_f32_16x16x32_bf16 v[244:247], a[52:55], a[164:167], v[244:247]
  v_mfma_f32_16x16x32_bf16 v[240:243], a[52:55], a[160:163], v[240:243]
g1_s19:
  s_waitcnt vmcnt(28) lgkmcnt(0)
  v_mfma_f32_16x16x32_bf16 v[32:35], a[56:59], a[176:179], v[32:35]
  s_barrier
  v_mfma_f32_16x16x32_bf16 v[36:39], a[56:59], a[180:183], v[36:39]
  ds_read_b64_tr_b16 a[0:1], v9 offset:0
  v_mfma_f32_16x16x32_bf16 v[40:43], a[56:59], a[184:187], v[40:43]
  ds_read_b64_tr_b16 a[2:3], v9 offset:3584
  v_mfma_f32_16x16x32_bf16 v[44:47], a[56:59], a[188:191], v[44:47]
  buffer_load_dwordx4 a[160:163], v1, s[4:7], s20 offen offset:0
  v_mfma_f32_16x16x32_bf16 v[60:63], a[60:63], a[188:191], v[60:63]
  ds_read_b64_tr_b16 a[4:5], v9 offset:7168
  v_mfma_f32_16x16x32_bf16 v[56:59], a[60:63], a[184:187], v[56:59]
  ds_read_b64_tr_b16 a[6:7], v9 offset:10752
  v_mfma_f32_16x16x32_bf16 v[52:55], a[60:63], a[180:183], v[52:55]
  buffer_load_dwordx4 a[164:167], v1, s[4:7], s20 offen offset:256
  v_mfma_f32_16x16x32_bf16 v[48:51], a[60:63], a[176:179], v[48:51]
  ds_read_b64_tr_b16 a[8:9], v9 offset:32
  v_mfma_f32_16x16x32_bf16 v[64:67], a[64:67], a[176:179], v[64:67]
  ds_read_b64_tr_b16 a[10:11], v9 offset:3616
  v_mfma_f32_16x16x32_bf16 v[68:71], a[64:67], a[180:183], v[68:71]
  buffer_load_dwordx4 a[168:171], v1, s[4:7], s20 offen offset:512
  v_mfma_f32_16x16x32_bf16 v[72:75], a[64:67], a[184:187], v[72:75]
  ds_read_b64_tr_b16 a[12:13], v9 offset:7200
  v_mfma_f32_16x16x32_bf16 v[76:79], a[64:67], a[188:191], v[76:79]
  ds_read_b64_tr_b16 a[14:15], v9 offset:10784
  v_mfma_f32_16x16x32_bf16 v[92:95], a[68:71], a[188:191], v[92:95]
  ds_read_b64_tr_b16 a[16:17], v9 offset:64
  v_mfma_f32_16x16x32_bf16 v[88:91], a[68:71], a[184:187], v[88:91]
  buffer_load_dwordx4 a[172:175], v1, s[4:7], s20 offen offset:768
  v_mfma_f32_16x16x32_bf16 v[84:87], a[68:71], a[180:183], v[84:87]
  s_add_u32 s20, s20, 0x20000
  v_mfma_f32_16x16x32_bf16 v[80:83], a[68:71], a[176:179], v[80:83]
  s_and_b32 s20, s20, 0x3fffff
  v_mfma_f32_16x16x32_bf16 v[96:99], a[72:75], a[176:179], v[96:99]
  ds_read_b64_tr_b16 a[18:19], v9 offset:3648
  v_mfma_f32_16x16x32_bf16 v[100:103], a[72:75], a[180:183], v[100:103]
  ds_read_b64_tr_b16 a[20:21], v9 offset:7232
  v_mfma_f32_16x16x32_bf16 v[104:107], a[72:75], a[184:187], v[104:107]
  s_add_u32 m0, s25, 86016
  v_mfma_f32_16x16x32_bf16 v[108:111], a[72:75], a[188:191], v[108:111]
  ds_read_b64_tr_b16 a[22:23], v9 offset:10816
  v_mfma_f32_16x16x32_bf16 v[124:127], a[76:79], a[188:191], v[124:127]
  buffer_load_dwordx4 v2, s[8:11], s21 offen offset:0  lds
  v_mfma_f32_16x16x32_bf16 v[120:123], a[76:79], a[184:187], v[120:123]
  ds_read_b64_tr_b16 a[24:25], v9 offset:96
  v_mfma_f32_16x16x32_bf16 v[116:119], a[76:79], a[180:183], v[116:119]
  ds_read_b64_tr_b16 a[26:27], v9 offset:3680
  v_mfma_f32_16x16x32_bf16 v[112:115], a[76:79], a[176:179], v[112:115]
  buffer_load_dwordx4 v3, s[8:11], s21 offen offset:1024  lds
  v_mfma_f32_16x16x32_bf16 v[128:131], a[80:83], a[176:179], v[128:131]
  ds_read_b64_tr_b16 a[28:29], v9 offset:7264
  v_mfma_f32_16x16x32_bf16 v[132:135], a[80:83], a[180:183], v[132:135]
  ds_read_b64_tr_b16 a[30:31], v9 offset:10848
  v_mfma_f32_16x16x32_bf16 v[136:139], a[80:83], a[184:187], v[136:139]
  ds_read_b64_tr_b16 a[32:33], v9 offset:128
  v_mfma_f32_16x16x32_bf16 v[140:143], a[80:83], a[188:191], v[140:143]
  buffer_load_dwordx4 v4, s[8:11], s21 offen offset:2048  lds
  v_mfma_f32_16x16x32_bf16 v[156:159], a[84:87], a[188:191], v[156:159]
  ds_read_b64_tr_b16 a[34:35], v9 offset:3712
  v_mfma_f32_16x16x32_bf16 v[152:155], a[84:87], a[184:187], v[152:155]
  ds_read_b64_tr_b16 a[36:37], v9 offset:7296
  v_mfma_f32_16x16x32_bf16 v[148:151], a[84:87], a[180:183], v[148:151]
  ds_read_b64_tr_b16 a[38:39], v9 offset:10880
  v_mfma_f32_16x16x32_bf16 v[144:147], a[84:87], a[176:179], v[144:147]
  ds_read_b64_tr_b16 a[40:41], v9 offset:160
  v_mfma_f32_16x16x32_bf16 v[160:163], a[88:91], a[176:179], v[160:163]
  ds_read_b64_tr_b16 a[42:43], v9 offset:3744
  v_mfma_f32_16x16x32_bf16 v[164:167], a[88:91], a[180:183], v[164:167]
  ds_read_b64_tr_b16 a[44:45], v9 offset:7328
  v_mfma_f32_16x16x32_bf16 v[168:171], a[88:91], a[184:187], v[168:171]
  ds_read_b64_tr_b16 a[46:47], v9 offset:10912
  v_mfma_f32_16x16x32_bf16 v[172:175], a[88:91], a[188:191], v[172:175]
  ds_read_b64_tr_b16 a[48:49], v9 offset:192
  v_mfma_f32_16x16x32_bf16 v[188:191], a[92:95], a[188:191], v[188:191]
  ds_read_b64_tr_b16 a[50:51], v9 offset:3776
  v_mfma_f32_16x16x32_bf16 v[184:187], a[92:95], a[184:187], v[184:187]
  ds_read_b64_tr_b16 a[52:53], v9 offset:7360
  v_mfma_f32_16x16x32_bf16 v[180:183], a[92:95], a[180:183], v[180:183]
  ds_read_b64_tr_b16 a[54:55], v9 offset:10944
  v_mfma_f32_16x16x32_bf16 v[176:179], a[92:95], a[176:179], v[176:179]
  v_mfma_f32_16x16x32_bf16 v[192:195], a[96:99], a[176:179], v[192:195]
  v_mfma_f32_16x16x32_bf16 v[196:199], a[96:99], a[180:183], v[196:199]
  v_mfma_f32_16x16x32_bf16 v[200:203], a[96:99], a[184:187], v[200:203]
  v_mfma_f32_16x16x32_bf16 v[204:207], a[96:99], a[188:191], v[204:207]
  v_mfma_f32_16x16x32_bf16 v[220:223], a[100:103], a[188:191], v[220:223]
  v_mfma_f32_16x16x32_bf16 v[216:219], a[100:103], a[184:187], v[216:219]
  v_mfma_f32_16x16x32_bf16 v[212:215], a[100:103], a[180:183], v[212:215]
  v_mfma_f32_16x16x32_bf16 v[208:211], a[100:103], a[176:179], v[208:211]
  v_mfma_f32_16x16x32_bf16 v[224:227], a[104:107], a[176:179], v[224:227]
  v_mfma_f32_16x16x32_bf16 v[228:231], a[104:107], a[180:183], v[228:231]
  v_mfma_f32_16x16x32_bf16 v[232:235], a[104:107], a[184:187], v[232:235]
  v_mfma_f32_16x16x32_bf16 v[236:239], a[104:107], a[188:191], v[236:239]
  v_mfma_f32_16x16x32_bf16 v[252:255], a[108:111], a[188:191], v[252:255]
  v_mfma_f32_16x16x32_bf16 v[248:251], a[108:111], a[184:187], v[248:251]
  v_mfma_f32_16x16x32_bf16 v[244:247], a[108:111], a[180:183], v[244:247]
  v_mfma_f32_16x16x32_bf16 v[240:243], a[108:111], a[176:179], v[240:243]
g1_s20:
  s_waitcnt vmcnt(27) lgkmcnt(0)
  v_mfma_f32_16x16x32_bf16 v[32:35], a[0:3], a[112:115], v[32:35]
  ds_read_b64_tr_b16 a[56:57], v9 offset:14336
  v_mfma_f32_16x16x32_bf16 v[36:39], a[0:3], a[116:119], v[36:39]
  ds_read_b64_tr_b16 a[58:59], v9 offset:17920
  v_mfma_f32_16x16x32_bf16 v[40:43], a[0:3], a[120:123], v[40:43]
  buffer_load_dwordx4 a[176:179], v1, s[4:7], s20 offen offset:0
  v_mfma_f32_16x16x32_bf16 v[44:47], a[0:3], a[124:127], v[44:47]
  ds_read_b64_tr_b16 a[60:61], v9 offset:21504
  v_mfma_f32_16x16x32_bf16 v[60:63], a[4:7], a[124:127], v[60:63]
  ds_read_b64_tr_b16 a[62:63], v9 offset:25088
  v_mfma_f32_16x16x32_bf16 v[56:59], a[4:7], a[120:123], v[56:59]
  buffer_load_dwordx4 a[180:183], v1, s[4:7], s20 offen offset:256
  v_mfma_f32_16x16x32_bf16 v[52:55], a[4:7], a[116:119], v[52:55]
  ds_read_b64_tr_b16 a[64:65], v9 offset:14368
  v_mfma_f32_16x16x32_bf16 v[48:51], a[4:7], a[112:115], v[48:51]
  ds_read_b64_tr_b16 a[66:67], v9 offset:17952
  v_mfma_f32_16x16x32_bf16 v[64:67], a[8:11], a[112:115], v[64:67]
  buffer_load_dwordx4 a[184:187], v1, s[4:7], s20 offen offset:512
  v_mfma_f32_16x16x32_bf16 v[68:71], a[8:11], a[116:119], v[68:71]
  ds_read_b64_tr_b16 a[68:69], v9 offset:21536
  v_mfma_f32_16x16x32_bf16 v[72:75], a[8:11], a[120:123], v[72:75]
  ds_read_b64_tr_b16 a[70:71], v9 offset:25120
  v_mfma_f32_16x16x32_bf16 v[76:79], a[8:11], a[124:127], v[76:79]
  ds_read_b64_tr_b16 a[72:73], v9 offset:14400
  v_mfma_f32_16x16x32_bf16 v[92:95], a[12:15], a[124:127], v[92:95]
  buffer_load_dwordx4 a[188:191], v1, s[4:7], s20 offen offset:768
  v_mfma_f32_16x16x32_bf16 v[88:91], a[12:15], a[120:123], v[88:91]
  s_add_u32 s20, s20, 0x20000
  v_mfma_f32_16x16x32_bf16 v[84:87], a[12:15], a[116:119], v[84:87]
  ds_read_b64_tr_b16 a[74:75], v9 offset:17984
  v_mfma_f32_16x16x32_bf16 v[80:83], a[12:15], a[112:115], v[80:83]
  ds_read_b64_tr_b16 a[76:77], v9 offset:21568
  v_mfma_f32_16x16x32_bf16 v[96:99], a[16:19], a[112:115], v[96:99]
  ds_read_b64_tr_b16 a[78:79], v9 offset:25152
  v_mfma_f32_16x16x32_bf16 v[100:103], a[16:19], a[116:119], v[100:103]
  buffer_load_dwordx4 v5, s[8:11], s21 offen offset:3072  lds
  v_mfma_f32_16x16x32_bf16 v[104:107], a[16:19], a[120:123], v[104:107]
  ds_read_b64_tr_b16 a[80:81], v9 offset:14432
  v_mfma_f32_16x16x32_bf16 v[108:111], a[16:19], a[124:127], v[108:111]
  ds_read_b64_tr_b16 a[82:83], v9 offset:18016
  v_mfma_f32_16x16x32_bf16 v[124:127], a[20:23], a[124:127], v[124:127]
  s_add_u32 m0, s25, 90112
  v_mfma_f32_16x16x32_bf16 v[120:123], a[20:23], a[120:123], v[120:123]
  buffer_load_dwordx4 v6, s[8:11], s21 offen offset:0  lds
  v_mfma_f32_16x16x32_bf16 v[116:119], a[20:23], a[116:119], v[116:119]
  ds_read_b64_tr_b16 a[84:85], v9 offset:21600
  v_mfma_f32_16x16x32_bf16 v[112:115], a[20:23], a[112:115], v[112:115]
  ds_read_b64_tr_b16 a[86:87], v9 offset:25184
  v_mfma_f32_16x16x32_bf16 v[128:131], a[24:27], a[112:115], v[128:131]
  ds_read_b64_tr_b16 a[88:89], v9 offset:14464
  v_mfma_f32_16x16x32_bf16 v[132:135], a[24:27], a[116:119], v[132:135]
  buffer_load_dwordx4 v7, s[8:11], s21 offen offset:1024  lds
  v_mfma_f32_16x16x32_bf16 v[136:139], a[24:27], a[120:123], v[136:139]
  ds_read_b64_tr_b16 a[90:91], v9 offset:18048
  v_mfma_f32_16x16x32_bf16 v[140:143], a[24:27], a[124:127], v[140:143]
  ds_read_b64_tr_b16 a[92:93], v9 offset:21632
  v_mfma_f32_16x16x32_bf16 v[156:159], a[28:31], a[124:127], v[156:159]
  ds_read_b64_tr_b16 a[94:95], v9 offset:25216
  v_mfma_f32_16x16x32_bf16 v[152:155], a[28:31], a[120:123], v[152:155]
  buffer_load_dwordx4 v8, s[8:11], s21 offen offset:2048  lds
  v_mfma_f32_16x16x32_bf16 v[148:151], a[28:31], a[116:119], v[148:151]
  s_add_u32 s21, s21, 458752
  s_cmp_eq_u32 s21, 7340032
  s_cselect_b32 s21, 0, s21
  v_mfma_f32_16x16x32_bf16 v[144:147], a[28:31], a[112:115], v[144:147]
  v_mfma_f32_16x16x32_bf16 v[160:163], a[32:35], a[112:115], v[160:163]
  v_mfma_f32_16x16x32_bf16 v[164:167], a[32:35], a[116:119], v[164:167]
  ds_read_b64_tr_b16 a[96:97], v9 offset:14496
  v_mfma_f32_16x16x32_bf16 v[168:171], a[32:35], a[120:123], v[168:171]
  ds_read_b64_tr_b16 a[98:99], v9 offset:18080
  v_mfma_f32_16x16x32_bf16 v[172:175], a[32:35], a[124:127], v[172:175]
  ds_read_b64_tr_b16 a[100:101], v9 offset:21664
  v_mfma_f32_16x16x32_bf16 v[188:191], a[36:39], a[124:127], v[188:191]
  ds_read_b64_tr_b16 a[102:103], v9 offset:25248
  v_mfma_f32_16x16x32_bf16 v[184:187], a[36:39], a[120:123], v[184:187]
  ds_read_b64_tr_b16 a[104:105], v9 offset:14528
  v_mfma_f32_16x16x32_bf16 v[180:183], a[36:39], a[116:119], v[180:183]
  ds_read_b64_tr_b16 a[106:107], v9 offset:18112
  v_mfma_f32_16x16x32_bf16 v[176:179], a[36:39], a[112:115], v[176:179]
  ds_read_b64_tr_b16 a[108:109], v9 offset:21696
  v_mfma_f32_16x16x32_bf16 v[192:195], a[40:43], a[112:115], v[192:195]
  ds_read_b64_tr_b16 a[110:111], v9 offset:25280
  v_mfma_f32_16x16x32_bf16 v[196:199], a[40:43], a[116:119], v[196:199]
  buffer_load_dword a212, v21, s[44:47], s52 offen
  s_add_u32 s52, s52, 7168
  v_mfma_f32_16x16x32_bf16 v[200:203], a[40:43], a[120:123], v[200:203]
  v_mfma_f32_16x16x32_bf16 v[204:207], a[40:43], a[124:127], v[204:207]
  v_mfma_f32_16x16x32_bf16 v[220:223], a[44:47], a[124:127], v[220:223]
  v_mfma_f32_16x16x32_bf16 v[216:219], a[44:47], a[120:123], v[216:219]
  v_mfma_f32_16x16x32_bf16 v[212:215], a[44:47], a[116:119], v[212:215]
  v_mfma_f32_16x16x32_bf16 v[208:211], a[44:47], a[112:115], v[208:211]
  v_mfma_f32_16x16x32_bf16 v[224:227], a[48:51], a[112:115], v[224:227]
  v_mfma_f32_16x16x32_bf16 v[228:231], a[48:51], a[116:119], v[228:231]
  v_mfma_f32_16x16x32_bf16 v[232:235], a[48:51], a[120:123], v[232:235]
  v_mfma_f32_16x16x32_bf16 v[236:239], a[48:51], a[124:127], v[236:239]
  v_mfma_f32_16x16x32_bf16 v[252:255], a[52:55], a[124:127], v[252:255]
  v_mfma_f32_16x16x32_bf16 v[248:251], a[52:55], a[120:123], v[248:251]
  v_mfma_f32_16x16x32_bf16 v[244:247], a[52:55], a[116:119], v[244:247]
  v_mfma_f32_16x16x32_bf16 v[240:243], a[52:55], a[112:115], v[240:243]
g1_s21:
  s_waitcnt vmcnt(28) lgkmcnt(0)
  v_mfma_f32_16x16x32_bf16 v[32:35], a[56:59], a[128:131], v[32:35]
  s_barrier
  v_mfma_f32_16x16x32_bf16 v[36:39], a[56:59], a[132:135], v[36:39]
  ds_read_b64_tr_b16 a[0:1], v9 offset:28672
  v_mfma_f32_16x16x32_bf16 v[40:43], a[56:59], a[136:139], v[40:43]
  ds_read_b64_tr_b16 a[2:3], v9 offset:32256
  v_mfma_f32_16x16x32_bf16 v[44:47], a[56:59], a[140:143], v[44:47]
  buffer_load_dwordx4 a[112:115], v1, s[4:7], s20 offen offset:0
  v_mfma_f32_16x16x32_bf16 v[60:63], a[60:63], a[140:143], v[60:63]
  ds_read_b64_tr_b16 a[4:5], v9 offset:35840
  v_mfma_f32_16x16x32_bf16 v[56:59], a[60:63], a[136:139], v[56:59]
  ds_read_b64_tr_b16 a[6:7], v9 offset:39424
  v_mfma_f32_16x16x32_bf16 v[52:55], a[60:63], a[132:135], v[52:55]
  buffer_load_dwordx4 a[116:119], v1, s[4:7], s20 offen offset:256
  v_mfma_f32_16x16x32_bf16 v[48:51], a[60:63], a[128:131], v[48:51]
  ds_read_b64_tr_b16 a[8:9], v9 offset:28704
  v_mfma_f32_16x16x32_bf16 v[64:67], a[64:67], a[128:131], v[64:67]
  ds_read_b64_tr_b16 a[10:11], v9 offset:32288
  v_mfma_f32_16x16x32_bf16 v[68:71], a[64:67], a[132:135], v[68:71]
  buffer_load_dwordx4 a[120:123], v1, s[4:7], s20 offen offset:512
  v_mfma_f32_16x16x32_bf16 v[72:75], a[64:67], a[136:139], v[72:75]
  ds_read_b64_tr_b16 a[12:13], v9 offset:35872
  v_mfma_f32_16x16x32_bf16 v[76:79], a[64:67], a[140:143], v[76:79]
  ds_read_b64_tr_b16 a[14:15], v9 offset:39456
  v_mfma_f32_16x16x32_bf16 v[92:95], a[68:71], a[140:143], v[92:95]
  ds_read_b64_tr_b16 a[16:17], v9 offset:28736
  v_mfma_f32_16x16x32_bf16 v[88:91], a[68:71], a[136:139], v[88:91]
  buffer_load_dwordx4 a[124:127], v1, s[4:7], s20 offen offset:768
  v_mfma_f32_16x16x32_bf16 v[84:87], a[68:71], a[132:135], v[84:87]
  s_add_u32 s20, s20, 0x20000
  v_mfma_f32_16x16x32_bf16 v[80:83], a[68:71], a[128:131], v[80:83]
  ds_read_b64_tr_b16 a[18:19], v9 offset:32320
  v_mfma_f32_16x16x32_bf16 v[96:99], a[72:75], a[128:131], v[96:99]
  ds_read_b64_tr_b16 a[20:21], v9 offset:35904
  v_mfma_f32_16x16x32_bf16 v[100:103], a[72:75], a[132:135], v[100:103]
  s_add_u32 m0, s25, 114688
  v_mfma_f32_16x16x32_bf16 v[104:107], a[72:75], a[136:139], v[104:107]
  ds_read_b64_tr_b16 a[22:23], v9 offset:39488
  v_mfma_f32_16x16x32_bf16 v[108:111], a[72:75], a[140:143], v[108:111]
  buffer_load_dwordx4 v2, s[8:11], s21 offen offset:0  lds
  v_mfma_f32_16x16x32_bf16 v[124:127], a[76:79], a[140:143], v[124:127]
  ds_read_b64_tr_b16 a[24:25], v9 offset:28768
  v_mfma_f32_16x16x32_bf16 v[120:123], a[76:79], a[136:139], v[120:123]
  ds_read_b64_tr_b16 a[26:27], v9 offset:32352
  v_mfma_f32_16x16x32_bf16 v[116:119], a[76:79], a[132:135], v[116:119]
  buffer_load_dwordx4 v3, s[8:11], s21 offen offset:1024  lds
  v_mfma_f32_16x16x32_bf16 v[112:115], a[76:79], a[128:131], v[112:115]
  ds_read_b64_tr_b16 a[28:29], v9 offset:35936
  v_mfma_f32_16x16x32_bf16 v[128:131], a[80:83], a[128:131], v[128:131]
  ds_read_b64_tr_b16 a[30:31], v9 offset:39520
  v_mfma_f32_16x16x32_bf16 v[132:135], a[80:83], a[132:135], v[132:135]
  ds_read_b64_tr_b16 a[32:33], v9 offset:28800
  v_mfma_f32_16x16x32_bf16 v[136:139], a[80:83], a[136:139], v[136:139]
  buffer_load_dwordx4 v4, s[8:11], s21 offen offset:2048  lds
  v_mfma_f32_16x16x32_bf16 v[140:143], a[80:83], a[140:143], v[140:143]
  ds_read_b64_tr_b16 a[34:35], v9 offset:32384
  v_mfma_f32_16x16x32_bf16 v[156:159], a[84:87], a[140:143], v[156:159]
  ds_read_b64_tr_b16 a[36:37], v9 offset:35968
  v_mfma_f32_16x16x32_bf16 v[152:155], a[84:87], a[136:139], v[152:155]
  ds_read_b64_tr_b16 a[38:39], v9 offset:39552
  v_mfma_f32_16x16x32_bf16 v[148:151], a[84:87], a[132:135], v[148:151]
  ds_read_b64_tr_b16 a[40:41], v9 offset:28832
  v_mfma_f32_16x16x32_bf16 v[144:147], a[84:87], a[128:131], v[144:147]
  ds_read_b64_tr_b16 a[42:43], v9 offset:32416
  v_mfma_f32_16x16x32_bf16 v[160:163], a[88:91], a[128:131], v[160:163]
  ds_read_b64_tr_b16 a[44:45], v9 offset:36000
  v_mfma_f32_16x16x32_bf16 v[164:167], a[88:91], a[132:135], v[164:167]
  ds_read_b64_tr_b16 a[46:47], v9 offset:39584
  v_mfma_f32_16x16x32_bf16 v[168:171], a[88:91], a[136:139], v[168:171]
  ds_read_b64_tr_b16 a[48:49], v9 offset:28864
  v_mfma_f32_16x16x32_bf16 v[172:175], a[88:91], a[140:143], v[172:175]
  ds_read_b64_tr_b16 a[50:51], v9 offset:32448
  v_mfma_f32_16x16x32_bf16 v[188:191], a[92:95], a[140:143], v[188:191]
  ds_read_b64_tr_b16 a[52:53], v9 offset:36032
  v_mfma_f32_16x16x32_bf16 v[184:187], a[92:95], a[136:139], v[184:187]
  ds_read_b64_tr_b16 a[54:55], v9 offset:39616
  v_mfma_f32_16x16x32_bf16 v[180:183], a[92:95], a[132:135], v[180:183]
  s_add_u32 s51, s50, g1_s24 - g1_pc
  v_mfma_f32_16x16x32_bf16 v[176:179], a[92:95], a[128:131], v[176:179]
  s_min_u32 s51, s51, code_end - g1_pc - 4
  v_mfma_f32_16x16x32_bf16 v[192:195], a[96:99], a[128:131], v[192:195]
  v_mov_b32 v23, s51
  v_mfma_f32_16x16x32_bf16 v[196:199], a[96:99], a[132:135], v[196:199]
  global_load_dword a212, v23, s[48:49]
  v_mfma_f32_16x16x32_bf16 v[200:203], a[96:99], a[136:139], v[200:203]
  v_mfma_f32_16x16x32_bf16 v[204:207], a[96:99], a[140:143], v[204:207]
  v_mfma_f32_16x16x32_bf16 v[220:223], a[100:103], a[140:143], v[220:223]
  v_mfma_f32_16x16x32_bf16 v[216:219], a[100:103], a[136:139], v[216:219]
  v_mfma_f32_16x16x32_bf16 v[212:215], a[100:103], a[132:135], v[212:215]
  v_mfma_f32_16x16x32_bf16 v[208:211], a[100:103], a[128:131], v[208:211]
  v_mfma_f32_16x16x32_bf16 v[224:227], a[104:107], a[128:131], v[224:227]
  v_mfma_f32_16x16x32_bf16 v[228:231], a[104:107], a[132:135], v[228:231]
  v_mfma_f32_16x16x32_bf16 v[232:235], a[104:107], a[136:139], v[232:235]
  v_mfma_f32_16x16x32_bf16 v[236:239], a[104:107], a[140:143], v[236:239]
  v_mfma_f32_16x16x32_bf16 v[252:255], a[108:111], a[140:143], v[252:255]
  v_mfma_f32_16x16x32_bf16 v[248:251], a[108:111], a[136:139], v[248:251]
  v_mfma_f32_16x16x32_bf16 v[244:247], a[108:111], a[132:135], v[244:247]
  v_mfma_f32_16x16x32_bf16 v[240:243], a[108:111], a[128:131], v[240:243]
g1_s22:
  s_waitcnt vmcnt(28) lgkmcnt(0)
  v_mfma_f32_16x16x32_bf16 v[32:35], a[0:3], a[144:147], v[32:35]
  ds_read_b64_tr_b16 a[56:57], v9 offset:43008
  v_mfma_f32_16x16x32_bf16 v[36:39], a[0:3], a[148:151], v[36:39]
  ds_read_b64_tr_b16 a[58:59], v9 offset:46592
  v_mfma_f32_16x16x32_bf16 v[40:43], a[0:3], a[152:155], v[40:43]
  buffer_load_dwordx4 a[128:131], v1, s[4:7], s20 offen offset:0
  v_mfma_f32_16x16x32_bf16 v[44:47], a[0:3], a[156:159], v[44:47]
  ds_read_b64_tr_b16 a[60:61], v9 offset:50176
  v_mfma_f32_16x16x32_bf16 v[60:63], a[4:7], a[156:159], v[60:63]
  ds_read_b64_tr_b16 a[62:63], v9 offset:53760
  v_mfma_f32_16x16x32_bf16 v[56:59], a[4:7], a[152:155], v[56:59]
  buffer_load_dwordx4 a[132:135], v1, s[4:7], s20 offen offset:256
  v_mfma_f32_16x16x32_bf16 v[52:55], a[4:7], a[148:151], v[52:55]
  ds_read_b64_tr_b16 a[64:65], v9 offset:43040
  v_mfma_f32_16x16x32_bf16 v[48:51], a[4:7], a[144:147], v[48:51]
  ds_read_b64_tr_b16 a[66:67], v9 offset:46624
  v_mfma_f32_16x16x32_bf16 v[64:67], a[8:11], a[144:147], v[64:67]
  buffer_load_dwordx4 a[136:139], v1, s[4:7], s20 offen offset:512
  v_mfma_f32_16x16x32_bf16 v[68:71], a[8:11], a[148:151], v[68:71]
  ds_read_b64_tr_b16 a[68:69], v9 offset:50208
  v_mfma_f32_16x16x32_bf16 v[72:75], a[8:11], a[152:155], v[72:75]
  ds_read_b64_tr_b16 a[70:71], v9 offset:53792
  v_mfma_f32_16x16x32_bf16 v[76:79], a[8:11], a[156:159], v[76:79]
  ds_read_b64_tr_b16 a[72:73], v9 offset:43072
  v_mfma_f32_16x16x32_bf16 v[92:95], a[12:15], a[156:159], v[92:95]
  buffer_load_dwordx4 a[140:143], v1, s[4:7], s20 offen offset:768
  v_mfma_f32_16x16x32_bf16 v[88:91], a[12:15], a[152:155], v[88:91]
  s_add_u32 s20, s20, 0x20000
  v_mfma_f32_16x16x32_bf16 v[84:87], a[12:15], a[148:151], v[84:87]
  ds_read_b64_tr_b16 a[74:75], v9 offset:46656
  v_mfma_f32_16x16x32_bf16 v[80:83], a[12:15], a[144:147], v[80:83]
  ds_read_b64_tr_b16 a[76:77], v9 offset:50240
  v_mfma_f32_16x16x32_bf16 v[96:99], a[16:19], a[144:147], v[96:99]
  ds_read_b64_tr_b16 a[78:79], v9 offset:53824
  v_mfma_f32_16x16x32_bf16 v[100:103], a[16:19], a[148:151], v[100:103]
  buffer_load_dwordx4 v5, s[8:11], s21 offen offset:3072  lds
  v_mfma_f32_16x16x32_bf16 v[104:107], a[16:19], a[152:155], v[104:107]
  ds_read_b64_tr_b16 a[80:81], v9 offset:43104
  v_mfma_f32_16x16x32_bf16 v[108:111], a[16:19], a[156:159], v[108:111]
  ds_read_b64_tr_b16 a[82:83], v9 offset:46688
  v_mfma_f32_16x16x32_bf16 v[124:127], a[20:23], a[156:159], v[124:127]
  s_add_u32 m0, s25, 118784
  v_mfma_f32_16x16x32_bf16 v[120:123], a[20:23], a[152:155], v[120:123]
  buffer_load_dwordx4 v6, s[8:11], s21 offen offset:0  lds
  v_mfma_f32_16x16x32_bf16 v[116:119], a[20:23], a[148:151], v[116:119]
  ds_read_b64_tr_b16 a[84:85], v9 offset:50272
  v_mfma_f32_16x16x32_bf16 v[112:115], a[20:23], a[144:147], v[112:115]
  ds_read_b64_tr_b16 a[86:87], v9 offset:53856
  v_mfma_f32_16x16x32_bf16 v[128:131], a[24:27], a[144:147], v[128:131]
  ds_read_b64_tr_b16 a[88:89], v9 offset:43136
  v_mfma_f32_16x16x32_bf16 v[132:135], a[24:27], a[148:151], v[132:135]
  buffer_load_dwordx4 v7, s[8:11], s21 offen offset:1024  lds
  v_mfma_f32_16x16x32_bf16 v[136:139], a[24:27], a[152:155], v[136:139]
  ds_read_b64_tr_b16 a[90:91], v9 offset:46720
  v_mfma_f32_16x16x32_bf16 v[140:143], a[24:27], a[156:159], v[140:143]
  ds_read_b64_tr_b16 a[92:93], v9 offset:50304
  v_mfma_f32_16x16x32_bf16 v[156:159], a[28:31], a[156:159], v[156:159]
  ds_read_b64_tr_b16 a[94:95], v9 offset:53888
  v_mfma_f32_16x16x32_bf16 v[152:155], a[28:31], a[152:155], v[152:155]
  buffer_load_dwordx4 v8, s[8:11], s21 offen offset:2048  lds
  v_mfma_f32_16x16x32_bf16 v[148:151], a[28:31], a[148:151], v[148:151]
  s_add_u32 s21, s21, 458752
  v_mfma_f32_16x16x32_bf16 v[144:147], a[28:31], a[144:147], v[144:147]
  ds_read_b64_tr_b16 a[96:97], v9 offset:43168
  v_mfma_f32_16x16x32_bf16 v[160:163], a[32:35], a[144:147], v[160:163]
  ds_read_b64_tr_b16 a[98:99], v9 offset:46752
  v_mfma_f32_16x16x32_bf16 v[164:167], a[32:35], a[148:151], v[164:167]
  ds_read_b64_tr_b16 a[100:101], v9 offset:50336
  v_mfma_f32_16x16x32_bf16 v[168:171], a[32:35], a[152:155], v[168:171]
  ds_read_b64_tr_b16 a[102:103], v9 offset:53920
  v_mfma_f32_16x16x32_bf16 v[172:175], a[32:35], a[156:159], v[172:175]
  ds_read_b64_tr_b16 a[104:105], v9 offset:43200
  v_mfma_f32_16x16x32_bf16 v[188:191], a[36:39], a[156:159], v[188:191]
  ds_read_b64_tr_b16 a[106:107], v9 offset:46784
  v_mfma_f32_16x16x32_bf16 v[184:187], a[36:39], a[152:155], v[184:187]
  ds_read_b64_tr_b16 a[108:109], v9 offset:50368
  v_mfma_f32_16x16x32_bf16 v[180:183], a[36:39], a[148:151], v[180:183]
  ds_read_b64_tr_b16 a[110:111], v9 offset:53952
  v_mfma_f32_16x16x32_bf16 v[176:179], a[36:39], a[144:147], v[176:179]
  v_mfma_f32_16x16x32_bf16 v[192:195], a[40:43], a[144:147], v[192:195]
  v_mfma_f32_16x16x32_bf16 v[196:199], a[40:43], a[148:151], v[196:199]
  v_mfma_f32_16x16x32_bf16 v[200:203], a[40:43], a[152:155], v[200:203]
  v_mfma_f32_16x16x32_bf16 v[204:207], a[40:43], a[156:159], v[204:207]
  v_mfma_f32_16x16x32_bf16 v[220:223], a[44:47], a[156:159], v[220:223]
  v_mfma_f32_16x16x32_bf16 v[216:219], a[44:47], a[152:155], v[216:219]
  v_mfma_f32_16x16x32_bf16 v[212:215], a[44:47], a[148:151], v[212:215]
  v_mfma_f32_16x16x32_bf16 v[208:211], a[44:47], a[144:147], v[208:211]
  v_mfma_f32_16x16x32_bf16 v[224:227], a[48:51], a[144:147], v[224:227]
  v_mfma_f32_16x16x32_bf16 v[228:231], a[48:51], a[148:151], v[228:231]
  v_mfma_f32_16x16x32_bf16 v[232:235], a[48:51], a[152:155], v[232:235]
  v_mfma_f32_16x16x32_bf16 v[236:239], a[48:51], a[156:159], v[236:239]
  v_mfma_f32_16x16x32_bf16 v[252:255], a[52:55], a[156:159], v[252:255]
  v_mfma_f32_16x16x32_bf16 v[248:251], a[52:55], a[152:155], v[248:251]
  v_mfma_f32_16x16x32_bf16 v[244:247], a[52:55], a[148:151], v[244:247]
  v_mfma_f32_16x16x32_bf16 v[240:243], a[52:55], a[144:147], v[240:243]
g1_s23:
  s_waitcnt vmcnt(28) lgkmcnt(0)
  v_mfma_f32_16x16x32_bf16 v[32:35], a[56:59], a[160:163], v[32:35]
  s_barrier
  v_mfma_f32_16x16x32_bf16 v[36:39], a[56:59], a[164:167], v[36:39]
  ds_read_b64_tr_b16 a[0:1], v10 offset:0
  v_mfma_f32_16x16x32_bf16 v[40:43], a[56:59], a[168:171], v[40:43]
  ds_read_b64_tr_b16 a[2:3], v10 offset:3584
  v_mfma_f32_16x16x32_bf16 v[44:47], a[56:59], a[172:175], v[44:47]
  buffer_load_dwordx4 a[144:147], v1, s[4:7], s20 offen offset:0
  v_mfma_f32_16x16x32_bf16 v[60:63], a[60:63], a[172:175], v[60:63]
  ds_read_b64_tr_b16 a[4:5], v10 offset:7168
  v_mfma_f32_16x16x32_bf16 v[56:59], a[60:63], a[168:171], v[56:59]
  ds_read_b64_tr_b16 a[6:7], v10 offset:10752
  v_mfma_f32_16x16x32_bf16 v[52:55], a[60:63], a[164:167], v[52:55]
  buffer_load_dwordx4 a[148:151], v1, s[4:7], s20 offen offset:256
  v_mfma_f32_16x16x32_bf16 v[48:51], a[60:63], a[160:163], v[48:51]
  ds_read_b64_tr_b16 a[8:9], v10 offset:32
  v_mfma_f32_16x16x32_bf16 v[64:67], a[64:67], a[160:163], v[64:67]
  ds_read_b64_tr_b16 a[10:11], v10 offset:3616
  v_mfma_f32_16x16x32_bf16 v[68:71], a[64:67], a[164:167], v[68:71]
  buffer_load_dwordx4 a[152:155], v1, s[4:7], s20 offen offset:512
  v_mfma_f32_16x16x32_bf16 v[72:75], a[64:67], a[168:171], v[72:75]
  ds_read_b64_tr_b16 a[12:13], v10 offset:7200
  v_mfma_f32_16x16x32_bf16 v[76:79], a[64:67], a[172:175], v[76:79]
  ds_read_b64_tr_b16 a[14:15], v10 offset:10784
  v_mfma_f32_16x16x32_bf16 v[92:95], a[68:71], a[172:175], v[92:95]
  ds_read_b64_tr_b16 a[16:17], v10 offset:64
  v_mfma_f32_16x16x32_bf16 v[88:91], a[68:71], a[168:171], v[88:91]
  buffer_load_dwordx4 a[156:159], v1, s[4:7], s20 offen offset:768
  v_mfma_f32_16x16x32_bf16 v[84:87], a[68:71], a[164:167], v[84:87]
  s_add_u32 s20, s20, 0x20000
  v_mfma_f32_16x16x32_bf16 v[80:83], a[68:71], a[160:163], v[80:83]
  s_and_b32 s20, s20, 0x3fffff
  v_mfma_f32_16x16x32_bf16 v[96:99], a[72:75], a[160:163], v[96:99]
  ds_read_b64_tr_b16 a[18:19], v10 offset:3648
  v_mfma_f32_16x16x32_bf16 v[100:103], a[72:75], a[164:167], v[100:103]
  ds_read_b64_tr_b16 a[20:21], v10 offset:7232
  v_mfma_f32_16x16x32_bf16 v[104:107], a[72:75], a[168:171], v[104:107]
  s_add_u32 m0, s25, 0
  v_mfma_f32_16x16x32_bf16 v[108:111], a[72:75], a[172:175], v[108:111]
  ds_read_b64_tr_b16 a[22:23], v10 offset:10816
  v_mfma_f32_16x16x32_bf16 v[124:127], a[76:79], a[172:175], v[124:127]
  buffer_load_dwordx4 v2, s[8:11], s21 offen offset:0  lds
  v_mfma_f32_16x16x32_bf16 v[120:123], a[76:79], a[168:171], v[120:123]
  ds_read_b64_tr_b16 a[24:25], v10 offset:96
  v_mfma_f32_16x16x32_bf16 v[116:119], a[76:79], a[164:167], v[116:119]
  ds_read_b64_tr_b16 a[26:27], v10 offset:3680
  v_mfma_f32_16x16x32_bf16 v[112:115], a[76:79], a[160:163], v[112:115]
  buffer_load_dwordx4 v3, s[8:11], s21 offen offset:1024  lds
  v_mfma_f32_16x16x32_bf16 v[128:131], a[80:83], a[160:163], v[128:131]
  ds_read_b64_tr_b16 a[28:29], v10 offset:7264
  v_mfma_f32_16x16x32_bf16 v[132:135], a[80:83], a[164:167], v[132:135]
  ds_read_b64_tr_b16 a[30:31], v10 offset:10848
  v_mfma_f32_16x16x32_bf16 v[136:139], a[80:83], a[168:171], v[136:139]
  ds_read_b64_tr_b16 a[32:33], v10 offset:128
  v_mfma_f32_16x16x32_bf16 v[140:143], a[80:83], a[172:175], v[140:143]
  buffer_load_dwordx4 v4, s[8:11], s21 offen offset:2048  lds
  v_mfma_f32_16x16x32_bf16 v[156:159], a[84:87], a[172:175], v[156:159]
  ds_read_b64_tr_b16 a[34:35], v10 offset:3712
  v_mfma_f32_16x16x32_bf16 v[152:155], a[84:87], a[168:171], v[152:155]
  ds_read_b64_tr_b16 a[36:37], v10 offset:7296
  v_mfma_f32_16x16x32_bf16 v[148:151], a[84:87], a[164:167], v[148:151]
  ds_read_b64_tr_b16 a[38:39], v10 offset:10880
  v_mfma_f32_16x16x32_bf16 v[144:147], a[84:87], a[160:163], v[144:147]
  ds_read_b64_tr_b16 a[40:41], v10 offset:160
  v_mfma_f32_16x16x32_bf16 v[160:163], a[88:91], a[160:163], v[160:163]
  ds_read_b64_tr_b16 a[42:43], v10 offset:3744
  v_mfma_f32_16x16x32_bf16 v[164:167], a[88:91], a[164:167], v[164:167]
  ds_read_b64_tr_b16 a[44:45], v10 offset:7328
  v_mfma_f32_16x16x32_bf16 v[168:171], a[88:91], a[168:171], v[168:171]
  ds_read_b64_tr_b16 a[46:47], v10 offset:10912
  v_mfma_f32_16x16x32_bf16 v[172:175], a[88:91], a[172:175], v[172:175]
  ds_read_b64_tr_b16 a[48:49], v10 offset:192
  v_mfma_f32_16x16x32_bf16 v[188:191], a[92:95], a[172:175], v[188:191]
  ds_read_b64_tr_b16 a[50:51], v10 offset:3776
  v_mfma_f32_16x16x32_bf16 v[184:187], a[92:95], a[168:171], v[184:187]
  ds_read_b64_tr_b16 a[52:53], v10 offset:7360
  v_mfma_f32_16x16x32_bf16 v[180:183], a[92:95], a[164:167], v[180:183]
  ds_read_b64_tr_b16 a[54:55], v10 offset:10944
  v_mfma_f32_16x16x32_bf16 v[176:179], a[92:95], a[160:163], v[176:179]
  buffer_load_dword a212, v21, s[44:47], s52 offen
  s_add_u32 s52, s52, 7168
  v_mfma_f32_16x16x32_bf16 v[192:195], a[96:99], a[160:163], v[192:195]
  v_mfma_f32_16x16x32_bf16 v[196:199], a[96:99], a[164:167], v[196:199]
  v_mfma_f32_16x16x32_bf16 v[200:203], a[96:99], a[168:171], v[200:203]
  v_mfma_f32_16x16x32_bf16 v[204:207], a[96:99], a[172:175], v[204:207]
  v_mfma_f32_16x16x32_bf16 v[220:223], a[100:103], a[172:175], v[220:223]
  v_mfma_f32_16x16x32_bf16 v[216:219], a[100:103], a[168:171], v[216:219]
  v_mfma_f32_16x16x32_bf16 v[212:215], a[100:103], a[164:167], v[212:215]
  v_mfma_f32_16x16x32_bf16 v[208:211], a[100:103], a[160:163], v[208:211]
  v_mfma_f32_16x16x32_bf16 v[224:227], a[104:107], a[160:163], v[224:227]
  v_mfma_f32_16x16x32_bf16 v[228:231], a[104:107], a[164:167], v[228:231]
  v_mfma_f32_16x16x32_bf16 v[232:235], a[104:107], a[168:171], v[232:235]
  v_mfma_f32_16x16x32_bf16 v[236:239], a[104:107], a[172:175], v[236:239]
  v_mfma_f32_16x16x32_bf16 v[252:255], a[108:111], a[172:175], v[252:255]
  v_mfma_f32_16x16x32_bf16 v[248:251], a[108:111], a[168:171], v[248:251]
  v_mfma_f32_16x16x32_bf16 v[244:247], a[108:111], a[164:167], v[244:247]
  v_mfma_f32_16x16x32_bf16 v[240:243], a[108:111], a[160:163], v[240:243]
g1_s24:
  s_waitcnt vmcnt(29) lgkmcnt(0)
  v_mfma_f32_16x16x32_bf16 v[32:35], a[0:3], a[176:179], v[32:35]
  ds_read_b64_tr_b16 a[56:57], v10 offset:14336
  v_mfma_f32_16x16x32_bf16 v[36:39], a[0:3], a[180:183], v[36:39]
  ds_read_b64_tr_b16 a[58:59], v10 offset:17920
  v_mfma_f32_16x16x32_bf16 v[40:43], a[0:3], a[184:187], v[40:43]
  buffer_load_dwordx4 a[160:163], v1, s[4:7], s20 offen offset:0
  v_mfma_f32_16x16x32_bf16 v[44:47], a[0:3], a[188:191], v[44:47]
  ds_read_b64_tr_b16 a[60:61], v10 offset:21504
  v_mfma_f32_16x16x32_bf16 v[60:63], a[4:7], a[188:191], v[60:63]
  ds_read_b64_tr_b16 a[62:63], v10 offset:25088
  v_mfma_f32_16x16x32_bf16 v[56:59], a[4:7], a[184:187], v[56:59]
  buffer_load_dwordx4 a[164:167], v1, s[4:7], s20 offen offset:256
  v_mfma_f32_16x16x32_bf16 v[52:55], a[4:7], a[180:183], v[52:55]
  ds_read_b64_tr_b16 a[64:65], v10 offset:14368
  v_mfma_f32_16x16x32_bf16 v[48:51], a[4:7], a[176:179], v[48:51]
  ds_read_b64_tr_b16 a[66:67], v10 offset:17952
  v_mfma_f32_16x16x32_bf16 v[64:67], a[8:11], a[176:179], v[64:67]
  buffer_load_dwordx4 a[168:171], v1, s[4:7], s20 offen offset:512
  v_mfma_f32_16x16x32_bf16 v[68:71], a[8:11], a[180:183], v[68:71]
  ds_read_b64_tr_b16 a[68:69], v10 offset:21536
  v_mfma_f32_16x16x32_bf16 v[72:75], a[8:11], a[184:187], v[72:75]
  ds_read_b64_tr_b16 a[70:71], v10 offset:25120
  v_mfma_f32_16x16x32_bf16 v[76:79], a[8:11], a[188:191], v[76:79]
  ds_read_b64_tr_b16 a[72:73], v10 offset:14400
  v_mfma_f32_16x16x32_bf16 v[92:95], a[12:15], a[188:191], v[92:95]
  buffer_load_dwordx4 a[172:175], v1, s[4:7], s20 offen offset:768
  v_mfma_f32_16x16x32_bf16 v[88:91], a[12:15], a[184:187], v[88:91]
  s_add_u32 s20, s20, 0x20000
  v_mfma_f32_16x16x32_bf16 v[84:87], a[12:15], a[180:183], v[84:87]
  ds_read_b64_tr_b16 a[74:75], v10 offset:17984
  v_mfma_f32_16x16x32_bf16 v[80:83], a[12:15], a[176:179], v[80:83]
  ds_read_b64_tr_b16 a[76:77], v10 offset:21568
  v_mfma_f32_16x16x32_bf16 v[96:99], a[16:19], a[176:179], v[96:99]
  ds_read_b64_tr_b16 a[78:79], v10 offset:25152
  v_mfma_f32_16x16x32_bf16 v[100:103], a[16:19], a[180:183], v[100:103]
  buffer_load_dwordx4 v5, s[8:11], s21 offen offset:3072  lds
  v_mfma_f32_16x16x32_bf16 v[104:107], a[16:19], a[184:187], v[104:107]
  ds_read_b64_tr_b16 a[80:81], v10 offset:14432
  v_mfma_f32_16x16x32_bf16 v[108:111], a[16:19], a[188:191], v[108:111]
  ds_read_b64_tr_b16 a[82:83], v10 offset:18016
  v_mfma_f32_16x16x32_bf16 v[124:127], a[20:23], a[188:191], v[124:127]
  s_add_u32 m0, s25, 4096
  v_mfma_f32_16x16x32_bf16 v[120:123], a[20:23], a[184:187], v[120:123]
  buffer_load_dwordx4 v6, s[8:11], s21 offen offset:0  lds
  v_mfma_f32_16x16x32_bf16 v[116:119], a[20:23], a[180:183], v[116:119]
  ds_read_b64_tr_b16 a[84:85], v10 offset:21600
  v_mfma_f32_16x16x32_bf16 v[112:115], a[20:23], a[176:179], v[112:115]
  ds_read_b64_tr_b16 a[86:87], v10 offset:25184
  v_mfma_f32_16x16x32_bf16 v[128:131], a[24:27], a[176:179], v[128:131]
  ds_read_b64_tr_b16 a[88:89], v10 offset:14464
  v_mfma_f32_16x16x32_bf16 v[132:135], a[24:27], a[180:183], v[132:135]
  buffer_load_dwordx4 v7, s[8:11], s21 offen offset:1024  lds
  v_mfma_f32_16x16x32_bf16 v[136:139], a[24:27], a[184:187], v[136:139]
  ds_read_b64_tr_b16 a[90:91], v10 offset:18048
  v_mfma_f32_16x16x32_bf16 v[140:143], a[24:27], a[188:191], v[140:143]
  ds_read_b64_tr_b16 a[92:93], v10 offset:21632
  v_mfma_f32_16x16x32_bf16 v[156:159], a[28:31], a[188:191], v[156:159]
  ds_read_b64_tr_b16 a[94:95], v10 offset:25216
  v_mfma_f32_16x16x32_bf16 v[152:155], a[28:31], a[184:187], v[152:155]
  buffer_load_dwordx4 v8, s[8:11], s21 offen offset:2048  lds
  v_mfma_f32_16x16x32_bf16 v[148:151], a[28:31], a[180:183], v[148:151]
  s_add_u32 s21, s21, 458752
  s_cmp_eq_u32 s21, 7340032
  s_cselect_b32 s21, 0, s21
  v_mfma_f32_16x16x32_bf16 v[144:147], a[28:31], a[176:179], v[144:147]
  v_mfma_f32_16x16x32_bf16 v[160:163], a[32:35], a[176:179], v[160:163]
  v_mfma_f32_16x16x32_bf16 v[164:167], a[32:35], a[180:183], v[164:167]
  ds_read_b64_tr_b16 a[96:97], v10 offset:14496
  v_mfma_f32_16x16x32_bf16 v[168:171], a[32:35], a[184:187], v[168:171]
  ds_read_b64_tr_b16 a[98:99], v10 offset:18080
  v_mfma_f32_16x16x32_bf16 v[172:175], a[32:35], a[188:191], v[172:175]
  ds_read_b64_tr_b16 a[100:101], v10 offset:21664
  v_mfma_f32_16x16x32_bf16 v[188:191], a[36:39], a[188:191], v[188:191]
  ds_read_b64_tr_b16 a[102:103], v10 offset:25248
  v_mfma_f32_16x16x32_bf16 v[184:187], a[36:39], a[184:187], v[184:187]
  ds_read_b64_tr_b16 a[104:105], v10 offset:14528
  v_mfma_f32_16x16x32_bf16 v[180:183], a[36:39], a[180:183], v[180:183]
  ds_read_b64_tr_b16 a[106:107], v10 offset:18112
  v_mfma_f32_16x16x32_bf16 v[176:179], a[36:39], a[176:179], v[176:179]
  ds_read_b64_tr_b16 a[108:109], v10 offset:21696
  v_mfma_f32_16x16x32_bf16 v[192:195], a[40:43], a[176:179], v[192:195]
  ds_read_b64_tr_b16 a[110:111], v10 offset:25280
  v_mfma_f32_16x16x32_bf16 v[196:199], a[40:43], a[180:183], v[196:199]
  v_mfma_f32_16x16x32_bf16 v[200:203], a[40:43], a[184:187], v[200:203]
  v_mfma_f32_16x16x32_bf16 v[204:207], a[40:43], a[188:191], v[204:207]
  v_mfma_f32_16x16x32_bf16 v[220:223], a[44:47], a[188:191], v[220:223]
  v_mfma_f32_16x16x32_bf16 v[216:219], a[44:47], a[184:187], v[216:219]
  v_mfma_f32_16x16x32_bf16 v[212:215], a[44:47], a[180:183], v[212:215]
  v_mfma_f32_16x16x32_bf16 v[208:211], a[44:47], a[176:179], v[208:211]
  v_mfma_f32_16x16x32_bf16 v[224:227], a[48:51], a[176:179], v[224:227]
  v_mfma_f32_16x16x32_bf16 v[228:231], a[48:51], a[180:183], v[228:231]
  v_mfma_f32_16x16x32_bf16 v[232:235], a[48:51], a[184:187], v[232:235]
  v_mfma_f32_16x16x32_bf16 v[236:239], a[48:51], a[188:191], v[236:239]
  v_mfma_f32_16x16x32_bf16 v[252:255], a[52:55], a[188:191], v[252:255]
  v_mfma_f32_16x16x32_bf16 v[248:251], a[52:55], a[184:187], v[248:251]
  v_mfma_f32_16x16x32_bf16 v[244:247], a[52:55], a[180:183], v[244:247]
  v_mfma_f32_16x16x32_bf16 v[240:243], a[52:55], a[176:179], v[240:243]
g1_s25:
  s_waitcnt vmcnt(28) lgkmcnt(0)
  v_mfma_f32_16x16x32_bf16 v[32:35], a[56:59], a[112:115], v[32:35]
  s_barrier
  v_mfma_f32_16x16x32_bf16 v[36:39], a[56:59], a[116:119], v[36:39]
  ds_read_b64_tr_b16 a[0:1], v10 offset:28672
  v_mfma_f32_16x16x32_bf16 v[40:43], a[56:59], a[120:123], v[40:43]
  ds_read_b64_tr_b16 a[2:3], v10 offset:32256
  v_mfma_f32_16x16x32_bf16 v[44:47], a[56:59], a[124:127], v[44:47]
  buffer_load_dwordx4 a[176:179], v1, s[4:7], s20 offen offset:0
  v_mfma_f32_16x16x32_bf16 v[60:63], a[60:63], a[124:127], v[60:63]
  ds_read_b64_tr_b16 a[4:5], v10 offset:35840
  v_mfma_f32_16x16x32_bf16 v[56:59], a[60:63], a[120:123], v[56:59]
  ds_read_b64_tr_b16 a[6:7], v10 offset:39424
  v_mfma_f32_16x16x32_bf16 v[52:55], a[60:63], a[116:119], v[52:55]
  buffer_load_dwordx4 a[180:183], v1, s[4:7], s20 offen offset:256
  v_mfma_f32_16x16x32_bf16 v[48:51], a[60:63], a[112:115], v[48:51]
  ds_read_b64_tr_b16 a[8:9], v10 offset:28704
  v_mfma_f32_16x16x32_bf16 v[64:67], a[64:67], a[112:115], v[64:67]
  ds_read_b64_tr_b16 a[10:11], v10 offset:32288
  v_mfma_f32_16x16x32_bf16 v[68:71], a[64:67], a[116:119], v[68:71]
  buffer_load_dwordx4 a[184:187], v1, s[4:7], s20 offen offset:512
  v_mfma_f32_16x16x32_bf16 v[72:75], a[64:67], a[120:123], v[72:75]
  ds_read_b64_tr_b16 a[12:13], v10 offset:35872
  v_mfma_f32_16x16x32_bf16 v[76:79], a[64:67], a[124:127], v[76:79]
  ds_read_b64_tr_b16 a[14:15], v10 offset:39456
  v_mfma_f32_16x16x32_bf16 v[92:95], a[68:71], a[124:127], v[92:95]
  ds_read_b64_tr_b16 a[16:17], v10 offset:28736
  v_mfma_f32_16x16x32_bf16 v[88:91], a[68:71], a[120:123], v[88:91]
  buffer_load_dwordx4 a[188:191], v1, s[4:7], s20 offen offset:768
  v_mfma_f32_16x16x32_bf16 v[84:87], a[68:71], a[116:119], v[84:87]
  s_add_u32 s20, s20, 0x20000
  v_mfma_f32_16x16x32_bf16 v[80:83], a[68:71], a[112:115], v[80:83]
  ds_read_b64_tr_b16 a[18:19], v10 offset:32320
  v_mfma_f32_16x16x32_bf16 v[96:99], a[72:75], a[112:115], v[96:99]
  ds_read_b64_tr_b16 a[20:21], v10 offset:35904
  v_mfma_f32_16x16x32_bf16 v[100:103], a[72:75], a[116:119], v[100:103]
  ds_read_b64_tr_b16 a[22:23], v10 offset:39488
  v_mfma_f32_16x16x32_bf16 v[104:107], a[72:75], a[120:123], v[104:107]
  ds_read_b64_tr_b16 a[24:25], v10 offset:28768
  v_mfma_f32_16x16x32_bf16 v[108:111], a[72:75], a[124:127], v[108:111]
  ds_read_b64_tr_b16 a[26:27], v10 offset:32352
  v_mfma_f32_16x16x32_bf16 v[124:127], a[76:79], a[124:127], v[124:127]
  ds_read_b64_tr_b16 a[28:29], v10 offset:35936
  v_mfma_f32_16x16x32_bf16 v[120:123], a[76:79], a[120:123], v[120:123]
  ds_read_b64_tr_b16 a[30:31], v10 offset:39520
  v_mfma_f32_16x16x32_bf16 v[116:119], a[76:79], a[116:119], v[116:119]
  ds_read_b64_tr_b16 a[32:33], v10 offset:28800
  v_mfma_f32_16x16x32_bf16 v[112:115], a[76:79], a[112:115], v[112:115]
  ds_read_b64_tr_b16 a[34:35], v10 offset:32384
  v_mfma_f32_16x16x32_bf16 v[128:131], a[80:83], a[112:115], v[128:131]
  ds_read_b64_tr_b16 a[36:37], v10 offset:35968
  v_mfma_f32_16x16x32_bf16 v[132:135], a[80:83], a[116:119], v[132:135]
  ds_read_b64_tr_b16 a[38:39], v10 offset:39552
  v_mfma_f32_16x16x32_bf16 v[136:139], a[80:83], a[120:123], v[136:139]
  ds_read_b64_tr_b16 a[40:41], v10 offset:28832
  v_mfma_f32_16x16x32_bf16 v[140:143], a[80:83], a[124:127], v[140:143]
  ds_read_b64_tr_b16 a[42:43], v10 offset:32416
  v_mfma_f32_16x16x32_bf16 v[156:159], a[84:87], a[124:127], v[156:159]
  ds_read_b64_tr_b16 a[44:45], v10 offset:36000
  v_mfma_f32_16x16x32_bf16 v[152:155], a[84:87], a[120:123], v[152:155]
  ds_read_b64_tr_b16 a[46:47], v10 offset:39584
  v_mfma_f32_16x16x32_bf16 v[148:151], a[84:87], a[116:119], v[148:151]
  ds_read_b64_tr_b16 a[48:49], v10 offset:28864
  v_mfma_f32_16x16x32_bf16 v[144:147], a[84:87], a[112:115], v[144:147]
  ds_read_b64_tr_b16 a[50:51], v10 offset:32448
  v_mfma_f32_16x16x32_bf16 v[160:163], a[88:91], a[112:115], v[160:163]
  ds_read_b64_tr_b16 a[52:53], v10 offset:36032
  v_mfma_f32_16x16x32_bf16 v[164:167], a[88:91], a[116:119], v[164:167]
  ds_read_b64_tr_b16 a[54:55], v10 offset:39616
  v_mfma_f32_16x16x32_bf16 v[168:171], a[88:91], a[120:123], v[168:171]
  v_mfma_f32_16x16x32_bf16 v[172:175], a[88:91], a[124:127], v[172:175]
  v_mfma_f32_16x16x32_bf16 v[188:191], a[92:95], a[124:127], v[188:191]
  v_mfma_f32_16x16x32_bf16 v[184:187], a[92:95], a[120:123], v[184:187]
  v_mfma_f32_16x16x32_bf16 v[180:183], a[92:95], a[116:119], v[180:183]
  v_mfma_f32_16x16x32_bf16 v[176:179], a[92:95], a[112:115], v[176:179]
  v_mfma_f32_16x16x32_bf16 v[192:195], a[96:99], a[112:115], v[192:195]
  v_mfma_f32_16x16x32_bf16 v[196:199], a[96:99], a[116:119], v[196:199]
  v_mfma_f32_16x16x32_bf16 v[200:203], a[96:99], a[120:123], v[200:203]
  v_mfma_f32_16x16x32_bf16 v[204:207], a[96:99], a[124:127], v[204:207]
  v_mfma_f32_16x16x32_bf16 v[220:223], a[100:103], a[124:127], v[220:223]
  v_mfma_f32_16x16x32_bf16 v[216:219], a[100:103], a[120:123], v[216:219]
  v_mfma_f32_16x16x32_bf16 v[212:215], a[100:103], a[116:119], v[212:215]
  v_mfma_f32_16x16x32_bf16 v[208:211], a[100:103], a[112:115], v[208:211]
  v_mfma_f32_16x16x32_bf16 v[224:227], a[104:107], a[112:115], v[224:227]
  v_mfma_f32_16x16x32_bf16 v[228:231], a[104:107], a[116:119], v[228:231]
  v_mfma_f32_16x16x32_bf16 v[232:235], a[104:107], a[120:123], v[232:235]
  v_mfma_f32_16x16x32_bf16 v[236:239], a[104:107], a[124:127], v[236:239]
  v_mfma_f32_16x16x32_bf16 v[252:255], a[108:111], a[124:127], v[252:255]
  v_mfma_f32_16x16x32_bf16 v[248:251], a[108:111], a[120:123], v[248:251]
  v_mfma_f32_16x16x32_bf16 v[244:247], a[108:111], a[116:119], v[244:247]
  v_mfma_f32_16x16x32_bf16 v[240:243], a[108:111], a[112:115], v[240:243]
g1_s26:
  s_waitcnt vmcnt(24) lgkmcnt(0)
  v_mfma_f32_16x16x32_bf16 v[32:35], a[0:3], a[128:131], v[32:35]
  ds_read_b64_tr_b16 a[56:57], v10 offset:43008
  v_mfma_f32_16x16x32_bf16 v[36:39], a[0:3], a[132:135], v[36:39]
  ds_read_b64_tr_b16 a[58:59], v10 offset:46592
  v_mfma_f32_16x16x32_bf16 v[40:43], a[0:3], a[136:139], v[40:43]
  buffer_load_dwordx4 a[112:115], v1, s[4:7], s20 offen offset:0
  v_mfma_f32_16x16x32_bf16 v[44:47], a[0:3], a[140:143], v[44:47]
  ds_read_b64_tr_b16 a[60:61], v10 offset:50176
  v_mfma_f32_16x16x32_bf16 v[60:63], a[4:7], a[140:143], v[60:63]
  ds_read_b64_tr_b16 a[62:63], v10 offset:53760
  v_mfma_f32_16x16x32_bf16 v[56:59], a[4:7], a[136:139], v[56:59]
  buffer_load_dwordx4 a[116:119], v1, s[4:7], s20 offen offset:256
  v_mfma_f32_16x16x32_bf16 v[52:55], a[4:7], a[132:135], v[52:55]
  ds_read_b64_tr_b16 a[64:65], v10 offset:43040
  v_mfma_f32_16x16x32_bf16 v[48:51], a[4:7], a[128:131], v[48:51]
  ds_read_b64_tr_b16 a[66:67], v10 offset:46624
  v_mfma_f32_16x16x32_bf16 v[64:67], a[8:11], a[128:131], v[64:67]
  buffer_load_dwordx4 a[120:123], v1, s[4:7], s20 offen offset:512
  v_mfma_f32_16x16x32_bf16 v[68:71], a[8:11], a[132:135], v[68:71]
  ds_read_b64_tr_b16 a[68:69], v10 offset:50208
  v_mfma_f32_16x16x32_bf16 v[72:75], a[8:11], a[136:139], v[72:75]
  ds_read_b64_tr_b16 a[70:71], v10 offset:53792
  v_mfma_f32_16x16x32_bf16 v[76:79], a[8:11], a[140:143], v[76:79]
  ds_read_b64_tr_b16 a[72:73], v10 offset:43072
  v_mfma_f32_16x16x32_bf16 v[92:95], a[12:15], a[140:143], v[92:95]
  buffer_load_dwordx4 a[124:127], v1, s[4:7], s20 offen offset:768
  v_mfma_f32_16x16x32_bf16 v[88:91], a[12:15], a[136:139], v[88:91]
  s_add_u32 s20, s20, 0x20000
  v_mfma_f32_16x16x32_bf16 v[84:87], a[12:15], a[132:135], v[84:87]
  ds_read_b64_tr_b16 a[74:75], v10 offset:46656
  v_mfma_f32_16x16x32_bf16 v[80:83], a[12:15], a[128:131], v[80:83]
  ds_read_b64_tr_b16 a[76:77], v10 offset:50240
  v_mfma_f32_16x16x32_bf16 v[96:99], a[16:19], a[128:131], v[96:99]
  ds_read_b64_tr_b16 a[78:79], v10 offset:53824
  v_mfma_f32_16x16x32_bf16 v[100:103], a[16:19], a[132:135], v[100:103]
  ds_read_b64_tr_b16 a[80:81], v10 offset:43104
  v_mfma_f32_16x16x32_bf16 v[104:107], a[16:19], a[136:139], v[104:107]
  ds_read_b64_tr_b16 a[82:83], v10 offset:46688
  v_mfma_f32_16x16x32_bf16 v[108:111], a[16:19], a[140:143], v[108:111]
  ds_read_b64_tr_b16 a[84:85], v10 offset:50272
  v_mfma_f32_16x16x32_bf16 v[124:127], a[20:23], a[140:143], v[124:127]
  ds_read_b64_tr_b16 a[86:87], v10 offset:53856
  v_mfma_f32_16x16x32_bf16 v[120:123], a[20:23], a[136:139], v[120:123]
  ds_read_b64_tr_b16 a[88:89], v10 offset:43136
  v_mfma_f32_16x16x32_bf16 v[116:119], a[20:23], a[132:135], v[116:119]
  ds_read_b64_tr_b16 a[90:91], v10 offset:46720
  v_mfma_f32_16x16x32_bf16 v[112:115], a[20:23], a[128:131], v[112:115]
  ds_read_b64_tr_b16 a[92:93], v10 offset:50304
  v_mfma_f32_16x16x32_bf16 v[128:131], a[24:27], a[128:131], v[128:131]
  ds_read_b64_tr_b16 a[94:95], v10 offset:53888
  v_mfma_f32_16x16x32_bf16 v[132:135], a[24:27], a[132:135], v[132:135]
  ds_read_b64_tr_b16 a[96:97], v10 offset:43168
  v_mfma_f32_16x16x32_bf16 v[136:139], a[24:27], a[136:139], v[136:139]
  ds_read_b64_tr_b16 a[98:99], v10 offset:46752
  v_mfma_f32_16x16x32_bf16 v[140:143], a[24:27], a[140:143], v[140:143]
  ds_read_b64_tr_b16 a[100:101], v10 offset:50336
  v_mfma_f32_16x16x32_bf16 v[156:159], a[28:31], a[140:143], v[156:159]
  ds_read_b64_tr_b16 a[102:103], v10 offset:53920
  v_mfma_f32_16x16x32_bf16 v[152:155], a[28:31], a[136:139], v[152:155]
  ds_read_b64_tr_b16 a[104:105], v10 offset:43200
  v_mfma_f32_16x16x32_bf16 v[148:151], a[28:31], a[132:135], v[148:151]
  ds_read_b64_tr_b16 a[106:107], v10 offset:46784
  v_mfma_f32_16x16x32_bf16 v[144:147], a[28:31], a[128:131], v[144:147]
  ds_read_b64_tr_b16 a[108:109], v10 offset:50368
  v_mfma_f32_16x16x32_bf16 v[160:163], a[32:35], a[128:131], v[160:163]
  ds_read_b64_tr_b16 a[110:111], v10 offset:53952
  v_mfma_f32_16x16x32_bf16 v[164:167], a[32:35], a[132:135], v[164:167]
  s_add_u32 s51, s50, g1_epi - g1_pc
  v_mfma_f32_16x16x32_bf16 v[168:171], a[32:35], a[136:139], v[168:171]
  s_min_u32 s51, s51, code_end - g1_pc - 4
  v_mfma_f32_16x16x32_bf16 v[172:175], a[32:35], a[140:143], v[172:175]
  v_mov_b32 v23, s51
  v_mfma_f32_16x16x32_bf16 v[188:191], a[36:39], a[140:143], v[188:191]
  global_load_dword a212, v23, s[48:49]
  v_mfma_f32_16x16x32_bf16 v[184:187], a[36:39], a[136:139], v[184:187]
  v_mfma_f32_16x16x32_bf16 v[180:183], a[36:39], a[132:135], v[180:183]
  v_mfma_f32_16x16x32_bf16 v[176:179], a[36:39], a[128:131], v[176:179]
  v_mfma_f32_16x16x32_bf16 v[192:195], a[40:43], a[128:131], v[192:195]
  v_mfma_f32_16x16x32_bf16 v[196:199], a[40:43], a[132:135], v[196:199]
  v_mfma_f32_16x16x32_bf16 v[200:203], a[40:43], a[136:139], v[200:203]
  v_mfma_f32_16x16x32_bf16 v[204:207], a[40:43], a[140:143], v[204:207]
  v_mfma_f32_16x16x32_bf16 v[220:223], a[44:47], a[140:143], v[220:223]
  v_mfma_f32_16x16x32_bf16 v[216:219], a[44:47], a[136:139], v[216:219]
  v_mfma_f32_16x16x32_bf16 v[212:215], a[44:47], a[132:135], v[212:215]
  v_mfma_f32_16x16x32_bf16 v[208:211], a[44:47], a[128:131], v[208:211]
  v_mfma_f32_16x16x32_bf16 v[224:227], a[48:51], a[128:131], v[224:227]
  v_mfma_f32_16x16x32_bf16 v[228:231], a[48:51], a[132:135], v[228:231]
  v_mfma_f32_16x16x32_bf16 v[232:235], a[48:51], a[136:139], v[232:235]
  v_mfma_f32_16x16x32_bf16 v[236:239], a[48:51], a[140:143], v[236:239]
  v_mfma_f32_16x16x32_bf16 v[252:255], a[52:55], a[140:143], v[252:255]
  v_mfma_f32_16x16x32_bf16 v[248:251], a[52:55], a[136:139], v[248:251]
  v_mfma_f32_16x16x32_bf16 v[244:247], a[52:55], a[132:135], v[244:247]
  v_mfma_f32_16x16x32_bf16 v[240:243], a[52:55], a[128:131], v[240:243]
g1_s27:
  s_waitcnt vmcnt(21) lgkmcnt(0)
  v_mfma_f32_16x16x32_bf16 v[32:35], a[56:59], a[144:147], v[32:35]
  s_barrier
  ds_read_b64_tr_b16 a[0:1], v11 offset:0
  v_mfma_f32_16x16x32_bf16 v[36:39], a[56:59], a[148:151], v[36:39]
  ds_read_b64_tr_b16 a[2:3], v11 offset:3584
  v_mfma_f32_16x16x32_bf16 v[40:43], a[56:59], a[152:155], v[40:43]
  buffer_load_dwordx4 a[128:131], v1, s[4:7], s20 offen offset:0
  v_mfma_f32_16x16x32_bf16 v[44:47], a[56:59], a[156:159], v[44:47]
  v_min_u32 v13, 223, v0
  v_mfma_f32_16x16x32_bf16 v[60:63], a[60:63], a[156:159], v[60:63]
  v_lshlrev_b32 v13, 2, v13
  v_mfma_f32_16x16x32_bf16 v[56:59], a[60:63], a[152:155], v[56:59]
  ds_read_b64_tr_b16 a[4:5], v11 offset:7168
  s_mul_i32 s56, s18, 896
  v_mfma_f32_16x16x32_bf16 v[52:55], a[60:63], a[148:151], v[52:55]
  s_add_u32 s56, s56, 262144
  v_mfma_f32_16x16x32_bf16 v[48:51], a[60:63], a[144:147], v[48:51]
  ds_read_b64_tr_b16 a[6:7], v11 offset:10752
  v_mfma_f32_16x16x32_bf16 v[64:67], a[64:67], a[144:147], v[64:67]
  buffer_load_dwordx4 a[132:135], v1, s[4:7], s20 offen offset:256
  v_mfma_f32_16x16x32_bf16 v[68:71], a[64:67], a[148:151], v[68:71]
  s_add_u32 s57, s56, 28672
  v_mfma_f32_16x16x32_bf16 v[72:75], a[64:67], a[152:155], v[72:75]
  ds_read_b64_tr_b16 a[8:9], v11 offset:32
  s_add_u32 s58, s57, 28672
  v_mfma_f32_16x16x32_bf16 v[76:79], a[64:67], a[156:159], v[76:79]
  s_add_u32 s59, s58, 28672
  v_mfma_f32_16x16x32_bf16 v[92:95], a[68:71], a[156:159], v[92:95]
  ds_read_b64_tr_b16 a[10:11], v11 offset:3616
  v_mfma_f32_16x16x32_bf16 v[88:91], a[68:71], a[152:155], v[88:91]
  s_add_u32 s60, s59, 28672
  v_mfma_f32_16x16x32_bf16 v[84:87], a[68:71], a[148:151], v[84:87]
  buffer_load_dwordx4 a[136:139], v1, s[4:7], s20 offen offset:512
  v_mfma_f32_16x16x32_bf16 v[80:83], a[68:71], a[144:147], v[80:83]
  s_add_u32 s61, s60, 28672
  v_mfma_f32_16x16x32_bf16 v[96:99], a[72:75], a[144:147], v[96:99]
  ds_read_b64_tr_b16 a[12:13], v11 offset:7200
  s_add_u32 s62, s61, 28672
  v_mfma_f32_16x16x32_bf16 v[100:103], a[72:75], a[148:151], v[100:103]
  ds_read_b64_tr_b16 a[14:15], v11 offset:10784
  v_mfma_f32_16x16x32_bf16 v[104:107], a[72:75], a[152:155], v[104:107]
  s_add_u32 s63, s62, 28672
  v_mfma_f32_16x16x32_bf16 v[108:111], a[72:75], a[156:159], v[108:111]
  v_and_b32 v14, 15, v12
  v_mfma_f32_16x16x32_bf16 v[124:127], a[76:79], a[156:159], v[124:127]
  ds_read_b64_tr_b16 a[16:17], v11 offset:64
  v_mfma_f32_16x16x32_bf16 v[120:123], a[76:79], a[152:155], v[120:123]
  v_lshlrev_b32 v14, 3, v14
  buffer_load_dwordx4 a[140:143], v1, s[4:7], s20 offen offset:768
  v_mfma_f32_16x16x32_bf16 v[116:119], a[76:79], a[148:151], v[116:119]
  s_add_u32 s20, s20, 0x20000
  v_mfma_f32_16x16x32_bf16 v[112:115], a[76:79], a[144:147], v[112:115]
  s_and_b32 s20, s20, 0x3fffff
  v_mfma_f32_16x16x32_bf16 v[128:131], a[80:83], a[144:147], v[128:131]
  s_lshl_b32 s37, s17, 2
  v_mfma_f32_16x16x32_bf16 v[132:135], a[80:83], a[148:151], v[132:135]
  ds_read_b64_tr_b16 a[18:19], v11 offset:3648
  v_mfma_f32_16x16x32_bf16 v[136:139], a[80:83], a[152:155], v[136:139]
  s_add_u32 s37, s37, s16
  v_mfma_f32_16x16x32_bf16 v[140:143], a[80:83], a[156:159], v[140:143]
  ds_read_b64_tr_b16 a[20:21], v11 offset:7232
  s_lshl_b32 s37, s37, 9
  v_mfma_f32_16x16x32_bf16 v[156:159], a[84:87], a[156:159], v[156:159]
  s_add_u32 s37, s37, 245760
  v_mfma_f32_16x16x32_bf16 v[152:155], a[84:87], a[152:155], v[152:155]
  ds_read_b64_tr_b16 a[22:23], v11 offset:10816
  v_mfma_f32_16x16x32_bf16 v[148:151], a[84:87], a[148:151], v[148:151]
  buffer_load_dword v24, v13, s[40:43], s56 offen sc0 sc1
  v_mfma_f32_16x16x32_bf16 v[144:147], a[84:87], a[144:147], v[144:147]
  ds_read_b64_tr_b16 a[24:25], v11 offset:96
  v_mfma_f32_16x16x32_bf16 v[160:163], a[88:91], a[144:147], v[160:163]
  buffer_load_dword v25, v13, s[40:43], s57 offen sc0 sc1
  ds_read_b64_tr_b16 a[26:27], v11 offset:3680
  v_mfma_f32_16x16x32_bf16 v[164:167], a[88:91], a[148:151], v[164:167]
  buffer_load_dword v26, v13, s[40:43], s58 offen sc0 sc1
  v_mfma_f32_16x16x32_bf16 v[168:171], a[88:91], a[152:155], v[168:171]
  ds_read_b64_tr_b16 a[28:29], v11 offset:7264
  v_mfma_f32_16x16x32_bf16 v[172:175], a[88:91], a[156:159], v[172:175]
  buffer_load_dword v27, v13, s[40:43], s59 offen sc0 sc1
  v_mfma_f32_16x16x32_bf16 v[188:191], a[92:95], a[156:159], v[188:191]
  ds_read_b64_tr_b16 a[30:31], v11 offset:10848
  v_mfma_f32_16x16x32_bf16 v[184:187], a[92:95], a[152:155], v[184:187]
  ds_read_b64_tr_b16 a[32:33], v11 offset:128
  buffer_load_dword v28, v13, s[40:43], s60 offen sc0 sc1
  v_mfma_f32_16x16x32_bf16 v[180:183], a[92:95], a[148:151], v[180:183]
  ds_read_b64_tr_b16 a[34:35], v11 offset:3712
  v_mfma_f32_16x16x32_bf16 v[176:179], a[92:95], a[144:147], v[176:179]
  buffer_load_dword v29, v13, s[40:43], s61 offen sc0 sc1
  v_mfma_f32_16x16x32_bf16 v[192:195], a[96:99], a[144:147], v[192:195]
  ds_read_b64_tr_b16 a[36:37], v11 offset:7296
  v_mfma_f32_16x16x32_bf16 v[196:199], a[96:99], a[148:151], v[196:199]
  buffer_load_dword v30, v13, s[40:43], s62 offen sc0 sc1
  v_mfma_f32_16x16x32_bf16 v[200:203], a[96:99], a[152:155], v[200:203]
  ds_read_b64_tr_b16 a[38:39], v11 offset:10880
  v_mfma_f32_16x16x32_bf16 v[204:207], a[96:99], a[156:159], v[204:207]
  buffer_load_dword v31, v13, s[40:43], s63 offen sc0 sc1
  ds_read_b64_tr_b16 a[40:41], v11 offset:160
  v_mfma_f32_16x16x32_bf16 v[220:223], a[100:103], a[156:159], v[220:223]
  buffer_load_dwordx2 v[16:17], v14, s[40:43], s37 offen offset:0 sc0 sc1
  v_mfma_f32_16x16x32_bf16 v[216:219], a[100:103], a[152:155], v[216:219]
  ds_read_b64_tr_b16 a[42:43], v11 offset:3744
  v_mfma_f32_16x16x32_bf16 v[212:215], a[100:103], a[148:151], v[212:215]
  ds_read_b64_tr_b16 a[44:45], v11 offset:7328
  v_mfma_f32_16x16x32_bf16 v[208:211], a[100:103], a[144:147], v[208:211]
  buffer_load_dwordx2 v[18:19], v14, s[40:43], s37 offen offset:128 sc0 sc1
  v_mfma_f32_16x16x32_bf16 v[224:227], a[104:107], a[144:147], v[224:227]
  ds_read_b64_tr_b16 a[46:47], v11 offset:10912
  buffer_load_dwordx2 v[20:21], v14, s[40:43], s37 offen offset:256 sc0 sc1
  v_mfma_f32_16x16x32_bf16 v[228:231], a[104:107], a[148:151], v[228:231]
  ds_read_b64_tr_b16 a[48:49], v11 offset:192
  v_mfma_f32_16x16x32_bf16 v[232:235], a[104:107], a[152:155], v[232:235]
  buffer_load_dwordx2 v[22:23], v14, s[40:43], s37 offen offset:384 sc0 sc1
  v_mfma_f32_16x16x32_bf16 v[236:239], a[104:107], a[156:159], v[236:239]
  ds_read_b64_tr_b16 a[50:51], v11 offset:3776
  v_mfma_f32_16x16x32_bf16 v[252:255], a[108:111], a[156:159], v[252:255]
  ds_read_b64_tr_b16 a[52:53], v11 offset:7360
  v_mfma_f32_16x16x32_bf16 v[248:251], a[108:111], a[152:155], v[248:251]
  ds_read_b64_tr_b16 a[54:55], v11 offset:10944
  v_mfma_f32_16x16x32_bf16 v[244:247], a[108:111], a[148:151], v[244:247]
  v_mfma_f32_16x16x32_bf16 v[240:243], a[108:111], a[144:147], v[240:243]
g1_s28:
  s_waitcnt vmcnt(29) lgkmcnt(0)
  v_mfma_f32_16x16x32_bf16 v[32:35], a[0:3], a[160:163], v[32:35]
  ds_read_b64_tr_b16 a[56:57], v11 offset:14336
  ds_read_b64_tr_b16 a[58:59], v11 offset:17920
  v_mfma_f32_16x16x32_bf16 v[36:39], a[0:3], a[164:167], v[36:39]
  s_load_dwordx2 s[30:31], s[0:1], 104
  v_mfma_f32_16x16x32_bf16 v[40:43], a[0:3], a[168:171], v[40:43]
  ds_read_b64_tr_b16 a[60:61], v11 offset:21504
  v_mfma_f32_16x16x32_bf16 v[44:47], a[0:3], a[172:175], v[44:47]
  s_sub_u32 s8, s44, 2048
  v_mfma_f32_16x16x32_bf16 v[60:63], a[4:7], a[172:175], v[60:63]
  s_subb_u32 s9, s45, 0
  v_mfma_f32_16x16x32_bf16 v[56:59], a[4:7], a[168:171], v[56:59]
  ds_read_b64_tr_b16 a[62:63], v11 offset:25088
  v_mfma_f32_16x16x32_bf16 v[52:55], a[4:7], a[164:167], v[52:55]
  s_mov_b32 s10, 7342080
  v_mfma_f32_16x16x32_bf16 v[48:51], a[4:7], a[160:163], v[48:51]
  ds_read_b64_tr_b16 a[64:65], v11 offset:14368
  v_mfma_f32_16x16x32_bf16 v[64:67], a[8:11], a[160:163], v[64:67]
  s_bfe_u32 s21, s2, 0x20001
  v_mfma_f32_16x16x32_bf16 v[68:71], a[8:11], a[164:167], v[68:71]
  s_lshl_b32 s21, s21, 2
  v_mfma_f32_16x16x32_bf16 v[72:75], a[8:11], a[168:171], v[72:75]
  ds_read_b64_tr_b16 a[66:67], v11 offset:17952
  v_mfma_f32_16x16x32_bf16 v[76:79], a[8:11], a[172:175], v[76:79]
  s_lshr_b32 s27, s2, 6
  v_mfma_f32_16x16x32_bf16 v[92:95], a[12:15], a[172:175], v[92:95]
  s_add_u32 s21, s21, s27
  v_mfma_f32_16x16x32_bf16 v[88:91], a[12:15], a[168:171], v[88:91]
  ds_read_b64_tr_b16 a[68:69], v11 offset:21536
  v_mfma_f32_16x16x32_bf16 v[84:87], a[12:15], a[164:167], v[84:87]
  s_and_b32 s35, s2, 1
  v_mfma_f32_16x16x32_bf16 v[80:83], a[12:15], a[160:163], v[80:83]
  ds_read_b64_tr_b16 a[70:71], v11 offset:25120
  v_mfma_f32_16x16x32_bf16 v[96:99], a[16:19], a[160:163], v[96:99]
  s_bfe_u32 s22, s2, 0x30003
  v_mfma_f32_16x16x32_bf16 v[100:103], a[16:19], a[164:167], v[100:103]
  s_lshl_b32 s22, s22, 1
  v_mfma_f32_16x16x32_bf16 v[104:107], a[16:19], a[168:171], v[104:107]
  ds_read_b64_tr_b16 a[72:73], v11 offset:14400
  v_mfma_f32_16x16x32_bf16 v[108:111], a[16:19], a[172:175], v[108:111]
  s_add_u32 s22, s22, s35
  v_mfma_f32_16x16x32_bf16 v[124:127], a[20:23], a[172:175], v[124:127]
  v_lshrrev_b32 v2, 3, v12
  v_mfma_f32_16x16x32_bf16 v[120:123], a[20:23], a[168:171], v[120:123]
  ds_read_b64_tr_b16 a[74:75], v11 offset:17984
  v_mfma_f32_16x16x32_bf16 v[116:119], a[20:23], a[164:167], v[116:119]
  v_and_b32 v4, 7, v12
  v_mfma_f32_16x16x32_bf16 v[112:115], a[20:23], a[160:163], v[112:115]
  ds_read_b64_tr_b16 a[76:77], v11 offset:21568
  v_mfma_f32_16x16x32_bf16 v[128:131], a[24:27], a[160:163], v[128:131]
  v_bfe_u32 v5, v12, 4, 2
  v_mfma_f32_16x16x32_bf16 v[132:135], a[24:27], a[164:167], v[132:135]
  v_lshlrev_b32 v5, 1, v5
  v_mfma_f32_16x16x32_bf16 v[136:139], a[24:27], a[168:171], v[136:139]
  ds_read_b64_tr_b16 a[78:79], v11 offset:25152
  v_mfma_f32_16x16x32_bf16 v[140:143], a[24:27], a[172:175], v[140:143]
  v_xor_b32 v4, v4, v5
  v_mfma_f32_16x16x32_bf16 v[156:159], a[28:31], a[172:175], v[156:159]
  v_lshrrev_b32 v5, 2, v2
  v_mfma_f32_16x16x32_bf16 v[152:155], a[28:31], a[168:171], v[152:155]
  ds_read_b64_tr_b16 a[80:81], v11 offset:14432
  v_mfma_f32_16x16x32_bf16 v[148:151], a[28:31], a[164:167], v[148:151]
  v_lshlrev_b32 v5, 3, v5
  v_mfma_f32_16x16x32_bf16 v[144:147], a[28:31], a[160:163], v[144:147]
  ds_read_b64_tr_b16 a[82:83], v11 offset:18016
  v_mfma_f32_16x16x32_bf16 v[160:163], a[32:35], a[160:163], v[160:163]
  v_and_b32 v2, 3, v2
  v_mfma_f32_16x16x32_bf16 v[164:167], a[32:35], a[164:167], v[164:167]
  v_add_u32 v2, v2, v5
  v_mfma_f32_16x16x32_bf16 v[168:171], a[32:35], a[168:171], v[168:171]
  ds_read_b64_tr_b16 a[84:85], v11 offset:21600
  v_mfma_f32_16x16x32_bf16 v[172:175], a[32:35], a[172:175], v[172:175]
  v_lshlrev_b32 v2, 11, v2
  v_mfma_f32_16x16x32_bf16 v[188:191], a[36:39], a[172:175], v[188:191]
  v_lshl_add_u32 v2, v4, 4, v2
  v_mfma_f32_16x16x32_bf16 v[184:187], a[36:39], a[168:171], v[184:187]
  ds_read_b64_tr_b16 a[86:87], v11 offset:25184
  v_mfma_f32_16x16x32_bf16 v[180:183], a[36:39], a[164:167], v[180:183]
  s_lshr_b32 s36, s16, 1
  v_mfma_f32_16x16x32_bf16 v[176:179], a[36:39], a[160:163], v[176:179]
  ds_read_b64_tr_b16 a[88:89], v11 offset:14464
  v_mfma_f32_16x16x32_bf16 v[192:195], a[40:43], a[160:163], v[192:195]
  s_lshl_b32 s36, s36, 13
  v_mfma_f32_16x16x32_bf16 v[196:199], a[40:43], a[164:167], v[196:199]
  s_add_u32 s36, s36, 2048
  v_mfma_f32_16x16x32_bf16 v[200:203], a[40:43], a[168:171], v[200:203]
  ds_read_b64_tr_b16 a[90:91], v11 offset:18048
  v_mfma_f32_16x16x32_bf16 v[204:207], a[40:43], a[172:175], v[204:207]
  s_and_b32 s27, s16, 1
  v_mfma_f32_16x16x32_bf16 v[220:223], a[44:47], a[172:175], v[220:223]
  ds_read_b64_tr_b16 a[92:93], v11 offset:21632
  v_mfma_f32_16x16x32_bf16 v[216:219], a[44:47], a[168:171], v[216:219]
  ds_read_b64_tr_b16 a[94:95], v11 offset:25216
  v_mfma_f32_16x16x32_bf16 v[212:215], a[44:47], a[164:167], v[212:215]
  ds_read_b64_tr_b16 a[96:97], v11 offset:14496
  v_mfma_f32_16x16x32_bf16 v[208:211], a[44:47], a[160:163], v[208:211]
  ds_read_b64_tr_b16 a[98:99], v11 offset:18080
  v_mfma_f32_16x16x32_bf16 v[224:227], a[48:51], a[160:163], v[224:227]
  ds_read_b64_tr_b16 a[100:101], v11 offset:21664
  v_mfma_f32_16x16x32_bf16 v[228:231], a[48:51], a[164:167], v[228:231]
  ds_read_b64_tr_b16 a[102:103], v11 offset:25248
  v_mfma_f32_16x16x32_bf16 v[232:235], a[48:51], a[168:171], v[232:235]
  ds_read_b64_tr_b16 a[104:105], v11 offset:14528
  v_mfma_f32_16x16x32_bf16 v[236:239], a[48:51], a[172:175], v[236:239]
  ds_read_b64_tr_b16 a[106:107], v11 offset:18112
  v_mfma_f32_16x16x32_bf16 v[252:255], a[52:55], a[172:175], v[252:255]
  ds_read_b64_tr_b16 a[108:109], v11 offset:21696
  v_mfma_f32_16x16x32_bf16 v[248:251], a[52:55], a[168:171], v[248:251]
  ds_read_b64_tr_b16 a[110:111], v11 offset:25280
  v_mfma_f32_16x16x32_bf16 v[244:247], a[52:55], a[164:167], v[244:247]
  v_mfma_f32_16x16x32_bf16 v[240:243], a[52:55], a[160:163], v[240:243]
g1_s29:
  s_waitcnt vmcnt(21) lgkmcnt(0)
  v_mfma_f32_16x16x32_bf16 v[32:35], a[56:59], a[176:179], v[32:35]
  s_barrier
  ds_read_b64_tr_b16 a[0:1], v9 offset:0
  v_mfma_f32_16x16x32_bf16 v[36:39], a[56:59], a[180:183], v[36:39]
  ds_read_b64_tr_b16 a[2:3], v9 offset:3584
  v_mfma_f32_16x16x32_bf16 v[40:43], a[56:59], a[184:187], v[40:43]
  s_lshl_b32 s27, s27, 15
  v_mfma_f32_16x16x32_bf16 v[44:47], a[56:59], a[188:191], v[44:47]
  ds_read_b64_tr_b16 a[4:5], v9 offset:7168
  v_mfma_f32_16x16x32_bf16 v[60:63], a[60:63], a[188:191], v[60:63]
  s_add_u32 s36, s36, s27
  v_mfma_f32_16x16x32_bf16 v[56:59], a[60:63], a[184:187], v[56:59]
  v_add_u32 v3, s36, v2
  v_mfma_f32_16x16x32_bf16 v[52:55], a[60:63], a[180:183], v[52:55]
  ds_read_b64_tr_b16 a[6:7], v9 offset:10752
  v_mfma_f32_16x16x32_bf16 v[48:51], a[60:63], a[176:179], v[48:51]
  s_mul_i32 s27, s27, 2
  v_mfma_f32_16x16x32_bf16 v[64:67], a[64:67], a[176:179], v[64:67]
  ds_read_b64_tr_b16 a[8:9], v9 offset:32
  v_mfma_f32_16x16x32_bf16 v[68:71], a[64:67], a[180:183], v[68:71]
  v_add_u32 v2, s27, v3
  v_mfma_f32_16x16x32_bf16 v[72:75], a[64:67], a[184:187], v[72:75]
  s_lshl_b32 s26, s16, 11
  v_mfma_f32_16x16x32_bf16 v[76:79], a[64:67], a[188:191], v[76:79]
  ds_read_b64_tr_b16 a[10:11], v9 offset:3616
  v_mfma_f32_16x16x32_bf16 v[92:95], a[68:71], a[188:191], v[92:95]
  s_lshl_b32 s25, s22, 7
  v_mfma_f32_16x16x32_bf16 v[88:91], a[68:71], a[184:187], v[88:91]
  s_lshl_b32 s55, s35, 8
  v_mfma_f32_16x16x32_bf16 v[84:87], a[68:71], a[180:183], v[84:87]
  ds_read_b64_tr_b16 a[12:13], v9 offset:7200
  v_mfma_f32_16x16x32_bf16 v[80:83], a[68:71], a[176:179], v[80:83]
  s_sub_u32 s55, -896, s55
  v_mfma_f32_16x16x32_bf16 v[96:99], a[72:75], a[176:179], v[96:99]
  ds_read_b64_tr_b16 a[14:15], v9 offset:10784
  v_mfma_f32_16x16x32_bf16 v[100:103], a[72:75], a[180:183], v[100:103]
  s_mul_i32 s19, s35, 3670016
  v_mfma_f32_16x16x32_bf16 v[104:107], a[72:75], a[184:187], v[104:107]
  s_mul_i32 s20, s35, 2752512
  ds_read_b64_tr_b16 a[16:17], v9 offset:64
  v_mfma_f32_16x16x32_bf16 v[108:111], a[72:75], a[188:191], v[108:111]
  s_add_u32 s19, s19, s25
  v_mfma_f32_16x16x32_bf16 v[124:127], a[76:79], a[188:191], v[124:127]
  s_add_u32 s20, s20, s25
  v_mfma_f32_16x16x32_bf16 v[120:123], a[76:79], a[184:187], v[120:123]
  ds_read_b64_tr_b16 a[18:19], v9 offset:3648
  v_mfma_f32_16x16x32_bf16 v[116:119], a[76:79], a[180:183], v[116:119]
  v_accvgpr_write_b32 a213, v2
  v_mfma_f32_16x16x32_bf16 v[112:115], a[76:79], a[176:179], v[112:115]
  ds_read_b64_tr_b16 a[20:21], v9 offset:7232
  v_mfma_f32_16x16x32_bf16 v[128:131], a[80:83], a[176:179], v[128:131]
  s_lshl_b32 s39, s17, 2
  v_mfma_f32_16x16x32_bf16 v[132:135], a[80:83], a[180:183], v[132:135]
  s_add_u32 s39, s39, s16
  v_mfma_f32_16x16x32_bf16 v[136:139], a[80:83], a[184:187], v[136:139]
  ds_read_b64_tr_b16 a[22:23], v9 offset:10816
  v_mfma_f32_16x16x32_bf16 v[140:143], a[80:83], a[188:191], v[140:143]
  s_lshl_b32 s39, s39, 5
  v_mfma_f32_16x16x32_bf16 v[156:159], a[84:87], a[188:191], v[156:159]
  s_add_u32 s39, s39, s18
  v_mfma_f32_16x16x32_bf16 v[152:155], a[84:87], a[184:187], v[152:155]
  ds_read_b64_tr_b16 a[24:25], v9 offset:96
  v_mfma_f32_16x16x32_bf16 v[148:151], a[84:87], a[180:183], v[148:151]
  s_lshl_b32 s39, s39, 2
  v_mfma_f32_16x16x32_bf16 v[144:147], a[84:87], a[176:179], v[144:147]
  ds_read_b64_tr_b16 a[26:27], v9 offset:3680
  v_mfma_f32_16x16x32_bf16 v[160:163], a[88:91], a[176:179], v[160:163]
  s_add_u32 s39, s39, 491520
  v_mfma_f32_16x16x32_bf16 v[164:167], a[88:91], a[180:183], v[164:167]
  s_lshl_b32 s52, s21, 1
  v_mfma_f32_16x16x32_bf16 v[168:171], a[88:91], a[184:187], v[168:171]
  ds_read_b64_tr_b16 a[28:29], v9 offset:7264
  v_mfma_f32_16x16x32_bf16 v[172:175], a[88:91], a[188:191], v[172:175]
  s_lshr_b32 s27, s16, 1
  v_mfma_f32_16x16x32_bf16 v[188:191], a[92:95], a[188:191], v[188:191]
  s_add_u32 s52, s52, s27
  ds_read_b64_tr_b16 a[30:31], v9 offset:10848
  v_mfma_f32_16x16x32_bf16 v[184:187], a[92:95], a[184:187], v[184:187]
  s_lshl_b32 s52, s52, 7
  v_mfma_f32_16x16x32_bf16 v[180:183], a[92:95], a[180:183], v[180:183]
  ds_read_b64_tr_b16 a[32:33], v9 offset:128
  v_mfma_f32_16x16x32_bf16 v[176:179], a[92:95], a[176:179], v[176:179]
  s_add_u32 s53, s52, 503808
  v_mfma_f32_16x16x32_bf16 v[192:195], a[96:99], a[176:179], v[192:195]
  s_lshl_b32 s27, s35, 6
  v_mfma_f32_16x16x32_bf16 v[196:199], a[96:99], a[180:183], v[196:199]
  ds_read_b64_tr_b16 a[34:35], v9 offset:3712
  v_mfma_f32_16x16x32_bf16 v[200:203], a[96:99], a[184:187], v[200:203]
  s_add_u32 s52, s52, s27
  v_mfma_f32_16x16x32_bf16 v[204:207], a[96:99], a[188:191], v[204:207]
  s_add_u32 s52, s52, 491520
  v_mfma_f32_16x16x32_bf16 v[220:223], a[100:103], a[188:191], v[220:223]
  ds_read_b64_tr_b16 a[36:37], v9 offset:7296
  v_mfma_f32_16x16x32_bf16 v[216:219], a[100:103], a[184:187], v[216:219]
  ds_read_b64_tr_b16 a[38:39], v9 offset:10880
  v_mfma_f32_16x16x32_bf16 v[212:215], a[100:103], a[180:183], v[212:215]
  ds_read_b64_tr_b16 a[40:41], v9 offset:160
  v_mfma_f32_16x16x32_bf16 v[208:211], a[100:103], a[176:179], v[208:211]
  ds_read_b64_tr_b16 a[42:43], v9 offset:3744
  v_mfma_f32_16x16x32_bf16 v[224:227], a[104:107], a[176:179], v[224:227]
  ds_read_b64_tr_b16 a[44:45], v9 offset:7328
  v_mfma_f32_16x16x32_bf16 v[228:231], a[104:107], a[180:183], v[228:231]
  ds_read_b64_tr_b16 a[46:47], v9 offset:10912
  v_mfma_f32_16x16x32_bf16 v[232:235], a[104:107], a[184:187], v[232:235]
  ds_read_b64_tr_b16 a[48:49], v9 offset:192
  v_mfma_f32_16x16x32_bf16 v[236:239], a[104:107], a[188:191], v[236:239]
  ds_read_b64_tr_b16 a[50:51], v9 offset:3776
  v_mfma_f32_16x16x32_bf16 v[252:255], a[108:111], a[188:191], v[252:255]
  ds_read_b64_tr_b16 a[52:53], v9 offset:7360
  v_mfma_f32_16x16x32_bf16 v[248:251], a[108:111], a[184:187], v[248:251]
  ds_read_b64_tr_b16 a[54:55], v9 offset:10944
  v_mfma_f32_16x16x32_bf16 v[244:247], a[108:111], a[180:183], v[244:247]
  v_mfma_f32_16x16x32_bf16 v[240:243], a[108:111], a[176:179], v[240:243]
g1_s30:
  s_waitcnt vmcnt(17) lgkmcnt(0)
  v_mfma_f32_16x16x32_bf16 v[32:35], a[0:3], a[112:115], v[32:35]
  ds_read_b64_tr_b16 a[56:57], v9 offset:14336
  v_mfma_f32_16x16x32_bf16 v[36:39], a[0:3], a[116:119], v[36:39]
  ds_read_b64_tr_b16 a[58:59], v9 offset:17920
  v_mfma_f32_16x16x32_bf16 v[40:43], a[0:3], a[120:123], v[40:43]
  s_waitcnt vmcnt(0)
  v_mfma_f32_16x16x32_bf16 v[44:47], a[0:3], a[124:127], v[44:47]
  s_mov_b32 s38, 0
  v_mfma_f32_16x16x32_bf16 v[60:63], a[4:7], a[124:127], v[60:63]
  ds_read_b64_tr_b16 a[60:61], v9 offset:21504
  v_mfma_f32_16x16x32_bf16 v[56:59], a[4:7], a[120:123], v[56:59]
  v_max3_u32 v15, v24, v25, v26
  v_mfma_f32_16x16x32_bf16 v[52:55], a[4:7], a[116:119], v[52:55]
  v_max3_u32 v15, v15, v27, v28
  v_mfma_f32_16x16x32_bf16 v[48:51], a[4:7], a[112:115], v[48:51]
  ds_read_b64_tr_b16 a[62:63], v9 offset:25088
  v_mfma_f32_16x16x32_bf16 v[64:67], a[8:11], a[112:115], v[64:67]
  v_max3_u32 v15, v15, v29, v30
  v_mfma_f32_16x16x32_bf16 v[68:71], a[8:11], a[116:119], v[68:71]
  ds_read_b64_tr_b16 a[64:65], v9 offset:14368
  v_mfma_f32_16x16x32_bf16 v[72:75], a[8:11], a[120:123], v[72:75]
  v_max3_u32 v15, v15, v31, v17
  v_mfma_f32_16x16x32_bf16 v[76:79], a[8:11], a[124:127], v[76:79]
  v_max3_u32 v15, v15, v19, v21
  v_mfma_f32_16x16x32_bf16 v[92:95], a[12:15], a[124:127], v[92:95]
  ds_read_b64_tr_b16 a[66:67], v9 offset:17952
  v_mfma_f32_16x16x32_bf16 v[88:91], a[12:15], a[120:123], v[88:91]
  v_max_u32 v15, v15, v23
  v_mfma_f32_16x16x32_bf16 v[84:87], a[12:15], a[116:119], v[84:87]
  v_cmp_eq_u32 vcc, -1, v15
  v_mfma_f32_16x16x32_bf16 v[80:83], a[12:15], a[112:115], v[80:83]
  ds_read_b64_tr_b16 a[68:69], v9 offset:21536
  v_mfma_f32_16x16x32_bf16 v[96:99], a[16:19], a[112:115], v[96:99]
  ds_read_b64_tr_b16 a[70:71], v9 offset:25120
  v_mfma_f32_16x16x32_bf16 v[100:103], a[16:19], a[116:119], v[100:103]
  s_cbranch_vccz g1_polled
g1_poll:
  buffer_load_dword v24, v13, s[40:43], s56 offen sc0 sc1
  buffer_load_dword v25, v13, s[40:43], s57 offen sc0 sc1
  buffer_load_dword v26, v13, s[40:43], s58 offen sc0 sc1
  buffer_load_dword v27, v13, s[40:43], s59 offen sc0 sc1
  buffer_load_dword v28, v13, s[40:43], s60 offen sc0 sc1
  buffer_load_dword v29, v13, s[40:43], s61 offen sc0 sc1
  buffer_load_dword v30, v13, s[40:43], s62 offen sc0 sc1
  buffer_load_dword v31, v13, s[40:43], s63 offen sc0 sc1
  buffer_load_dwordx2 v[16:17], v14, s[40:43], s37 offen offset:0 sc0 sc1
  buffer_load_dwordx2 v[18:19], v14, s[40:43], s37 offen offset:128 sc0 sc1
  buffer_load_dwordx2 v[20:21], v14, s[40:43], s37 offen offset:256 sc0 sc1
  buffer_load_dwordx2 v[22:23], v14, s[40:43], s37 offen offset:384 sc0 sc1
  s_waitcnt vmcnt(0)
  v_max3_u32 v15, v24, v25, v26
  v_max3_u32 v15, v15, v27, v28
  v_max3_u32 v15, v15, v29, v30
  v_max3_u32 v15, v15, v31, v17
  v_max3_u32 v15, v15, v19, v21
  v_max_u32 v15, v15, v23
  v_cmp_eq_u32 vcc, -1, v15
  s_add_u32 s38, s38, 1
  s_cmp_lt_u32 s38, 0x20000
  s_cbranch_vccz g1_polled
  s_cbranch_scc1 g1_poll
g1_polled:
  v_mfma_f32_16x16x32_bf16 v[104:107], a[16:19], a[120:123], v[104:107]
  v_mfma_f32_16x16x32_bf16 v[108:111], a[16:19], a[124:127], v[108:111]
  ds_read_b64_tr_b16 a[72:73], v9 offset:14400
  v_mfma_f32_16x16x32_bf16 v[124:127], a[20:23], a[124:127], v[124:127]
  ds_read_b64_tr_b16 a[74:75], v9 offset:17984
  v_mfma_f32_16x16x32_bf16 v[120:123], a[20:23], a[120:123], v[120:123]
  ds_read_b64_tr_b16 a[76:77], v9 offset:21568
  v_mfma_f32_16x16x32_bf16 v[116:119], a[20:23], a[116:119], v[116:119]
  ds_read_b64_tr_b16 a[78:79], v9 offset:25152
  v_mfma_f32_16x16x32_bf16 v[112:115], a[20:23], a[112:115], v[112:115]
  ds_read_b64_tr_b16 a[80:81], v9 offset:14432
  v_mfma_f32_16x16x32_bf16 v[128:131], a[24:27], a[112:115], v[128:131]
  ds_read_b64_tr_b16 a[82:83], v9 offset:18016
  v_mfma_f32_16x16x32_bf16 v[132:135], a[24:27], a[116:119], v[132:135]
  ds_read_b64_tr_b16 a[84:85], v9 offset:21600
  v_mfma_f32_16x16x32_bf16 v[136:139], a[24:27], a[120:123], v[136:139]
  ds_read_b64_tr_b16 a[86:87], v9 offset:25184
  v_mfma_f32_16x16x32_bf16 v[140:143], a[24:27], a[124:127], v[140:143]
  ds_read_b64_tr_b16 a[88:89], v9 offset:14464
  v_mfma_f32_16x16x32_bf16 v[156:159], a[28:31], a[124:127], v[156:159]
  ds_read_b64_tr_b16 a[90:91], v9 offset:18048
  v_mfma_f32_16x16x32_bf16 v[152:155], a[28:31], a[120:123], v[152:155]
  ds_read_b64_tr_b16 a[92:93], v9 offset:21632
  v_mfma_f32_16x16x32_bf16 v[148:151], a[28:31], a[116:119], v[148:151]
  ds_read_b64_tr_b16 a[94:95], v9 offset:25216
  v_mfma_f32_16x16x32_bf16 v[144:147], a[28:31], a[112:115], v[144:147]
  ds_read_b64_tr_b16 a[96:97], v9 offset:14496
  v_mfma_f32_16x16x32_bf16 v[160:163], a[32:35], a[112:115], v[160:163]
  ds_read_b64_tr_b16 a[98:99], v9 offset:18080
  v_mfma_f32_16x16x32_bf16 v[164:167], a[32:35], a[116:119], v[164:167]
  ds_read_b64_tr_b16 a[100:101], v9 offset:21664
  v_mfma_f32_16x16x32_bf16 v[168:171], a[32:35], a[120:123], v[168:171]
  ds_read_b64_tr_b16 a[102:103], v9 offset:25248
  v_mfma_f32_16x16x32_bf16 v[172:175], a[32:35], a[124:127], v[172:175]
  ds_read_b64_tr_b16 a[104:105], v9 offset:14528
  v_mfma_f32_16x16x32_bf16 v[188:191], a[36:39], a[124:127], v[188:191]
  ds_read_b64_tr_b16 a[106:107], v9 offset:18112
  v_mfma_f32_16x16x32_bf16 v[184:187], a[36:39], a[120:123], v[184:187]
  ds_read_b64_tr_b16 a[108:109], v9 offset:21696
  v_mfma_f32_16x16x32_bf16 v[180:183], a[36:39], a[116:119], v[180:183]
  ds_read_b64_tr_b16 a[110:111], v9 offset:25280
  v_mfma_f32_16x16x32_bf16 v[176:179], a[36:39], a[112:115], v[176:179]
  v_mfma_f32_16x16x32_bf16 v[192:195], a[40:43], a[112:115], v[192:195]
  v_mfma_f32_16x16x32_bf16 v[196:199], a[40:43], a[116:119], v[196:199]
  v_mfma_f32_16x16x32_bf16 v[200:203], a[40:43], a[120:123], v[200:203]
  v_mfma_f32_16x16x32_bf16 v[204:207], a[40:43], a[124:127], v[204:207]
  v_mfma_f32_16x16x32_bf16 v[220:223], a[44:47], a[124:127], v[220:223]
  v_mfma_f32_16x16x32_bf16 v[216:219], a[44:47], a[120:123], v[216:219]
  v_mfma_f32_16x16x32_bf16 v[212:215], a[44:47], a[116:119], v[212:215]
  v_mfma_f32_16x16x32_bf16 v[208:211], a[44:47], a[112:115], v[208:211]
  v_mfma_f32_16x16x32_bf16 v[224:227], a[48:51], a[112:115], v[224:227]
  v_mfma_f32_16x16x32_bf16 v[228:231], a[48:51], a[116:119], v[228:231]
  v_mfma_f32_16x16x32_bf16 v[232:235], a[48:51], a[120:123], v[232:235]
  v_mfma_f32_16x16x32_bf16 v[236:239], a[48:51], a[124:127], v[236:239]
  v_mfma_f32_16x16x32_bf16 v[252:255], a[52:55], a[124:127], v[252:255]
  v_mfma_f32_16x16x32_bf16 v[248:251], a[52:55], a[120:123], v[248:251]
  v_mfma_f32_16x16x32_bf16 v[244:247], a[52:55], a[116:119], v[244:247]
  v_mfma_f32_16x16x32_bf16 v[240:243], a[52:55], a[112:115], v[240:243]
g1_s31:
  s_waitcnt vmcnt(12) lgkmcnt(0)
  v_mfma_f32_16x16x32_bf16 v[32:35], a[56:59], a[128:131], v[32:35]
  v_add_f32 v24, v24, v28
  v_mfma_f32_16x16x32_bf16 v[36:39], a[56:59], a[132:135], v[36:39]
  v_add_f32 v25, v25, v29
  v_mfma_f32_16x16x32_bf16 v[40:43], a[56:59], a[136:139], v[40:43]
  v_add_f32 v26, v26, v30
  v_mfma_f32_16x16x32_bf16 v[44:47], a[56:59], a[140:143], v[44:47]
  v_add_f32 v27, v27, v31
  v_mfma_f32_16x16x32_bf16 v[60:63], a[60:63], a[140:143], v[60:63]
  v_add_f32 v24, v24, v25
  v_mfma_f32_16x16x32_bf16 v[56:59], a[60:63], a[136:139], v[56:59]
  v_add_f32 v26, v26, v27
  v_mfma_f32_16x16x32_bf16 v[52:55], a[60:63], a[132:135], v[52:55]
  v_add_f32 v24, v24, v26
  v_mfma_f32_16x16x32_bf16 v[48:51], a[60:63], a[128:131], v[48:51]
  v_add_u32 v13, 143616, v13
  v_mfma_f32_16x16x32_bf16 v[64:67], a[64:67], a[128:131], v[64:67]
  ds_write_b32 v13, v24
  v_mfma_f32_16x16x32_bf16 v[68:71], a[64:67], a[132:135], v[68:71]
  s_mul_i32 s38, s18, 131072
  v_mfma_f32_16x16x32_bf16 v[72:75], a[64:67], a[136:139], v[72:75]
  s_lshl_b32 s37, s17, 12
  v_mfma_f32_16x16x32_bf16 v[76:79], a[64:67], a[140:143], v[76:79]
  s_add_u32 s38, s38, s37
  v_mfma_f32_16x16x32_bf16 v[92:95], a[68:71], a[140:143], v[92:95]
  s_lshl_b32 s37, s16, 10
  v_mfma_f32_16x16x32_bf16 v[88:91], a[68:71], a[136:139], v[88:91]
  s_add_u32 s38, s38, s37
  v_mfma_f32_16x16x32_bf16 v[84:87], a[68:71], a[132:135], v[84:87]
  s_mul_i32 s60, s18, 196608
  v_mfma_f32_16x16x32_bf16 v[80:83], a[68:71], a[128:131], v[80:83]
  s_add_u32 s60, s60, 4128768
  v_mfma_f32_16x16x32_bf16 v[96:99], a[72:75], a[128:131], v[96:99]
  v_lshrrev_b32 v2, 5, v12
  v_mfma_f32_16x16x32_bf16 v[100:103], a[72:75], a[132:135], v[100:103]
  v_lshlrev_b32 v2, 15, v2
  v_mfma_f32_16x16x32_bf16 v[104:107], a[72:75], a[136:139], v[104:107]
  v_and_b32 v1, 31, v12
  v_mfma_f32_16x16x32_bf16 v[108:111], a[72:75], a[140:143], v[108:111]
  v_lshl_add_u32 v1, v1, 4, v2
  v_mfma_f32_16x16x32_bf16 v[124:127], a[76:79], a[140:143], v[124:127]
  v_and_b32 v2, 48, v12
  v_mfma_f32_16x16x32_bf16 v[120:123], a[76:79], a[136:139], v[120:123]
  v_add_u32 v2, 143616, v2
  v_mfma_f32_16x16x32_bf16 v[116:119], a[76:79], a[132:135], v[116:119]
  v_rsq_f32 v4, v17
  v_mfma_f32_16x16x32_bf16 v[112:115], a[76:79], a[128:131], v[112:115]
  v_rsq_f32 v5, v19
  v_mfma_f32_16x16x32_bf16 v[128:131], a[80:83], a[128:131], v[128:131]
  v_rsq_f32 v6, v21
  v_mfma_f32_16x16x32_bf16 v[132:135], a[80:83], a[132:135], v[132:135]
  v_rsq_f32 v7, v23
  v_mfma_f32_16x16x32_bf16 v[136:139], a[80:83], a[136:139], v[136:139]
  v_mul_f32 v4, 0xbfb8aa3b, v4
  v_mfma_f32_16x16x32_bf16 v[140:143], a[80:83], a[140:143], v[140:143]
  v_mul_f32 v5, 0xbfb8aa3b, v5
  v_mfma_f32_16x16x32_bf16 v[156:159], a[84:87], a[140:143], v[156:159]
  v_mul_f32 v6, 0xbfb8aa3b, v6
  v_mfma_f32_16x16x32_bf16 v[152:155], a[84:87], a[136:139], v[152:155]
  v_mul_f32 v7, 0xbfb8aa3b, v7
  v_mfma_f32_16x16x32_bf16 v[148:151], a[84:87], a[132:135], v[148:151]
  s_waitcnt lgkmcnt(0)
  s_barrier
  ds_read_b128 v[8:11], v2
  ds_read_b128 v[12:15], v2 offset:64
  v_mfma_f32_16x16x32_bf16 v[144:147], a[84:87], a[128:131], v[144:147]
  v_mfma_f32_16x16x32_bf16 v[160:163], a[88:91], a[128:131], v[160:163]
  v_mfma_f32_16x16x32_bf16 v[164:167], a[88:91], a[132:135], v[164:167]
  v_mfma_f32_16x16x32_bf16 v[168:171], a[88:91], a[136:139], v[168:171]
  v_mfma_f32_16x16x32_bf16 v[172:175], a[88:91], a[140:143], v[172:175]
  v_mfma_f32_16x16x32_bf16 v[188:191], a[92:95], a[140:143], v[188:191]
  v_mfma_f32_16x16x32_bf16 v[184:187], a[92:95], a[136:139], v[184:187]
  v_mfma_f32_16x16x32_bf16 v[180:183], a[92:95], a[132:135], v[180:183]
  v_mfma_f32_16x16x32_bf16 v[176:179], a[92:95], a[128:131], v[176:179]
  v_mfma_f32_16x16x32_bf16 v[192:195], a[96:99], a[128:131], v[192:195]
  v_mfma_f32_16x16x32_bf16 v[196:199], a[96:99], a[132:135], v[196:199]
  v_mfma_f32_16x16x32_bf16 v[200:203], a[96:99], a[136:139], v[200:203]
  v_mfma_f32_16x16x32_bf16 v[204:207], a[96:99], a[140:143], v[204:207]
  v_mfma_f32_16x16x32_bf16 v[220:223], a[100:103], a[140:143], v[220:223]
  v_mfma_f32_16x16x32_bf16 v[216:219], a[100:103], a[136:139], v[216:219]
  v_mfma_f32_16x16x32_bf16 v[212:215], a[100:103], a[132:135], v[212:215]
  v_mfma_f32_16x16x32_bf16 v[208:211], a[100:103], a[128:131], v[208:211]
  v_mfma_f32_16x16x32_bf16 v[224:227], a[104:107], a[128:131], v[224:227]
  v_mfma_f32_16x16x32_bf16 v[228:231], a[104:107], a[132:135], v[228:231]
  v_mfma_f32_16x16x32_bf16 v[232:235], a[104:107], a[136:139], v[232:235]
  v_mfma_f32_16x16x32_bf16 v[236:239], a[104:107], a[140:143], v[236:239]
  v_mfma_f32_16x16x32_bf16 v[252:255], a[108:111], a[140:143], v[252:255]
  v_mfma_f32_16x16x32_bf16 v[248:251], a[108:111], a[136:139], v[248:251]
  v_mfma_f32_16x16x32_bf16 v[244:247], a[108:111], a[132:135], v[244:247]
  v_mfma_f32_16x16x32_bf16 v[240:243], a[108:111], a[128:131], v[240:243]
g1_epi:
  s_nop 4
  s_waitcnt lgkmcnt(0)
  v_pk_fma_f32 v[32:33], v[8:9], v[16:17], v[32:33] op_sel_hi:[1,0,1]
  v_pk_fma_f32 v[34:35], v[10:11], v[16:17], v[34:35] op_sel_hi:[1,0,1]
  v_pk_fma_f32 v[36:37], v[8:9], v[18:19], v[36:37] op_sel_hi:[1,0,1]
  v_pk_fma_f32 v[38:39], v[10:11], v[18:19], v[38:39] op_sel_hi:[1,0,1]
  v_pk_fma_f32 v[48:49], v[12:13], v[16:17], v[48:49] op_sel_hi:[1,0,1]
  v_pk_fma_f32 v[50:51], v[14:15], v[16:17], v[50:51] op_sel_hi:[1,0,1]
  v_pk_fma_f32 v[52:53], v[12:13], v[18:19], v[52:53] op_sel_hi:[1,0,1]
  v_pk_fma_f32 v[54:55], v[14:15], v[18:19], v[54:55] op_sel_hi:[1,0,1]
  v_pk_mul_f32 v[24:25], v[32:33], v[4:5] op_sel_hi:[1,0]
  v_pk_mul_f32 v[26:27], v[34:35], v[4:5] op_sel_hi:[1,0]
  v_pk_mul_f32 v[28:29], v[36:37], v[4:5] op_sel:[0,1]
  v_pk_mul_f32 v[30:31], v[38:39], v[4:5] op_sel:[0,1]
  v_exp_f32 v24, v24
  v_exp_f32 v25, v25
  v_exp_f32 v26, v26
  v_exp_f32 v27, v27
  v_exp_f32 v28, v28
  v_exp_f32 v29, v29
  v_exp_f32 v30, v30
  v_exp_f32 v31, v31
  v_pk_mul_f32 v[32:33], v[32:33], v[48:49]
  v_pk_mul_f32 v[34:35], v[34:35], v[50:51]
  v_pk_mul_f32 v[36:37], v[36:37], v[52:53]
  v_pk_mul_f32 v[38:39], v[38:39], v[54:55]
  v_pk_fma_f32 v[24:25], v[24:25], v[16:17], v[16:17] op_sel:[0,1,1]
  v_pk_fma_f32 v[26:27], v[26:27], v[16:17], v[16:17] op_sel:[0,1,1]
  v_pk_fma_f32 v[28:29], v[28:29], v[18:19], v[18:19] op_sel:[0,1,1]
  v_pk_fma_f32 v[30:31], v[30:31], v[18:19], v[18:19] op_sel:[0,1,1]
  v_rcp_f32 v24, v24
  v_rcp_f32 v25, v25
  v_rcp_f32 v26, v26
  v_rcp_f32 v27, v27
  v_rcp_f32 v28, v28
  v_rcp_f32 v29, v29
  v_rcp_f32 v30, v30
  v_rcp_f32 v31, v31
  v_pk_mul_f32 v[32:33], v[32:33], v[24:25]
  v_pk_mul_f32 v[34:35], v[34:35], v[26:27]
  v_pk_mul_f32 v[36:37], v[36:37], v[28:29]
  v_pk_mul_f32 v[38:39], v[38:39], v[30:31]
  v_cvt_pk_bf16_f32 v48, v32, v33
  v_cvt_pk_bf16_f32 v49, v34, v35
  v_cvt_pk_bf16_f32 v50, v36, v37
  v_cvt_pk_bf16_f32 v51, v38, v39
  s_nop 0
  v_permlane16_swap_b32 v48, v50
  v_permlane16_swap_b32 v49, v51
  buffer_store_dwordx4 v[48:51], v1, s[12:15], s38 offen offset:0 sc1
  v_add_u32 v34, s55, v3
  v_pk_fma_f32 v[40:41], v[8:9], v[20:21], v[40:41] op_sel_hi:[1,0,1]
  v_pk_fma_f32 v[42:43], v[10:11], v[20:21], v[42:43] op_sel_hi:[1,0,1]
  v_pk_fma_f32 v[44:45], v[8:9], v[22:23], v[44:45] op_sel_hi:[1,0,1]
  v_pk_fma_f32 v[46:47], v[10:11], v[22:23], v[46:47] op_sel_hi:[1,0,1]
  v_pk_fma_f32 v[56:57], v[12:13], v[20:21], v[56:57] op_sel_hi:[1,0,1]
  v_pk_fma_f32 v[58:59], v[14:15], v[20:21], v[58:59] op_sel_hi:[1,0,1]
  v_pk_fma_f32 v[60:61], v[12:13], v[22:23], v[60:61] op_sel_hi:[1,0,1]
  v_pk_fma_f32 v[62:63], v[14:15], v[22:23], v[62:63] op_sel_hi:[1,0,1]
  ds_read_b128 v[8:11], v2 offset:128
  ds_read_b128 v[12:15], v2 offset:192
  v_pk_mul_f32 v[24:25], v[40:41], v[6:7] op_sel_hi:[1,0]
  v_pk_mul_f32 v[26:27], v[42:43], v[6:7] op_sel_hi:[1,0]
  v_pk_mul_f32 v[28:29], v[44:45], v[6:7] op_sel:[0,1]
  v_pk_mul_f32 v[30:31], v[46:47], v[6:7] op_sel:[0,1]
  v_exp_f32 v24, v24
  v_exp_f32 v25, v25
  v_exp_f32 v26, v26
  v_exp_f32 v27, v27
  v_exp_f32 v28, v28
  v_exp_f32 v29, v29
  v_exp_f32 v30, v30
  v_exp_f32 v31, v31
  v_pk_mul_f32 v[40:41], v[40:41], v[56:57]
  v_pk_mul_f32 v[42:43], v[42:43], v[58:59]
  v_pk_mul_f32 v[44:45], v[44:45], v[60:61]
  v_pk_mul_f32 v[46:47], v[46:47], v[62:63]
  v_pk_fma_f32 v[24:25], v[24:25], v[20:21], v[20:21] op_sel:[0,1,1]
  v_pk_fma_f32 v[26:27], v[26:27], v[20:21], v[20:21] op_sel:[0,1,1]
  v_pk_fma_f32 v[28:29], v[28:29], v[22:23], v[22:23] op_sel:[0,1,1]
  v_pk_fma_f32 v[30:31], v[30:31], v[22:23], v[22:23] op_sel:[0,1,1]
  v_rcp_f32 v24, v24
  v_rcp_f32 v25, v25
  v_rcp_f32 v26, v26
  v_rcp_f32 v27, v27
  v_rcp_f32 v28, v28
  v_rcp_f32 v29, v29
  v_rcp_f32 v30, v30
  v_rcp_f32 v31, v31
  v_pk_mul_f32 v[40:41], v[40:41], v[24:25]
  v_pk_mul_f32 v[42:43], v[42:43], v[26:27]
  v_pk_mul_f32 v[44:45], v[44:45], v[28:29]
  v_pk_mul_f32 v[46:47], v[46:47], v[30:31]
  v_cvt_pk_bf16_f32 v56, v40, v41
  v_cvt_pk_bf16_f32 v57, v42, v43
  v_cvt_pk_bf16_f32 v58, v44, v45
  v_cvt_pk_bf16_f32 v59, v46, v47
  s_nop 0
  v_permlane16_swap_b32 v56, v58
  v_permlane16_swap_b32 v57, v59
  buffer_store_dwordx4 v[56:59], v1, s[12:15], s38 offen offset:512 sc1
  s_add_u32 s38, s38, 0x10000
  s_waitcnt lgkmcnt(0)
  v_pk_fma_f32 v[64:65], v[8:9], v[16:17], v[64:65] op_sel_hi:[1,0,1]
  v_pk_fma_f32 v[66:67], v[10:11], v[16:17], v[66:67] op_sel_hi:[1,0,1]
  v_pk_fma_f32 v[68:69], v[8:9], v[18:19], v[68:69] op_sel_hi:[1,0,1]
  v_pk_fma_f32 v[70:71], v[10:11], v[18:19], v[70:71] op_sel_hi:[1,0,1]
  v_pk_fma_f32 v[80:81], v[12:13], v[16:17], v[80:81] op_sel_hi:[1,0,1]
  v_pk_fma_f32 v[82:83], v[14:15], v[16:17], v[82:83] op_sel_hi:[1,0,1]
  v_pk_fma_f32 v[84:85], v[12:13], v[18:19], v[84:85] op_sel_hi:[1,0,1]
  v_pk_fma_f32 v[86:87], v[14:15], v[18:19], v[86:87] op_sel_hi:[1,0,1]
  v_pk_mul_f32 v[24:25], v[64:65], v[4:5] op_sel_hi:[1,0]
  v_pk_mul_f32 v[26:27], v[66:67], v[4:5] op_sel_hi:[1,0]
  v_pk_mul_f32 v[28:29], v[68:69], v[4:5] op_sel:[0,1]
  v_pk_mul_f32 v[30:31], v[70:71], v[4:5] op_sel:[0,1]
  v_exp_f32 v24, v24
  v_exp_f32 v25, v25
  v_exp_f32 v26, v26
  v_exp_f32 v27, v27
  v_exp_f32 v28, v28
  v_exp_f32 v29, v29
  v_exp_f32 v30, v30
  v_exp_f32 v31, v31
  v_pk_mul_f32 v[64:65], v[64:65], v[80:81]
  v_pk_mul_f32 v[66:67], v[66:67], v[82:83]
  v_pk_mul_f32 v[68:69], v[68:69], v[84:85]
  v_pk_mul_f32 v[70:71], v[70:71], v[86:87]
  v_pk_fma_f32 v[24:25], v[24:25], v[16:17], v[16:17] op_sel:[0,1,1]
  v_pk_fma_f32 v[26:27], v[26:27], v[16:17], v[16:17] op_sel:[0,1,1]
  v_pk_fma_f32 v[28:29], v[28:29], v[18:19], v[18:19] op_sel:[0,1,1]
  v_pk_fma_f32 v[30:31], v[30:31], v[18:19], v[18:19] op_sel:[0,1,1]
  v_rcp_f32 v24, v24
  v_rcp_f32 v25, v25
  v_rcp_f32 v26, v26
  v_rcp_f32 v27, v27
  v_rcp_f32 v28, v28
  v_rcp_f32 v29, v29
  v_rcp_f32 v30, v30
  v_rcp_f32 v31, v31
  v_pk_mul_f32 v[64:65], v[64:65], v[24:25]
  v_pk_mul_f32 v[66:67], v[66:67], v[26:27]
  v_pk_mul_f32 v[68:69], v[68:69], v[28:29]
  v_pk_mul_f32 v[70:71], v[70:71], v[30:31]
  v_cvt_pk_bf16_f32 v80, v64, v65
  v_cvt_pk_bf16_f32 v81, v66, v67
  v_cvt_pk_bf16_f32 v82, v68, v69
  v_cvt_pk_bf16_f32 v83, v70, v71
  s_nop 0
  v_permlane16_swap_b32 v80, v82
  v_permlane16_swap_b32 v81, v83
  buffer_store_dwordx4 v[80:83], v1, s[12:15], s38 offen offset:0 sc1
  v_pk_fma_f32 v[72:73], v[8:9], v[20:21], v[72:73] op_sel_hi:[1,0,1]
  v_pk_fma_f32 v[74:75], v[10:11], v[20:21], v[74:75] op_sel_hi:[1,0,1]
  v_pk_fma_f32 v[76:77], v[8:9], v[22:23], v[76:77] op_sel_hi:[1,0,1]
  v_pk_fma_f32 v[78:79], v[10:11], v[22:23], v[78:79] op_sel_hi:[1,0,1]
  v_pk_fma_f32 v[88:89], v[12:13], v[20:21], v[88:89] op_sel_hi:[1,0,1]
  v_pk_fma_f32 v[90:91], v[14:15], v[20:21], v[90:91] op_sel_hi:[1,0,1]
  v_pk_fma_f32 v[92:93], v[12:13], v[22:23], v[92:93] op_sel_hi:[1,0,1]
  v_pk_fma_f32 v[94:95], v[14:15], v[22:23], v[94:95] op_sel_hi:[1,0,1]
  ds_read_b128 v[8:11], v2 offset:256
  ds_read_b128 v[12:15], v2 offset:320
  v_pk_mul_f32 v[24:25], v[72:73], v[6:7] op_sel_hi:[1,0]
  v_pk_mul_f32 v[26:27], v[74:75], v[6:7] op_sel_hi:[1,0]
  v_pk_mul_f32 v[28:29], v[76:77], v[6:7] op_sel:[0,1]
  v_pk_mul_f32 v[30:31], v[78:79], v[6:7] op_sel:[0,1]
  v_exp_f32 v24, v24
  v_exp_f32 v25, v25
  v_exp_f32 v26, v26
  v_exp_f32 v27, v27
  v_exp_f32 v28, v28
  v_exp_f32 v29, v29
  v_exp_f32 v30, v30
  v_exp_f32 v31, v31
  s_add_u32 m0, s26, 0
  s_add_u32 s24, s19, 0
  buffer_load_dwordx4 v3, s[8:11], s24 offen lds
  v_pk_mul_f32 v[72:73], v[72:73], v[88:89]
  v_pk_mul_f32 v[74:75], v[74:75], v[90:91]
  v_pk_mul_f32 v[76:77], v[76:77], v[92:93]
  v_pk_mul_f32 v[78:79], v[78:79], v[94:95]
  v_pk_fma_f32 v[24:25], v[24:25], v[20:21], v[20:21] op_sel:[0,1,1]
  v_pk_fma_f32 v[26:27], v[26:27], v[20:21], v[20:21] op_sel:[0,1,1]
  v_pk_fma_f32 v[28:29], v[28:29], v[22:23], v[22:23] op_sel:[0,1,1]
  v_pk_fma_f32 v[30:31], v[30:31], v[22:23], v[22:23] op_sel:[0,1,1]
  v_rcp_f32 v24, v24
  v_rcp_f32 v25, v25
  v_rcp_f32 v26, v26
  v_rcp_f32 v27, v27
  buffer_load_dwordx4 v34, s[8:11], s24 offen offset:1024 lds
  v_rcp_f32 v28, v28
  v_rcp_f32 v29, v29
  v_rcp_f32 v30, v30
  v_rcp_f32 v31, v31
  v_pk_mul_f32 v[72:73], v[72:73], v[24:25]
  v_pk_mul_f32 v[74:75], v[74:75], v[26:27]
  v_pk_mul_f32 v[76:77], v[76:77], v[28:29]
  v_pk_mul_f32 v[78:79], v[78:79], v[30:31]
  v_cvt_pk_bf16_f32 v88, v72, v73
  v_cvt_pk_bf16_f32 v89, v74, v75
  v_cvt_pk_bf16_f32 v90, v76, v77
  v_cvt_pk_bf16_f32 v91, v78, v79
  s_nop 0
  v_permlane16_swap_b32 v88, v90
  v_permlane16_swap_b32 v89, v91
  buffer_store_dwordx4 v[88:91], v1, s[12:15], s38 offen offset:512 sc1
  s_add_u32 s38, s38, s60
  s_waitcnt lgkmcnt(0)
  v_pk_fma_f32 v[96:97], v[8:9], v[16:17], v[96:97] op_sel_hi:[1,0,1]
  v_pk_fma_f32 v[98:99], v[10:11], v[16:17], v[98:99] op_sel_hi:[1,0,1]
  v_pk_fma_f32 v[100:101], v[8:9], v[18:19], v[100:101] op_sel_hi:[1,0,1]
  v_pk_fma_f32 v[102:103], v[10:11], v[18:19], v[102:103] op_sel_hi:[1,0,1]
  v_pk_fma_f32 v[112:113], v[12:13], v[16:17], v[112:113] op_sel_hi:[1,0,1]
  v_pk_fma_f32 v[114:115], v[14:15], v[16:17], v[114:115] op_sel_hi:[1,0,1]
  v_pk_fma_f32 v[116:117], v[12:13], v[18:19], v[116:117] op_sel_hi:[1,0,1]
  v_pk_fma_f32 v[118:119], v[14:15], v[18:19], v[118:119] op_sel_hi:[1,0,1]
  v_pk_mul_f32 v[24:25], v[96:97], v[4:5] op_sel_hi:[1,0]
  v_pk_mul_f32 v[26:27], v[98:99], v[4:5] op_sel_hi:[1,0]
  v_pk_mul_f32 v[28:29], v[100:101], v[4:5] op_sel:[0,1]
  v_pk_mul_f32 v[30:31], v[102:103], v[4:5] op_sel:[0,1]
  v_exp_f32 v24, v24
  v_exp_f32 v25, v25
  v_exp_f32 v26, v26
  v_exp_f32 v27, v27
  s_add_u32 m0, s26, 8192
  s_add_u32 s24, s19, 229376
  buffer_load_dwordx4 v3, s[8:11], s24 offen lds
  v_exp_f32 v28, v28
  v_exp_f32 v29, v29
  v_exp_f32 v30, v30
  v_exp_f32 v31, v31
  buffer_load_dwordx4 v34, s[8:11], s24 offen offset:1024 lds
  v_pk_mul_f32 v[96:97], v[96:97], v[112:113]
  v_pk_mul_f32 v[98:99], v[98:99], v[114:115]
  v_pk_mul_f32 v[100:101], v[100:101], v[116:117]
  v_pk_mul_f32 v[102:103], v[102:103], v[118:119]
  v_pk_fma_f32 v[24:25], v[24:25], v[16:17], v[16:17] op_sel:[0,1,1]
  v_pk_fma_f32 v[26:27], v[26:27], v[16:17], v[16:17] op_sel:[0,1,1]
  v_pk_fma_f32 v[28:29], v[28:29], v[18:19], v[18:19] op_sel:[0,1,1]
  v_pk_fma_f32 v[30:31], v[30:31], v[18:19], v[18:19] op_sel:[0,1,1]
  v_rcp_f32 v24, v24
  v_rcp_f32 v25, v25
  v_rcp_f32 v26, v26
  v_rcp_f32 v27, v27
  s_add_u32 m0, s26, 16384
  s_add_u32 s24, s19, 458752
  buffer_load_dwordx4 v3, s[8:11], s24 offen lds
  v_rcp_f32 v28, v28
  v_rcp_f32 v29, v29
  v_rcp_f32 v30, v30
  v_rcp_f32 v31, v31
  v_pk_mul_f32 v[96:97], v[96:97], v[24:25]
  v_pk_mul_f32 v[98:99], v[98:99], v[26:27]
  v_pk_mul_f32 v[100:101], v[100:101], v[28:29]
  v_pk_mul_f32 v[102:103], v[102:103], v[30:31]
  v_cvt_pk_bf16_f32 v112, v96, v97
  v_cvt_pk_bf16_f32 v113, v98, v99
  v_cvt_pk_bf16_f32 v114, v100, v101
  v_cvt_pk_bf16_f32 v115, v102, v103
  s_nop 0
  v_permlane16_swap_b32 v112, v114
  v_permlane16_swap_b32 v113, v115
  buffer_store_dwordx4 v[112:115], v1, s[12:15], s38 offen offset:0 sc1
  v_mov_b32 v32, 1
  v_mov_b32 v33, 0
  s_waitcnt vmcnt(4)
  s_mov_b64 exec, 1
  buffer_store_dword v32, v33, s[40:43], s39 offen sc0 sc1
  s_mov_b64 exec, -1
  v_pk_fma_f32 v[104:105], v[8:9], v[20:21], v[104:105] op_sel_hi:[1,0,1]
  v_pk_fma_f32 v[106:107], v[10:11], v[20:21], v[106:107] op_sel_hi:[1,0,1]
  v_pk_fma_f32 v[108:109], v[8:9], v[22:23], v[108:109] op_sel_hi:[1,0,1]
  v_pk_fma_f32 v[110:111], v[10:11], v[22:23], v[110:111] op_sel_hi:[1,0,1]
  v_pk_fma_f32 v[120:121], v[12:13], v[20:21], v[120:121] op_sel_hi:[1,0,1]
  v_pk_fma_f32 v[122:123], v[14:15], v[20:21], v[122:123] op_sel_hi:[1,0,1]
  v_pk_fma_f32 v[124:125], v[12:13], v[22:23], v[124:125] op_sel_hi:[1,0,1]
  v_pk_fma_f32 v[126:127], v[14:15], v[22:23], v[126:127] op_sel_hi:[1,0,1]
  ds_read_b128 v[8:11], v2 offset:384
  ds_read_b128 v[12:15], v2 offset:448
  v_pk_mul_f32 v[24:25], v[104:105], v[6:7] op_sel_hi:[1,0]
  v_pk_mul_f32 v[26:27], v[106:107], v[6:7] op_sel_hi:[1,0]
  v_pk_mul_f32 v[28:29], v[108:109], v[6:7] op_sel:[0,1]
  v_pk_mul_f32 v[30:31], v[110:111], v[6:7] op_sel:[0,1]
  v_exp_f32 v24, v24
  v_exp_f32 v25, v25
  v_exp_f32 v26, v26
  v_exp_f32 v27, v27
  buffer_load_dwordx4 v34, s[8:11], s24 offen offset:1024 lds
  v_exp_f32 v28, v28
  v_exp_f32 v29, v29
  v_exp_f32 v30, v30
  v_exp_f32 v31, v31
  s_add_u32 m0, s26, 24576
  s_add_u32 s24, s19, 688128
  buffer_load_dwordx4 v3, s[8:11], s24 offen lds
  v_pk_mul_f32 v[104:105], v[104:105], v[120:121]
  v_pk_mul_f32 v[106:107], v[106:107], v[122:123]
  v_pk_mul_f32 v[108:109], v[108:109], v[124:125]
  v_pk_mul_f32 v[110:111], v[110:111], v[126:127]
  v_pk_fma_f32 v[24:25], v[24:25], v[20:21], v[20:21] op_sel:[0,1,1]
  v_pk_fma_f32 v[26:27], v[26:27], v[20:21], v[20:21] op_sel:[0,1,1]
  v_pk_fma_f32 v[28:29], v[28:29], v[22:23], v[22:23] op_sel:[0,1,1]
  v_pk_fma_f32 v[30:31], v[30:31], v[22:23], v[22:23] op_sel:[0,1,1]
  v_rcp_f32 v24, v24
  v_rcp_f32 v25, v25
  v_rcp_f32 v26, v26
  v_rcp_f32 v27, v27
  buffer_load_dwordx4 v34, s[8:11], s24 offen offset:1024 lds
  v_rcp_f32 v28, v28
  v_rcp_f32 v29, v29
  v_rcp_f32 v30, v30
  v_rcp_f32 v31, v31
  v_pk_mul_f32 v[104:105], v[104:105], v[24:25]
  v_pk_mul_f32 v[106:107], v[106:107], v[26:27]
  v_pk_mul_f32 v[108:109], v[108:109], v[28:29]
  v_pk_mul_f32 v[110:111], v[110:111], v[30:31]
  v_cvt_pk_bf16_f32 v120, v104, v105
  v_cvt_pk_bf16_f32 v121, v106, v107
  v_cvt_pk_bf16_f32 v122, v108, v109
  v_cvt_pk_bf16_f32 v123, v110, v111
  s_nop 0
  v_permlane16_swap_b32 v120, v122
  v_permlane16_swap_b32 v121, v123
  buffer_store_dwordx4 v[120:123], v1, s[12:15], s38 offen offset:512 sc1
  s_add_u32 s38, s38, 0x10000
  s_waitcnt lgkmcnt(0)
  v_pk_fma_f32 v[128:129], v[8:9], v[16:17], v[128:129] op_sel_hi:[1,0,1]
  v_pk_fma_f32 v[130:131], v[10:11], v[16:17], v[130:131] op_sel_hi:[1,0,1]
  v_pk_fma_f32 v[132:133], v[8:9], v[18:19], v[132:133] op_sel_hi:[1,0,1]
  v_pk_fma_f32 v[134:135], v[10:11], v[18:19], v[134:135] op_sel_hi:[1,0,1]
  v_pk_fma_f32 v[144:145], v[12:13], v[16:17], v[144:145] op_sel_hi:[1,0,1]
  v_pk_fma_f32 v[146:147], v[14:15], v[16:17], v[146:147] op_sel_hi:[1,0,1]
  v_pk_fma_f32 v[148:149], v[12:13], v[18:19], v[148:149] op_sel_hi:[1,0,1]
  v_pk_fma_f32 v[150:151], v[14:15], v[18:19], v[150:151] op_sel_hi:[1,0,1]
  v_pk_mul_f32 v[24:25], v[128:129], v[4:5] op_sel_hi:[1,0]
  v_pk_mul_f32 v[26:27], v[130:131], v[4:5] op_sel_hi:[1,0]
  v_pk_mul_f32 v[28:29], v[132:133], v[4:5] op_sel:[0,1]
  v_pk_mul_f32 v[30:31], v[134:135], v[4:5] op_sel:[0,1]
  v_exp_f32 v24, v24
  v_exp_f32 v25, v25
  v_exp_f32 v26, v26
  v_exp_f32 v27, v27
  s_add_u32 m0, s26, 32768
  s_add_u32 s24, s19, 917504
  buffer_load_dwordx4 v3, s[8:11], s24 offen lds
  v_exp_f32 v28, v28
  v_exp_f32 v29, v29
  v_exp_f32 v30, v30
  v_exp_f32 v31, v31
  buffer_load_dwordx4 v34, s[8:11], s24 offen offset:1024 lds
  v_pk_mul_f32 v[128:129], v[128:129], v[144:145]
  v_pk_mul_f32 v[130:131], v[130:131], v[146:147]
  v_pk_mul_f32 v[132:133], v[132:133], v[148:149]
  v_pk_mul_f32 v[134:135], v[134:135], v[150:151]
  v_pk_fma_f32 v[24:25], v[24:25], v[16:17], v[16:17] op_sel:[0,1,1]
  v_pk_fma_f32 v[26:27], v[26:27], v[16:17], v[16:17] op_sel:[0,1,1]
  v_pk_fma_f32 v[28:29], v[28:29], v[18:19], v[18:19] op_sel:[0,1,1]
  v_pk_fma_f32 v[30:31], v[30:31], v[18:19], v[18:19] op_sel:[0,1,1]
  v_rcp_f32 v24, v24
  v_rcp_f32 v25, v25
  v_rcp_f32 v26, v26
  v_rcp_f32 v27, v27
  s_add_u32 m0, s26, 40960
  s_add_u32 s24, s19, 1146880
  buffer_load_dwordx4 v3, s[8:11], s24 offen lds
  v_rcp_f32 v28, v28
  v_rcp_f32 v29, v29
  v_rcp_f32 v30, v30
  v_rcp_f32 v31, v31
  v_pk_mul_f32 v[128:129], v[128:129], v[24:25]
  v_pk_mul_f32 v[130:131], v[130:131], v[26:27]
  v_pk_mul_f32 v[132:133], v[132:133], v[28:29]
  v_pk_mul_f32 v[134:135], v[134:135], v[30:31]
  v_cvt_pk_bf16_f32 v144, v128, v129
  v_cvt_pk_bf16_f32 v145, v130, v131
  v_cvt_pk_bf16_f32 v146, v132, v133
  v_cvt_pk_bf16_f32 v147, v134, v135
  s_nop 0
  v_permlane16_swap_b32 v144, v146
  v_permlane16_swap_b32 v145, v147
  buffer_store_dwordx4 v[144:147], v1, s[12:15], s38 offen offset:0 sc1
  v_pk_fma_f32 v[136:137], v[8:9], v[20:21], v[136:137] op_sel_hi:[1,0,1]
  v_pk_fma_f32 v[138:139], v[10:11], v[20:21], v[138:139] op_sel_hi:[1,0,1]
  v_pk_fma_f32 v[140:141], v[8:9], v[22:23], v[140:141] op_sel_hi:[1,0,1]
  v_pk_fma_f32 v[142:143], v[10:11], v[22:23], v[142:143] op_sel_hi:[1,0,1]
  v_pk_fma_f32 v[152:153], v[12:13], v[20:21], v[152:153] op_sel_hi:[1,0,1]
  v_pk_fma_f32 v[154:155], v[14:15], v[20:21], v[154:155] op_sel_hi:[1,0,1]
  v_pk_fma_f32 v[156:157], v[12:13], v[22:23], v[156:157] op_sel_hi:[1,0,1]
  v_pk_fma_f32 v[158:159], v[14:15], v[22:23], v[158:159] op_sel_hi:[1,0,1]
  ds_read_b128 v[8:11], v2 offset:512
  ds_read_b128 v[12:15], v2 offset:576
  v_pk_mul_f32 v[24:25], v[136:137], v[6:7] op_sel_hi:[1,0]
  v_pk_mul_f32 v[26:27], v[138:139], v[6:7] op_sel_hi:[1,0]
  v_pk_mul_f32 v[28:29], v[140:141], v[6:7] op_sel:[0,1]
  v_pk_mul_f32 v[30:31], v[142:143], v[6:7] op_sel:[0,1]
  v_exp_f32 v24, v24
  v_exp_f32 v25, v25
  v_exp_f32 v26, v26
  v_exp_f32 v27, v27
  buffer_load_dwordx4 v34, s[8:11], s24 offen offset:1024 lds
  v_exp_f32 v28, v28
  v_exp_f32 v29, v29
  v_exp_f32 v30, v30
  v_exp_f32 v31, v31
  s_add_u32 m0, s26, 49152
  s_add_u32 s24, s19, 1376256
  buffer_load_dwordx4 v3, s[8:11], s24 offen lds
  v_pk_mul_f32 v[136:137], v[136:137], v[152:153]
  v_pk_mul_f32 v[138:139], v[138:139], v[154:155]
  v_pk_mul_f32 v[140:141], v[140:141], v[156:157]
  v_pk_mul_f32 v[142:143], v[142:143], v[158:159]
  v_pk_fma_f32 v[24:25], v[24:25], v[20:21], v[20:21] op_sel:[0,1,1]
  v_pk_fma_f32 v[26:27], v[26:27], v[20:21], v[20:21] op_sel:[0,1,1]
  v_pk_fma_f32 v[28:29], v[28:29], v[22:23], v[22:23] op_sel:[0,1,1]
  v_pk_fma_f32 v[30:31], v[30:31], v[22:23], v[22:23] op_sel:[0,1,1]
  v_rcp_f32 v24, v24
  v_rcp_f32 v25, v25
  v_rcp_f32 v26, v26
  v_rcp_f32 v27, v27
  buffer_load_dwordx4 v34, s[8:11], s24 offen offset:1024 lds
  v_rcp_f32 v28, v28
  v_rcp_f32 v29, v29
  v_rcp_f32 v30, v30
  v_rcp_f32 v31, v31
  v_pk_mul_f32 v[136:137], v[136:137], v[24:25]
  v_pk_mul_f32 v[138:139], v[138:139], v[26:27]
  v_pk_mul_f32 v[140:141], v[140:141], v[28:29]
  v_pk_mul_f32 v[142:143], v[142:143], v[30:31]
  v_cvt_pk_bf16_f32 v152, v136, v137
  v_cvt_pk_bf16_f32 v153, v138, v139
  v_cvt_pk_bf16_f32 v154, v140, v141
  v_cvt_pk_bf16_f32 v155, v142, v143
  s_nop 0
  v_permlane16_swap_b32 v152, v154
  v_permlane16_swap_b32 v153, v155
  buffer_store_dwordx4 v[152:155], v1, s[12:15], s38 offen offset:512 sc1
  s_add_u32 s38, s38, 0x10000
  s_waitcnt lgkmcnt(0)
  v_pk_fma_f32 v[160:161], v[8:9], v[16:17], v[160:161] op_sel_hi:[1,0,1]
  v_pk_fma_f32 v[162:163], v[10:11], v[16:17], v[162:163] op_sel_hi:[1,0,1]
  v_pk_fma_f32 v[164:165], v[8:9], v[18:19], v[164:165] op_sel_hi:[1,0,1]
  v_pk_fma_f32 v[166:167], v[10:11], v[18:19], v[166:167] op_sel_hi:[1,0,1]
  v_pk_fma_f32 v[176:177], v[12:13], v[16:17], v[176:177] op_sel_hi:[1,0,1]
  v_pk_fma_f32 v[178:179], v[14:15], v[16:17], v[178:179] op_sel_hi:[1,0,1]
  v_pk_fma_f32 v[180:181], v[12:13], v[18:19], v[180:181] op_sel_hi:[1,0,1]
  v_pk_fma_f32 v[182:183], v[14:15], v[18:19], v[182:183] op_sel_hi:[1,0,1]
  v_pk_mul_f32 v[24:25], v[160:161], v[4:5] op_sel_hi:[1,0]
  v_pk_mul_f32 v[26:27], v[162:163], v[4:5] op_sel_hi:[1,0]
  v_pk_mul_f32 v[28:29], v[164:165], v[4:5] op_sel:[0,1]
  v_pk_mul_f32 v[30:31], v[166:167], v[4:5] op_sel:[0,1]
  v_exp_f32 v24, v24
  v_exp_f32 v25, v25
  v_exp_f32 v26, v26
  v_exp_f32 v27, v27
  s_add_u32 m0, s26, 57344
  s_add_u32 s24, s19, 1605632
  buffer_load_dwordx4 v3, s[8:11], s24 offen lds
  v_exp_f32 v28, v28
  v_exp_f32 v29, v29
  v_exp_f32 v30, v30
  v_exp_f32 v31, v31
  buffer_load_dwordx4 v34, s[8:11], s24 offen offset:1024 lds
  v_pk_mul_f32 v[160:161], v[160:161], v[176:177]
  v_pk_mul_f32 v[162:163], v[162:163], v[178:179]
  v_pk_mul_f32 v[164:165], v[164:165], v[180:181]
  v_pk_mul_f32 v[166:167], v[166:167], v[182:183]
  v_pk_fma_f32 v[24:25], v[24:25], v[16:17], v[16:17] op_sel:[0,1,1]
  v_pk_fma_f32 v[26:27], v[26:27], v[16:17], v[16:17] op_sel:[0,1,1]
  v_pk_fma_f32 v[28:29], v[28:29], v[18:19], v[18:19] op_sel:[0,1,1]
  v_pk_fma_f32 v[30:31], v[30:31], v[18:19], v[18:19] op_sel:[0,1,1]
  v_rcp_f32 v24, v24
  v_rcp_f32 v25, v25
  v_rcp_f32 v26, v26
  v_rcp_f32 v27, v27
  s_add_u32 m0, s26, 65536
  s_add_u32 s24, s19, 1835008
  buffer_load_dwordx4 v3, s[8:11], s24 offen lds
  v_rcp_f32 v28, v28
  v_rcp_f32 v29, v29
  v_rcp_f32 v30, v30
  v_rcp_f32 v31, v31
  v_pk_mul_f32 v[160:161], v[160:161], v[24:25]
  v_pk_mul_f32 v[162:163], v[162:163], v[26:27]
  v_pk_mul_f32 v[164:165], v[164:165], v[28:29]
  v_pk_mul_f32 v[166:167], v[166:167], v[30:31]
  v_cvt_pk_bf16_f32 v176, v160, v161
  v_cvt_pk_bf16_f32 v177, v162, v163
  v_cvt_pk_bf16_f32 v178, v164, v165
  v_cvt_pk_bf16_f32 v179, v166, v167
  s_nop 0
  v_permlane16_swap_b32 v176, v178
  v_permlane16_swap_b32 v177, v179
  buffer_store_dwordx4 v[176:179], v1, s[12:15], s38 offen offset:0 sc1
  v_pk_fma_f32 v[168:169], v[8:9], v[20:21], v[168:169] op_sel_hi:[1,0,1]
  v_pk_fma_f32 v[170:171], v[10:11], v[20:21], v[170:171] op_sel_hi:[1,0,1]
  v_pk_fma_f32 v[172:173], v[8:9], v[22:23], v[172:173] op_sel_hi:[1,0,1]
  v_pk_fma_f32 v[174:175], v[10:11], v[22:23], v[174:175] op_sel_hi:[1,0,1]
  v_pk_fma_f32 v[184:185], v[12:13], v[20:21], v[184:185] op_sel_hi:[1,0,1]
  v_pk_fma_f32 v[186:187], v[14:15], v[20:21], v[186:187] op_sel_hi:[1,0,1]
  v_pk_fma_f32 v[188:189], v[12:13], v[22:23], v[188:189] op_sel_hi:[1,0,1]
  v_pk_fma_f32 v[190:191], v[14:15], v[22:23], v[190:191] op_sel_hi:[1,0,1]
  ds_read_b128 v[8:11], v2 offset:640
  ds_read_b128 v[12:15], v2 offset:704
  v_pk_mul_f32 v[24:25], v[168:169], v[6:7] op_sel_hi:[1,0]
  v_pk_mul_f32 v[26:27], v[170:171], v[6:7] op_sel_hi:[1,0]
  v_pk_mul_f32 v[28:29], v[172:173], v[6:7] op_sel:[0,1]
  v_pk_mul_f32 v[30:31], v[174:175], v[6:7] op_sel:[0,1]
  v_exp_f32 v24, v24
  v_exp_f32 v25, v25
  v_exp_f32 v26, v26
  v_exp_f32 v27, v27
  buffer_load_dwordx4 v34, s[8:11], s24 offen offset:1024 lds
  v_exp_f32 v28, v28
  v_exp_f32 v29, v29
  v_exp_f32 v30, v30
  v_exp_f32 v31, v31
  s_add_u32 m0, s26, 73728
  s_add_u32 s24, s19, 2064384
  buffer_load_dwordx4 v3, s[8:11], s24 offen lds
  v_pk_mul_f32 v[168:169], v[168:169], v[184:185]
  v_pk_mul_f32 v[170:171], v[170:171], v[186:187]
  v_pk_mul_f32 v[172:173], v[172:173], v[188:189]
  v_pk_mul_f32 v[174:175], v[174:175], v[190:191]
  v_pk_fma_f32 v[24:25], v[24:25], v[20:21], v[20:21] op_sel:[0,1,1]
  v_pk_fma_f32 v[26:27], v[26:27], v[20:21], v[20:21] op_sel:[0,1,1]
  v_pk_fma_f32 v[28:29], v[28:29], v[22:23], v[22:23] op_sel:[0,1,1]
  v_pk_fma_f32 v[30:31], v[30:31], v[22:23], v[22:23] op_sel:[0,1,1]
  v_rcp_f32 v24, v24
  v_rcp_f32 v25, v25
  v_rcp_f32 v26, v26
  v_rcp_f32 v27, v27
  buffer_load_dwordx4 v34, s[8:11], s24 offen offset:1024 lds
  v_rcp_f32 v28, v28
  v_rcp_f32 v29, v29
  v_rcp_f32 v30, v30
  v_rcp_f32 v31, v31
  v_pk_mul_f32 v[168:169], v[168:169], v[24:25]
  v_pk_mul_f32 v[170:171], v[170:171], v[26:27]
  v_pk_mul_f32 v[172:173], v[172:173], v[28:29]
  v_pk_mul_f32 v[174:175], v[174:175], v[30:31]
  v_cvt_pk_bf16_f32 v184, v168, v169
  v_cvt_pk_bf16_f32 v185, v170, v171
  v_cvt_pk_bf16_f32 v186, v172, v173
  v_cvt_pk_bf16_f32 v187, v174, v175
  s_nop 0
  v_permlane16_swap_b32 v184, v186
  v_permlane16_swap_b32 v185, v187
  buffer_store_dwordx4 v[184:187], v1, s[12:15], s38 offen offset:512 sc1
  v_accvgpr_read_b32 v164, a213
  v_add_u32 v166, s55, v3
  v_add_u32 v165, s55, v164
  s_add_u32 s38, s38, 0x10000
  s_waitcnt lgkmcnt(0)
  v_pk_fma_f32 v[192:193], v[8:9], v[16:17], v[192:193] op_sel_hi:[1,0,1]
  v_pk_fma_f32 v[194:195], v[10:11], v[16:17], v[194:195] op_sel_hi:[1,0,1]
  v_pk_fma_f32 v[196:197], v[8:9], v[18:19], v[196:197] op_sel_hi:[1,0,1]
  v_pk_fma_f32 v[198:199], v[10:11], v[18:19], v[198:199] op_sel_hi:[1,0,1]
  v_pk_fma_f32 v[208:209], v[12:13], v[16:17], v[208:209] op_sel_hi:[1,0,1]
  v_pk_fma_f32 v[210:211], v[14:15], v[16:17], v[210:211] op_sel_hi:[1,0,1]
  v_pk_fma_f32 v[212:213], v[12:13], v[18:19], v[212:213] op_sel_hi:[1,0,1]
  v_pk_fma_f32 v[214:215], v[14:15], v[18:19], v[214:215] op_sel_hi:[1,0,1]
  v_pk_mul_f32 v[24:25], v[192:193], v[4:5] op_sel_hi:[1,0]
  v_pk_mul_f32 v[26:27], v[194:195], v[4:5] op_sel_hi:[1,0]
  v_pk_mul_f32 v[28:29], v[196:197], v[4:5] op_sel:[0,1]
  v_pk_mul_f32 v[30:31], v[198:199], v[4:5] op_sel:[0,1]
  v_exp_f32 v24, v24
  v_exp_f32 v25, v25
  v_exp_f32 v26, v26
  v_exp_f32 v27, v27
  s_add_u32 m0, s26, 81920
  s_add_u32 s24, s19, 2293760
  buffer_load_dwordx4 v3, s[8:11], s24 offen lds
  v_exp_f32 v28, v28
  v_exp_f32 v29, v29
  v_exp_f32 v30, v30
  v_exp_f32 v31, v31
  buffer_load_dwordx4 v34, s[8:11], s24 offen offset:1024 lds
  v_pk_mul_f32 v[192:193], v[192:193], v[208:209]
  v_pk_mul_f32 v[194:195], v[194:195], v[210:211]
  v_pk_mul_f32 v[196:197], v[196:197], v[212:213]
  v_pk_mul_f32 v[198:199], v[198:199], v[214:215]
  v_pk_fma_f32 v[24:25], v[24:25], v[16:17], v[16:17] op_sel:[0,1,1]
  v_pk_fma_f32 v[26:27], v[26:27], v[16:17], v[16:17] op_sel:[0,1,1]
  v_pk_fma_f32 v[28:29], v[28:29], v[18:19], v[18:19] op_sel:[0,1,1]
  v_pk_fma_f32 v[30:31], v[30:31], v[18:19], v[18:19] op_sel:[0,1,1]
  v_rcp_f32 v24, v24
  v_rcp_f32 v25, v25
  v_rcp_f32 v26, v26
  v_rcp_f32 v27, v27
  s_add_u32 m0, s26, 90112
  s_add_u32 s24, s19, 2523136
  buffer_load_dwordx4 v3, s[8:11], s24 offen lds
  v_rcp_f32 v28, v28
  v_rcp_f32 v29, v29
  v_rcp_f32 v30, v30
  v_rcp_f32 v31, v31
  v_pk_mul_f32 v[192:193], v[192:193], v[24:25]
  v_pk_mul_f32 v[194:195], v[194:195], v[26:27]
  v_pk_mul_f32 v[196:197], v[196:197], v[28:29]
  v_pk_mul_f32 v[198:199], v[198:199], v[30:31]
  v_cvt_pk_bf16_f32 v208, v192, v193
  v_cvt_pk_bf16_f32 v209, v194, v195
  v_cvt_pk_bf16_f32 v210, v196, v197
  v_cvt_pk_bf16_f32 v211, v198, v199
  s_nop 0
  v_permlane16_swap_b32 v208, v210
  v_permlane16_swap_b32 v209, v211
  buffer_store_dwordx4 v[208:211], v1, s[12:15], s38 offen offset:0 sc1
  v_pk_fma_f32 v[200:201], v[8:9], v[20:21], v[200:201] op_sel_hi:[1,0,1]
  v_pk_fma_f32 v[202:203], v[10:11], v[20:21], v[202:203] op_sel_hi:[1,0,1]
  v_pk_fma_f32 v[204:205], v[8:9], v[22:23], v[204:205] op_sel_hi:[1,0,1]
  v_pk_fma_f32 v[206:207], v[10:11], v[22:23], v[206:207] op_sel_hi:[1,0,1]
  v_pk_fma_f32 v[216:217], v[12:13], v[20:21], v[216:217] op_sel_hi:[1,0,1]
  v_pk_fma_f32 v[218:219], v[14:15], v[20:21], v[218:219] op_sel_hi:[1,0,1]
  v_pk_fma_f32 v[220:221], v[12:13], v[22:23], v[220:221] op_sel_hi:[1,0,1]
  v_pk_fma_f32 v[222:223], v[14:15], v[22:23], v[222:223] op_sel_hi:[1,0,1]
  ds_read_b128 v[8:11], v2 offset:768
  ds_read_b128 v[12:15], v2 offset:832
  v_pk_mul_f32 v[24:25], v[200:201], v[6:7] op_sel_hi:[1,0]
  v_pk_mul_f32 v[26:27], v[202:203], v[6:7] op_sel_hi:[1,0]
  v_pk_mul_f32 v[28:29], v[204:205], v[6:7] op_sel:[0,1]
  v_pk_mul_f32 v[30:31], v[206:207], v[6:7] op_sel:[0,1]
  v_exp_f32 v24, v24
  v_exp_f32 v25, v25
  v_exp_f32 v26, v26
  v_exp_f32 v27, v27
  buffer_load_dwordx4 v34, s[8:11], s24 offen offset:1024 lds
  v_exp_f32 v28, v28
  v_exp_f32 v29, v29
  v_exp_f32 v30, v30
  v_exp_f32 v31, v31
  v_pk_mul_f32 v[200:201], v[200:201], v[216:217]
  v_pk_mul_f32 v[202:203], v[202:203], v[218:219]
  v_pk_mul_f32 v[204:205], v[204:205], v[220:221]
  v_pk_mul_f32 v[206:207], v[206:207], v[222:223]
  v_pk_fma_f32 v[24:25], v[24:25], v[20:21], v[20:21] op_sel:[0,1,1]
  v_pk_fma_f32 v[26:27], v[26:27], v[20:21], v[20:21] op_sel:[0,1,1]
  v_pk_fma_f32 v[28:29], v[28:29], v[22:23], v[22:23] op_sel:[0,1,1]
  v_pk_fma_f32 v[30:31], v[30:31], v[22:23], v[22:23] op_sel:[0,1,1]
  v_rcp_f32 v24, v24
  v_rcp_f32 v25, v25
  v_rcp_f32 v26, v26
  v_rcp_f32 v27, v27
  v_rcp_f32 v28, v28
  v_rcp_f32 v29, v29
  v_rcp_f32 v30, v30
  v_rcp_f32 v31, v31
  v_pk_mul_f32 v[200:201], v[200:201], v[24:25]
  v_pk_mul_f32 v[202:203], v[202:203], v[26:27]
  v_pk_mul_f32 v[204:205], v[204:205], v[28:29]
  v_pk_mul_f32 v[206:207], v[206:207], v[30:31]
  v_cvt_pk_bf16_f32 v216, v200, v201
  v_cvt_pk_bf16_f32 v217, v202, v203
  v_cvt_pk_bf16_f32 v218, v204, v205
  v_cvt_pk_bf16_f32 v219, v206, v207
  s_nop 0
  v_permlane16_swap_b32 v216, v218
  v_permlane16_swap_b32 v217, v219
  buffer_store_dwordx4 v[216:219], v1, s[12:15], s38 offen offset:512 sc1
  v_and_b32 v163, 15, v0
  v_lshlrev_b32 v163, 2, v163
  buffer_load_dword v168, v163, s[40:43], s52 offen sc0 sc1
  s_add_u32 s38, s38, 0x10000
  s_waitcnt lgkmcnt(0)
  v_pk_fma_f32 v[224:225], v[8:9], v[16:17], v[224:225] op_sel_hi:[1,0,1]
  v_pk_fma_f32 v[226:227], v[10:11], v[16:17], v[226:227] op_sel_hi:[1,0,1]
  v_pk_fma_f32 v[228:229], v[8:9], v[18:19], v[228:229] op_sel_hi:[1,0,1]
  v_pk_fma_f32 v[230:231], v[10:11], v[18:19], v[230:231] op_sel_hi:[1,0,1]
  v_pk_fma_f32 v[240:241], v[12:13], v[16:17], v[240:241] op_sel_hi:[1,0,1]
  v_pk_fma_f32 v[242:243], v[14:15], v[16:17], v[242:243] op_sel_hi:[1,0,1]
  v_pk_fma_f32 v[244:245], v[12:13], v[18:19], v[244:245] op_sel_hi:[1,0,1]
  v_pk_fma_f32 v[246:247], v[14:15], v[18:19], v[246:247] op_sel_hi:[1,0,1]
  v_pk_mul_f32 v[24:25], v[224:225], v[4:5] op_sel_hi:[1,0]
  v_pk_mul_f32 v[26:27], v[226:227], v[4:5] op_sel_hi:[1,0]
  v_pk_mul_f32 v[28:29], v[228:229], v[4:5] op_sel:[0,1]
  v_pk_mul_f32 v[30:31], v[230:231], v[4:5] op_sel:[0,1]
  v_exp_f32 v24, v24
  v_exp_f32 v25, v25
  v_exp_f32 v26, v26
  v_exp_f32 v27, v27
  v_exp_f32 v28, v28
  v_exp_f32 v29, v29
  v_exp_f32 v30, v30
  v_exp_f32 v31, v31
  v_pk_mul_f32 v[224:225], v[224:225], v[240:241]
  v_pk_mul_f32 v[226:227], v[226:227], v[242:243]
  v_pk_mul_f32 v[228:229], v[228:229], v[244:245]
  v_pk_mul_f32 v[230:231], v[230:231], v[246:247]
  v_pk_fma_f32 v[24:25], v[24:25], v[16:17], v[16:17] op_sel:[0,1,1]
  v_pk_fma_f32 v[26:27], v[26:27], v[16:17], v[16:17] op_sel:[0,1,1]
  v_pk_fma_f32 v[28:29], v[28:29], v[18:19], v[18:19] op_sel:[0,1,1]
  v_pk_fma_f32 v[30:31], v[30:31], v[18:19], v[18:19] op_sel:[0,1,1]
  v_rcp_f32 v24, v24
  v_rcp_f32 v25, v25
  v_rcp_f32 v26, v26
  v_rcp_f32 v27, v27
  v_rcp_f32 v28, v28
  v_rcp_f32 v29, v29
  v_rcp_f32 v30, v30
  v_rcp_f32 v31, v31
  v_pk_mul_f32 v[224:225], v[224:225], v[24:25]
  v_pk_mul_f32 v[226:227], v[226:227], v[26:27]
  v_pk_mul_f32 v[228:229], v[228:229], v[28:29]
  v_pk_mul_f32 v[230:231], v[230:231], v[30:31]
  v_cvt_pk_bf16_f32 v240, v224, v225
  v_cvt_pk_bf16_f32 v241, v226, v227
  v_cvt_pk_bf16_f32 v242, v228, v229
  v_cvt_pk_bf16_f32 v243, v230, v231
  s_nop 0
  v_permlane16_swap_b32 v240, v242
  v_permlane16_swap_b32 v241, v243
  buffer_store_dwordx4 v[240:243], v1, s[12:15], s38 offen offset:0 sc1
  v_pk_fma_f32 v[232:233], v[8:9], v[20:21], v[232:233] op_sel_hi:[1,0,1]
  v_pk_fma_f32 v[234:235], v[10:11], v[20:21], v[234:235] op_sel_hi:[1,0,1]
  v_pk_fma_f32 v[236:237], v[8:9], v[22:23], v[236:237] op_sel_hi:[1,0,1]
  v_pk_fma_f32 v[238:239], v[10:11], v[22:23], v[238:239] op_sel_hi:[1,0,1]
  v_pk_fma_f32 v[248:249], v[12:13], v[20:21], v[248:249] op_sel_hi:[1,0,1]
  v_pk_fma_f32 v[250:251], v[14:15], v[20:21], v[250:251] op_sel_hi:[1,0,1]
  v_pk_fma_f32 v[252:253], v[12:13], v[22:23], v[252:253] op_sel_hi:[1,0,1]
  v_pk_fma_f32 v[254:255], v[14:15], v[22:23], v[254:255] op_sel_hi:[1,0,1]
  v_pk_mul_f32 v[24:25], v[232:233], v[6:7] op_sel_hi:[1,0]
  v_pk_mul_f32 v[26:27], v[234:235], v[6:7] op_sel_hi:[1,0]
  v_pk_mul_f32 v[28:29], v[236:237], v[6:7] op_sel:[0,1]
  v_pk_mul_f32 v[30:31], v[238:239], v[6:7] op_sel:[0,1]
  v_exp_f32 v24, v24
  v_exp_f32 v25, v25
  v_exp_f32 v26, v26
  v_exp_f32 v27, v27
  v_exp_f32 v28, v28
  v_exp_f32 v29, v29
  v_exp_f32 v30, v30
  v_exp_f32 v31, v31
  v_pk_mul_f32 v[232:233], v[232:233], v[248:249]
  v_pk_mul_f32 v[234:235], v[234:235], v[250:251]
  v_pk_mul_f32 v[236:237], v[236:237], v[252:253]
  v_pk_mul_f32 v[238:239], v[238:239], v[254:255]
  v_pk_fma_f32 v[24:25], v[24:25], v[20:21], v[20:21] op_sel:[0,1,1]
  v_pk_fma_f32 v[26:27], v[26:27], v[20:21], v[20:21] op_sel:[0,1,1]
  v_pk_fma_f32 v[28:29], v[28:29], v[22:23], v[22:23] op_sel:[0,1,1]
  v_pk_fma_f32 v[30:31], v[30:31], v[22:23], v[22:23] op_sel:[0,1,1]
  v_rcp_f32 v24, v24
  v_rcp_f32 v25, v25
  v_rcp_f32 v26, v26
  v_rcp_f32 v27, v27
  v_rcp_f32 v28, v28
  v_rcp_f32 v29, v29
  v_rcp_f32 v30, v30
  v_rcp_f32 v31, v31
  v_pk_mul_f32 v[232:233], v[232:233], v[24:25]
  v_pk_mul_f32 v[234:235], v[234:235], v[26:27]
  v_pk_mul_f32 v[236:237], v[236:237], v[28:29]
  v_pk_mul_f32 v[238:239], v[238:239], v[30:31]
  v_cvt_pk_bf16_f32 v248, v232, v233
  v_cvt_pk_bf16_f32 v249, v234, v235
  v_cvt_pk_bf16_f32 v250, v236, v237
  v_cvt_pk_bf16_f32 v251, v238, v239
  s_nop 0
  v_permlane16_swap_b32 v248, v250
  v_permlane16_swap_b32 v249, v251
  buffer_store_dwordx4 v[248:251], v1, s[12:15], s38 offen offset:512 sc1
  v_and_b32 v15, 63, v0
  v_lshrrev_b32 v12, 4, v15
  v_and_b32 v13, 15, v15
  v_lshlrev_b32 v1, 15, v12
  v_lshl_add_u32 v1, v13, 4, v1
  s_lshl_b32 s34, s21, 11
  s_lshl_b32 s27, s16, 9
  s_add_u32 s34, s34, s27
  s_mul_i32 s61, s35, 2097152
  s_mul_i32 s62, s35, 3932160
  s_add_u32 s61, s61, s34
  s_add_u32 s62, s62, s34
  s_mov_b32 s63, s34
  s_add_u32 s4, s32, 0x1000000
  s_addc_u32 s5, s33, 0
  s_mov_b32 s6, 0xe00000
  s_mov_b32 s7, 0x20000
  s_mov_b32 s36, 0
  s_waitcnt vmcnt(2)
g2_w1:
  v_cmp_ne_u32 vcc, 1, v168
  s_cbranch_vccz g2_w1d
  buffer_load_dword v168, v163, s[40:43], s52 offen sc0 sc1
  s_add_u32 s36, s36, 1
  s_cmp_lt_u32 s36, 0x40000
  s_waitcnt vmcnt(0)
  s_cbranch_scc1 g2_w1
g2_w1d:
  s_add_u32 s23, s61, 0
  buffer_load_dwordx4 a[0:3], v1, s[4:7], s23 offen offset:0 sc1
  buffer_load_dwordx4 a[4:7], v1, s[4:7], s23 offen offset:256 sc1
  s_add_u32 s23, s61, 131072
  buffer_load_dwordx4 a[8:11], v1, s[4:7], s23 offen offset:0 sc1
  buffer_load_dwordx4 a[12:15], v1, s[4:7], s23 offen offset:256 sc1
  s_add_u32 s23, s61, 262144
  buffer_load_dwordx4 a[16:19], v1, s[4:7], s23 offen offset:0 sc1
  buffer_load_dwordx4 a[20:23], v1, s[4:7], s23 offen offset:256 sc1
  s_add_u32 s23, s61, 393216
  buffer_load_dwordx4 a[24:27], v1, s[4:7], s23 offen offset:0 sc1
  v_lshrrev_b32 v12, 2, v15
  v_and_b32 v13, 3, v15
  v_and_b32 v14, 7, v12
  v_lshlrev_b32 v14, 7, v14
  v_lshrrev_b32 v12, 3, v12
  v_lshl_add_u32 v14, v12, 11, v14
  v_lshl_add_u32 v14, v13, 3, v14
  v_bfe_u32 v12, v15, 3, 2
  v_xor_b32 v13, 0, v12
  v_lshl_add_u32 v4, v13, 5, v14
  v_add_u32 v8, 0x10000, v4
  v_xor_b32 v13, 1, v12
  v_lshl_add_u32 v5, v13, 5, v14
  v_add_u32 v9, 0x10000, v5
  v_xor_b32 v13, 2, v12
  v_lshl_add_u32 v6, v13, 5, v14
  v_add_u32 v10, 0x10000, v6
  v_xor_b32 v13, 3, v12
  v_lshl_add_u32 v7, v13, 5, v14
  v_add_u32 v11, 0x10000, v7
  v_lshlrev_b32 v2, 4, v15
  s_lshl_b32 s44, s2, 2
  s_add_u32 s44, s44, s16
  s_xor_b32 s45, s44, 4
  s_lshl_b32 s46, s44, 3
  s_lshl_b32 s47, s45, 3
  s_lshl_b32 s44, s44, 13
  s_lshl_b32 s45, s45, 13
  s_add_u32 s44, s44, 33554432
  s_add_u32 s45, s45, 33554432
  s_add_u32 s46, s46, 495616
  s_add_u32 s47, s47, 495616
  s_add_u32 s12, s32, 0x100000
  s_addc_u32 s13, s33, 0
  s_mov_b32 s14, 0x400000
  s_mov_b32 s15, 0x20000
  s_mov_b32 s56, s30
  s_mov_b32 s57, s31
  s_mov_b32 s58, 0x400000
  s_mov_b32 s59, 0x20000
  s_getpc_b64 s[48:49]
g2_pc:
  s_lshr_b32 s50, s2, 3
  s_lshl_b32 s50, s50, 2
  s_add_u32 s50, s50, s16
  s_lshl_b32 s50, s50, 7
  s_waitcnt vmcnt(33)
  s_barrier
  ds_read_b64_tr_b16 v[80:81], v4 offset:0
  ds_read_b64_tr_b16 v[82:83], v4 offset:4096
  ds_read_b64_tr_b16 v[84:85], v5 offset:0
  ds_read_b64_tr_b16 v[86:87], v5 offset:4096
  ds_read_b64_tr_b16 v[88:89], v6 offset:0
  ds_read_b64_tr_b16 v[90:91], v6 offset:4096
  ds_read_b64_tr_b16 v[92:93], v7 offset:0
  ds_read_b64_tr_b16 v[94:95], v7 offset:4096
  ds_read_b64_tr_b16 v[96:97], v4 offset:1024
  ds_read_b64_tr_b16 v[98:99], v4 offset:5120
  ds_read_b64_tr_b16 v[100:101], v5 offset:1024
  ds_read_b64_tr_b16 v[102:103], v5 offset:5120
  ds_read_b64_tr_b16 v[104:105], v6 offset:1024
  ds_read_b64_tr_b16 v[106:107], v6 offset:5120
  ds_read_b64_tr_b16 v[108:109], v7 offset:1024
  ds_read_b64_tr_b16 v[110:111], v7 offset:5120
g2_s0:
  s_waitcnt vmcnt(5) lgkmcnt(8)
  v_mfma_f32_16x16x32_bf16 v[16:19], v[80:83], a[0:3], 0
  v_mov_b32 v12, 1
  v_mov_b32 v13, 0
  s_add_u32 s39, s39, 12288
  s_mov_b64 exec, 1
  buffer_store_dword v12, v13, s[40:43], s39 offen sc0 sc1
  s_mov_b64 exec, -1
  v_mfma_f32_16x16x32_bf16 v[20:23], v[80:83], a[4:7], 0
  v_mfma_f32_16x16x32_bf16 v[24:27], v[84:87], a[0:3], 0
  v_mfma_f32_16x16x32_bf16 v[28:31], v[84:87], a[4:7], 0
  ds_read_b64_tr_b16 v[112:113], v4 offset:8192
  ds_read_b64_tr_b16 v[114:115], v4 offset:12288
  v_mfma_f32_16x16x32_bf16 v[32:35], v[88:91], a[0:3], 0
  buffer_load_dwordx4 a[28:31], v1, s[4:7], s23 offen offset:256 sc1
  v_and_b32 v163, 31, v0
  v_mfma_f32_16x16x32_bf16 v[36:39], v[88:91], a[4:7], 0
  v_lshlrev_b32 v163, 2, v163
  ds_read_b64_tr_b16 v[116:117], v5 offset:8192
  v_mfma_f32_16x16x32_bf16 v[40:43], v[92:95], a[0:3], 0
  ds_read_b64_tr_b16 v[118:119], v5 offset:12288
  s_add_u32 s23, s61, 524288
  v_mfma_f32_16x16x32_bf16 v[44:47], v[92:95], a[4:7], 0
  ds_read_b64_tr_b16 v[120:121], v6 offset:8192
  buffer_load_dwordx4 a[32:35], v1, s[4:7], s23 offen offset:0 sc1
  s_waitcnt lgkmcnt(5)
  v_mfma_f32_16x16x32_bf16 v[48:51], v[96:99], a[0:3], 0
  ds_read_b64_tr_b16 v[122:123], v6 offset:12288
  ds_read_b64_tr_b16 v[124:125], v7 offset:8192
  v_mfma_f32_16x16x32_bf16 v[52:55], v[96:99], a[4:7], 0
  ds_read_b64_tr_b16 v[126:127], v7 offset:12288
  buffer_load_dwordx4 a[36:39], v1, s[4:7], s23 offen offset:256 sc1
  v_mfma_f32_16x16x32_bf16 v[56:59], v[100:103], a[0:3], 0
  ds_read_b64_tr_b16 v[128:129], v4 offset:9216
  ds_read_b64_tr_b16 v[130:131], v4 offset:13312
  v_mfma_f32_16x16x32_bf16 v[60:63], v[100:103], a[4:7], 0
  s_add_u32 s23, s61, 655360
  ds_read_b64_tr_b16 v[132:133], v5 offset:9216
  v_mfma_f32_16x16x32_bf16 v[64:67], v[104:107], a[0:3], 0
  buffer_load_dwordx4 a[40:43], v1, s[4:7], s23 offen offset:0 sc1
  ds_read_b64_tr_b16 v[134:135], v5 offset:13312
  v_mfma_f32_16x16x32_bf16 v[68:71], v[104:107], a[4:7], 0
  ds_read_b64_tr_b16 v[136:137], v6 offset:9216
  ds_read_b64_tr_b16 v[138:139], v6 offset:13312
  v_mfma_f32_16x16x32_bf16 v[72:75], v[108:111], a[0:3], 0
  ds_read_b64_tr_b16 v[140:141], v7 offset:9216
  ds_read_b64_tr_b16 v[142:143], v7 offset:13312
  v_mfma_f32_16x16x32_bf16 v[76:79], v[108:111], a[4:7], 0
  buffer_load_dwordx4 a[44:47], v1, s[4:7], s23 offen offset:256 sc1
g2_s1:
  s_waitcnt vmcnt(9) lgkmcnt(8)
  v_mfma_f32_16x16x32_bf16 v[16:19], v[112:115], a[8:11], v[16:19]
  ds_read_b64_tr_b16 v[80:81], v4 offset:16384
  s_add_u32 s23, s61, 786432
  v_mfma_f32_16x16x32_bf16 v[20:23], v[112:115], a[12:15], v[20:23]
  ds_read_b64_tr_b16 v[82:83], v4 offset:20480
  v_mfma_f32_16x16x32_bf16 v[24:27], v[116:119], a[8:11], v[24:27]
  buffer_load_dwordx4 a[48:51], v1, s[4:7], s23 offen offset:0 sc1
  ds_read_b64_tr_b16 v[84:85], v5 offset:16384
  v_mfma_f32_16x16x32_bf16 v[28:31], v[116:119], a[12:15], v[28:31]
  ds_read_b64_tr_b16 v[86:87], v5 offset:20480
  v_mfma_f32_16x16x32_bf16 v[32:35], v[120:123], a[8:11], v[32:35]
  ds_read_b64_tr_b16 v[88:89], v6 offset:16384
  buffer_load_dwordx4 a[52:55], v1, s[4:7], s23 offen offset:256 sc1
  v_mfma_f32_16x16x32_bf16 v[36:39], v[120:123], a[12:15], v[36:39]
  ds_read_b64_tr_b16 v[90:91], v6 offset:20480
  v_mfma_f32_16x16x32_bf16 v[40:43], v[124:127], a[8:11], v[40:43]
  ds_read_b64_tr_b16 v[92:93], v7 offset:16384
  s_add_u32 s23, s61, 917504
  v_mfma_f32_16x16x32_bf16 v[44:47], v[124:127], a[12:15], v[44:47]
  ds_read_b64_tr_b16 v[94:95], v7 offset:20480
  s_waitcnt lgkmcnt(8)
  v_mfma_f32_16x16x32_bf16 v[48:51], v[128:131], a[8:11], v[48:51]
  buffer_load_dwordx4 a[56:59], v1, s[4:7], s23 offen offset:0 sc1
  ds_read_b64_tr_b16 v[96:97], v4 offset:17408
  v_mfma_f32_16x16x32_bf16 v[52:55], v[128:131], a[12:15], v[52:55]
  ds_read_b64_tr_b16 v[98:99], v4 offset:21504
  v_mfma_f32_16x16x32_bf16 v[56:59], v[132:135], a[8:11], v[56:59]
  ds_read_b64_tr_b16 v[100:101], v5 offset:17408
  buffer_load_dwordx4 a[60:63], v1, s[4:7], s23 offen offset:256 sc1
  v_mfma_f32_16x16x32_bf16 v[60:63], v[132:135], a[12:15], v[60:63]
  ds_read_b64_tr_b16 v[102:103], v5 offset:21504
  v_mfma_f32_16x16x32_bf16 v[64:67], v[136:139], a[8:11], v[64:67]
  ds_read_b64_tr_b16 v[104:105], v6 offset:17408
  ds_read_b64_tr_b16 v[106:107], v6 offset:21504
  v_mfma_f32_16x16x32_bf16 v[68:71], v[136:139], a[12:15], v[68:71]
  ds_read_b64_tr_b16 v[108:109], v7 offset:17408
  v_mfma_f32_16x16x32_bf16 v[72:75], v[140:143], a[8:11], v[72:75]
  s_add_u32 s23, s61, 1048576
  ds_read_b64_tr_b16 v[110:111], v7 offset:21504
  v_mfma_f32_16x16x32_bf16 v[76:79], v[140:143], a[12:15], v[76:79]
  buffer_load_dwordx4 a[64:67], v1, s[4:7], s23 offen offset:0 sc1
g2_s2:
  s_waitcnt vmcnt(12) lgkmcnt(8)
  v_mfma_f32_16x16x32_bf16 v[16:19], v[80:83], a[16:19], v[16:19]
  ds_read_b64_tr_b16 v[112:113], v4 offset:24576
  ds_read_b64_tr_b16 v[114:115], v4 offset:28672
  v_mfma_f32_16x16x32_bf16 v[20:23], v[80:83], a[20:23], v[20:23]
  buffer_load_dwordx4 a[68:71], v1, s[4:7], s23 offen offset:256 sc1
  v_mfma_f32_16x16x32_bf16 v[24:27], v[84:87], a[16:19], v[24:27]
  ds_read_b64_tr_b16 v[116:117], v5 offset:24576
  ds_read_b64_tr_b16 v[118:119], v5 offset:28672
  v_mfma_f32_16x16x32_bf16 v[28:31], v[84:87], a[20:23], v[28:31]
  s_add_u32 m0, s26, 98304
  v_mfma_f32_16x16x32_bf16 v[32:35], v[88:91], a[16:19], v[32:35]
  s_add_u32 s24, s19, 2752512
  ds_read_b64_tr_b16 v[120:121], v6 offset:24576
  v_mfma_f32_16x16x32_bf16 v[36:39], v[88:91], a[20:23], v[36:39]
  buffer_load_dwordx4 v3, s[8:11], s24 offen lds
  v_mfma_f32_16x16x32_bf16 v[40:43], v[92:95], a[16:19], v[40:43]
  ds_read_b64_tr_b16 v[122:123], v6 offset:28672
  ds_read_b64_tr_b16 v[124:125], v7 offset:24576
  v_mfma_f32_16x16x32_bf16 v[44:47], v[92:95], a[20:23], v[44:47]
  ds_read_b64_tr_b16 v[126:127], v7 offset:28672
  s_waitcnt lgkmcnt(8)
  v_mfma_f32_16x16x32_bf16 v[48:51], v[96:99], a[16:19], v[48:51]
  buffer_load_dwordx4 v166, s[8:11], s24 offen offset:1024 lds
  v_mfma_f32_16x16x32_bf16 v[52:55], v[96:99], a[20:23], v[52:55]
  ds_read_b64_tr_b16 v[128:129], v4 offset:25600
  ds_read_b64_tr_b16 v[130:131], v4 offset:29696
  v_mfma_f32_16x16x32_bf16 v[56:59], v[100:103], a[16:19], v[56:59]
  s_add_u32 s23, s61, 1179648
  v_mfma_f32_16x16x32_bf16 v[60:63], v[100:103], a[20:23], v[60:63]
  ds_read_b64_tr_b16 v[132:133], v5 offset:25600
  buffer_load_dwordx4 a[72:75], v1, s[4:7], s23 offen offset:0 sc1
  v_mfma_f32_16x16x32_bf16 v[64:67], v[104:107], a[16:19], v[64:67]
  ds_read_b64_tr_b16 v[134:135], v5 offset:29696
  v_mfma_f32_16x16x32_bf16 v[68:71], v[104:107], a[20:23], v[68:71]
  ds_read_b64_tr_b16 v[136:137], v6 offset:25600
  ds_read_b64_tr_b16 v[138:139], v6 offset:29696
  v_mfma_f32_16x16x32_bf16 v[72:75], v[108:111], a[16:19], v[72:75]
  ds_read_b64_tr_b16 v[140:141], v7 offset:25600
  v_mfma_f32_16x16x32_bf16 v[76:79], v[108:111], a[20:23], v[76:79]
  ds_read_b64_tr_b16 v[142:143], v7 offset:29696
g2_s3:
  s_waitcnt vmcnt(13) lgkmcnt(8)
  v_mfma_f32_16x16x32_bf16 v[16:19], v[112:115], a[24:27], v[16:19]
  s_barrier
  ds_read_b64_tr_b16 v[80:81], v4 offset:32768
  v_mfma_f32_16x16x32_bf16 v[20:23], v[112:115], a[28:31], v[20:23]
  ds_read_b64_tr_b16 v[82:83], v4 offset:36864
  v_mfma_f32_16x16x32_bf16 v[24:27], v[116:119], a[24:27], v[24:27]
  buffer_load_dwordx4 a[76:79], v1, s[4:7], s23 offen offset:256 sc1
  ds_read_b64_tr_b16 v[84:85], v5 offset:32768
  v_mfma_f32_16x16x32_bf16 v[28:31], v[116:119], a[28:31], v[28:31]
  ds_read_b64_tr_b16 v[86:87], v5 offset:36864
  v_mfma_f32_16x16x32_bf16 v[32:35], v[120:123], a[24:27], v[32:35]
  s_add_u32 m0, s26, 106496
  s_add_u32 s24, s19, 2981888
  v_mfma_f32_16x16x32_bf16 v[36:39], v[120:123], a[28:31], v[36:39]
  ds_read_b64_tr_b16 v[88:89], v6 offset:32768
  v_mfma_f32_16x16x32_bf16 v[40:43], v[124:127], a[24:27], v[40:43]
  buffer_load_dwordx4 v3, s[8:11], s24 offen lds
  ds_read_b64_tr_b16 v[90:91], v6 offset:36864
  v_mfma_f32_16x16x32_bf16 v[44:47], v[124:127], a[28:31], v[44:47]
  ds_read_b64_tr_b16 v[92:93], v7 offset:32768
  s_waitcnt lgkmcnt(7)
  v_mfma_f32_16x16x32_bf16 v[48:51], v[128:131], a[24:27], v[48:51]
  ds_read_b64_tr_b16 v[94:95], v7 offset:36864
  buffer_load_dwordx4 v166, s[8:11], s24 offen offset:1024 lds
  v_mfma_f32_16x16x32_bf16 v[52:55], v[128:131], a[28:31], v[52:55]
  ds_read_b64_tr_b16 v[96:97], v4 offset:33792
  v_mfma_f32_16x16x32_bf16 v[56:59], v[132:135], a[24:27], v[56:59]
  ds_read_b64_tr_b16 v[98:99], v4 offset:37888
  s_add_u32 s23, s61, 1310720
  v_mfma_f32_16x16x32_bf16 v[60:63], v[132:135], a[28:31], v[60:63]
  ds_read_b64_tr_b16 v[100:101], v5 offset:33792
  v_mfma_f32_16x16x32_bf16 v[64:67], v[136:139], a[24:27], v[64:67]
  buffer_load_dwordx4 a[80:83], v1, s[4:7], s23 offen offset:0 sc1
  ds_read_b64_tr_b16 v[102:103], v5 offset:37888
  v_mfma_f32_16x16x32_bf16 v[68:71], v[136:139], a[28:31], v[68:71]
  ds_read_b64_tr_b16 v[104:105], v6 offset:33792
  v_mfma_f32_16x16x32_bf16 v[72:75], v[140:143], a[24:27], v[72:75]
  ds_read_b64_tr_b16 v[106:107], v6 offset:37888
  ds_read_b64_tr_b16 v[108:109], v7 offset:33792
  v_mfma_f32_16x16x32_bf16 v[76:79], v[140:143], a[28:31], v[76:79]
  ds_read_b64_tr_b16 v[110:111], v7 offset:37888
g2_s4:
  s_waitcnt vmcnt(15) lgkmcnt(8)
  v_mfma_f32_16x16x32_bf16 v[16:19], v[80:83], a[32:35], v[16:19]
  ds_read_b64_tr_b16 v[112:113], v4 offset:40960
  ds_read_b64_tr_b16 v[114:115], v4 offset:45056
  v_mfma_f32_16x16x32_bf16 v[20:23], v[80:83], a[36:39], v[20:23]
  buffer_load_dwordx4 a[84:87], v1, s[4:7], s23 offen offset:256 sc1
  ds_read_b64_tr_b16 v[116:117], v5 offset:40960
  v_mfma_f32_16x16x32_bf16 v[24:27], v[84:87], a[32:35], v[24:27]
  ds_read_b64_tr_b16 v[118:119], v5 offset:45056
  s_add_u32 m0, s26, 114688
  v_mfma_f32_16x16x32_bf16 v[28:31], v[84:87], a[36:39], v[28:31]
  s_add_u32 s24, s19, 3211264
  v_mfma_f32_16x16x32_bf16 v[32:35], v[88:91], a[32:35], v[32:35]
  ds_read_b64_tr_b16 v[120:121], v6 offset:40960
  buffer_load_dwordx4 v3, s[8:11], s24 offen lds
  v_mfma_f32_16x16x32_bf16 v[36:39], v[88:91], a[36:39], v[36:39]
  ds_read_b64_tr_b16 v[122:123], v6 offset:45056
  ds_read_b64_tr_b16 v[124:125], v7 offset:40960
  v_mfma_f32_16x16x32_bf16 v[40:43], v[92:95], a[32:35], v[40:43]
  ds_read_b64_tr_b16 v[126:127], v7 offset:45056
  v_mfma_f32_16x16x32_bf16 v[44:47], v[92:95], a[36:39], v[44:47]
  buffer_load_dwordx4 v166, s[8:11], s24 offen offset:1024 lds
  ds_read_b64_tr_b16 v[128:129], v4 offset:41984
  s_waitcnt lgkmcnt(9)
  v_mfma_f32_16x16x32_bf16 v[48:51], v[96:99], a[32:35], v[48:51]
  ds_read_b64_tr_b16 v[130:131], v4 offset:46080
  s_add_u32 s23, s61, 1441792
  v_mfma_f32_16x16x32_bf16 v[52:55], v[96:99], a[36:39], v[52:55]
  ds_read_b64_tr_b16 v[132:133], v5 offset:41984
  v_mfma_f32_16x16x32_bf16 v[56:59], v[100:103], a[32:35], v[56:59]
  buffer_load_dwordx4 a[88:91], v1, s[4:7], s23 offen offset:0 sc1
  ds_read_b64_tr_b16 v[134:135], v5 offset:46080
  v_mfma_f32_16x16x32_bf16 v[60:63], v[100:103], a[36:39], v[60:63]
  ds_read_b64_tr_b16 v[136:137], v6 offset:41984
  ds_read_b64_tr_b16 v[138:139], v6 offset:46080
  v_mfma_f32_16x16x32_bf16 v[64:67], v[104:107], a[32:35], v[64:67]
  s_add_u32 s51, s50, g2_s10 - g2_pc
  v_mfma_f32_16x16x32_bf16 v[68:71], v[104:107], a[36:39], v[68:71]
  s_min_u32 s51, s51, code_end - g2_pc - 4
  ds_read_b64_tr_b16 v[140:141], v7 offset:41984
  v_mfma_f32_16x16x32_bf16 v[72:75], v[108:111], a[32:35], v[72:75]
  v_mov_b32 v162, s51
  global_load_dword a128, v162, s[48:49]
  v_mfma_f32_16x16x32_bf16 v[76:79], v[108:111], a[36:39], v[76:79]
  ds_read_b64_tr_b16 v[142:143], v7 offset:46080
g2_s5:
  s_waitcnt vmcnt(18) lgkmcnt(8)
  v_mfma_f32_16x16x32_bf16 v[16:19], v[112:115], a[40:43], v[16:19]
  ds_read_b64_tr_b16 v[80:81], v4 offset:49152
  ds_read_b64_tr_b16 v[82:83], v4 offset:53248
  v_mfma_f32_16x16x32_bf16 v[20:23], v[112:115], a[44:47], v[20:23]
  buffer_load_dwordx4 a[92:95], v1, s[4:7], s23 offen offset:256 sc1
  v_mfma_f32_16x16x32_bf16 v[24:27], v[116:119], a[40:43], v[24:27]
  ds_read_b64_tr_b16 v[84:85], v5 offset:49152
  ds_read_b64_tr_b16 v[86:87], v5 offset:53248
  v_mfma_f32_16x16x32_bf16 v[28:31], v[116:119], a[44:47], v[28:31]
  s_add_u32 m0, s26, 122880
  v_mfma_f32_16x16x32_bf16 v[32:35], v[120:123], a[40:43], v[32:35]
  s_add_u32 s24, s19, 3440640
  ds_read_b64_tr_b16 v[88:89], v6 offset:49152
  v_mfma_f32_16x16x32_bf16 v[36:39], v[120:123], a[44:47], v[36:39]
  buffer_load_dwordx4 v3, s[8:11], s24 offen lds
  v_mfma_f32_16x16x32_bf16 v[40:43], v[124:127], a[40:43], v[40:43]
  ds_read_b64_tr_b16 v[90:91], v6 offset:53248
  ds_read_b64_tr_b16 v[92:93], v7 offset:49152
  v_mfma_f32_16x16x32_bf16 v[44:47], v[124:127], a[44:47], v[44:47]
  ds_read_b64_tr_b16 v[94:95], v7 offset:53248
  s_waitcnt lgkmcnt(8)
  v_mfma_f32_16x16x32_bf16 v[48:51], v[128:131], a[40:43], v[48:51]
  buffer_load_dwordx4 v166, s[8:11], s24 offen offset:1024 lds
  v_mfma_f32_16x16x32_bf16 v[52:55], v[128:131], a[44:47], v[52:55]
  ds_read_b64_tr_b16 v[96:97], v4 offset:50176
  ds_read_b64_tr_b16 v[98:99], v4 offset:54272
  v_mfma_f32_16x16x32_bf16 v[56:59], v[132:135], a[40:43], v[56:59]
  s_add_u32 s23, s61, 1572864
  v_mfma_f32_16x16x32_bf16 v[60:63], v[132:135], a[44:47], v[60:63]
  ds_read_b64_tr_b16 v[100:101], v5 offset:50176
  buffer_load_dwordx4 a[96:99], v1, s[4:7], s23 offen offset:0 sc1
  v_mfma_f32_16x16x32_bf16 v[64:67], v[136:139], a[40:43], v[64:67]
  ds_read_b64_tr_b16 v[102:103], v5 offset:54272
  v_mfma_f32_16x16x32_bf16 v[68:71], v[136:139], a[44:47], v[68:71]
  ds_read_b64_tr_b16 v[104:105], v6 offset:50176
  ds_read_b64_tr_b16 v[106:107], v6 offset:54272
  v_mfma_f32_16x16x32_bf16 v[72:75], v[140:143], a[40:43], v[72:75]
  ds_read_b64_tr_b16 v[108:109], v7 offset:50176
  v_mfma_f32_16x16x32_bf16 v[76:79], v[140:143], a[44:47], v[76:79]
  ds_read_b64_tr_b16 v[110:111], v7 offset:54272
g2_s6:
  s_waitcnt vmcnt(20) lgkmcnt(8)
  v_mfma_f32_16x16x32_bf16 v[16:19], v[80:83], a[48:51], v[16:19]
  ds_read_b64_tr_b16 v[112:113], v4 offset:57344
  ds_read_b64_tr_b16 v[114:115], v4 offset:61440
  v_mfma_f32_16x16x32_bf16 v[20:23], v[80:83], a[52:55], v[20:23]
  buffer_load_dwordx4 a[100:103], v1, s[4:7], s23 offen offset:256 sc1
  v_mfma_f32_16x16x32_bf16 v[24:27], v[84:87], a[48:51], v[24:27]
  ds_read_b64_tr_b16 v[116:117], v5 offset:57344
  v_mfma_f32_16x16x32_bf16 v[28:31], v[84:87], a[52:55], v[28:31]
  ds_read_b64_tr_b16 v[118:119], v5 offset:61440
  v_mfma_f32_16x16x32_bf16 v[32:35], v[88:91], a[48:51], v[32:35]
  s_add_u32 s23, s61, 1703936
  v_mfma_f32_16x16x32_bf16 v[36:39], v[88:91], a[52:55], v[36:39]
  ds_read_b64_tr_b16 v[120:121], v6 offset:57344
  buffer_load_dwordx4 a[104:107], v1, s[4:7], s23 offen offset:0 sc1
  v_mfma_f32_16x16x32_bf16 v[40:43], v[92:95], a[48:51], v[40:43]
  ds_read_b64_tr_b16 v[122:123], v6 offset:61440
  v_mfma_f32_16x16x32_bf16 v[44:47], v[92:95], a[52:55], v[44:47]
  ds_read_b64_tr_b16 v[124:125], v7 offset:57344
  s_waitcnt lgkmcnt(7)
  v_mfma_f32_16x16x32_bf16 v[48:51], v[96:99], a[48:51], v[48:51]
  ds_read_b64_tr_b16 v[126:127], v7 offset:61440
  v_mfma_f32_16x16x32_bf16 v[52:55], v[96:99], a[52:55], v[52:55]
  ds_read_b64_tr_b16 v[128:129], v4 offset:58368
  v_mfma_f32_16x16x32_bf16 v[56:59], v[100:103], a[48:51], v[56:59]
  ds_read_b64_tr_b16 v[130:131], v4 offset:62464
  ds_read_b64_tr_b16 v[132:133], v5 offset:58368
  v_mfma_f32_16x16x32_bf16 v[60:63], v[100:103], a[52:55], v[60:63]
  ds_read_b64_tr_b16 v[134:135], v5 offset:62464
  v_mfma_f32_16x16x32_bf16 v[64:67], v[104:107], a[48:51], v[64:67]
  ds_read_b64_tr_b16 v[136:137], v6 offset:58368
  v_mfma_f32_16x16x32_bf16 v[68:71], v[104:107], a[52:55], v[68:71]
  ds_read_b64_tr_b16 v[138:139], v6 offset:62464
  v_mfma_f32_16x16x32_bf16 v[72:75], v[108:111], a[48:51], v[72:75]
  ds_read_b64_tr_b16 v[140:141], v7 offset:58368
  v_mfma_f32_16x16x32_bf16 v[76:79], v[108:111], a[52:55], v[76:79]
  ds_read_b64_tr_b16 v[142:143], v7 offset:62464
g2_s7:
  s_waitcnt vmcnt(20) lgkmcnt(8)
  v_mfma_f32_16x16x32_bf16 v[16:19], v[112:115], a[56:59], v[16:19]
  s_barrier
  ds_read_b64_tr_b16 v[80:81], v8 offset:0
  v_mfma_f32_16x16x32_bf16 v[20:23], v[112:115], a[60:63], v[20:23]
  s_add_u32 m0, s26, 0
  s_add_u32 s24, s20, 65536
  v_mfma_f32_16x16x32_bf16 v[24:27], v[116:119], a[56:59], v[24:27]
  ds_read_b64_tr_b16 v[82:83], v8 offset:4096
  v_mfma_f32_16x16x32_bf16 v[28:31], v[116:119], a[60:63], v[28:31]
  buffer_load_dwordx4 v3, s[8:11], s24 offen lds
  ds_read_b64_tr_b16 v[84:85], v9 offset:0
  v_mfma_f32_16x16x32_bf16 v[32:35], v[120:123], a[56:59], v[32:35]
  ds_read_b64_tr_b16 v[86:87], v9 offset:4096
  ds_read_b64_tr_b16 v[88:89], v10 offset:0
  v_mfma_f32_16x16x32_bf16 v[36:39], v[120:123], a[60:63], v[36:39]
  buffer_load_dwordx4 v166, s[8:11], s24 offen offset:1024 lds
  v_mfma_f32_16x16x32_bf16 v[40:43], v[124:127], a[56:59], v[40:43]
  ds_read_b64_tr_b16 v[90:91], v10 offset:4096
  ds_read_b64_tr_b16 v[92:93], v11 offset:0
  v_mfma_f32_16x16x32_bf16 v[44:47], v[124:127], a[60:63], v[44:47]
  ds_read_b64_tr_b16 v[94:95], v11 offset:4096
  s_waitcnt lgkmcnt(8)
  v_mfma_f32_16x16x32_bf16 v[48:51], v[128:131], a[56:59], v[48:51]
  buffer_load_dwordx4 a[108:111], v1, s[4:7], s23 offen offset:256 sc1
  ds_read_b64_tr_b16 v[96:97], v8 offset:1024
  v_mfma_f32_16x16x32_bf16 v[52:55], v[128:131], a[60:63], v[52:55]
  ds_read_b64_tr_b16 v[98:99], v8 offset:5120
  s_add_u32 m0, s26, 8192
  v_mfma_f32_16x16x32_bf16 v[56:59], v[132:135], a[56:59], v[56:59]
  s_add_u32 s24, s20, 131072
  v_mfma_f32_16x16x32_bf16 v[60:63], v[132:135], a[60:63], v[60:63]
  ds_read_b64_tr_b16 v[100:101], v9 offset:1024
  buffer_load_dwordx4 v3, s[8:11], s24 offen lds
  v_mfma_f32_16x16x32_bf16 v[64:67], v[136:139], a[56:59], v[64:67]
  ds_read_b64_tr_b16 v[102:103], v9 offset:5120
  ds_read_b64_tr_b16 v[104:105], v10 offset:1024
  v_mfma_f32_16x16x32_bf16 v[68:71], v[136:139], a[60:63], v[68:71]
  ds_read_b64_tr_b16 v[106:107], v10 offset:5120
  v_mfma_f32_16x16x32_bf16 v[72:75], v[140:143], a[56:59], v[72:75]
  ds_read_b64_tr_b16 v[108:109], v11 offset:1024
  ds_read_b64_tr_b16 v[110:111], v11 offset:5120
  v_mfma_f32_16x16x32_bf16 v[76:79], v[140:143], a[60:63], v[76:79]
  buffer_load_dwordx4 v166, s[8:11], s24 offen offset:1024 lds
g2_s8:
  s_waitcnt vmcnt(23) lgkmcnt(8)
  v_mfma_f32_16x16x32_bf16 v[16:19], v[80:83], a[64:67], v[16:19]
  ds_read_b64_tr_b16 v[112:113], v8 offset:8192
  s_add_u32 s23, s61, 1835008
  v_mfma_f32_16x16x32_bf16 v[20:23], v[80:83], a[68:71], v[20:23]
  ds_read_b64_tr_b16 v[114:115], v8 offset:12288
  buffer_load_dwordx4 a[112:115], v1, s[4:7], s23 offen offset:0 sc1
  v_mfma_f32_16x16x32_bf16 v[24:27], v[84:87], a[64:67], v[24:27]
  ds_read_b64_tr_b16 v[116:117], v9 offset:8192
  v_mfma_f32_16x16x32_bf16 v[28:31], v[84:87], a[68:71], v[28:31]
  ds_read_b64_tr_b16 v[118:119], v9 offset:12288
  ds_read_b64_tr_b16 v[120:121], v10 offset:8192
  v_mfma_f32_16x16x32_bf16 v[32:35], v[88:91], a[64:67], v[32:35]
  buffer_load_dwordx4 a[116:119], v1, s[4:7], s23 offen offset:256 sc1
  v_mfma_f32_16x16x32_bf16 v[36:39], v[88:91], a[68:71], v[36:39]
  ds_read_b64_tr_b16 v[122:123], v10 offset:12288
  ds_read_b64_tr_b16 v[124:125], v11 offset:8192
  v_mfma_f32_16x16x32_bf16 v[40:43], v[92:95], a[64:67], v[40:43]
  s_add_u32 m0, s26, 16384
  v_mfma_f32_16x16x32_bf16 v[44:47], v[92:95], a[68:71], v[44:47]
  s_add_u32 s24, s20, 196608
  ds_read_b64_tr_b16 v[126:127], v11 offset:12288
  s_waitcnt lgkmcnt(8)
  v_mfma_f32_16x16x32_bf16 v[48:51], v[96:99], a[64:67], v[48:51]
  buffer_load_dwordx4 v164, s[8:11], s24 offen lds
  ds_read_b64_tr_b16 v[128:129], v8 offset:9216
  v_mfma_f32_16x16x32_bf16 v[52:55], v[96:99], a[68:71], v[52:55]
  ds_read_b64_tr_b16 v[130:131], v8 offset:13312
  v_mfma_f32_16x16x32_bf16 v[56:59], v[100:103], a[64:67], v[56:59]
  ds_read_b64_tr_b16 v[132:133], v9 offset:9216
  buffer_load_dwordx4 v165, s[8:11], s24 offen offset:1024 lds
  v_mfma_f32_16x16x32_bf16 v[60:63], v[100:103], a[68:71], v[60:63]
  ds_read_b64_tr_b16 v[134:135], v9 offset:13312
  v_mfma_f32_16x16x32_bf16 v[64:67], v[104:107], a[64:67], v[64:67]
  ds_read_b64_tr_b16 v[136:137], v10 offset:9216
  ds_read_b64_tr_b16 v[138:139], v10 offset:13312
  v_mfma_f32_16x16x32_bf16 v[68:71], v[104:107], a[68:71], v[68:71]
  ds_read_b64_tr_b16 v[140:141], v11 offset:9216
  v_mfma_f32_16x16x32_bf16 v[72:75], v[108:111], a[64:67], v[72:75]
  s_add_u32 s23, s61, 1966080
  ds_read_b64_tr_b16 v[142:143], v11 offset:13312
  v_mfma_f32_16x16x32_bf16 v[76:79], v[108:111], a[68:71], v[76:79]
  buffer_load_dwordx4 a[120:123], v1, s[4:7], s23 offen offset:0 sc1
g2_s9:
  s_waitcnt vmcnt(24) lgkmcnt(8)
  v_mfma_f32_16x16x32_bf16 v[16:19], v[112:115], a[72:75], v[16:19]
  ds_read_b64_tr_b16 v[80:81], v8 offset:16384
  ds_read_b64_tr_b16 v[82:83], v8 offset:20480
  v_mfma_f32_16x16x32_bf16 v[20:23], v[112:115], a[76:79], v[20:23]
  buffer_load_dwordx4 a[124:127], v1, s[4:7], s23 offen offset:256 sc1
  v_mfma_f32_16x16x32_bf16 v[24:27], v[116:119], a[72:75], v[24:27]
  ds_read_b64_tr_b16 v[84:85], v9 offset:16384
  v_mfma_f32_16x16x32_bf16 v[28:31], v[116:119], a[76:79], v[28:31]
  ds_read_b64_tr_b16 v[86:87], v9 offset:20480
  s_add_u32 m0, s26, 24576
  v_mfma_f32_16x16x32_bf16 v[32:35], v[120:123], a[72:75], v[32:35]
  s_add_u32 s24, s20, 327680
  v_mfma_f32_16x16x32_bf16 v[36:39], v[120:123], a[76:79], v[36:39]
  ds_read_b64_tr_b16 v[88:89], v10 offset:16384
  v_mfma_f32_16x16x32_bf16 v[40:43], v[124:127], a[72:75], v[40:43]
  buffer_load_dwordx4 v3, s[8:11], s24 offen lds
  ds_read_b64_tr_b16 v[90:91], v10 offset:20480
  v_mfma_f32_16x16x32_bf16 v[44:47], v[124:127], a[76:79], v[44:47]
  ds_read_b64_tr_b16 v[92:93], v11 offset:16384
  s_waitcnt lgkmcnt(7)
  v_mfma_f32_16x16x32_bf16 v[48:51], v[128:131], a[72:75], v[48:51]
  ds_read_b64_tr_b16 v[94:95], v11 offset:20480
  v_mfma_f32_16x16x32_bf16 v[52:55], v[128:131], a[76:79], v[52:55]
  buffer_load_dwordx4 v166, s[8:11], s24 offen offset:1024 lds
  ds_read_b64_tr_b16 v[96:97], v8 offset:17408
  v_mfma_f32_16x16x32_bf16 v[56:59], v[132:135], a[72:75], v[56:59]
  ds_read_b64_tr_b16 v[98:99], v8 offset:21504
  v_mfma_f32_16x16x32_bf16 v[60:63], v[132:135], a[76:79], v[60:63]
  ds_read_b64_tr_b16 v[100:101], v9 offset:17408
  v_mfma_f32_16x16x32_bf16 v[64:67], v[136:139], a[72:75], v[64:67]
  ds_read_b64_tr_b16 v[102:103], v9 offset:21504
  ds_read_b64_tr_b16 v[104:105], v10 offset:17408
  v_mfma_f32_16x16x32_bf16 v[68:71], v[136:139], a[76:79], v[68:71]
  ds_read_b64_tr_b16 v[106:107], v10 offset:21504
  v_mfma_f32_16x16x32_bf16 v[72:75], v[140:143], a[72:75], v[72:75]
  ds_read_b64_tr_b16 v[108:109], v11 offset:17408
  v_mfma_f32_16x16x32_bf16 v[76:79], v[140:143], a[76:79], v[76:79]
  ds_read_b64_tr_b16 v[110:111], v11 offset:21504
g2_s10:
  s_waitcnt vmcnt(23) lgkmcnt(8)
  v_mfma_f32_16x16x32_bf16 v[16:19], v[80:83], a[80:83], v[16:19]
  ds_read_b64_tr_b16 v[112:113], v8 offset:24576
  v_mfma_f32_16x16x32_bf16 v[20:23], v[80:83], a[84:87], v[20:23]
  ds_read_b64_tr_b16 v[114:115], v8 offset:28672
  v_mfma_f32_16x16x32_bf16 v[24:27], v[84:87], a[80:83], v[24:27]
  ds_read_b64_tr_b16 v[116:117], v9 offset:24576
  v_mfma_f32_16x16x32_bf16 v[28:31], v[84:87], a[84:87], v[28:31]
  ds_read_b64_tr_b16 v[118:119], v9 offset:28672
  v_mfma_f32_16x16x32_bf16 v[32:35], v[88:91], a[80:83], v[32:35]
  ds_read_b64_tr_b16 v[120:121], v10 offset:24576
  v_mfma_f32_16x16x32_bf16 v[36:39], v[88:91], a[84:87], v[36:39]
  ds_read_b64_tr_b16 v[122:123], v10 offset:28672
  v_mfma_f32_16x16x32_bf16 v[40:43], v[92:95], a[80:83], v[40:43]
  ds_read_b64_tr_b16 v[124:125], v11 offset:24576
  v_mfma_f32_16x16x32_bf16 v[44:47], v[92:95], a[84:87], v[44:47]
  ds_read_b64_tr_b16 v[126:127], v11 offset:28672
  s_waitcnt lgkmcnt(8)
  v_mfma_f32_16x16x32_bf16 v[48:51], v[96:99], a[80:83], v[48:51]
  ds_read_b64_tr_b16 v[128:129], v8 offset:25600
  v_mfma_f32_16x16x32_bf16 v[52:55], v[96:99], a[84:87], v[52:55]
  ds_read_b64_tr_b16 v[130:131], v8 offset:29696
  v_mfma_f32_16x16x32_bf16 v[56:59], v[100:103], a[80:83], v[56:59]
  ds_read_b64_tr_b16 v[132:133], v9 offset:25600
  v_mfma_f32_16x16x32_bf16 v[60:63], v[100:103], a[84:87], v[60:63]
  ds_read_b64_tr_b16 v[134:135], v9 offset:29696
  v_mfma_f32_16x16x32_bf16 v[64:67], v[104:107], a[80:83], v[64:67]
  ds_read_b64_tr_b16 v[136:137], v10 offset:25600
  v_mfma_f32_16x16x32_bf16 v[68:71], v[104:107], a[84:87], v[68:71]
  ds_read_b64_tr_b16 v[138:139], v10 offset:29696
  v_mfma_f32_16x16x32_bf16 v[72:75], v[108:111], a[80:83], v[72:75]
  ds_read_b64_tr_b16 v[140:141], v11 offset:25600
  v_mfma_f32_16x16x32_bf16 v[76:79], v[108:111], a[84:87], v[76:79]
  ds_read_b64_tr_b16 v[142:143], v11 offset:29696
g2_s11:
  s_waitcnt vmcnt(16) lgkmcnt(8)
  v_mfma_f32_16x16x32_bf16 v[16:19], v[112:115], a[88:91], v[16:19]
  buffer_load_dword v168, v163, s[40:43], s53 offen sc0 sc1
  s_barrier
  v_mfma_f32_16x16x32_bf16 v[20:23], v[112:115], a[92:95], v[20:23]
  ds_read_b64_tr_b16 v[80:81], v8 offset:32768
  s_add_u32 m0, s26, 32768
  v_mfma_f32_16x16x32_bf16 v[24:27], v[116:119], a[88:91], v[24:27]
  s_add_u32 s24, s20, 393216
  v_mfma_f32_16x16x32_bf16 v[28:31], v[116:119], a[92:95], v[28:31]
  ds_read_b64_tr_b16 v[82:83], v8 offset:36864
  buffer_load_dwordx4 v3, s[8:11], s24 offen lds
  v_mfma_f32_16x16x32_bf16 v[32:35], v[120:123], a[88:91], v[32:35]
  ds_read_b64_tr_b16 v[84:85], v9 offset:32768
  ds_read_b64_tr_b16 v[86:87], v9 offset:36864
  v_mfma_f32_16x16x32_bf16 v[36:39], v[120:123], a[92:95], v[36:39]
  ds_read_b64_tr_b16 v[88:89], v10 offset:32768
  v_mfma_f32_16x16x32_bf16 v[40:43], v[124:127], a[88:91], v[40:43]
  buffer_load_dwordx4 v166, s[8:11], s24 offen offset:1024 lds
  ds_read_b64_tr_b16 v[90:91], v10 offset:36864
  v_mfma_f32_16x16x32_bf16 v[44:47], v[124:127], a[92:95], v[44:47]
  ds_read_b64_tr_b16 v[92:93], v11 offset:32768
  s_waitcnt lgkmcnt(7)
  v_mfma_f32_16x16x32_bf16 v[48:51], v[128:131], a[88:91], v[48:51]
  s_add_u32 m0, s26, 40960
  s_add_u32 s24, s20, 524288
  v_mfma_f32_16x16x32_bf16 v[52:55], v[128:131], a[92:95], v[52:55]
  ds_read_b64_tr_b16 v[94:95], v11 offset:36864
  buffer_load_dwordx4 v3, s[8:11], s24 offen lds
  v_mfma_f32_16x16x32_bf16 v[56:59], v[132:135], a[88:91], v[56:59]
  ds_read_b64_tr_b16 v[96:97], v8 offset:33792
  v_mfma_f32_16x16x32_bf16 v[60:63], v[132:135], a[92:95], v[60:63]
  ds_read_b64_tr_b16 v[98:99], v8 offset:37888
  ds_read_b64_tr_b16 v[100:101], v9 offset:33792
  v_mfma_f32_16x16x32_bf16 v[64:67], v[136:139], a[88:91], v[64:67]
  buffer_load_dwordx4 v166, s[8:11], s24 offen offset:1024 lds
  ds_read_b64_tr_b16 v[102:103], v9 offset:37888
  v_mfma_f32_16x16x32_bf16 v[68:71], v[136:139], a[92:95], v[68:71]
  ds_read_b64_tr_b16 v[104:105], v10 offset:33792
  v_mfma_f32_16x16x32_bf16 v[72:75], v[140:143], a[88:91], v[72:75]
  ds_read_b64_tr_b16 v[106:107], v10 offset:37888
  ds_read_b64_tr_b16 v[108:109], v11 offset:33792
  v_mfma_f32_16x16x32_bf16 v[76:79], v[140:143], a[92:95], v[76:79]
  ds_read_b64_tr_b16 v[110:111], v11 offset:37888
g2_s12:
  s_waitcnt vmcnt(19) lgkmcnt(8)
  v_mfma_f32_16x16x32_bf16 v[16:19], v[80:83], a[96:99], v[16:19]
  ds_read_b64_tr_b16 v[112:113], v8 offset:40960
  s_add_u32 m0, s26, 49152
  v_mfma_f32_16x16x32_bf16 v[20:23], v[80:83], a[100:103], v[20:23]
  s_add_u32 s24, s20, 589824
  v_mfma_f32_16x16x32_bf16 v[24:27], v[84:87], a[96:99], v[24:27]
  ds_read_b64_tr_b16 v[114:115], v8 offset:45056
  v_mfma_f32_16x16x32_bf16 v[28:31], v[84:87], a[100:103], v[28:31]
  buffer_load_dwordx4 v3, s[8:11], s24 offen lds
  v_mfma_f32_16x16x32_bf16 v[32:35], v[88:91], a[96:99], v[32:35]
  ds_read_b64_tr_b16 v[116:117], v9 offset:40960
  ds_read_b64_tr_b16 v[118:119], v9 offset:45056
  v_mfma_f32_16x16x32_bf16 v[36:39], v[88:91], a[100:103], v[36:39]
  ds_read_b64_tr_b16 v[120:121], v10 offset:40960
  v_mfma_f32_16x16x32_bf16 v[40:43], v[92:95], a[96:99], v[40:43]
  buffer_load_dwordx4 v166, s[8:11], s24 offen offset:1024 lds
  v_mfma_f32_16x16x32_bf16 v[44:47], v[92:95], a[100:103], v[44:47]
  ds_read_b64_tr_b16 v[122:123], v10 offset:45056
  s_waitcnt lgkmcnt(6)
  v_mfma_f32_16x16x32_bf16 v[48:51], v[96:99], a[96:99], v[48:51]
  ds_read_b64_tr_b16 v[124:125], v11 offset:40960
  ds_read_b64_tr_b16 v[126:127], v11 offset:45056
  v_mfma_f32_16x16x32_bf16 v[52:55], v[96:99], a[100:103], v[52:55]
  ds_read_b64_tr_b16 v[128:129], v8 offset:41984
  v_mfma_f32_16x16x32_bf16 v[56:59], v[100:103], a[96:99], v[56:59]
  ds_read_b64_tr_b16 v[130:131], v8 offset:46080
  v_mfma_f32_16x16x32_bf16 v[60:63], v[100:103], a[100:103], v[60:63]
  ds_read_b64_tr_b16 v[132:133], v9 offset:41984
  v_mfma_f32_16x16x32_bf16 v[64:67], v[104:107], a[96:99], v[64:67]
  ds_read_b64_tr_b16 v[134:135], v9 offset:46080
  ds_read_b64_tr_b16 v[136:137], v10 offset:41984
  v_mfma_f32_16x16x32_bf16 v[68:71], v[104:107], a[100:103], v[68:71]
  ds_read_b64_tr_b16 v[138:139], v10 offset:46080
  v_mfma_f32_16x16x32_bf16 v[72:75], v[108:111], a[96:99], v[72:75]
  ds_read_b64_tr_b16 v[140:141], v11 offset:41984
  v_mfma_f32_16x16x32_bf16 v[76:79], v[108:111], a[100:103], v[76:79]
  ds_read_b64_tr_b16 v[142:143], v11 offset:46080
g2_s13:
  s_waitcnt vmcnt(17) lgkmcnt(8)
  v_mfma_f32_16x16x32_bf16 v[16:19], v[112:115], a[104:107], v[16:19]
  ds_read_b64_tr_b16 v[80:81], v8 offset:49152
  s_add_u32 m0, s26, 57344
  v_mfma_f32_16x16x32_bf16 v[20:23], v[112:115], a[108:111], v[20:23]
  s_add_u32 s24, s20, 655360
  v_mfma_f32_16x16x32_bf16 v[24:27], v[116:119], a[104:107], v[24:27]
  ds_read_b64_tr_b16 v[82:83], v8 offset:53248
  v_mfma_f32_16x16x32_bf16 v[28:31], v[116:119], a[108:111], v[28:31]
  buffer_load_dwordx4 v164, s[8:11], s24 offen lds
  v_mfma_f32_16x16x32_bf16 v[32:35], v[120:123], a[104:107], v[32:35]
  ds_read_b64_tr_b16 v[84:85], v9 offset:49152
  ds_read_b64_tr_b16 v[86:87], v9 offset:53248
  v_mfma_f32_16x16x32_bf16 v[36:39], v[120:123], a[108:111], v[36:39]
  ds_read_b64_tr_b16 v[88:89], v10 offset:49152
  v_mfma_f32_16x16x32_bf16 v[40:43], v[124:127], a[104:107], v[40:43]
  buffer_load_dwordx4 v165, s[8:11], s24 offen offset:1024 lds
  v_mfma_f32_16x16x32_bf16 v[44:47], v[124:127], a[108:111], v[44:47]
  ds_read_b64_tr_b16 v[90:91], v10 offset:53248
  s_waitcnt lgkmcnt(6)
  v_mfma_f32_16x16x32_bf16 v[48:51], v[128:131], a[104:107], v[48:51]
  ds_read_b64_tr_b16 v[92:93], v11 offset:49152
  ds_read_b64_tr_b16 v[94:95], v11 offset:53248
  v_mfma_f32_16x16x32_bf16 v[52:55], v[128:131], a[108:111], v[52:55]
  ds_read_b64_tr_b16 v[96:97], v8 offset:50176
  v_mfma_f32_16x16x32_bf16 v[56:59], v[132:135], a[104:107], v[56:59]
  ds_read_b64_tr_b16 v[98:99], v8 offset:54272
  v_mfma_f32_16x16x32_bf16 v[60:63], v[132:135], a[108:111], v[60:63]
  ds_read_b64_tr_b16 v[100:101], v9 offset:50176
  v_mfma_f32_16x16x32_bf16 v[64:67], v[136:139], a[104:107], v[64:67]
  ds_read_b64_tr_b16 v[102:103], v9 offset:54272
  ds_read_b64_tr_b16 v[104:105], v10 offset:50176
  v_mfma_f32_16x16x32_bf16 v[68:71], v[136:139], a[108:111], v[68:71]
  ds_read_b64_tr_b16 v[106:107], v10 offset:54272
  v_mfma_f32_16x16x32_bf16 v[72:75], v[140:143], a[104:107], v[72:75]
  ds_read_b64_tr_b16 v[108:109], v11 offset:50176
  v_mfma_f32_16x16x32_bf16 v[76:79], v[140:143], a[108:111], v[76:79]
  ds_read_b64_tr_b16 v[110:111], v11 offset:54272
g2_s14:
  s_waitcnt vmcnt(15) lgkmcnt(8)
  v_mfma_f32_16x16x32_bf16 v[16:19], v[80:83], a[112:115], v[16:19]
  s_waitcnt vmcnt(8)
  s_mov_b32 s36, 0
g2_w2:
  v_cmp_ne_u32 vcc, 1, v168
  s_cbranch_vccz g2_w2d
  buffer_load_dword v168, v163, s[40:43], s53 offen sc0 sc1
  s_add_u32 s36, s36, 1
  s_cmp_lt_u32 s36, 0x40000
  s_waitcnt vmcnt(0)
  s_cbranch_scc1 g2_w2
g2_w2d:
  v_mfma_f32_16x16x32_bf16 v[20:23], v[80:83], a[116:119], v[20:23]
  ds_read_b64_tr_b16 v[112:113], v8 offset:57344
  s_add_u32 s23, s62, 4194304
  v_mfma_f32_16x16x32_bf16 v[24:27], v[84:87], a[112:115], v[24:27]
  ds_read_b64_tr_b16 v[114:115], v8 offset:61440
  v_mfma_f32_16x16x32_bf16 v[28:31], v[84:87], a[116:119], v[28:31]
  buffer_load_dwordx4 a[0:3], v1, s[4:7], s23 offen offset:0 sc1
  ds_read_b64_tr_b16 v[116:117], v9 offset:57344
  v_mfma_f32_16x16x32_bf16 v[32:35], v[88:91], a[112:115], v[32:35]
  ds_read_b64_tr_b16 v[118:119], v9 offset:61440
  ds_read_b64_tr_b16 v[120:121], v10 offset:57344
  v_mfma_f32_16x16x32_bf16 v[36:39], v[88:91], a[116:119], v[36:39]
  buffer_load_dwordx4 a[4:7], v1, s[4:7], s23 offen offset:256 sc1
  v_mfma_f32_16x16x32_bf16 v[40:43], v[92:95], a[112:115], v[40:43]
  ds_read_b64_tr_b16 v[122:123], v10 offset:61440
  ds_read_b64_tr_b16 v[124:125], v11 offset:57344
  v_mfma_f32_16x16x32_bf16 v[44:47], v[92:95], a[116:119], v[44:47]
  s_add_u32 s23, s62, 4325376
  s_waitcnt lgkmcnt(7)
  v_mfma_f32_16x16x32_bf16 v[48:51], v[96:99], a[112:115], v[48:51]
  ds_read_b64_tr_b16 v[126:127], v11 offset:61440
  buffer_load_dwordx4 a[8:11], v1, s[4:7], s23 offen offset:0 sc1
  v_mfma_f32_16x16x32_bf16 v[52:55], v[96:99], a[116:119], v[52:55]
  ds_read_b64_tr_b16 v[128:129], v8 offset:58368
  ds_read_b64_tr_b16 v[130:131], v8 offset:62464
  v_mfma_f32_16x16x32_bf16 v[56:59], v[100:103], a[112:115], v[56:59]
  ds_read_b64_tr_b16 v[132:133], v9 offset:58368
  v_mfma_f32_16x16x32_bf16 v[60:63], v[100:103], a[116:119], v[60:63]
  buffer_load_dwordx4 a[12:15], v1, s[4:7], s23 offen offset:256 sc1
  ds_read_b64_tr_b16 v[134:135], v9 offset:62464
  v_mfma_f32_16x16x32_bf16 v[64:67], v[104:107], a[112:115], v[64:67]
  ds_read_b64_tr_b16 v[136:137], v10 offset:58368
  ds_read_b64_tr_b16 v[138:139], v10 offset:62464
  v_mfma_f32_16x16x32_bf16 v[68:71], v[104:107], a[116:119], v[68:71]
  ds_read_b64_tr_b16 v[140:141], v11 offset:58368
  v_mfma_f32_16x16x32_bf16 v[72:75], v[108:111], a[112:115], v[72:75]
  s_add_u32 s23, s62, 4456448
  ds_read_b64_tr_b16 v[142:143], v11 offset:62464
  v_mfma_f32_16x16x32_bf16 v[76:79], v[108:111], a[116:119], v[76:79]
  buffer_load_dwordx4 a[16:19], v1, s[4:7], s23 offen offset:0 sc1
g2_s15:
  s_waitcnt vmcnt(14) lgkmcnt(8)
  v_mfma_f32_16x16x32_bf16 v[16:19], v[112:115], a[120:123], v[16:19]
  s_barrier
  ds_read_b64_tr_b16 v[80:81], v4 offset:0
  v_mfma_f32_16x16x32_bf16 v[20:23], v[112:115], a[124:127], v[20:23]
  ds_read_b64_tr_b16 v[82:83], v4 offset:4096
  v_mfma_f32_16x16x32_bf16 v[24:27], v[116:119], a[120:123], v[24:27]
  buffer_load_dwordx4 a[20:23], v1, s[4:7], s23 offen offset:256 sc1
  ds_read_b64_tr_b16 v[84:85], v5 offset:0
  v_mfma_f32_16x16x32_bf16 v[28:31], v[116:119], a[124:127], v[28:31]
  ds_read_b64_tr_b16 v[86:87], v5 offset:4096
  v_mfma_f32_16x16x32_bf16 v[32:35], v[120:123], a[120:123], v[32:35]
  s_add_u32 s23, s62, 4587520
  ds_read_b64_tr_b16 v[88:89], v6 offset:0
  v_mfma_f32_16x16x32_bf16 v[36:39], v[120:123], a[124:127], v[36:39]
  buffer_load_dwordx4 a[24:27], v1, s[4:7], s23 offen offset:0 sc1
  v_mfma_f32_16x16x32_bf16 v[40:43], v[124:127], a[120:123], v[40:43]
  ds_read_b64_tr_b16 v[90:91], v6 offset:4096
  ds_read_b64_tr_b16 v[92:93], v7 offset:0
  v_mfma_f32_16x16x32_bf16 v[44:47], v[124:127], a[124:127], v[44:47]
  ds_read_b64_tr_b16 v[94:95], v7 offset:4096
  s_waitcnt lgkmcnt(8)
  v_mfma_f32_16x16x32_bf16 v[48:51], v[128:131], a[120:123], v[48:51]
  buffer_load_dwordx4 a[28:31], v1, s[4:7], s23 offen offset:256 sc1
  ds_read_b64_tr_b16 v[96:97], v4 offset:1024
  v_mfma_f32_16x16x32_bf16 v[52:55], v[128:131], a[124:127], v[52:55]
  ds_read_b64_tr_b16 v[98:99], v4 offset:5120
  v_mfma_f32_16x16x32_bf16 v[56:59], v[132:135], a[120:123], v[56:59]
  s_add_u32 s23, s62, 4718592
  ds_read_b64_tr_b16 v[100:101], v5 offset:1024
  v_mfma_f32_16x16x32_bf16 v[60:63], v[132:135], a[124:127], v[60:63]
  buffer_load_dwordx4 a[32:35], v1, s[4:7], s23 offen offset:0 sc1
  v_mfma_f32_16x16x32_bf16 v[64:67], v[136:139], a[120:123], v[64:67]
  ds_read_b64_tr_b16 v[102:103], v5 offset:5120
  ds_read_b64_tr_b16 v[104:105], v6 offset:1024
  v_mfma_f32_16x16x32_bf16 v[68:71], v[136:139], a[124:127], v[68:71]
  ds_read_b64_tr_b16 v[106:107], v6 offset:5120
  v_mfma_f32_16x16x32_bf16 v[72:75], v[140:143], a[120:123], v[72:75]
  ds_read_b64_tr_b16 v[108:109], v7 offset:1024
  ds_read_b64_tr_b16 v[110:111], v7 offset:5120
  v_mfma_f32_16x16x32_bf16 v[76:79], v[140:143], a[124:127], v[76:79]
  buffer_load_dwordx4 a[36:39], v1, s[4:7], s23 offen offset:256 sc1
g2_s16:
  s_waitcnt vmcnt(8) lgkmcnt(8)
  v_mfma_f32_16x16x32_bf16 v[16:19], v[80:83], a[0:3], v[16:19]
  ds_read_b64_tr_b16 v[112:113], v4 offset:8192
  s_add_u32 m0, s26, 65536
  v_mfma_f32_16x16x32_bf16 v[20:23], v[80:83], a[4:7], v[20:23]
  s_add_u32 s24, s20, 786432
  ds_read_b64_tr_b16 v[114:115], v4 offset:12288
  v_mfma_f32_16x16x32_bf16 v[24:27], v[84:87], a[0:3], v[24:27]
  buffer_load_dwordx4 v3, s[8:11], s24 offen lds
  ds_read_b64_tr_b16 v[116:117], v5 offset:8192
  v_mfma_f32_16x16x32_bf16 v[28:31], v[84:87], a[4:7], v[28:31]
  ds_read_b64_tr_b16 v[118:119], v5 offset:12288
  ds_read_b64_tr_b16 v[120:121], v6 offset:8192
  v_mfma_f32_16x16x32_bf16 v[32:35], v[88:91], a[0:3], v[32:35]
  buffer_load_dwordx4 v166, s[8:11], s24 offen offset:1024 lds
  ds_read_b64_tr_b16 v[122:123], v6 offset:12288
  v_mfma_f32_16x16x32_bf16 v[36:39], v[88:91], a[4:7], v[36:39]
  ds_read_b64_tr_b16 v[124:125], v7 offset:8192
  s_add_u32 s23, s62, 4849664
  v_mfma_f32_16x16x32_bf16 v[40:43], v[92:95], a[0:3], v[40:43]
  ds_read_b64_tr_b16 v[126:127], v7 offset:12288
  buffer_load_dwordx4 a[40:43], v1, s[4:7], s23 offen offset:0 sc1
  v_mfma_f32_16x16x32_bf16 v[44:47], v[92:95], a[4:7], v[44:47]
  ds_read_b64_tr_b16 v[128:129], v4 offset:9216
  s_waitcnt lgkmcnt(9)
  v_mfma_f32_16x16x32_bf16 v[48:51], v[96:99], a[0:3], v[48:51]
  ds_read_b64_tr_b16 v[130:131], v4 offset:13312
  ds_read_b64_tr_b16 v[132:133], v5 offset:9216
  v_mfma_f32_16x16x32_bf16 v[52:55], v[96:99], a[4:7], v[52:55]
  buffer_load_dwordx4 a[44:47], v1, s[4:7], s23 offen offset:256 sc1
  ds_read_b64_tr_b16 v[134:135], v5 offset:13312
  v_mfma_f32_16x16x32_bf16 v[56:59], v[100:103], a[0:3], v[56:59]
  ds_read_b64_tr_b16 v[136:137], v6 offset:9216
  ds_read_b64_tr_b16 v[138:139], v6 offset:13312
  v_mfma_f32_16x16x32_bf16 v[60:63], v[100:103], a[4:7], v[60:63]
  s_add_u32 s51, s50, g2_s24 - g2_pc
  s_min_u32 s51, s51, code_end - g2_pc - 4
  v_mfma_f32_16x16x32_bf16 v[64:67], v[104:107], a[0:3], v[64:67]
  ds_read_b64_tr_b16 v[140:141], v7 offset:9216
  v_mov_b32 v162, s51
  v_mfma_f32_16x16x32_bf16 v[68:71], v[104:107], a[4:7], v[68:71]
  global_load_dword a128, v162, s[48:49]
  s_add_u32 m0, s26, 73728
  v_mfma_f32_16x16x32_bf16 v[72:75], v[108:111], a[0:3], v[72:75]
  s_add_u32 s24, s20, 851968
  ds_read_b64_tr_b16 v[142:143], v7 offset:13312
  v_mfma_f32_16x16x32_bf16 v[76:79], v[108:111], a[4:7], v[76:79]
  buffer_load_dwordx4 v3, s[8:11], s24 offen lds
g2_s17:
  s_waitcnt vmcnt(12) lgkmcnt(8)
  v_mfma_f32_16x16x32_bf16 v[16:19], v[112:115], a[8:11], v[16:19]
  ds_read_b64_tr_b16 v[80:81], v4 offset:16384
  ds_read_b64_tr_b16 v[82:83], v4 offset:20480
  v_mfma_f32_16x16x32_bf16 v[20:23], v[112:115], a[12:15], v[20:23]
  buffer_load_dwordx4 v166, s[8:11], s24 offen offset:1024 lds
  v_mfma_f32_16x16x32_bf16 v[24:27], v[116:119], a[8:11], v[24:27]
  ds_read_b64_tr_b16 v[84:85], v5 offset:16384
  ds_read_b64_tr_b16 v[86:87], v5 offset:20480
  v_mfma_f32_16x16x32_bf16 v[28:31], v[116:119], a[12:15], v[28:31]
  s_add_u32 s23, s62, 4980736
  v_mfma_f32_16x16x32_bf16 v[32:35], v[120:123], a[8:11], v[32:35]
  ds_read_b64_tr_b16 v[88:89], v6 offset:16384
  buffer_load_dwordx4 a[48:51], v1, s[4:7], s23 offen offset:0 sc1
  v_mfma_f32_16x16x32_bf16 v[36:39], v[120:123], a[12:15], v[36:39]
  ds_read_b64_tr_b16 v[90:91], v6 offset:20480
  v_mfma_f32_16x16x32_bf16 v[40:43], v[124:127], a[8:11], v[40:43]
  ds_read_b64_tr_b16 v[92:93], v7 offset:16384
  ds_read_b64_tr_b16 v[94:95], v7 offset:20480
  v_mfma_f32_16x16x32_bf16 v[44:47], v[124:127], a[12:15], v[44:47]
  buffer_load_dwordx4 a[52:55], v1, s[4:7], s23 offen offset:256 sc1
  s_waitcnt lgkmcnt(8)
  v_mfma_f32_16x16x32_bf16 v[48:51], v[128:131], a[8:11], v[48:51]
  ds_read_b64_tr_b16 v[96:97], v4 offset:17408
  ds_read_b64_tr_b16 v[98:99], v4 offset:21504
  v_mfma_f32_16x16x32_bf16 v[52:55], v[128:131], a[12:15], v[52:55]
  s_add_u32 m0, s26, 81920
  v_mfma_f32_16x16x32_bf16 v[56:59], v[132:135], a[8:11], v[56:59]
  s_add_u32 s24, s20, 983040
  ds_read_b64_tr_b16 v[100:101], v5 offset:17408
  v_mfma_f32_16x16x32_bf16 v[60:63], v[132:135], a[12:15], v[60:63]
  buffer_load_dwordx4 v3, s[8:11], s24 offen lds
  v_mfma_f32_16x16x32_bf16 v[64:67], v[136:139], a[8:11], v[64:67]
  ds_read_b64_tr_b16 v[102:103], v5 offset:21504
  ds_read_b64_tr_b16 v[104:105], v6 offset:17408
  v_mfma_f32_16x16x32_bf16 v[68:71], v[136:139], a[12:15], v[68:71]
  ds_read_b64_tr_b16 v[106:107], v6 offset:21504
  v_mfma_f32_16x16x32_bf16 v[72:75], v[140:143], a[8:11], v[72:75]
  ds_read_b64_tr_b16 v[108:109], v7 offset:17408
  ds_read_b64_tr_b16 v[110:111], v7 offset:21504
  v_mfma_f32_16x16x32_bf16 v[76:79], v[140:143], a[12:15], v[76:79]
  buffer_load_dwordx4 v166, s[8:11], s24 offen offset:1024 lds
g2_s18:
  s_waitcnt vmcnt(15) lgkmcnt(8)
  v_mfma_f32_16x16x32_bf16 v[16:19], v[80:83], a[16:19], v[16:19]
  ds_read_b64_tr_b16 v[112:113], v4 offset:24576
  s_add_u32 s23, s62, 5111808
  v_mfma_f32_16x16x32_bf16 v[20:23], v[80:83], a[20:23], v[20:23]
  ds_read_b64_tr_b16 v[114:115], v4 offset:28672
  buffer_load_dwordx4 a[56:59], v1, s[4:7], s23 offen offset:0 sc1
  v_mfma_f32_16x16x32_bf16 v[24:27], v[84:87], a[16:19], v[24:27]
  ds_read_b64_tr_b16 v[116:117], v5 offset:24576
  v_mfma_f32_16x16x32_bf16 v[28:31], v[84:87], a[20:23], v[28:31]
  ds_read_b64_tr_b16 v[118:119], v5 offset:28672
  ds_read_b64_tr_b16 v[120:121], v6 offset:24576
  v_mfma_f32_16x16x32_bf16 v[32:35], v[88:91], a[16:19], v[32:35]
  buffer_load_dwordx4 a[60:63], v1, s[4:7], s23 offen offset:256 sc1
  v_mfma_f32_16x16x32_bf16 v[36:39], v[88:91], a[20:23], v[36:39]
  ds_read_b64_tr_b16 v[122:123], v6 offset:28672
  ds_read_b64_tr_b16 v[124:125], v7 offset:24576
  v_mfma_f32_16x16x32_bf16 v[40:43], v[92:95], a[16:19], v[40:43]
  s_add_u32 m0, s26, 90112
  v_mfma_f32_16x16x32_bf16 v[44:47], v[92:95], a[20:23], v[44:47]
  s_add_u32 s24, s20, 1048576
  ds_read_b64_tr_b16 v[126:127], v7 offset:28672
  s_waitcnt lgkmcnt(8)
  v_mfma_f32_16x16x32_bf16 v[48:51], v[96:99], a[16:19], v[48:51]
  buffer_load_dwordx4 v3, s[8:11], s24 offen lds
  ds_read_b64_tr_b16 v[128:129], v4 offset:25600
  v_mfma_f32_16x16x32_bf16 v[52:55], v[96:99], a[20:23], v[52:55]
  ds_read_b64_tr_b16 v[130:131], v4 offset:29696
  v_mfma_f32_16x16x32_bf16 v[56:59], v[100:103], a[16:19], v[56:59]
  ds_read_b64_tr_b16 v[132:133], v5 offset:25600
  buffer_load_dwordx4 v166, s[8:11], s24 offen offset:1024 lds
  v_mfma_f32_16x16x32_bf16 v[60:63], v[100:103], a[20:23], v[60:63]
  ds_read_b64_tr_b16 v[134:135], v5 offset:29696
  v_mfma_f32_16x16x32_bf16 v[64:67], v[104:107], a[16:19], v[64:67]
  ds_read_b64_tr_b16 v[136:137], v6 offset:25600
  ds_read_b64_tr_b16 v[138:139], v6 offset:29696
  v_mfma_f32_16x16x32_bf16 v[68:71], v[104:107], a[20:23], v[68:71]
  ds_read_b64_tr_b16 v[140:141], v7 offset:25600
  v_mfma_f32_16x16x32_bf16 v[72:75], v[108:111], a[16:19], v[72:75]
  s_add_u32 s23, s62, 5242880
  ds_read_b64_tr_b16 v[142:143], v7 offset:29696
  v_mfma_f32_16x16x32_bf16 v[76:79], v[108:111], a[20:23], v[76:79]
  buffer_load_dwordx4 a[64:67], v1, s[4:7], s23 offen offset:0 sc1
g2_s19:
  s_waitcnt vmcnt(18) lgkmcnt(8)
  v_mfma_f32_16x16x32_bf16 v[16:19], v[112:115], a[24:27], v[16:19]
  s_barrier
  ds_read_b64_tr_b16 v[80:81], v4 offset:32768
  v_mfma_f32_16x16x32_bf16 v[20:23], v[112:115], a[28:31], v[20:23]
  ds_read_b64_tr_b16 v[82:83], v4 offset:36864
  buffer_load_dwordx4 a[68:71], v1, s[4:7], s23 offen offset:256 sc1
  v_mfma_f32_16x16x32_bf16 v[24:27], v[116:119], a[24:27], v[24:27]
  ds_read_b64_tr_b16 v[84:85], v5 offset:32768
  v_mfma_f32_16x16x32_bf16 v[28:31], v[116:119], a[28:31], v[28:31]
  ds_read_b64_tr_b16 v[86:87], v5 offset:36864
  s_add_u32 m0, s26, 98304
  v_mfma_f32_16x16x32_bf16 v[32:35], v[120:123], a[24:27], v[32:35]
  s_add_u32 s24, s20, 1114112
  v_mfma_f32_16x16x32_bf16 v[36:39], v[120:123], a[28:31], v[36:39]
  ds_read_b64_tr_b16 v[88:89], v6 offset:32768
  buffer_load_dwordx4 v164, s[8:11], s24 offen lds
  v_mfma_f32_16x16x32_bf16 v[40:43], v[124:127], a[24:27], v[40:43]
  ds_read_b64_tr_b16 v[90:91], v6 offset:36864
  v_mfma_f32_16x16x32_bf16 v[44:47], v[124:127], a[28:31], v[44:47]
  ds_read_b64_tr_b16 v[92:93], v7 offset:32768
  ds_read_b64_tr_b16 v[94:95], v7 offset:36864
  s_waitcnt lgkmcnt(8)
  v_mfma_f32_16x16x32_bf16 v[48:51], v[128:131], a[24:27], v[48:51]
  buffer_load_dwordx4 v165, s[8:11], s24 offen offset:1024 lds
  ds_read_b64_tr_b16 v[96:97], v4 offset:33792
  v_mfma_f32_16x16x32_bf16 v[52:55], v[128:131], a[28:31], v[52:55]
  ds_read_b64_tr_b16 v[98:99], v4 offset:37888
  v_mfma_f32_16x16x32_bf16 v[56:59], v[132:135], a[24:27], v[56:59]
  s_add_u32 s23, s62, 5373952
  ds_read_b64_tr_b16 v[100:101], v5 offset:33792
  v_mfma_f32_16x16x32_bf16 v[60:63], v[132:135], a[28:31], v[60:63]
  buffer_load_dwordx4 a[72:75], v1, s[4:7], s23 offen offset:0 sc1
  v_mfma_f32_16x16x32_bf16 v[64:67], v[136:139], a[24:27], v[64:67]
  ds_read_b64_tr_b16 v[102:103], v5 offset:37888
  ds_read_b64_tr_b16 v[104:105], v6 offset:33792
  v_mfma_f32_16x16x32_bf16 v[68:71], v[136:139], a[28:31], v[68:71]
  ds_read_b64_tr_b16 v[106:107], v6 offset:37888
  v_mfma_f32_16x16x32_bf16 v[72:75], v[140:143], a[24:27], v[72:75]
  ds_read_b64_tr_b16 v[108:109], v7 offset:33792
  ds_read_b64_tr_b16 v[110:111], v7 offset:37888
  v_mfma_f32_16x16x32_bf16 v[76:79], v[140:143], a[28:31], v[76:79]
  buffer_load_dwordx4 a[76:79], v1, s[4:7], s23 offen offset:256 sc1
g2_s20:
  s_waitcnt vmcnt(21) lgkmcnt(8)
  v_mfma_f32_16x16x32_bf16 v[16:19], v[80:83], a[32:35], v[16:19]
  ds_read_b64_tr_b16 v[112:113], v4 offset:40960
  s_add_u32 m0, s26, 106496
  v_mfma_f32_16x16x32_bf16 v[20:23], v[80:83], a[36:39], v[20:23]
  s_add_u32 s24, s20, 1245184
  ds_read_b64_tr_b16 v[114:115], v4 offset:45056
  v_mfma_f32_16x16x32_bf16 v[24:27], v[84:87], a[32:35], v[24:27]
  buffer_load_dwordx4 v3, s[8:11], s24 offen lds
  v_mfma_f32_16x16x32_bf16 v[28:31], v[84:87], a[36:39], v[28:31]
  ds_read_b64_tr_b16 v[116:117], v5 offset:40960
  ds_read_b64_tr_b16 v[118:119], v5 offset:45056
  v_mfma_f32_16x16x32_bf16 v[32:35], v[88:91], a[32:35], v[32:35]
  ds_read_b64_tr_b16 v[120:121], v6 offset:40960
  buffer_load_dwordx4 v166, s[8:11], s24 offen offset:1024 lds
  v_mfma_f32_16x16x32_bf16 v[36:39], v[88:91], a[36:39], v[36:39]
  ds_read_b64_tr_b16 v[122:123], v6 offset:45056
  v_mfma_f32_16x16x32_bf16 v[40:43], v[92:95], a[32:35], v[40:43]
  ds_read_b64_tr_b16 v[124:125], v7 offset:40960
  s_add_u32 s23, s62, 5505024
  v_mfma_f32_16x16x32_bf16 v[44:47], v[92:95], a[36:39], v[44:47]
  ds_read_b64_tr_b16 v[126:127], v7 offset:45056
  s_waitcnt lgkmcnt(8)
  v_mfma_f32_16x16x32_bf16 v[48:51], v[96:99], a[32:35], v[48:51]
  buffer_load_dwordx4 a[80:83], v1, s[4:7], s23 offen offset:0 sc1
  ds_read_b64_tr_b16 v[128:129], v4 offset:41984
  v_mfma_f32_16x16x32_bf16 v[52:55], v[96:99], a[36:39], v[52:55]
  ds_read_b64_tr_b16 v[130:131], v4 offset:46080
  ds_read_b64_tr_b16 v[132:133], v5 offset:41984
  v_mfma_f32_16x16x32_bf16 v[56:59], v[100:103], a[32:35], v[56:59]
  buffer_load_dwordx4 a[84:87], v1, s[4:7], s23 offen offset:256 sc1
  v_mfma_f32_16x16x32_bf16 v[60:63], v[100:103], a[36:39], v[60:63]
  ds_read_b64_tr_b16 v[134:135], v5 offset:46080
  ds_read_b64_tr_b16 v[136:137], v6 offset:41984
  v_mfma_f32_16x16x32_bf16 v[64:67], v[104:107], a[32:35], v[64:67]
  ds_read_b64_tr_b16 v[138:139], v6 offset:46080
  ds_read_b64_tr_b16 v[140:141], v7 offset:41984
  v_mfma_f32_16x16x32_bf16 v[68:71], v[104:107], a[36:39], v[68:71]
  s_add_u32 m0, s26, 114688
  v_mfma_f32_16x16x32_bf16 v[72:75], v[108:111], a[32:35], v[72:75]
  s_add_u32 s24, s20, 1310720
  ds_read_b64_tr_b16 v[142:143], v7 offset:46080
  v_mfma_f32_16x16x32_bf16 v[76:79], v[108:111], a[36:39], v[76:79]
  buffer_load_dwordx4 v3, s[8:11], s24 offen lds
g2_s21:
  s_waitcnt vmcnt(22) lgkmcnt(8)
  v_mfma_f32_16x16x32_bf16 v[16:19], v[112:115], a[40:43], v[16:19]
  ds_read_b64_tr_b16 v[80:81], v4 offset:49152
  ds_read_b64_tr_b16 v[82:83], v4 offset:53248
  v_mfma_f32_16x16x32_bf16 v[20:23], v[112:115], a[44:47], v[20:23]
  buffer_load_dwordx4 v166, s[8:11], s24 offen offset:1024 lds
  v_mfma_f32_16x16x32_bf16 v[24:27], v[116:119], a[40:43], v[24:27]
  ds_read_b64_tr_b16 v[84:85], v5 offset:49152
  ds_read_b64_tr_b16 v[86:87], v5 offset:53248
  v_mfma_f32_16x16x32_bf16 v[28:31], v[116:119], a[44:47], v[28:31]
  s_add_u32 s23, s62, 5636096
  v_mfma_f32_16x16x32_bf16 v[32:35], v[120:123], a[40:43], v[32:35]
  ds_read_b64_tr_b16 v[88:89], v6 offset:49152
  buffer_load_dwordx4 a[88:91], v1, s[4:7], s23 offen offset:0 sc1
  v_mfma_f32_16x16x32_bf16 v[36:39], v[120:123], a[44:47], v[36:39]
  ds_read_b64_tr_b16 v[90:91], v6 offset:53248
  v_mfma_f32_16x16x32_bf16 v[40:43], v[124:127], a[40:43], v[40:43]
  ds_read_b64_tr_b16 v[92:93], v7 offset:49152
  ds_read_b64_tr_b16 v[94:95], v7 offset:53248
  v_mfma_f32_16x16x32_bf16 v[44:47], v[124:127], a[44:47], v[44:47]
  buffer_load_dwordx4 a[92:95], v1, s[4:7], s23 offen offset:256 sc1
  s_waitcnt lgkmcnt(8)
  v_mfma_f32_16x16x32_bf16 v[48:51], v[128:131], a[40:43], v[48:51]
  ds_read_b64_tr_b16 v[96:97], v4 offset:50176
  ds_read_b64_tr_b16 v[98:99], v4 offset:54272
  v_mfma_f32_16x16x32_bf16 v[52:55], v[128:131], a[44:47], v[52:55]
  s_add_u32 m0, s26, 122880
  v_mfma_f32_16x16x32_bf16 v[56:59], v[132:135], a[40:43], v[56:59]
  s_add_u32 s24, s20, 1441792
  ds_read_b64_tr_b16 v[100:101], v5 offset:50176
  v_mfma_f32_16x16x32_bf16 v[60:63], v[132:135], a[44:47], v[60:63]
  buffer_load_dwordx4 v3, s[8:11], s24 offen lds
  v_mfma_f32_16x16x32_bf16 v[64:67], v[136:139], a[40:43], v[64:67]
  ds_read_b64_tr_b16 v[102:103], v5 offset:54272
  ds_read_b64_tr_b16 v[104:105], v6 offset:50176
  v_mfma_f32_16x16x32_bf16 v[68:71], v[136:139], a[44:47], v[68:71]
  ds_read_b64_tr_b16 v[106:107], v6 offset:54272
  v_mfma_f32_16x16x32_bf16 v[72:75], v[140:143], a[40:43], v[72:75]
  ds_read_b64_tr_b16 v[108:109], v7 offset:50176
  ds_read_b64_tr_b16 v[110:111], v7 offset:54272
  v_mfma_f32_16x16x32_bf16 v[76:79], v[140:143], a[44:47], v[76:79]
  buffer_load_dwordx4 v166, s[8:11], s24 offen offset:1024 lds
g2_s22:
  s_waitcnt vmcnt(22) lgkmcnt(8)
  v_mfma_f32_16x16x32_bf16 v[16:19], v[80:83], a[48:51], v[16:19]
  ds_read_b64_tr_b16 v[112:113], v4 offset:57344
  s_add_u32 s23, s62, 5767168
  v_mfma_f32_16x16x32_bf16 v[20:23], v[80:83], a[52:55], v[20:23]
  ds_read_b64_tr_b16 v[114:115], v4 offset:61440
  v_mfma_f32_16x16x32_bf16 v[24:27], v[84:87], a[48:51], v[24:27]
  buffer_load_dwordx4 a[96:99], v1, s[4:7], s23 offen offset:0 sc1
  v_mfma_f32_16x16x32_bf16 v[28:31], v[84:87], a[52:55], v[28:31]
  ds_read_b64_tr_b16 v[116:117], v5 offset:57344
  ds_read_b64_tr_b16 v[118:119], v5 offset:61440
  v_mfma_f32_16x16x32_bf16 v[32:35], v[88:91], a[48:51], v[32:35]
  ds_read_b64_tr_b16 v[120:121], v6 offset:57344
  v_mfma_f32_16x16x32_bf16 v[36:39], v[88:91], a[52:55], v[36:39]
  buffer_load_dwordx4 a[100:103], v1, s[4:7], s23 offen offset:256 sc1
  v_mfma_f32_16x16x32_bf16 v[40:43], v[92:95], a[48:51], v[40:43]
  ds_read_b64_tr_b16 v[122:123], v6 offset:61440
  ds_read_b64_tr_b16 v[124:125], v7 offset:57344
  v_mfma_f32_16x16x32_bf16 v[44:47], v[92:95], a[52:55], v[44:47]
  s_add_u32 s23, s62, 5898240
  s_waitcnt lgkmcnt(7)
  v_mfma_f32_16x16x32_bf16 v[48:51], v[96:99], a[48:51], v[48:51]
  ds_read_b64_tr_b16 v[126:127], v7 offset:61440
  v_mfma_f32_16x16x32_bf16 v[52:55], v[96:99], a[52:55], v[52:55]
  buffer_load_dwordx4 a[104:107], v1, s[4:7], s23 offen offset:0 sc1
  ds_read_b64_tr_b16 v[128:129], v4 offset:58368
  v_mfma_f32_16x16x32_bf16 v[56:59], v[100:103], a[48:51], v[56:59]
  ds_read_b64_tr_b16 v[130:131], v4 offset:62464
  v_mfma_f32_16x16x32_bf16 v[60:63], v[100:103], a[52:55], v[60:63]
  ds_read_b64_tr_b16 v[132:133], v5 offset:58368
  v_mfma_f32_16x16x32_bf16 v[64:67], v[104:107], a[48:51], v[64:67]
  ds_read_b64_tr_b16 v[134:135], v5 offset:62464
  ds_read_b64_tr_b16 v[136:137], v6 offset:58368
  v_mfma_f32_16x16x32_bf16 v[68:71], v[104:107], a[52:55], v[68:71]
  ds_read_b64_tr_b16 v[138:139], v6 offset:62464
  v_mfma_f32_16x16x32_bf16 v[72:75], v[108:111], a[48:51], v[72:75]
  ds_read_b64_tr_b16 v[140:141], v7 offset:58368
  v_mfma_f32_16x16x32_bf16 v[76:79], v[108:111], a[52:55], v[76:79]
  ds_read_b64_tr_b16 v[142:143], v7 offset:62464
g2_s23:
  s_waitcnt vmcnt(19) lgkmcnt(8)
  v_mfma_f32_16x16x32_bf16 v[16:19], v[112:115], a[56:59], v[16:19]
  s_barrier
  ds_read_b64_tr_b16 v[80:81], v8 offset:0
  v_mfma_f32_16x16x32_bf16 v[20:23], v[112:115], a[60:63], v[20:23]
  s_add_u32 m0, s26, 0
  s_add_u32 s24, s20, 1507328
  v_mfma_f32_16x16x32_bf16 v[24:27], v[116:119], a[56:59], v[24:27]
  ds_read_b64_tr_b16 v[82:83], v8 offset:4096
  v_mfma_f32_16x16x32_bf16 v[28:31], v[116:119], a[60:63], v[28:31]
  buffer_load_dwordx4 v3, s[8:11], s24 offen lds
  ds_read_b64_tr_b16 v[84:85], v9 offset:0
  v_mfma_f32_16x16x32_bf16 v[32:35], v[120:123], a[56:59], v[32:35]
  ds_read_b64_tr_b16 v[86:87], v9 offset:4096
  ds_read_b64_tr_b16 v[88:89], v10 offset:0
  v_mfma_f32_16x16x32_bf16 v[36:39], v[120:123], a[60:63], v[36:39]
  buffer_load_dwordx4 v166, s[8:11], s24 offen offset:1024 lds
  v_mfma_f32_16x16x32_bf16 v[40:43], v[124:127], a[56:59], v[40:43]
  ds_read_b64_tr_b16 v[90:91], v10 offset:4096
  ds_read_b64_tr_b16 v[92:93], v11 offset:0
  v_mfma_f32_16x16x32_bf16 v[44:47], v[124:127], a[60:63], v[44:47]
  ds_read_b64_tr_b16 v[94:95], v11 offset:4096
  s_waitcnt lgkmcnt(8)
  v_mfma_f32_16x16x32_bf16 v[48:51], v[128:131], a[56:59], v[48:51]
  buffer_load_dwordx4 a[108:111], v1, s[4:7], s23 offen offset:256 sc1
  ds_read_b64_tr_b16 v[96:97], v8 offset:1024
  v_mfma_f32_16x16x32_bf16 v[52:55], v[128:131], a[60:63], v[52:55]
  ds_read_b64_tr_b16 v[98:99], v8 offset:5120
  s_add_u32 m0, s26, 8192
  v_mfma_f32_16x16x32_bf16 v[56:59], v[132:135], a[56:59], v[56:59]
  s_add_u32 s24, s20, 1572864
  v_mfma_f32_16x16x32_bf16 v[60:63], v[132:135], a[60:63], v[60:63]
  ds_read_b64_tr_b16 v[100:101], v9 offset:1024
  buffer_load_dwordx4 v164, s[8:11], s24 offen lds
  v_mfma_f32_16x16x32_bf16 v[64:67], v[136:139], a[56:59], v[64:67]
  ds_read_b64_tr_b16 v[102:103], v9 offset:5120
  ds_read_b64_tr_b16 v[104:105], v10 offset:1024
  v_mfma_f32_16x16x32_bf16 v[68:71], v[136:139], a[60:63], v[68:71]
  ds_read_b64_tr_b16 v[106:107], v10 offset:5120
  v_mfma_f32_16x16x32_bf16 v[72:75], v[140:143], a[56:59], v[72:75]
  ds_read_b64_tr_b16 v[108:109], v11 offset:1024
  ds_read_b64_tr_b16 v[110:111], v11 offset:5120
  v_mfma_f32_16x16x32_bf16 v[76:79], v[140:143], a[60:63], v[76:79]
  buffer_load_dwordx4 v165, s[8:11], s24 offen offset:1024 lds
g2_s24:
  s_waitcnt vmcnt(22) lgkmcnt(8)
  v_mfma_f32_16x16x32_bf16 v[16:19], v[80:83], a[64:67], v[16:19]
  v_lshrrev_b32 v160, 5, v15
  v_lshlrev_b32 v160, 15, v160
  v_and_b32 v161, 15, v15
  v_mfma_f32_16x16x32_bf16 v[20:23], v[80:83], a[68:71], v[20:23]
  v_lshl_add_u32 v160, v161, 4, v160
  ds_read_b64_tr_b16 v[112:113], v8 offset:8192
  v_mfma_f32_16x16x32_bf16 v[24:27], v[84:87], a[64:67], v[24:27]
  s_add_u32 s23, s62, 6029312
  v_bfe_u32 v161, v15, 4, 1
  v_mfma_f32_16x16x32_bf16 v[28:31], v[84:87], a[68:71], v[28:31]
  v_lshl_add_u32 v160, v161, 3, v160
  s_lshl_b32 s54, s22, 18
  v_mfma_f32_16x16x32_bf16 v[32:35], v[88:91], a[64:67], v[32:35]
  s_add_u32 s54, s54, s34
  ds_read_b64_tr_b16 v[114:115], v8 offset:12288
  buffer_load_dwordx4 a[112:115], v1, s[4:7], s23 offen offset:0 sc1
  v_mfma_f32_16x16x32_bf16 v[36:39], v[88:91], a[68:71], v[36:39]
  ds_read_b64_tr_b16 v[116:117], v9 offset:8192
  buffer_load_dwordx2 v[144:145], v160, s[12:15], s54 offen offset:0
  v_mfma_f32_16x16x32_bf16 v[40:43], v[92:95], a[64:67], v[40:43]
  ds_read_b64_tr_b16 v[118:119], v9 offset:12288
  ds_read_b64_tr_b16 v[120:121], v10 offset:8192
  v_mfma_f32_16x16x32_bf16 v[44:47], v[92:95], a[68:71], v[44:47]
  buffer_load_dwordx4 a[116:119], v1, s[4:7], s23 offen offset:256 sc1
  ds_read_b64_tr_b16 v[122:123], v10 offset:12288
  s_waitcnt lgkmcnt(6)
  v_mfma_f32_16x16x32_bf16 v[48:51], v[96:99], a[64:67], v[48:51]
  ds_read_b64_tr_b16 v[124:125], v11 offset:8192
  buffer_load_dwordx2 v[146:147], v160, s[12:15], s54 offen offset:256
  s_add_u32 s54, s54, 0x10000
  v_mfma_f32_16x16x32_bf16 v[52:55], v[96:99], a[68:71], v[52:55]
  s_add_u32 m0, s26, 16384
  s_add_u32 s24, s20, 1703936
  v_mfma_f32_16x16x32_bf16 v[56:59], v[100:103], a[64:67], v[56:59]
  ds_read_b64_tr_b16 v[126:127], v11 offset:12288
  buffer_load_dwordx4 v3, s[8:11], s24 offen lds
  v_mfma_f32_16x16x32_bf16 v[60:63], v[100:103], a[68:71], v[60:63]
  ds_read_b64_tr_b16 v[128:129], v8 offset:9216
  ds_read_b64_tr_b16 v[130:131], v8 offset:13312
  v_mfma_f32_16x16x32_bf16 v[64:67], v[104:107], a[64:67], v[64:67]
  ds_read_b64_tr_b16 v[132:133], v9 offset:9216
  buffer_load_dwordx4 v166, s[8:11], s24 offen offset:1024 lds
  ds_read_b64_tr_b16 v[134:135], v9 offset:13312
  v_mfma_f32_16x16x32_bf16 v[68:71], v[104:107], a[68:71], v[68:71]
  ds_read_b64_tr_b16 v[136:137], v10 offset:9216
  ds_read_b64_tr_b16 v[138:139], v10 offset:13312
  v_mfma_f32_16x16x32_bf16 v[72:75], v[108:111], a[64:67], v[72:75]
  ds_read_b64_tr_b16 v[140:141], v11 offset:9216
  s_add_u32 s23, s62, 6160384
  v_mfma_f32_16x16x32_bf16 v[76:79], v[108:111], a[68:71], v[76:79]
  ds_read_b64_tr_b16 v[142:143], v11 offset:13312
  buffer_load_dwordx4 a[120:123], v1, s[4:7], s23 offen offset:0 sc1
g2_s25:
  s_waitcnt vmcnt(25) lgkmcnt(8)
  v_mfma_f32_16x16x32_bf16 v[16:19], v[112:115], a[72:75], v[16:19]
  ds_read_b64_tr_b16 v[80:81], v8 offset:16384
  ds_read_b64_tr_b16 v[82:83], v8 offset:20480
  v_mfma_f32_16x16x32_bf16 v[20:23], v[112:115], a[76:79], v[20:23]
  buffer_load_dwordx4 a[124:127], v1, s[4:7], s23 offen offset:256 sc1
  ds_read_b64_tr_b16 v[84:85], v9 offset:16384
  v_mfma_f32_16x16x32_bf16 v[24:27], v[116:119], a[72:75], v[24:27]
  buffer_load_dwordx2 v[148:149], v160, s[12:15], s54 offen offset:0
  v_mfma_f32_16x16x32_bf16 v[28:31], v[116:119], a[76:79], v[28:31]
  ds_read_b64_tr_b16 v[86:87], v9 offset:20480
  s_add_u32 m0, s26, 24576
  v_mfma_f32_16x16x32_bf16 v[32:35], v[120:123], a[72:75], v[32:35]
  s_add_u32 s24, s20, 1769472
  ds_read_b64_tr_b16 v[88:89], v10 offset:16384
  v_mfma_f32_16x16x32_bf16 v[36:39], v[120:123], a[76:79], v[36:39]
  buffer_load_dwordx4 v3, s[8:11], s24 offen lds
  v_mfma_f32_16x16x32_bf16 v[40:43], v[124:127], a[72:75], v[40:43]
  ds_read_b64_tr_b16 v[90:91], v10 offset:20480
  ds_read_b64_tr_b16 v[92:93], v11 offset:16384
  v_mfma_f32_16x16x32_bf16 v[44:47], v[124:127], a[76:79], v[44:47]
  buffer_load_dwordx2 v[150:151], v160, s[12:15], s54 offen offset:256
  s_waitcnt lgkmcnt(7)
  v_mfma_f32_16x16x32_bf16 v[48:51], v[128:131], a[72:75], v[48:51]
  s_add_u32 s54, s54, 0x10000
  ds_read_b64_tr_b16 v[94:95], v11 offset:20480
  v_mfma_f32_16x16x32_bf16 v[52:55], v[128:131], a[76:79], v[52:55]
  buffer_load_dwordx4 v166, s[8:11], s24 offen offset:1024 lds
  ds_read_b64_tr_b16 v[96:97], v8 offset:17408
  v_mfma_f32_16x16x32_bf16 v[56:59], v[132:135], a[72:75], v[56:59]
  ds_read_b64_tr_b16 v[98:99], v8 offset:21504
  v_mfma_f32_16x16x32_bf16 v[60:63], v[132:135], a[76:79], v[60:63]
  s_add_u32 s23, s62, 6291456
  ds_read_b64_tr_b16 v[100:101], v9 offset:17408
  v_mfma_f32_16x16x32_bf16 v[64:67], v[136:139], a[72:75], v[64:67]
  buffer_load_dwordx4 a[0:3], v1, s[4:7], s23 offen offset:0 sc1
  ds_read_b64_tr_b16 v[102:103], v9 offset:21504
  v_mfma_f32_16x16x32_bf16 v[68:71], v[136:139], a[76:79], v[68:71]
  ds_read_b64_tr_b16 v[104:105], v10 offset:17408
  v_mfma_f32_16x16x32_bf16 v[72:75], v[140:143], a[72:75], v[72:75]
  ds_read_b64_tr_b16 v[106:107], v10 offset:21504
  ds_read_b64_tr_b16 v[108:109], v11 offset:17408
  v_mfma_f32_16x16x32_bf16 v[76:79], v[140:143], a[76:79], v[76:79]
  ds_read_b64_tr_b16 v[110:111], v11 offset:21504
g2_s26:
  s_waitcnt vmcnt(27) lgkmcnt(8)
  v_mfma_f32_16x16x32_bf16 v[16:19], v[80:83], a[80:83], v[16:19]
  ds_read_b64_tr_b16 v[112:113], v8 offset:24576
  ds_read_b64_tr_b16 v[114:115], v8 offset:28672
  v_mfma_f32_16x16x32_bf16 v[20:23], v[80:83], a[84:87], v[20:23]
  buffer_load_dwordx4 a[4:7], v1, s[4:7], s23 offen offset:256 sc1
  v_mfma_f32_16x16x32_bf16 v[24:27], v[84:87], a[80:83], v[24:27]
  ds_read_b64_tr_b16 v[116:117], v9 offset:24576
  buffer_load_dwordx2 v[152:153], v160, s[12:15], s54 offen offset:0
  v_mfma_f32_16x16x32_bf16 v[28:31], v[84:87], a[84:87], v[28:31]
  ds_read_b64_tr_b16 v[118:119], v9 offset:28672
  v_mfma_f32_16x16x32_bf16 v[32:35], v[88:91], a[80:83], v[32:35]
  s_add_u32 s23, s62, 6422528
  v_mfma_f32_16x16x32_bf16 v[36:39], v[88:91], a[84:87], v[36:39]
  ds_read_b64_tr_b16 v[120:121], v10 offset:24576
  buffer_load_dwordx4 a[8:11], v1, s[4:7], s23 offen offset:0 sc1
  v_mfma_f32_16x16x32_bf16 v[40:43], v[92:95], a[80:83], v[40:43]
  ds_read_b64_tr_b16 v[122:123], v10 offset:28672
  v_mfma_f32_16x16x32_bf16 v[44:47], v[92:95], a[84:87], v[44:47]
  ds_read_b64_tr_b16 v[124:125], v11 offset:24576
  s_waitcnt lgkmcnt(7)
  v_mfma_f32_16x16x32_bf16 v[48:51], v[96:99], a[80:83], v[48:51]
  buffer_load_dwordx2 v[154:155], v160, s[12:15], s54 offen offset:256
  s_add_u32 s54, s54, 0x10000
  v_mfma_f32_16x16x32_bf16 v[52:55], v[96:99], a[84:87], v[52:55]
  ds_read_b64_tr_b16 v[126:127], v11 offset:28672
  v_mfma_f32_16x16x32_bf16 v[56:59], v[100:103], a[80:83], v[56:59]
  ds_read_b64_tr_b16 v[128:129], v8 offset:25600
  ds_read_b64_tr_b16 v[130:131], v8 offset:29696
  v_mfma_f32_16x16x32_bf16 v[60:63], v[100:103], a[84:87], v[60:63]
  ds_read_b64_tr_b16 v[132:133], v9 offset:25600
  v_mfma_f32_16x16x32_bf16 v[64:67], v[104:107], a[80:83], v[64:67]
  ds_read_b64_tr_b16 v[134:135], v9 offset:29696
  v_mfma_f32_16x16x32_bf16 v[68:71], v[104:107], a[84:87], v[68:71]
  ds_read_b64_tr_b16 v[136:137], v10 offset:25600
  ds_read_b64_tr_b16 v[138:139], v10 offset:29696
  v_mfma_f32_16x16x32_bf16 v[72:75], v[108:111], a[80:83], v[72:75]
  ds_read_b64_tr_b16 v[140:141], v11 offset:25600
  v_mfma_f32_16x16x32_bf16 v[76:79], v[108:111], a[84:87], v[76:79]
  ds_read_b64_tr_b16 v[142:143], v11 offset:29696
g2_s27:
  s_waitcnt vmcnt(25) lgkmcnt(8)
  v_mfma_f32_16x16x32_bf16 v[16:19], v[112:115], a[88:91], v[16:19]
  s_barrier
  ds_read_b64_tr_b16 v[80:81], v8 offset:32768
  v_mfma_f32_16x16x32_bf16 v[20:23], v[112:115], a[92:95], v[20:23]
  s_add_u32 m0, s26, 32768
  s_add_u32 s24, s20, 1900544
  v_mfma_f32_16x16x32_bf16 v[24:27], v[116:119], a[88:91], v[24:27]
  ds_read_b64_tr_b16 v[82:83], v8 offset:36864
  buffer_load_dwordx4 v3, s[8:11], s24 offen lds
  v_mfma_f32_16x16x32_bf16 v[28:31], v[116:119], a[92:95], v[28:31]
  ds_read_b64_tr_b16 v[84:85], v9 offset:32768
  buffer_load_dwordx2 v[156:157], v160, s[12:15], s54 offen offset:0
  v_mfma_f32_16x16x32_bf16 v[32:35], v[120:123], a[88:91], v[32:35]
  ds_read_b64_tr_b16 v[86:87], v9 offset:36864
  ds_read_b64_tr_b16 v[88:89], v10 offset:32768
  v_mfma_f32_16x16x32_bf16 v[36:39], v[120:123], a[92:95], v[36:39]
  buffer_load_dwordx4 v166, s[8:11], s24 offen offset:1024 lds
  v_mfma_f32_16x16x32_bf16 v[40:43], v[124:127], a[88:91], v[40:43]
  ds_read_b64_tr_b16 v[90:91], v10 offset:36864
  ds_read_b64_tr_b16 v[92:93], v11 offset:32768
  v_mfma_f32_16x16x32_bf16 v[44:47], v[124:127], a[92:95], v[44:47]
  buffer_load_dwordx2 v[158:159], v160, s[12:15], s54 offen offset:256
  s_add_u32 s54, s54, 0x10000
  s_waitcnt lgkmcnt(7)
  v_mfma_f32_16x16x32_bf16 v[48:51], v[128:131], a[88:91], v[48:51]
  ds_read_b64_tr_b16 v[94:95], v11 offset:36864
  buffer_load_dwordx4 a[12:15], v1, s[4:7], s23 offen offset:256 sc1
  v_mfma_f32_16x16x32_bf16 v[52:55], v[128:131], a[92:95], v[52:55]
  ds_read_b64_tr_b16 v[96:97], v8 offset:33792
  ds_read_b64_tr_b16 v[98:99], v8 offset:37888
  v_mfma_f32_16x16x32_bf16 v[56:59], v[132:135], a[88:91], v[56:59]
  s_add_u32 m0, s26, 40960
  v_mfma_f32_16x16x32_bf16 v[60:63], v[132:135], a[92:95], v[60:63]
  s_add_u32 s24, s20, 1966080
  ds_read_b64_tr_b16 v[100:101], v9 offset:33792
  v_mfma_f32_16x16x32_bf16 v[64:67], v[136:139], a[88:91], v[64:67]
  buffer_load_dwordx4 v3, s[8:11], s24 offen lds
  ds_read_b64_tr_b16 v[102:103], v9 offset:37888
  v_mfma_f32_16x16x32_bf16 v[68:71], v[136:139], a[92:95], v[68:71]
  ds_read_b64_tr_b16 v[104:105], v10 offset:33792
  ds_read_b64_tr_b16 v[106:107], v10 offset:37888
  v_mfma_f32_16x16x32_bf16 v[72:75], v[140:143], a[88:91], v[72:75]
  ds_read_b64_tr_b16 v[108:109], v11 offset:33792
  ds_read_b64_tr_b16 v[110:111], v11 offset:37888
  v_mfma_f32_16x16x32_bf16 v[76:79], v[140:143], a[92:95], v[76:79]
  buffer_load_dwordx4 v166, s[8:11], s24 offen offset:1024 lds
g2_s28:
  s_waitcnt vmcnt(30) lgkmcnt(8)
  v_mfma_f32_16x16x32_bf16 v[16:19], v[80:83], a[96:99], v[16:19]
  ds_read_b64_tr_b16 v[112:113], v8 offset:40960
  s_add_u32 s23, s62, 6553600
  v_mfma_f32_16x16x32_bf16 v[20:23], v[80:83], a[100:103], v[20:23]
  ds_read_b64_tr_b16 v[114:115], v8 offset:45056
  buffer_load_dwordx4 a[16:19], v1, s[4:7], s23 offen offset:0 sc1
  v_mfma_f32_16x16x32_bf16 v[24:27], v[84:87], a[96:99], v[24:27]
  ds_read_b64_tr_b16 v[116:117], v9 offset:40960
  v_mfma_f32_16x16x32_bf16 v[28:31], v[84:87], a[100:103], v[28:31]
  ds_read_b64_tr_b16 v[118:119], v9 offset:45056
  ds_read_b64_tr_b16 v[120:121], v10 offset:40960
  v_mfma_f32_16x16x32_bf16 v[32:35], v[88:91], a[96:99], v[32:35]
  buffer_load_dwordx4 a[20:23], v1, s[4:7], s23 offen offset:256 sc1
  v_mfma_f32_16x16x32_bf16 v[36:39], v[88:91], a[100:103], v[36:39]
  ds_read_b64_tr_b16 v[122:123], v10 offset:45056
  ds_read_b64_tr_b16 v[124:125], v11 offset:40960
  v_mfma_f32_16x16x32_bf16 v[40:43], v[92:95], a[96:99], v[40:43]
  s_add_u32 m0, s26, 49152
  v_mfma_f32_16x16x32_bf16 v[44:47], v[92:95], a[100:103], v[44:47]
  s_add_u32 s24, s20, 2031616
  ds_read_b64_tr_b16 v[126:127], v11 offset:45056
  s_waitcnt lgkmcnt(8)
  v_mfma_f32_16x16x32_bf16 v[48:51], v[96:99], a[96:99], v[48:51]
  buffer_load_dwordx4 v164, s[8:11], s24 offen lds
  ds_read_b64_tr_b16 v[128:129], v8 offset:41984
  v_mfma_f32_16x16x32_bf16 v[52:55], v[96:99], a[100:103], v[52:55]
  ds_read_b64_tr_b16 v[130:131], v8 offset:46080
  v_mfma_f32_16x16x32_bf16 v[56:59], v[100:103], a[96:99], v[56:59]
  ds_read_b64_tr_b16 v[132:133], v9 offset:41984
  buffer_load_dwordx4 v165, s[8:11], s24 offen offset:1024 lds
  v_mfma_f32_16x16x32_bf16 v[60:63], v[100:103], a[100:103], v[60:63]
  ds_read_b64_tr_b16 v[134:135], v9 offset:46080
  v_mfma_f32_16x16x32_bf16 v[64:67], v[104:107], a[96:99], v[64:67]
  ds_read_b64_tr_b16 v[136:137], v10 offset:41984
  ds_read_b64_tr_b16 v[138:139], v10 offset:46080
  v_mfma_f32_16x16x32_bf16 v[68:71], v[104:107], a[100:103], v[68:71]
  ds_read_b64_tr_b16 v[140:141], v11 offset:41984
  v_mfma_f32_16x16x32_bf16 v[72:75], v[108:111], a[96:99], v[72:75]
  s_add_u32 s23, s62, 6684672
  ds_read_b64_tr_b16 v[142:143], v11 offset:46080
  v_mfma_f32_16x16x32_bf16 v[76:79], v[108:111], a[100:103], v[76:79]
  buffer_load_dwordx4 a[24:27], v1, s[4:7], s23 offen offset:0 sc1
g2_s29:
  s_waitcnt vmcnt(31) lgkmcnt(8)
  v_mfma_f32_16x16x32_bf16 v[16:19], v[112:115], a[104:107], v[16:19]
  ds_read_b64_tr_b16 v[80:81], v8 offset:49152
  ds_read_b64_tr_b16 v[82:83], v8 offset:53248
  v_mfma_f32_16x16x32_bf16 v[20:23], v[112:115], a[108:111], v[20:23]
  buffer_load_dwordx4 a[28:31], v1, s[4:7], s23 offen offset:256 sc1
  v_mfma_f32_16x16x32_bf16 v[24:27], v[116:119], a[104:107], v[24:27]
  ds_read_b64_tr_b16 v[84:85], v9 offset:49152
  ds_read_b64_tr_b16 v[86:87], v9 offset:53248
  v_mfma_f32_16x16x32_bf16 v[28:31], v[116:119], a[108:111], v[28:31]
  s_add_u32 m0, s26, 57344
  v_mfma_f32_16x16x32_bf16 v[32:35], v[120:123], a[104:107], v[32:35]
  s_add_u32 s24, s20, 2162688
  ds_read_b64_tr_b16 v[88:89], v10 offset:49152
  v_mfma_f32_16x16x32_bf16 v[36:39], v[120:123], a[108:111], v[36:39]
  buffer_load_dwordx4 v3, s[8:11], s24 offen lds
  v_mfma_f32_16x16x32_bf16 v[40:43], v[124:127], a[104:107], v[40:43]
  ds_read_b64_tr_b16 v[90:91], v10 offset:53248
  ds_read_b64_tr_b16 v[92:93], v11 offset:49152
  v_mfma_f32_16x16x32_bf16 v[44:47], v[124:127], a[108:111], v[44:47]
  ds_read_b64_tr_b16 v[94:95], v11 offset:53248
  s_waitcnt lgkmcnt(8)
  v_mfma_f32_16x16x32_bf16 v[48:51], v[128:131], a[104:107], v[48:51]
  buffer_load_dwordx4 v166, s[8:11], s24 offen offset:1024 lds
  v_mfma_f32_16x16x32_bf16 v[52:55], v[128:131], a[108:111], v[52:55]
  ds_read_b64_tr_b16 v[96:97], v8 offset:50176
  ds_read_b64_tr_b16 v[98:99], v8 offset:54272
  v_mfma_f32_16x16x32_bf16 v[56:59], v[132:135], a[104:107], v[56:59]
  s_add_u32 s23, s62, 6815744
  v_mfma_f32_16x16x32_bf16 v[60:63], v[132:135], a[108:111], v[60:63]
  ds_read_b64_tr_b16 v[100:101], v9 offset:50176
  buffer_load_dwordx4 a[32:35], v1, s[4:7], s23 offen offset:0 sc1
  v_mfma_f32_16x16x32_bf16 v[64:67], v[136:139], a[104:107], v[64:67]
  ds_read_b64_tr_b16 v[102:103], v9 offset:54272
  v_mfma_f32_16x16x32_bf16 v[68:71], v[136:139], a[108:111], v[68:71]
  ds_read_b64_tr_b16 v[104:105], v10 offset:50176
  ds_read_b64_tr_b16 v[106:107], v10 offset:54272
  v_mfma_f32_16x16x32_bf16 v[72:75], v[140:143], a[104:107], v[72:75]
  ds_read_b64_tr_b16 v[108:109], v11 offset:50176
  v_mfma_f32_16x16x32_bf16 v[76:79], v[140:143], a[108:111], v[76:79]
  ds_read_b64_tr_b16 v[110:111], v11 offset:54272
g2_s30:
  s_waitcnt vmcnt(30) lgkmcnt(8)
  v_mfma_f32_16x16x32_bf16 v[16:19], v[80:83], a[112:115], v[16:19]
  ds_read_b64_tr_b16 v[112:113], v8 offset:57344
  ds_read_b64_tr_b16 v[114:115], v8 offset:61440
  v_mfma_f32_16x16x32_bf16 v[20:23], v[80:83], a[116:119], v[20:23]
  buffer_load_dwordx4 a[36:39], v1, s[4:7], s23 offen offset:256 sc1
  v_mfma_f32_16x16x32_bf16 v[24:27], v[84:87], a[112:115], v[24:27]
  ds_read_b64_tr_b16 v[116:117], v9 offset:57344
  ds_read_b64_tr_b16 v[118:119], v9 offset:61440
  v_mfma_f32_16x16x32_bf16 v[28:31], v[84:87], a[116:119], v[28:31]
  s_add_u32 s23, s62, 6946816
  v_mfma_f32_16x16x32_bf16 v[32:35], v[88:91], a[112:115], v[32:35]
  ds_read_b64_tr_b16 v[120:121], v10 offset:57344
  buffer_load_dwordx4 a[40:43], v1, s[4:7], s23 offen offset:0 sc1
  v_mfma_f32_16x16x32_bf16 v[36:39], v[88:91], a[116:119], v[36:39]
  ds_read_b64_tr_b16 v[122:123], v10 offset:61440
  v_mfma_f32_16x16x32_bf16 v[40:43], v[92:95], a[112:115], v[40:43]
  ds_read_b64_tr_b16 v[124:125], v11 offset:57344
  ds_read_b64_tr_b16 v[126:127], v11 offset:61440
  v_mfma_f32_16x16x32_bf16 v[44:47], v[92:95], a[116:119], v[44:47]
  ds_read_b64_tr_b16 v[128:129], v8 offset:58368
  s_waitcnt lgkmcnt(9)
  v_mfma_f32_16x16x32_bf16 v[48:51], v[96:99], a[112:115], v[48:51]
  ds_read_b64_tr_b16 v[130:131], v8 offset:62464
  v_mfma_f32_16x16x32_bf16 v[52:55], v[96:99], a[116:119], v[52:55]
  ds_read_b64_tr_b16 v[132:133], v9 offset:58368
  ds_read_b64_tr_b16 v[134:135], v9 offset:62464
  v_mfma_f32_16x16x32_bf16 v[56:59], v[100:103], a[112:115], v[56:59]
  ds_read_b64_tr_b16 v[136:137], v10 offset:58368
  v_mfma_f32_16x16x32_bf16 v[60:63], v[100:103], a[116:119], v[60:63]
  ds_read_b64_tr_b16 v[138:139], v10 offset:62464
  s_add_u32 s51, s50, g2_s40 - g2_pc
  v_mfma_f32_16x16x32_bf16 v[64:67], v[104:107], a[112:115], v[64:67]
  s_min_u32 s51, s51, code_end - g2_pc - 4
  v_mfma_f32_16x16x32_bf16 v[68:71], v[104:107], a[116:119], v[68:71]
  ds_read_b64_tr_b16 v[140:141], v11 offset:58368
  v_mov_b32 v162, s51
  v_mfma_f32_16x16x32_bf16 v[72:75], v[108:111], a[112:115], v[72:75]
  global_load_dword a128, v162, s[48:49]
  v_mfma_f32_16x16x32_bf16 v[76:79], v[108:111], a[116:119], v[76:79]
  ds_read_b64_tr_b16 v[142:143], v11 offset:62464
g2_s31:
  s_waitcnt vmcnt(24) lgkmcnt(8)
  v_mfma_f32_16x16x32_bf16 v[16:19], v[112:115], a[120:123], v[16:19]
  s_barrier
  ds_read_b64_tr_b16 v[80:81], v4 offset:0
  v_mfma_f32_16x16x32_bf16 v[20:23], v[112:115], a[124:127], v[20:23]
  s_add_u32 m0, s26, 65536
  s_add_u32 s24, s20, 2228224
  v_mfma_f32_16x16x32_bf16 v[24:27], v[116:119], a[120:123], v[24:27]
  ds_read_b64_tr_b16 v[82:83], v4 offset:4096
  v_mfma_f32_16x16x32_bf16 v[28:31], v[116:119], a[124:127], v[28:31]
  buffer_load_dwordx4 v3, s[8:11], s24 offen lds
  ds_read_b64_tr_b16 v[84:85], v5 offset:0
  v_mfma_f32_16x16x32_bf16 v[32:35], v[120:123], a[120:123], v[32:35]
  ds_read_b64_tr_b16 v[86:87], v5 offset:4096
  ds_read_b64_tr_b16 v[88:89], v6 offset:0
  v_mfma_f32_16x16x32_bf16 v[36:39], v[120:123], a[124:127], v[36:39]
  buffer_load_dwordx4 v166, s[8:11], s24 offen offset:1024 lds
  v_mfma_f32_16x16x32_bf16 v[40:43], v[124:127], a[120:123], v[40:43]
  ds_read_b64_tr_b16 v[90:91], v6 offset:4096
  ds_read_b64_tr_b16 v[92:93], v7 offset:0
  v_mfma_f32_16x16x32_bf16 v[44:47], v[124:127], a[124:127], v[44:47]
  ds_read_b64_tr_b16 v[94:95], v7 offset:4096
  s_waitcnt lgkmcnt(8)
  v_mfma_f32_16x16x32_bf16 v[48:51], v[128:131], a[120:123], v[48:51]
  buffer_load_dwordx4 a[44:47], v1, s[4:7], s23 offen offset:256 sc1
  ds_read_b64_tr_b16 v[96:97], v4 offset:1024
  v_mfma_f32_16x16x32_bf16 v[52:55], v[128:131], a[124:127], v[52:55]
  ds_read_b64_tr_b16 v[98:99], v4 offset:5120
  s_add_u32 m0, s26, 73728
  v_mfma_f32_16x16x32_bf16 v[56:59], v[132:135], a[120:123], v[56:59]
  s_add_u32 s24, s20, 2359296
  v_mfma_f32_16x16x32_bf16 v[60:63], v[132:135], a[124:127], v[60:63]
  ds_read_b64_tr_b16 v[100:101], v5 offset:1024
  buffer_load_dwordx4 v3, s[8:11], s24 offen lds
  v_mfma_f32_16x16x32_bf16 v[64:67], v[136:139], a[120:123], v[64:67]
  ds_read_b64_tr_b16 v[102:103], v5 offset:5120
  ds_read_b64_tr_b16 v[104:105], v6 offset:1024
  v_mfma_f32_16x16x32_bf16 v[68:71], v[136:139], a[124:127], v[68:71]
  ds_read_b64_tr_b16 v[106:107], v6 offset:5120
  v_mfma_f32_16x16x32_bf16 v[72:75], v[140:143], a[120:123], v[72:75]
  ds_read_b64_tr_b16 v[108:109], v7 offset:1024
  ds_read_b64_tr_b16 v[110:111], v7 offset:5120
  v_mfma_f32_16x16x32_bf16 v[76:79], v[140:143], a[124:127], v[76:79]
  buffer_load_dwordx4 v166, s[8:11], s24 offen offset:1024 lds
g2_s32:
  s_waitcnt vmcnt(27) lgkmcnt(8)
  v_mfma_f32_16x16x32_bf16 v[16:19], v[80:83], a[0:3], v[16:19]
  ds_read_b64_tr_b16 v[112:113], v4 offset:8192
  s_add_u32 s23, s62, 7077888
  v_mfma_f32_16x16x32_bf16 v[20:23], v[80:83], a[4:7], v[20:23]
  ds_read_b64_tr_b16 v[114:115], v4 offset:12288
  buffer_load_dwordx4 a[48:51], v1, s[4:7], s23 offen offset:0 sc1
  v_mfma_f32_16x16x32_bf16 v[24:27], v[84:87], a[0:3], v[24:27]
  ds_read_b64_tr_b16 v[116:117], v5 offset:8192
  v_mfma_f32_16x16x32_bf16 v[28:31], v[84:87], a[4:7], v[28:31]
  ds_read_b64_tr_b16 v[118:119], v5 offset:12288
  ds_read_b64_tr_b16 v[120:121], v6 offset:8192
  v_mfma_f32_16x16x32_bf16 v[32:35], v[88:91], a[0:3], v[32:35]
  buffer_load_dwordx4 a[52:55], v1, s[4:7], s23 offen offset:256 sc1
  v_mfma_f32_16x16x32_bf16 v[36:39], v[88:91], a[4:7], v[36:39]
  ds_read_b64_tr_b16 v[122:123], v6 offset:12288
  ds_read_b64_tr_b16 v[124:125], v7 offset:8192
  v_mfma_f32_16x16x32_bf16 v[40:43], v[92:95], a[0:3], v[40:43]
  s_add_u32 m0, s26, 81920
  v_mfma_f32_16x16x32_bf16 v[44:47], v[92:95], a[4:7], v[44:47]
  s_add_u32 s24, s20, 2424832
  ds_read_b64_tr_b16 v[126:127], v7 offset:12288
  s_waitcnt lgkmcnt(8)
  v_mfma_f32_16x16x32_bf16 v[48:51], v[96:99], a[0:3], v[48:51]
  buffer_load_dwordx4 v3, s[8:11], s24 offen lds
  ds_read_b64_tr_b16 v[128:129], v4 offset:9216
  v_mfma_f32_16x16x32_bf16 v[52:55], v[96:99], a[4:7], v[52:55]
  ds_read_b64_tr_b16 v[130:131], v4 offset:13312
  v_mfma_f32_16x16x32_bf16 v[56:59], v[100:103], a[0:3], v[56:59]
  ds_read_b64_tr_b16 v[132:133], v5 offset:9216
  buffer_load_dwordx4 v166, s[8:11], s24 offen offset:1024 lds
  v_mfma_f32_16x16x32_bf16 v[60:63], v[100:103], a[4:7], v[60:63]
  ds_read_b64_tr_b16 v[134:135], v5 offset:13312
  v_mfma_f32_16x16x32_bf16 v[64:67], v[104:107], a[0:3], v[64:67]
  ds_read_b64_tr_b16 v[136:137], v6 offset:9216
  ds_read_b64_tr_b16 v[138:139], v6 offset:13312
  v_mfma_f32_16x16x32_bf16 v[68:71], v[104:107], a[4:7], v[68:71]
  ds_read_b64_tr_b16 v[140:141], v7 offset:9216
  v_mfma_f32_16x16x32_bf16 v[72:75], v[108:111], a[0:3], v[72:75]
  s_add_u32 s23, s62, 7208960
  ds_read_b64_tr_b16 v[142:143], v7 offset:13312
  v_mfma_f32_16x16x32_bf16 v[76:79], v[108:111], a[4:7], v[76:79]
  buffer_load_dwordx4 a[56:59], v1, s[4:7], s23 offen offset:0 sc1
g2_s33:
  s_waitcnt vmcnt(24) lgkmcnt(8)
  v_mfma_f32_16x16x32_bf16 v[16:19], v[112:115], a[8:11], v[16:19]
  ds_read_b64_tr_b16 v[80:81], v4 offset:16384
  ds_read_b64_tr_b16 v[82:83], v4 offset:20480
  v_mfma_f32_16x16x32_bf16 v[20:23], v[112:115], a[12:15], v[20:23]
  buffer_load_dwordx4 a[60:63], v1, s[4:7], s23 offen offset:256 sc1
  v_mfma_f32_16x16x32_bf16 v[24:27], v[116:119], a[8:11], v[24:27]
  ds_read_b64_tr_b16 v[84:85], v5 offset:16384
  ds_read_b64_tr_b16 v[86:87], v5 offset:20480
  v_mfma_f32_16x16x32_bf16 v[28:31], v[116:119], a[12:15], v[28:31]
  s_add_u32 m0, s26, 90112
  v_mfma_f32_16x16x32_bf16 v[32:35], v[120:123], a[8:11], v[32:35]
  s_add_u32 s24, s20, 2490368
  ds_read_b64_tr_b16 v[88:89], v6 offset:16384
  v_mfma_f32_16x16x32_bf16 v[36:39], v[120:123], a[12:15], v[36:39]
  buffer_load_dwordx4 v164, s[8:11], s24 offen lds
  v_mfma_f32_16x16x32_bf16 v[40:43], v[124:127], a[8:11], v[40:43]
  ds_read_b64_tr_b16 v[90:91], v6 offset:20480
  ds_read_b64_tr_b16 v[92:93], v7 offset:16384
  v_mfma_f32_16x16x32_bf16 v[44:47], v[124:127], a[12:15], v[44:47]
  ds_read_b64_tr_b16 v[94:95], v7 offset:20480
  s_waitcnt lgkmcnt(8)
  v_mfma_f32_16x16x32_bf16 v[48:51], v[128:131], a[8:11], v[48:51]
  buffer_load_dwordx4 v165, s[8:11], s24 offen offset:1024 lds
  v_mfma_f32_16x16x32_bf16 v[52:55], v[128:131], a[12:15], v[52:55]
  ds_read_b64_tr_b16 v[96:97], v4 offset:17408
  ds_read_b64_tr_b16 v[98:99], v4 offset:21504
  v_mfma_f32_16x16x32_bf16 v[56:59], v[132:135], a[8:11], v[56:59]
  s_add_u32 s23, s62, 7340032
  v_mfma_f32_16x16x32_bf16 v[60:63], v[132:135], a[12:15], v[60:63]
  ds_read_b64_tr_b16 v[100:101], v5 offset:17408
  buffer_load_dwordx4 a[64:67], v1, s[4:7], s23 offen offset:0 sc1
  v_mfma_f32_16x16x32_bf16 v[64:67], v[136:139], a[8:11], v[64:67]
  ds_read_b64_tr_b16 v[102:103], v5 offset:21504
  v_mfma_f32_16x16x32_bf16 v[68:71], v[136:139], a[12:15], v[68:71]
  ds_read_b64_tr_b16 v[104:105], v6 offset:17408
  ds_read_b64_tr_b16 v[106:107], v6 offset:21504
  v_mfma_f32_16x16x32_bf16 v[72:75], v[140:143], a[8:11], v[72:75]
  ds_read_b64_tr_b16 v[108:109], v7 offset:17408
  v_mfma_f32_16x16x32_bf16 v[76:79], v[140:143], a[12:15], v[76:79]
  ds_read_b64_tr_b16 v[110:111], v7 offset:21504
g2_s34:
  s_waitcnt vmcnt(24) lgkmcnt(8)
  v_mfma_f32_16x16x32_bf16 v[16:19], v[80:83], a[16:19], v[16:19]
  ds_read_b64_tr_b16 v[112:113], v4 offset:24576
  ds_read_b64_tr_b16 v[114:115], v4 offset:28672
  v_mfma_f32_16x16x32_bf16 v[20:23], v[80:83], a[20:23], v[20:23]
  buffer_load_dwordx4 a[68:71], v1, s[4:7], s23 offen offset:256 sc1
  v_mfma_f32_16x16x32_bf16 v[24:27], v[84:87], a[16:19], v[24:27]
  ds_read_b64_tr_b16 v[116:117], v5 offset:24576
  v_mfma_f32_16x16x32_bf16 v[28:31], v[84:87], a[20:23], v[28:31]
  ds_read_b64_tr_b16 v[118:119], v5 offset:28672
  v_mfma_f32_16x16x32_bf16 v[32:35], v[88:91], a[16:19], v[32:35]
  s_add_u32 s23, s62, 7471104
  v_mfma_f32_16x16x32_bf16 v[36:39], v[88:91], a[20:23], v[36:39]
  ds_read_b64_tr_b16 v[120:121], v6 offset:24576
  buffer_load_dwordx4 a[72:75], v1, s[4:7], s23 offen offset:0 sc1
  v_mfma_f32_16x16x32_bf16 v[40:43], v[92:95], a[16:19], v[40:43]
  ds_read_b64_tr_b16 v[122:123], v6 offset:28672
  v_mfma_f32_16x16x32_bf16 v[44:47], v[92:95], a[20:23], v[44:47]
  ds_read_b64_tr_b16 v[124:125], v7 offset:24576
  s_waitcnt lgkmcnt(7)
  v_mfma_f32_16x16x32_bf16 v[48:51], v[96:99], a[16:19], v[48:51]
  ds_read_b64_tr_b16 v[126:127], v7 offset:28672
  v_mfma_f32_16x16x32_bf16 v[52:55], v[96:99], a[20:23], v[52:55]
  ds_read_b64_tr_b16 v[128:129], v4 offset:25600
  v_mfma_f32_16x16x32_bf16 v[56:59], v[100:103], a[16:19], v[56:59]
  ds_read_b64_tr_b16 v[130:131], v4 offset:29696
  ds_read_b64_tr_b16 v[132:133], v5 offset:25600
  v_mfma_f32_16x16x32_bf16 v[60:63], v[100:103], a[20:23], v[60:63]
  ds_read_b64_tr_b16 v[134:135], v5 offset:29696
  v_mfma_f32_16x16x32_bf16 v[64:67], v[104:107], a[16:19], v[64:67]
  ds_read_b64_tr_b16 v[136:137], v6 offset:25600
  v_mfma_f32_16x16x32_bf16 v[68:71], v[104:107], a[20:23], v[68:71]
  ds_read_b64_tr_b16 v[138:139], v6 offset:29696
  v_mfma_f32_16x16x32_bf16 v[72:75], v[108:111], a[16:19], v[72:75]
  ds_read_b64_tr_b16 v[140:141], v7 offset:25600
  v_mfma_f32_16x16x32_bf16 v[76:79], v[108:111], a[20:23], v[76:79]
  ds_read_b64_tr_b16 v[142:143], v7 offset:29696
g2_s35:
  s_waitcnt vmcnt(20) lgkmcnt(8)
  v_mfma_f32_16x16x32_bf16 v[16:19], v[112:115], a[24:27], v[16:19]
  s_barrier
  ds_read_b64_tr_b16 v[80:81], v4 offset:32768
  v_mfma_f32_16x16x32_bf16 v[20:23], v[112:115], a[28:31], v[20:23]
  s_add_u32 m0, s26, 98304
  s_add_u32 s24, s25, 2621440
  v_mfma_f32_16x16x32_bf16 v[24:27], v[116:119], a[24:27], v[24:27]
  ds_read_b64_tr_b16 v[82:83], v4 offset:36864
  v_mfma_f32_16x16x32_bf16 v[28:31], v[116:119], a[28:31], v[28:31]
  buffer_load_dwordx4 v3, s[8:11], s24 offen lds
  ds_read_b64_tr_b16 v[84:85], v5 offset:32768
  v_mfma_f32_16x16x32_bf16 v[32:35], v[120:123], a[24:27], v[32:35]
  ds_read_b64_tr_b16 v[86:87], v5 offset:36864
  ds_read_b64_tr_b16 v[88:89], v6 offset:32768
  v_mfma_f32_16x16x32_bf16 v[36:39], v[120:123], a[28:31], v[36:39]
  buffer_load_dwordx4 a[76:79], v1, s[4:7], s23 offen offset:256 sc1
  v_mfma_f32_16x16x32_bf16 v[40:43], v[124:127], a[24:27], v[40:43]
  ds_read_b64_tr_b16 v[90:91], v6 offset:36864
  ds_read_b64_tr_b16 v[92:93], v7 offset:32768
  v_mfma_f32_16x16x32_bf16 v[44:47], v[124:127], a[28:31], v[44:47]
  s_add_u32 m0, s26, 106496
  s_waitcnt lgkmcnt(7)
  v_mfma_f32_16x16x32_bf16 v[48:51], v[128:131], a[24:27], v[48:51]
  s_add_u32 s24, s25, 2686976
  ds_read_b64_tr_b16 v[94:95], v7 offset:36864
  v_mfma_f32_16x16x32_bf16 v[52:55], v[128:131], a[28:31], v[52:55]
  buffer_load_dwordx4 v3, s[8:11], s24 offen lds
  ds_read_b64_tr_b16 v[96:97], v4 offset:33792
  v_mfma_f32_16x16x32_bf16 v[56:59], v[132:135], a[24:27], v[56:59]
  ds_read_b64_tr_b16 v[98:99], v4 offset:37888
  v_mfma_f32_16x16x32_bf16 v[60:63], v[132:135], a[28:31], v[60:63]
  s_add_u32 s23, s62, 7602176
  ds_read_b64_tr_b16 v[100:101], v5 offset:33792
  v_mfma_f32_16x16x32_bf16 v[64:67], v[136:139], a[24:27], v[64:67]
  buffer_load_dwordx4 a[80:83], v1, s[4:7], s23 offen offset:0 sc1
  ds_read_b64_tr_b16 v[102:103], v5 offset:37888
  v_mfma_f32_16x16x32_bf16 v[68:71], v[136:139], a[28:31], v[68:71]
  ds_read_b64_tr_b16 v[104:105], v6 offset:33792
  v_mfma_f32_16x16x32_bf16 v[72:75], v[140:143], a[24:27], v[72:75]
  ds_read_b64_tr_b16 v[106:107], v6 offset:37888
  ds_read_b64_tr_b16 v[108:109], v7 offset:33792
  v_mfma_f32_16x16x32_bf16 v[76:79], v[140:143], a[28:31], v[76:79]
  ds_read_b64_tr_b16 v[110:111], v7 offset:37888
g2_s36:
  s_waitcnt vmcnt(22) lgkmcnt(8)
  v_mfma_f32_16x16x32_bf16 v[16:19], v[80:83], a[32:35], v[16:19]
  ds_read_b64_tr_b16 v[112:113], v4 offset:40960
  ds_read_b64_tr_b16 v[114:115], v4 offset:45056
  v_mfma_f32_16x16x32_bf16 v[20:23], v[80:83], a[36:39], v[20:23]
  buffer_load_dwordx4 a[84:87], v1, s[4:7], s23 offen offset:256 sc1
  v_mfma_f32_16x16x32_bf16 v[24:27], v[84:87], a[32:35], v[24:27]
  ds_read_b64_tr_b16 v[116:117], v5 offset:40960
  ds_read_b64_tr_b16 v[118:119], v5 offset:45056
  v_mfma_f32_16x16x32_bf16 v[28:31], v[84:87], a[36:39], v[28:31]
  s_add_u32 m0, s26, 114688
  v_mfma_f32_16x16x32_bf16 v[32:35], v[88:91], a[32:35], v[32:35]
  s_add_u32 s24, s25, 5373952
  v_mfma_f32_16x16x32_bf16 v[36:39], v[88:91], a[36:39], v[36:39]
  ds_read_b64_tr_b16 v[120:121], v6 offset:40960
  buffer_load_dwordx4 v3, s[8:11], s24 offen lds
  v_mfma_f32_16x16x32_bf16 v[40:43], v[92:95], a[32:35], v[40:43]
  ds_read_b64_tr_b16 v[122:123], v6 offset:45056
  v_mfma_f32_16x16x32_bf16 v[44:47], v[92:95], a[36:39], v[44:47]
  ds_read_b64_tr_b16 v[124:125], v7 offset:40960
  s_waitcnt lgkmcnt(7)
  v_mfma_f32_16x16x32_bf16 v[48:51], v[96:99], a[32:35], v[48:51]
  s_add_u32 s23, s62, 7733248
  ds_read_b64_tr_b16 v[126:127], v7 offset:45056
  v_mfma_f32_16x16x32_bf16 v[52:55], v[96:99], a[36:39], v[52:55]
  buffer_load_dwordx4 a[88:91], v1, s[4:7], s23 offen offset:0 sc1
  v_mfma_f32_16x16x32_bf16 v[56:59], v[100:103], a[32:35], v[56:59]
  ds_read_b64_tr_b16 v[128:129], v4 offset:41984
  ds_read_b64_tr_b16 v[130:131], v4 offset:46080
  v_mfma_f32_16x16x32_bf16 v[60:63], v[100:103], a[36:39], v[60:63]
  ds_read_b64_tr_b16 v[132:133], v5 offset:41984
  v_mfma_f32_16x16x32_bf16 v[64:67], v[104:107], a[32:35], v[64:67]
  ds_read_b64_tr_b16 v[134:135], v5 offset:46080
  v_mfma_f32_16x16x32_bf16 v[68:71], v[104:107], a[36:39], v[68:71]
  ds_read_b64_tr_b16 v[136:137], v6 offset:41984
  ds_read_b64_tr_b16 v[138:139], v6 offset:46080
  v_mfma_f32_16x16x32_bf16 v[72:75], v[108:111], a[32:35], v[72:75]
  ds_read_b64_tr_b16 v[140:141], v7 offset:41984
  v_mfma_f32_16x16x32_bf16 v[76:79], v[108:111], a[36:39], v[76:79]
  ds_read_b64_tr_b16 v[142:143], v7 offset:46080
g2_s37:
  s_waitcnt vmcnt(20) lgkmcnt(8)
  v_mfma_f32_16x16x32_bf16 v[16:19], v[112:115], a[40:43], v[16:19]
  ds_read_b64_tr_b16 v[80:81], v4 offset:49152
  ds_read_b64_tr_b16 v[82:83], v4 offset:53248
  v_mfma_f32_16x16x32_bf16 v[20:23], v[112:115], a[44:47], v[20:23]
  buffer_load_dwordx4 a[92:95], v1, s[4:7], s23 offen offset:256 sc1
  v_mfma_f32_16x16x32_bf16 v[24:27], v[116:119], a[40:43], v[24:27]
  ds_read_b64_tr_b16 v[84:85], v5 offset:49152
  ds_read_b64_tr_b16 v[86:87], v5 offset:53248
  v_mfma_f32_16x16x32_bf16 v[28:31], v[116:119], a[44:47], v[28:31]
  s_add_u32 m0, s26, 122880
  v_mfma_f32_16x16x32_bf16 v[32:35], v[120:123], a[40:43], v[32:35]
  s_add_u32 s24, s25, 5439488
  v_mfma_f32_16x16x32_bf16 v[36:39], v[120:123], a[44:47], v[36:39]
  ds_read_b64_tr_b16 v[88:89], v6 offset:49152
  buffer_load_dwordx4 v3, s[8:11], s24 offen lds
  v_mfma_f32_16x16x32_bf16 v[40:43], v[124:127], a[40:43], v[40:43]
  ds_read_b64_tr_b16 v[90:91], v6 offset:53248
  v_mfma_f32_16x16x32_bf16 v[44:47], v[124:127], a[44:47], v[44:47]
  ds_read_b64_tr_b16 v[92:93], v7 offset:49152
  s_waitcnt lgkmcnt(7)
  v_mfma_f32_16x16x32_bf16 v[48:51], v[128:131], a[40:43], v[48:51]
  s_add_u32 s23, s63, 7864320
  ds_read_b64_tr_b16 v[94:95], v7 offset:53248
  v_mfma_f32_16x16x32_bf16 v[52:55], v[128:131], a[44:47], v[52:55]
  buffer_load_dwordx4 a[96:99], v1, s[4:7], s23 offen offset:0 sc1
  v_mfma_f32_16x16x32_bf16 v[56:59], v[132:135], a[40:43], v[56:59]
  ds_read_b64_tr_b16 v[96:97], v4 offset:50176
  ds_read_b64_tr_b16 v[98:99], v4 offset:54272
  v_mfma_f32_16x16x32_bf16 v[60:63], v[132:135], a[44:47], v[60:63]
  ds_read_b64_tr_b16 v[100:101], v5 offset:50176
  v_mfma_f32_16x16x32_bf16 v[64:67], v[136:139], a[40:43], v[64:67]
  ds_read_b64_tr_b16 v[102:103], v5 offset:54272
  v_mfma_f32_16x16x32_bf16 v[68:71], v[136:139], a[44:47], v[68:71]
  ds_read_b64_tr_b16 v[104:105], v6 offset:50176
  ds_read_b64_tr_b16 v[106:107], v6 offset:54272
  v_mfma_f32_16x16x32_bf16 v[72:75], v[140:143], a[40:43], v[72:75]
  ds_read_b64_tr_b16 v[108:109], v7 offset:50176
  v_mfma_f32_16x16x32_bf16 v[76:79], v[140:143], a[44:47], v[76:79]
  ds_read_b64_tr_b16 v[110:111], v7 offset:54272
g2_s38:
  s_waitcnt vmcnt(19) lgkmcnt(8)
  v_mfma_f32_16x16x32_bf16 v[16:19], v[80:83], a[48:51], v[16:19]
  ds_read_b64_tr_b16 v[112:113], v4 offset:57344
  ds_read_b64_tr_b16 v[114:115], v4 offset:61440
  v_mfma_f32_16x16x32_bf16 v[20:23], v[80:83], a[52:55], v[20:23]
  buffer_load_dwordx4 a[100:103], v1, s[4:7], s23 offen offset:256 sc1
  v_mfma_f32_16x16x32_bf16 v[24:27], v[84:87], a[48:51], v[24:27]
  ds_read_b64_tr_b16 v[116:117], v5 offset:57344
  v_mfma_f32_16x16x32_bf16 v[28:31], v[84:87], a[52:55], v[28:31]
  ds_read_b64_tr_b16 v[118:119], v5 offset:61440
  v_mfma_f32_16x16x32_bf16 v[32:35], v[88:91], a[48:51], v[32:35]
  s_add_u32 s23, s63, 7995392
  v_mfma_f32_16x16x32_bf16 v[36:39], v[88:91], a[52:55], v[36:39]
  ds_read_b64_tr_b16 v[120:121], v6 offset:57344
  buffer_load_dwordx4 a[104:107], v1, s[4:7], s23 offen offset:0 sc1
  v_mfma_f32_16x16x32_bf16 v[40:43], v[92:95], a[48:51], v[40:43]
  ds_read_b64_tr_b16 v[122:123], v6 offset:61440
  v_mfma_f32_16x16x32_bf16 v[44:47], v[92:95], a[52:55], v[44:47]
  ds_read_b64_tr_b16 v[124:125], v7 offset:57344
  s_waitcnt lgkmcnt(7)
  v_mfma_f32_16x16x32_bf16 v[48:51], v[96:99], a[48:51], v[48:51]
  ds_read_b64_tr_b16 v[126:127], v7 offset:61440
  v_mfma_f32_16x16x32_bf16 v[52:55], v[96:99], a[52:55], v[52:55]
  ds_read_b64_tr_b16 v[128:129], v4 offset:58368
  v_mfma_f32_16x16x32_bf16 v[56:59], v[100:103], a[48:51], v[56:59]
  ds_read_b64_tr_b16 v[130:131], v4 offset:62464
  ds_read_b64_tr_b16 v[132:133], v5 offset:58368
  v_mfma_f32_16x16x32_bf16 v[60:63], v[100:103], a[52:55], v[60:63]
  ds_read_b64_tr_b16 v[134:135], v5 offset:62464
  v_mfma_f32_16x16x32_bf16 v[64:67], v[104:107], a[48:51], v[64:67]
  ds_read_b64_tr_b16 v[136:137], v6 offset:58368
  v_mfma_f32_16x16x32_bf16 v[68:71], v[104:107], a[52:55], v[68:71]
  ds_read_b64_tr_b16 v[138:139], v6 offset:62464
  v_mfma_f32_16x16x32_bf16 v[72:75], v[108:111], a[48:51], v[72:75]
  ds_read_b64_tr_b16 v[140:141], v7 offset:58368
  v_mfma_f32_16x16x32_bf16 v[76:79], v[108:111], a[52:55], v[76:79]
  ds_read_b64_tr_b16 v[142:143], v7 offset:62464
g2_s39:
  s_waitcnt vmcnt(15) lgkmcnt(8)
  v_mfma_f32_16x16x32_bf16 v[16:19], v[112:115], a[56:59], v[16:19]
  s_barrier
  ds_read_b64_tr_b16 v[80:81], v8 offset:0
  v_mfma_f32_16x16x32_bf16 v[20:23], v[112:115], a[60:63], v[20:23]
  s_add_u32 m0, s26, 0
  s_add_u32 s24, s25, 5570560
  v_mfma_f32_16x16x32_bf16 v[24:27], v[116:119], a[56:59], v[24:27]
  ds_read_b64_tr_b16 v[82:83], v8 offset:4096
  v_mfma_f32_16x16x32_bf16 v[28:31], v[116:119], a[60:63], v[28:31]
  buffer_load_dwordx4 v3, s[8:11], s24 offen lds
  ds_read_b64_tr_b16 v[84:85], v9 offset:0
  v_mfma_f32_16x16x32_bf16 v[32:35], v[120:123], a[56:59], v[32:35]
  ds_read_b64_tr_b16 v[86:87], v9 offset:4096
  ds_read_b64_tr_b16 v[88:89], v10 offset:0
  v_mfma_f32_16x16x32_bf16 v[36:39], v[120:123], a[60:63], v[36:39]
  buffer_load_dwordx4 a[108:111], v1, s[4:7], s23 offen offset:256 sc1
  v_mfma_f32_16x16x32_bf16 v[40:43], v[124:127], a[56:59], v[40:43]
  ds_read_b64_tr_b16 v[90:91], v10 offset:4096
  ds_read_b64_tr_b16 v[92:93], v11 offset:0
  v_mfma_f32_16x16x32_bf16 v[44:47], v[124:127], a[60:63], v[44:47]
  s_add_u32 m0, s26, 8192
  s_waitcnt lgkmcnt(7)
  v_mfma_f32_16x16x32_bf16 v[48:51], v[128:131], a[56:59], v[48:51]
  s_add_u32 s24, s25, 5636096
  ds_read_b64_tr_b16 v[94:95], v11 offset:4096
  v_mfma_f32_16x16x32_bf16 v[52:55], v[128:131], a[60:63], v[52:55]
  buffer_load_dwordx4 v3, s[8:11], s24 offen lds
  ds_read_b64_tr_b16 v[96:97], v8 offset:1024
  v_mfma_f32_16x16x32_bf16 v[56:59], v[132:135], a[56:59], v[56:59]
  ds_read_b64_tr_b16 v[98:99], v8 offset:5120
  v_mfma_f32_16x16x32_bf16 v[60:63], v[132:135], a[60:63], v[60:63]
  s_add_u32 s23, s63, 11796480
  ds_read_b64_tr_b16 v[100:101], v9 offset:1024
  v_mfma_f32_16x16x32_bf16 v[64:67], v[136:139], a[56:59], v[64:67]
  buffer_load_dwordx4 a[112:115], v1, s[4:7], s23 offen offset:0 sc1
  ds_read_b64_tr_b16 v[102:103], v9 offset:5120
  v_mfma_f32_16x16x32_bf16 v[68:71], v[136:139], a[60:63], v[68:71]
  ds_read_b64_tr_b16 v[104:105], v10 offset:1024
  v_mfma_f32_16x16x32_bf16 v[72:75], v[140:143], a[56:59], v[72:75]
  ds_read_b64_tr_b16 v[106:107], v10 offset:5120
  ds_read_b64_tr_b16 v[108:109], v11 offset:1024
  v_mfma_f32_16x16x32_bf16 v[76:79], v[140:143], a[60:63], v[76:79]
  ds_read_b64_tr_b16 v[110:111], v11 offset:5120
g2_s40:
  s_waitcnt vmcnt(17) lgkmcnt(8)
  v_mfma_f32_16x16x32_bf16 v[16:19], v[80:83], a[64:67], v[16:19]
  ds_read_b64_tr_b16 v[112:113], v8 offset:8192
  ds_read_b64_tr_b16 v[114:115], v8 offset:12288
  v_mfma_f32_16x16x32_bf16 v[20:23], v[80:83], a[68:71], v[20:23]
  buffer_load_dwordx4 a[116:119], v1, s[4:7], s23 offen offset:256 sc1
  v_mfma_f32_16x16x32_bf16 v[24:27], v[84:87], a[64:67], v[24:27]
  ds_read_b64_tr_b16 v[116:117], v9 offset:8192
  ds_read_b64_tr_b16 v[118:119], v9 offset:12288
  v_mfma_f32_16x16x32_bf16 v[28:31], v[84:87], a[68:71], v[28:31]
  s_add_u32 m0, s26, 16384
  v_mfma_f32_16x16x32_bf16 v[32:35], v[88:91], a[64:67], v[32:35]
  s_add_u32 s24, s25, 5701632
  v_mfma_f32_16x16x32_bf16 v[36:39], v[88:91], a[68:71], v[36:39]
  ds_read_b64_tr_b16 v[120:121], v10 offset:8192
  buffer_load_dwordx4 v164, s[8:11], s24 offen lds
  v_mfma_f32_16x16x32_bf16 v[40:43], v[92:95], a[64:67], v[40:43]
  ds_read_b64_tr_b16 v[122:123], v10 offset:12288
  v_mfma_f32_16x16x32_bf16 v[44:47], v[92:95], a[68:71], v[44:47]
  ds_read_b64_tr_b16 v[124:125], v11 offset:8192
  s_waitcnt lgkmcnt(7)
  v_mfma_f32_16x16x32_bf16 v[48:51], v[96:99], a[64:67], v[48:51]
  s_add_u32 s23, s63, 11927552
  ds_read_b64_tr_b16 v[126:127], v11 offset:12288
  v_mfma_f32_16x16x32_bf16 v[52:55], v[96:99], a[68:71], v[52:55]
  buffer_load_dwordx4 a[120:123], v1, s[4:7], s23 offen offset:0 sc1
  v_mfma_f32_16x16x32_bf16 v[56:59], v[100:103], a[64:67], v[56:59]
  ds_read_b64_tr_b16 v[128:129], v8 offset:9216
  ds_read_b64_tr_b16 v[130:131], v8 offset:13312
  v_mfma_f32_16x16x32_bf16 v[60:63], v[100:103], a[68:71], v[60:63]
  ds_read_b64_tr_b16 v[132:133], v9 offset:9216
  v_mfma_f32_16x16x32_bf16 v[64:67], v[104:107], a[64:67], v[64:67]
  ds_read_b64_tr_b16 v[134:135], v9 offset:13312
  v_mfma_f32_16x16x32_bf16 v[68:71], v[104:107], a[68:71], v[68:71]
  ds_read_b64_tr_b16 v[136:137], v10 offset:9216
  ds_read_b64_tr_b16 v[138:139], v10 offset:13312
  v_mfma_f32_16x16x32_bf16 v[72:75], v[108:111], a[64:67], v[72:75]
  ds_read_b64_tr_b16 v[140:141], v11 offset:9216
  v_mfma_f32_16x16x32_bf16 v[76:79], v[108:111], a[68:71], v[76:79]
  ds_read_b64_tr_b16 v[142:143], v11 offset:13312
g2_s41:
  s_waitcnt vmcnt(17) lgkmcnt(8)
  v_mfma_f32_16x16x32_bf16 v[16:19], v[112:115], a[72:75], v[16:19]
  ds_read_b64_tr_b16 v[80:81], v8 offset:16384
  ds_read_b64_tr_b16 v[82:83], v8 offset:20480
  v_mfma_f32_16x16x32_bf16 v[20:23], v[112:115], a[76:79], v[20:23]
  buffer_load_dwordx4 a[124:127], v1, s[4:7], s23 offen offset:256 sc1
  v_mfma_f32_16x16x32_bf16 v[24:27], v[116:119], a[72:75], v[24:27]
  ds_read_b64_tr_b16 v[84:85], v9 offset:16384
  ds_read_b64_tr_b16 v[86:87], v9 offset:20480
  v_mfma_f32_16x16x32_bf16 v[28:31], v[116:119], a[76:79], v[28:31]
  s_add_u32 m0, s26, 24576
  v_mfma_f32_16x16x32_bf16 v[32:35], v[120:123], a[72:75], v[32:35]
  s_add_u32 s24, s25, 5832704
  v_mfma_f32_16x16x32_bf16 v[36:39], v[120:123], a[76:79], v[36:39]
  ds_read_b64_tr_b16 v[88:89], v10 offset:16384
  buffer_load_dwordx4 v3, s[8:11], s24 offen lds
  v_mfma_f32_16x16x32_bf16 v[40:43], v[124:127], a[72:75], v[40:43]
  ds_read_b64_tr_b16 v[90:91], v10 offset:20480
  v_mfma_f32_16x16x32_bf16 v[44:47], v[124:127], a[76:79], v[44:47]
  ds_read_b64_tr_b16 v[92:93], v11 offset:16384
  s_waitcnt lgkmcnt(7)
  v_mfma_f32_16x16x32_bf16 v[48:51], v[128:131], a[72:75], v[48:51]
  s_add_u32 s23, s63, 12058624
  ds_read_b64_tr_b16 v[94:95], v11 offset:20480
  v_mfma_f32_16x16x32_bf16 v[52:55], v[128:131], a[76:79], v[52:55]
  buffer_load_dwordx4 a[0:3], v1, s[4:7], s23 offen offset:0 sc1
  v_mfma_f32_16x16x32_bf16 v[56:59], v[132:135], a[72:75], v[56:59]
  ds_read_b64_tr_b16 v[96:97], v8 offset:17408
  ds_read_b64_tr_b16 v[98:99], v8 offset:21504
  v_mfma_f32_16x16x32_bf16 v[60:63], v[132:135], a[76:79], v[60:63]
  ds_read_b64_tr_b16 v[100:101], v9 offset:17408
  v_mfma_f32_16x16x32_bf16 v[64:67], v[136:139], a[72:75], v[64:67]
  ds_read_b64_tr_b16 v[102:103], v9 offset:21504
  v_mfma_f32_16x16x32_bf16 v[68:71], v[136:139], a[76:79], v[68:71]
  ds_read_b64_tr_b16 v[104:105], v10 offset:17408
  ds_read_b64_tr_b16 v[106:107], v10 offset:21504
  v_mfma_f32_16x16x32_bf16 v[72:75], v[140:143], a[72:75], v[72:75]
  ds_read_b64_tr_b16 v[108:109], v11 offset:17408
  v_mfma_f32_16x16x32_bf16 v[76:79], v[140:143], a[76:79], v[76:79]
  ds_read_b64_tr_b16 v[110:111], v11 offset:21504
g2_s42:
  s_waitcnt vmcnt(17) lgkmcnt(8)
  v_mfma_f32_16x16x32_bf16 v[16:19], v[80:83], a[80:83], v[16:19]
  ds_read_b64_tr_b16 v[112:113], v8 offset:24576
  ds_read_b64_tr_b16 v[114:115], v8 offset:28672
  v_mfma_f32_16x16x32_bf16 v[20:23], v[80:83], a[84:87], v[20:23]
  buffer_load_dwordx4 a[4:7], v1, s[4:7], s23 offen offset:256 sc1
  v_mfma_f32_16x16x32_bf16 v[24:27], v[84:87], a[80:83], v[24:27]
  ds_read_b64_tr_b16 v[116:117], v9 offset:24576
  v_mfma_f32_16x16x32_bf16 v[28:31], v[84:87], a[84:87], v[28:31]
  ds_read_b64_tr_b16 v[118:119], v9 offset:28672
  v_mfma_f32_16x16x32_bf16 v[32:35], v[88:91], a[80:83], v[32:35]
  s_add_u32 s23, s63, 12189696
  v_mfma_f32_16x16x32_bf16 v[36:39], v[88:91], a[84:87], v[36:39]
  ds_read_b64_tr_b16 v[120:121], v10 offset:24576
  buffer_load_dwordx4 a[8:11], v1, s[4:7], s23 offen offset:0 sc1
  v_mfma_f32_16x16x32_bf16 v[40:43], v[92:95], a[80:83], v[40:43]
  ds_read_b64_tr_b16 v[122:123], v10 offset:28672
  v_mfma_f32_16x16x32_bf16 v[44:47], v[92:95], a[84:87], v[44:47]
  ds_read_b64_tr_b16 v[124:125], v11 offset:24576
  s_waitcnt lgkmcnt(7)
  v_mfma_f32_16x16x32_bf16 v[48:51], v[96:99], a[80:83], v[48:51]
  ds_read_b64_tr_b16 v[126:127], v11 offset:28672
  v_mfma_f32_16x16x32_bf16 v[52:55], v[96:99], a[84:87], v[52:55]
  ds_read_b64_tr_b16 v[128:129], v8 offset:25600
  v_mfma_f32_16x16x32_bf16 v[56:59], v[100:103], a[80:83], v[56:59]
  ds_read_b64_tr_b16 v[130:131], v8 offset:29696
  ds_read_b64_tr_b16 v[132:133], v9 offset:25600
  v_mfma_f32_16x16x32_bf16 v[60:63], v[100:103], a[84:87], v[60:63]
  ds_read_b64_tr_b16 v[134:135], v9 offset:29696
  v_mfma_f32_16x16x32_bf16 v[64:67], v[104:107], a[80:83], v[64:67]
  ds_read_b64_tr_b16 v[136:137], v10 offset:25600
  v_mfma_f32_16x16x32_bf16 v[68:71], v[104:107], a[84:87], v[68:71]
  ds_read_b64_tr_b16 v[138:139], v10 offset:29696
  v_mfma_f32_16x16x32_bf16 v[72:75], v[108:111], a[80:83], v[72:75]
  ds_read_b64_tr_b16 v[140:141], v11 offset:25600
  v_mfma_f32_16x16x32_bf16 v[76:79], v[108:111], a[84:87], v[76:79]
  ds_read_b64_tr_b16 v[142:143], v11 offset:29696
g2_s43:
  s_waitcnt vmcnt(15) lgkmcnt(8)
  v_mfma_f32_16x16x32_bf16 v[16:19], v[112:115], a[88:91], v[16:19]
  s_barrier
  ds_read_b64_tr_b16 v[80:81], v8 offset:32768
  v_mfma_f32_16x16x32_bf16 v[20:23], v[112:115], a[92:95], v[20:23]
  s_add_u32 m0, s26, 32768
  v_mfma_f32_16x16x32_bf16 v[24:27], v[116:119], a[88:91], v[24:27]
  s_add_u32 s24, s25, 5898240
  v_mfma_f32_16x16x32_bf16 v[28:31], v[116:119], a[92:95], v[28:31]
  ds_read_b64_tr_b16 v[82:83], v8 offset:36864
  v_mfma_f32_16x16x32_bf16 v[32:35], v[120:123], a[88:91], v[32:35]
  buffer_load_dwordx4 v3, s[8:11], s24 offen lds
  v_mfma_f32_16x16x32_bf16 v[36:39], v[120:123], a[92:95], v[36:39]
  ds_read_b64_tr_b16 v[84:85], v9 offset:32768
  v_mfma_f32_16x16x32_bf16 v[40:43], v[124:127], a[88:91], v[40:43]
  ds_read_b64_tr_b16 v[86:87], v9 offset:36864
  v_mfma_f32_16x16x32_bf16 v[44:47], v[124:127], a[92:95], v[44:47]
  ds_read_b64_tr_b16 v[88:89], v10 offset:32768
  s_waitcnt lgkmcnt(5)
  v_mfma_f32_16x16x32_bf16 v[48:51], v[128:131], a[88:91], v[48:51]
  buffer_load_dwordx4 a[12:15], v1, s[4:7], s23 offen offset:256 sc1
  ds_read_b64_tr_b16 v[90:91], v10 offset:36864
  v_mfma_f32_16x16x32_bf16 v[52:55], v[128:131], a[92:95], v[52:55]
  ds_read_b64_tr_b16 v[92:93], v11 offset:32768
  v_mfma_f32_16x16x32_bf16 v[56:59], v[132:135], a[88:91], v[56:59]
  s_add_u32 m0, s26, 40960
  v_mfma_f32_16x16x32_bf16 v[60:63], v[132:135], a[92:95], v[60:63]
  s_add_u32 s24, s25, 6029312
  v_mfma_f32_16x16x32_bf16 v[64:67], v[136:139], a[88:91], v[64:67]
  ds_read_b64_tr_b16 v[94:95], v11 offset:36864
  v_mfma_f32_16x16x32_bf16 v[68:71], v[136:139], a[92:95], v[68:71]
  buffer_load_dwordx4 v3, s[8:11], s24 offen lds
  v_mfma_f32_16x16x32_bf16 v[72:75], v[140:143], a[88:91], v[72:75]
  s_add_u32 s23, s63, 12320768
  v_mfma_f32_16x16x32_bf16 v[76:79], v[140:143], a[92:95], v[76:79]
  buffer_load_dwordx4 a[16:19], v1, s[4:7], s23 offen offset:0 sc1
g2_s44:
  s_waitcnt vmcnt(17) lgkmcnt(4)
  v_mfma_f32_16x16x32_bf16 v[16:19], v[80:83], a[96:99], v[16:19]
  ds_read_b64_tr_b16 v[112:113], v8 offset:40960
  v_cvt_pk_bf16_f32 v48, v48, v49
  v_cvt_pk_bf16_f32 v49, v50, v51
  ds_read_b64_tr_b16 v[114:115], v8 offset:45056
  v_cvt_pk_bf16_f32 v50, v52, v53
  v_mfma_f32_16x16x32_bf16 v[20:23], v[80:83], a[100:103], v[20:23]
  v_cvt_pk_bf16_f32 v51, v54, v55
  buffer_load_dwordx4 a[20:23], v1, s[4:7], s23 offen offset:256 sc1
  ds_read_b64_tr_b16 v[116:117], v9 offset:40960
  v_cvt_pk_bf16_f32 v52, v56, v57
  v_mfma_f32_16x16x32_bf16 v[24:27], v[84:87], a[96:99], v[24:27]
  v_cvt_pk_bf16_f32 v53, v58, v59
  s_add_u32 m0, s26, 49152
  s_add_u32 s24, s25, 6094848
  ds_read_b64_tr_b16 v[118:119], v9 offset:45056
  v_mfma_f32_16x16x32_bf16 v[28:31], v[84:87], a[100:103], v[28:31]
  v_cvt_pk_bf16_f32 v54, v60, v61
  v_cvt_pk_bf16_f32 v55, v62, v63
  buffer_load_dwordx4 v3, s[8:11], s24 offen lds
  ds_read_b64_tr_b16 v[120:121], v10 offset:40960
  s_waitcnt lgkmcnt(5)
  v_mfma_f32_16x16x32_bf16 v[32:35], v[88:91], a[96:99], v[32:35]
  v_cvt_pk_bf16_f32 v56, v64, v65
  v_cvt_pk_bf16_f32 v57, v66, v67
  s_add_u32 s23, s63, 12451840
  ds_read_b64_tr_b16 v[122:123], v10 offset:45056
  v_cvt_pk_bf16_f32 v58, v68, v69
  v_mfma_f32_16x16x32_bf16 v[36:39], v[88:91], a[100:103], v[36:39]
  v_cvt_pk_bf16_f32 v59, v70, v71
  s_add_u32 s51, s50, g2_s56 - g2_pc
  s_min_u32 s51, s51, code_end - g2_pc - 4
  buffer_load_dwordx4 a[24:27], v1, s[4:7], s23 offen offset:0 sc1
  v_mfma_f32_16x16x32_bf16 v[40:43], v[92:95], a[96:99], v[40:43]
  ds_read_b64_tr_b16 v[124:125], v11 offset:40960
  v_cvt_pk_bf16_f32 v60, v72, v73
  v_cvt_pk_bf16_f32 v61, v74, v75
  v_mov_b32 v162, s51
  v_mfma_f32_16x16x32_bf16 v[44:47], v[92:95], a[100:103], v[44:47]
  global_load_dword a128, v162, s[48:49]
  ds_read_b64_tr_b16 v[126:127], v11 offset:45056
  v_cvt_pk_bf16_f32 v62, v76, v77
  v_cvt_pk_bf16_f32 v63, v78, v79
g2_s45:
  s_waitcnt vmcnt(18) lgkmcnt(4)
  v_mfma_f32_16x16x32_bf16 v[16:19], v[112:115], a[104:107], v[16:19]
  ds_read_b64_tr_b16 v[80:81], v8 offset:49152
  ds_read_b64_tr_b16 v[82:83], v8 offset:53248
  v_mfma_f32_16x16x32_bf16 v[20:23], v[112:115], a[108:111], v[20:23]
  buffer_load_dwordx4 a[28:31], v1, s[4:7], s23 offen offset:256 sc1
  ds_read_b64_tr_b16 v[84:85], v9 offset:49152
  v_mfma_f32_16x16x32_bf16 v[24:27], v[116:119], a[104:107], v[24:27]
  buffer_store_dwordx4 v[48:51], v2, s[40:43], s44 offen offset:0 sc0 sc1
  s_add_u32 m0, s26, 57344
  v_mfma_f32_16x16x32_bf16 v[28:31], v[116:119], a[108:111], v[28:31]
  s_add_u32 s24, s25, 6160384
  ds_read_b64_tr_b16 v[86:87], v9 offset:53248
  s_waitcnt lgkmcnt(4)
  v_mfma_f32_16x16x32_bf16 v[32:35], v[120:123], a[104:107], v[32:35]
  buffer_load_dwordx4 v164, s[8:11], s24 offen lds
  ds_read_b64_tr_b16 v[88:89], v10 offset:49152
  v_mfma_f32_16x16x32_bf16 v[36:39], v[120:123], a[108:111], v[36:39]
  buffer_store_dwordx4 v[52:55], v2, s[40:43], s44 offen offset:1024 sc0 sc1
  s_add_u32 s23, s63, 12582912
  v_mfma_f32_16x16x32_bf16 v[40:43], v[124:127], a[104:107], v[40:43]
  ds_read_b64_tr_b16 v[90:91], v10 offset:53248
  buffer_load_dwordx4 a[32:35], v1, s[4:7], s23 offen offset:0 sc1
  v_mfma_f32_16x16x32_bf16 v[44:47], v[124:127], a[108:111], v[44:47]
  ds_read_b64_tr_b16 v[92:93], v11 offset:49152
  ds_read_b64_tr_b16 v[94:95], v11 offset:53248
g2_s46:
  s_waitcnt vmcnt(20) lgkmcnt(4)
  v_mfma_f32_16x16x32_bf16 v[16:19], v[80:83], a[112:115], v[16:19]
  ds_read_b64_tr_b16 v[112:113], v8 offset:57344
  ds_read_b64_tr_b16 v[114:115], v8 offset:61440
  v_mfma_f32_16x16x32_bf16 v[20:23], v[80:83], a[116:119], v[20:23]
  buffer_load_dwordx4 a[36:39], v1, s[4:7], s23 offen offset:256 sc1
  ds_read_b64_tr_b16 v[116:117], v9 offset:57344
  v_mfma_f32_16x16x32_bf16 v[24:27], v[84:87], a[112:115], v[24:27]
  buffer_store_dwordx4 v[56:59], v2, s[40:43], s44 offen offset:2048 sc0 sc1
  s_add_u32 s23, s63, 12713984
  v_mfma_f32_16x16x32_bf16 v[28:31], v[84:87], a[116:119], v[28:31]
  ds_read_b64_tr_b16 v[118:119], v9 offset:61440
  s_waitcnt lgkmcnt(4)
  v_mfma_f32_16x16x32_bf16 v[32:35], v[88:91], a[112:115], v[32:35]
  buffer_load_dwordx4 a[40:43], v1, s[4:7], s23 offen offset:0 sc1
  ds_read_b64_tr_b16 v[120:121], v10 offset:57344
  v_mfma_f32_16x16x32_bf16 v[36:39], v[88:91], a[116:119], v[36:39]
  buffer_store_dwordx4 v[60:63], v2, s[40:43], s44 offen offset:3072 sc0 sc1
  s_add_u32 s44, s44, 4096
  v_mfma_f32_16x16x32_bf16 v[40:43], v[92:95], a[112:115], v[40:43]
  ds_read_b64_tr_b16 v[122:123], v10 offset:61440
  ds_read_b64_tr_b16 v[124:125], v11 offset:57344
  v_mfma_f32_16x16x32_bf16 v[44:47], v[92:95], a[116:119], v[44:47]
  ds_read_b64_tr_b16 v[126:127], v11 offset:61440
g2_s47:
  s_waitcnt vmcnt(20) lgkmcnt(4)
  v_mfma_f32_16x16x32_bf16 v[16:19], v[112:115], a[120:123], v[16:19]
  s_barrier
  ds_read_b64_tr_b16 v[80:81], v4 offset:0
  s_add_u32 m0, s26, 65536
  v_mfma_f32_16x16x32_bf16 v[20:23], v[112:115], a[124:127], v[20:23]
  s_add_u32 s24, s25, 6291456
  ds_read_b64_tr_b16 v[82:83], v4 offset:4096
  v_mfma_f32_16x16x32_bf16 v[24:27], v[116:119], a[120:123], v[24:27]
  buffer_load_dwordx4 v3, s[8:11], s24 offen lds
  ds_read_b64_tr_b16 v[84:85], v5 offset:0
  v_mfma_f32_16x16x32_bf16 v[28:31], v[116:119], a[124:127], v[28:31]
  ds_read_b64_tr_b16 v[86:87], v5 offset:4096
  buffer_load_dwordx4 a[44:47], v1, s[4:7], s23 offen offset:256 sc1
  s_waitcnt lgkmcnt(4)
  v_mfma_f32_16x16x32_bf16 v[32:35], v[120:123], a[120:123], v[32:35]
  ds_read_b64_tr_b16 v[88:89], v6 offset:0
  s_add_u32 m0, s26, 73728
  s_add_u32 s24, s25, 6356992
  v_mfma_f32_16x16x32_bf16 v[36:39], v[120:123], a[124:127], v[36:39]
  ds_read_b64_tr_b16 v[90:91], v6 offset:4096
  buffer_load_dwordx4 v3, s[8:11], s24 offen lds
  v_mfma_f32_16x16x32_bf16 v[40:43], v[124:127], a[120:123], v[40:43]
  ds_read_b64_tr_b16 v[92:93], v7 offset:0
  s_add_u32 s23, s63, 12845056
  v_mfma_f32_16x16x32_bf16 v[44:47], v[124:127], a[124:127], v[44:47]
  ds_read_b64_tr_b16 v[94:95], v7 offset:4096
  buffer_load_dwordx4 a[48:51], v1, s[4:7], s23 offen offset:0 sc1
g2_s48:
  s_waitcnt vmcnt(22) lgkmcnt(4)
  v_mfma_f32_16x16x32_bf16 v[16:19], v[80:83], a[0:3], v[16:19]
  ds_read_b64_tr_b16 v[112:113], v4 offset:8192
  ds_read_b64_tr_b16 v[114:115], v4 offset:12288
  v_mfma_f32_16x16x32_bf16 v[20:23], v[80:83], a[4:7], v[20:23]
  buffer_load_dwordx4 a[52:55], v1, s[4:7], s23 offen offset:256 sc1
  ds_read_b64_tr_b16 v[116:117], v5 offset:8192
  v_mfma_f32_16x16x32_bf16 v[24:27], v[84:87], a[0:3], v[24:27]
  s_add_u32 m0, s26, 81920
  s_add_u32 s24, s25, 6488064
  v_mfma_f32_16x16x32_bf16 v[28:31], v[84:87], a[4:7], v[28:31]
  ds_read_b64_tr_b16 v[118:119], v5 offset:12288
  s_waitcnt lgkmcnt(4)
  v_mfma_f32_16x16x32_bf16 v[32:35], v[88:91], a[0:3], v[32:35]
  buffer_load_dwordx4 v3, s[8:11], s24 offen lds
  ds_read_b64_tr_b16 v[120:121], v6 offset:8192
  v_mfma_f32_16x16x32_bf16 v[36:39], v[88:91], a[4:7], v[36:39]
  s_add_u32 s23, s63, 12976128
  ds_read_b64_tr_b16 v[122:123], v6 offset:12288
  v_mfma_f32_16x16x32_bf16 v[40:43], v[92:95], a[0:3], v[40:43]
  buffer_load_dwordx4 a[56:59], v1, s[4:7], s23 offen offset:0 sc1
  ds_read_b64_tr_b16 v[124:125], v7 offset:8192
  v_mfma_f32_16x16x32_bf16 v[44:47], v[92:95], a[4:7], v[44:47]
  ds_read_b64_tr_b16 v[126:127], v7 offset:12288
g2_s49:
  s_waitcnt vmcnt(22) lgkmcnt(4)
  v_mfma_f32_16x16x32_bf16 v[16:19], v[112:115], a[8:11], v[16:19]
  ds_read_b64_tr_b16 v[80:81], v4 offset:16384
  ds_read_b64_tr_b16 v[82:83], v4 offset:20480
  v_mfma_f32_16x16x32_bf16 v[20:23], v[112:115], a[12:15], v[20:23]
  buffer_load_dwordx4 a[60:63], v1, s[4:7], s23 offen offset:256 sc1
  ds_read_b64_tr_b16 v[84:85], v5 offset:16384
  v_mfma_f32_16x16x32_bf16 v[24:27], v[116:119], a[8:11], v[24:27]
  s_add_u32 m0, s26, 90112
  s_add_u32 s24, s25, 6553600
  v_mfma_f32_16x16x32_bf16 v[28:31], v[116:119], a[12:15], v[28:31]
  ds_read_b64_tr_b16 v[86:87], v5 offset:20480
  s_waitcnt lgkmcnt(4)
  v_mfma_f32_16x16x32_bf16 v[32:35], v[120:123], a[8:11], v[32:35]
  buffer_load_dwordx4 v3, s[8:11], s24 offen lds
  ds_read_b64_tr_b16 v[88:89], v6 offset:16384
  v_mfma_f32_16x16x32_bf16 v[36:39], v[120:123], a[12:15], v[36:39]
  s_add_u32 s23, s63, 13107200
  ds_read_b64_tr_b16 v[90:91], v6 offset:20480
  v_mfma_f32_16x16x32_bf16 v[40:43], v[124:127], a[8:11], v[40:43]
  buffer_load_dwordx4 a[64:67], v1, s[4:7], s23 offen offset:0 sc1
  ds_read_b64_tr_b16 v[92:93], v7 offset:16384
  v_mfma_f32_16x16x32_bf16 v[44:47], v[124:127], a[12:15], v[44:47]
  ds_read_b64_tr_b16 v[94:95], v7 offset:20480
g2_s50:
  s_waitcnt vmcnt(22) lgkmcnt(4)
  v_mfma_f32_16x16x32_bf16 v[16:19], v[80:83], a[16:19], v[16:19]
  ds_read_b64_tr_b16 v[112:113], v4 offset:24576
  ds_read_b64_tr_b16 v[114:115], v4 offset:28672
  v_mfma_f32_16x16x32_bf16 v[20:23], v[80:83], a[20:23], v[20:23]
  buffer_load_dwordx4 a[68:71], v1, s[4:7], s23 offen offset:256 sc1
  v_mfma_f32_16x16x32_bf16 v[24:27], v[84:87], a[16:19], v[24:27]
  ds_read_b64_tr_b16 v[116:117], v5 offset:24576
  s_add_u32 s23, s63, 13238272
  v_mfma_f32_16x16x32_bf16 v[28:31], v[84:87], a[20:23], v[28:31]
  ds_read_b64_tr_b16 v[118:119], v5 offset:28672
  s_waitcnt lgkmcnt(4)
  v_mfma_f32_16x16x32_bf16 v[32:35], v[88:91], a[16:19], v[32:35]
  buffer_load_dwordx4 a[72:75], v1, s[4:7], s23 offen offset:0 sc1
  v_mfma_f32_16x16x32_bf16 v[36:39], v[88:91], a[20:23], v[36:39]
  ds_read_b64_tr_b16 v[120:121], v6 offset:24576
  ds_read_b64_tr_b16 v[122:123], v6 offset:28672
  v_mfma_f32_16x16x32_bf16 v[40:43], v[92:95], a[16:19], v[40:43]
  ds_read_b64_tr_b16 v[124:125], v7 offset:24576
  v_mfma_f32_16x16x32_bf16 v[44:47], v[92:95], a[20:23], v[44:47]
  ds_read_b64_tr_b16 v[126:127], v7 offset:28672
g2_s51:
  s_waitcnt vmcnt(18) lgkmcnt(4)
  v_mfma_f32_16x16x32_bf16 v[16:19], v[112:115], a[24:27], v[16:19]
  s_barrier
  ds_read_b64_tr_b16 v[80:81], v4 offset:32768
  s_add_u32 m0, s26, 98304
  v_mfma_f32_16x16x32_bf16 v[20:23], v[112:115], a[28:31], v[20:23]
  s_add_u32 s24, s25, 6619136
  ds_read_b64_tr_b16 v[82:83], v4 offset:36864
  v_mfma_f32_16x16x32_bf16 v[24:27], v[116:119], a[24:27], v[24:27]
  buffer_load_dwordx4 v164, s[8:11], s24 offen lds
  ds_read_b64_tr_b16 v[84:85], v5 offset:32768
  v_mfma_f32_16x16x32_bf16 v[28:31], v[116:119], a[28:31], v[28:31]
  ds_read_b64_tr_b16 v[86:87], v5 offset:36864
  buffer_load_dwordx4 a[76:79], v1, s[4:7], s23 offen offset:256 sc1
  s_waitcnt lgkmcnt(4)
  v_mfma_f32_16x16x32_bf16 v[32:35], v[120:123], a[24:27], v[32:35]
  ds_read_b64_tr_b16 v[88:89], v6 offset:32768
  s_add_u32 m0, s26, 106496
  s_add_u32 s24, s25, 6750208
  v_mfma_f32_16x16x32_bf16 v[36:39], v[120:123], a[28:31], v[36:39]
  ds_read_b64_tr_b16 v[90:91], v6 offset:36864
  buffer_load_dwordx4 v3, s[8:11], s24 offen lds
  v_mfma_f32_16x16x32_bf16 v[40:43], v[124:127], a[24:27], v[40:43]
  ds_read_b64_tr_b16 v[92:93], v7 offset:32768
  s_add_u32 s23, s63, 13369344
  v_mfma_f32_16x16x32_bf16 v[44:47], v[124:127], a[28:31], v[44:47]
  ds_read_b64_tr_b16 v[94:95], v7 offset:36864
  buffer_load_dwordx4 a[80:83], v1, s[4:7], s23 offen offset:0 sc1
g2_s52:
  s_waitcnt vmcnt(19) lgkmcnt(4)
  v_mfma_f32_16x16x32_bf16 v[16:19], v[80:83], a[32:35], v[16:19]
  ds_read_b64_tr_b16 v[112:113], v4 offset:40960
  ds_read_b64_tr_b16 v[114:115], v4 offset:45056
  v_mfma_f32_16x16x32_bf16 v[20:23], v[80:83], a[36:39], v[20:23]
  buffer_load_dwordx4 a[84:87], v1, s[4:7], s23 offen offset:256 sc1
  ds_read_b64_tr_b16 v[116:117], v5 offset:40960
  v_mfma_f32_16x16x32_bf16 v[24:27], v[84:87], a[32:35], v[24:27]
  s_add_u32 m0, s26, 114688
  s_add_u32 s24, s25, 6815744
  v_mfma_f32_16x16x32_bf16 v[28:31], v[84:87], a[36:39], v[28:31]
  ds_read_b64_tr_b16 v[118:119], v5 offset:45056
  s_waitcnt lgkmcnt(4)
  v_mfma_f32_16x16x32_bf16 v[32:35], v[88:91], a[32:35], v[32:35]
  buffer_load_dwordx4 v3, s[8:11], s24 offen lds
  ds_read_b64_tr_b16 v[120:121], v6 offset:40960
  v_mfma_f32_16x16x32_bf16 v[36:39], v[88:91], a[36:39], v[36:39]
  s_add_u32 s23, s63, 13500416
  ds_read_b64_tr_b16 v[122:123], v6 offset:45056
  v_mfma_f32_16x16x32_bf16 v[40:43], v[92:95], a[32:35], v[40:43]
  buffer_load_dwordx4 a[88:91], v1, s[4:7], s23 offen offset:0 sc1
  ds_read_b64_tr_b16 v[124:125], v7 offset:40960
  v_mfma_f32_16x16x32_bf16 v[44:47], v[92:95], a[36:39], v[44:47]
  ds_read_b64_tr_b16 v[126:127], v7 offset:45056
g2_s53:
  s_waitcnt vmcnt(17) lgkmcnt(4)
  v_mfma_f32_16x16x32_bf16 v[16:19], v[112:115], a[40:43], v[16:19]
  v_mov_b32 v12, 1
  v_mov_b32 v13, 0
  s_mov_b64 exec, 1
  buffer_store_dword v12, v13, s[40:43], s46 offen sc0 sc1
  s_mov_b64 exec, -1
  v_mfma_f32_16x16x32_bf16 v[20:23], v[112:115], a[44:47], v[20:23]
  v_mfma_f32_16x16x32_bf16 v[24:27], v[116:119], a[40:43], v[24:27]
  ds_read_b64_tr_b16 v[80:81], v4 offset:49152
  ds_read_b64_tr_b16 v[82:83], v4 offset:53248
  buffer_load_dwordx4 a[92:95], v1, s[4:7], s23 offen offset:256 sc1
  v_mfma_f32_16x16x32_bf16 v[28:31], v[116:119], a[44:47], v[28:31]
  ds_read_b64_tr_b16 v[84:85], v5 offset:49152
  s_add_u32 m0, s26, 122880
  s_waitcnt lgkmcnt(3)
  v_mfma_f32_16x16x32_bf16 v[32:35], v[120:123], a[40:43], v[32:35]
  s_add_u32 s24, s25, 6946816
  ds_read_b64_tr_b16 v[86:87], v5 offset:53248
  v_mfma_f32_16x16x32_bf16 v[36:39], v[120:123], a[44:47], v[36:39]
  buffer_load_dwordx4 v3, s[8:11], s24 offen lds
  ds_read_b64_tr_b16 v[88:89], v6 offset:49152
  s_add_u32 s23, s63, 13631488
  v_mfma_f32_16x16x32_bf16 v[40:43], v[124:127], a[40:43], v[40:43]
  ds_read_b64_tr_b16 v[90:91], v6 offset:53248
  buffer_load_dwordx4 a[96:99], v1, s[4:7], s23 offen offset:0 sc1
  v_mfma_f32_16x16x32_bf16 v[44:47], v[124:127], a[44:47], v[44:47]
  ds_read_b64_tr_b16 v[92:93], v7 offset:49152
  ds_read_b64_tr_b16 v[94:95], v7 offset:53248
g2_s54:
  s_waitcnt vmcnt(18) lgkmcnt(4)
  v_mfma_f32_16x16x32_bf16 v[16:19], v[80:83], a[48:51], v[16:19]
  ds_read_b64_tr_b16 v[112:113], v4 offset:57344
  ds_read_b64_tr_b16 v[114:115], v4 offset:61440
  v_mfma_f32_16x16x32_bf16 v[20:23], v[80:83], a[52:55], v[20:23]
  buffer_load_dwordx4 a[100:103], v1, s[4:7], s23 offen offset:256 sc1
  v_mfma_f32_16x16x32_bf16 v[24:27], v[84:87], a[48:51], v[24:27]
  ds_read_b64_tr_b16 v[116:117], v5 offset:57344
  s_add_u32 s23, s63, 13762560
  v_mfma_f32_16x16x32_bf16 v[28:31], v[84:87], a[52:55], v[28:31]
  ds_read_b64_tr_b16 v[118:119], v5 offset:61440
  s_waitcnt lgkmcnt(4)
  v_mfma_f32_16x16x32_bf16 v[32:35], v[88:91], a[48:51], v[32:35]
  buffer_load_dwordx4 a[104:107], v1, s[4:7], s23 offen offset:0 sc1
  v_mfma_f32_16x16x32_bf16 v[36:39], v[88:91], a[52:55], v[36:39]
  ds_read_b64_tr_b16 v[120:121], v6 offset:57344
  ds_read_b64_tr_b16 v[122:123], v6 offset:61440
  v_mfma_f32_16x16x32_bf16 v[40:43], v[92:95], a[48:51], v[40:43]
  ds_read_b64_tr_b16 v[124:125], v7 offset:57344
  v_mfma_f32_16x16x32_bf16 v[44:47], v[92:95], a[52:55], v[44:47]
  ds_read_b64_tr_b16 v[126:127], v7 offset:61440
g2_s55:
  s_waitcnt vmcnt(16) lgkmcnt(4)
  v_mfma_f32_16x16x32_bf16 v[16:19], v[112:115], a[56:59], v[16:19]
  s_barrier
  ds_read_b64_tr_b16 v[80:81], v8 offset:0
  s_add_u32 m0, s26, 0
  v_mfma_f32_16x16x32_bf16 v[20:23], v[112:115], a[60:63], v[20:23]
  s_add_u32 s24, s25, 7012352
  ds_read_b64_tr_b16 v[82:83], v8 offset:4096
  v_mfma_f32_16x16x32_bf16 v[24:27], v[116:119], a[56:59], v[24:27]
  buffer_load_dwordx4 v3, s[8:11], s24 offen lds
  ds_read_b64_tr_b16 v[84:85], v9 offset:0
  v_mfma_f32_16x16x32_bf16 v[28:31], v[116:119], a[60:63], v[28:31]
  ds_read_b64_tr_b16 v[86:87], v9 offset:4096
  buffer_load_dwordx4 a[108:111], v1, s[4:7], s23 offen offset:256 sc1
  s_waitcnt lgkmcnt(4)
  v_mfma_f32_16x16x32_bf16 v[32:35], v[120:123], a[56:59], v[32:35]
  ds_read_b64_tr_b16 v[88:89], v10 offset:0
  s_add_u32 m0, s26, 8192
  s_add_u32 s24, s25, 7077888
  v_mfma_f32_16x16x32_bf16 v[36:39], v[120:123], a[60:63], v[36:39]
  ds_read_b64_tr_b16 v[90:91], v10 offset:4096
  buffer_load_dwordx4 v164, s[8:11], s24 offen lds
  v_mfma_f32_16x16x32_bf16 v[40:43], v[124:127], a[56:59], v[40:43]
  ds_read_b64_tr_b16 v[92:93], v11 offset:0
  s_add_u32 s23, s63, 13893632
  v_mfma_f32_16x16x32_bf16 v[44:47], v[124:127], a[60:63], v[44:47]
  ds_read_b64_tr_b16 v[94:95], v11 offset:4096
  buffer_load_dwordx4 a[112:115], v1, s[4:7], s23 offen offset:0 sc1
g2_s56:
  s_waitcnt vmcnt(18) lgkmcnt(4)
  v_mfma_f32_16x16x32_bf16 v[16:19], v[80:83], a[64:67], v[16:19]
  v_lshlrev_b32 v176, 16, v144
  ds_read_b64_tr_b16 v[112:113], v8 offset:8192
  v_and_b32 v177, 0xffff0000, v144
  v_mfma_f32_16x16x32_bf16 v[20:23], v[80:83], a[68:71], v[20:23]
  ds_read_b64_tr_b16 v[114:115], v8 offset:12288
  buffer_load_dwordx4 a[116:119], v1, s[4:7], s23 offen offset:256 sc1
  v_lshlrev_b32 v178, 16, v145
  v_mfma_f32_16x16x32_bf16 v[24:27], v[84:87], a[64:67], v[24:27]
  ds_read_b64_tr_b16 v[116:117], v9 offset:8192
  s_add_u32 m0, s26, 16384
  s_add_u32 s24, s25, 7208960
  v_mfma_f32_16x16x32_bf16 v[28:31], v[84:87], a[68:71], v[28:31]
  v_and_b32 v179, 0xffff0000, v145
  ds_read_b64_tr_b16 v[118:119], v9 offset:12288
  s_waitcnt lgkmcnt(4)
  v_mfma_f32_16x16x32_bf16 v[32:35], v[88:91], a[64:67], v[32:35]
  buffer_load_dwordx4 v3, s[8:11], s24 offen lds
  v_lshlrev_b32 v180, 16, v146
  ds_read_b64_tr_b16 v[120:121], v10 offset:8192
  v_mfma_f32_16x16x32_bf16 v[36:39], v[88:91], a[68:71], v[36:39]
  s_add_u32 s23, s63, 14024704
  v_and_b32 v181, 0xffff0000, v146
  ds_read_b64_tr_b16 v[122:123], v10 offset:12288
  v_mfma_f32_16x16x32_bf16 v[40:43], v[92:95], a[64:67], v[40:43]
  buffer_load_dwordx4 a[120:123], v1, s[4:7], s23 offen offset:0 sc1
  v_lshlrev_b32 v182, 16, v147
  ds_read_b64_tr_b16 v[124:125], v11 offset:8192
  v_mfma_f32_16x16x32_bf16 v[44:47], v[92:95], a[68:71], v[44:47]
  v_and_b32 v183, 0xffff0000, v147
  ds_read_b64_tr_b16 v[126:127], v11 offset:12288
g2_s57:
  s_waitcnt vmcnt(18) lgkmcnt(4)
  v_mfma_f32_16x16x32_bf16 v[16:19], v[112:115], a[72:75], v[16:19]
  v_lshlrev_b32 v184, 16, v148
  ds_read_b64_tr_b16 v[80:81], v8 offset:16384
  v_and_b32 v185, 0xffff0000, v148
  v_mfma_f32_16x16x32_bf16 v[20:23], v[112:115], a[76:79], v[20:23]
  ds_read_b64_tr_b16 v[82:83], v8 offset:20480
  buffer_load_dwordx4 a[124:127], v1, s[4:7], s23 offen offset:256 sc1
  v_lshlrev_b32 v186, 16, v149
  v_mfma_f32_16x16x32_bf16 v[24:27], v[116:119], a[72:75], v[24:27]
  ds_read_b64_tr_b16 v[84:85], v9 offset:16384
  s_add_u32 m0, s26, 24576
  s_add_u32 s24, s25, 7274496
  v_mfma_f32_16x16x32_bf16 v[28:31], v[116:119], a[76:79], v[28:31]
  v_and_b32 v187, 0xffff0000, v149
  ds_read_b64_tr_b16 v[86:87], v9 offset:20480
  s_waitcnt lgkmcnt(4)
  v_mfma_f32_16x16x32_bf16 v[32:35], v[120:123], a[72:75], v[32:35]
  buffer_load_dwordx4 v3, s[8:11], s24 offen lds
  v_lshlrev_b32 v188, 16, v150
  ds_read_b64_tr_b16 v[88:89], v10 offset:16384
  v_mfma_f32_16x16x32_bf16 v[36:39], v[120:123], a[76:79], v[36:39]
  s_add_u32 s23, s63, 14155776
  v_and_b32 v189, 0xffff0000, v150
  ds_read_b64_tr_b16 v[90:91], v10 offset:20480
  v_mfma_f32_16x16x32_bf16 v[40:43], v[124:127], a[72:75], v[40:43]
  buffer_load_dwordx4 a[0:3], v1, s[4:7], s23 offen offset:0 sc1
  v_lshlrev_b32 v190, 16, v151
  ds_read_b64_tr_b16 v[92:93], v11 offset:16384
  v_mfma_f32_16x16x32_bf16 v[44:47], v[124:127], a[76:79], v[44:47]
  v_and_b32 v191, 0xffff0000, v151
  ds_read_b64_tr_b16 v[94:95], v11 offset:20480
g2_s58:
  s_waitcnt vmcnt(18) lgkmcnt(4)
  v_mfma_f32_16x16x32_bf16 v[16:19], v[80:83], a[80:83], v[16:19]
  buffer_load_dword v14, v13, s[40:43], s47 offen sc0 sc1
  v_lshlrev_b32 v192, 16, v152
  ds_read_b64_tr_b16 v[112:113], v8 offset:24576
  v_mfma_f32_16x16x32_bf16 v[20:23], v[80:83], a[84:87], v[20:23]
  v_and_b32 v193, 0xffff0000, v152
  ds_read_b64_tr_b16 v[114:115], v8 offset:28672
  v_mfma_f32_16x16x32_bf16 v[24:27], v[84:87], a[80:83], v[24:27]
  buffer_load_dwordx4 a[4:7], v1, s[4:7], s23 offen offset:256 sc1
  v_lshlrev_b32 v194, 16, v153
  ds_read_b64_tr_b16 v[116:117], v9 offset:24576
  v_mfma_f32_16x16x32_bf16 v[28:31], v[84:87], a[84:87], v[28:31]
  s_add_u32 s23, s63, 14286848
  v_and_b32 v195, 0xffff0000, v153
  s_waitcnt lgkmcnt(3)
  v_mfma_f32_16x16x32_bf16 v[32:35], v[88:91], a[80:83], v[32:35]
  ds_read_b64_tr_b16 v[118:119], v9 offset:28672
  buffer_load_dwordx4 a[8:11], v1, s[4:7], s23 offen offset:0 sc1
  v_lshlrev_b32 v196, 16, v154
  v_mfma_f32_16x16x32_bf16 v[36:39], v[88:91], a[84:87], v[36:39]
  ds_read_b64_tr_b16 v[120:121], v10 offset:24576
  v_and_b32 v197, 0xffff0000, v154
  v_mfma_f32_16x16x32_bf16 v[40:43], v[92:95], a[80:83], v[40:43]
  ds_read_b64_tr_b16 v[122:123], v10 offset:28672
  v_lshlrev_b32 v198, 16, v155
  ds_read_b64_tr_b16 v[124:125], v11 offset:24576
  v_mfma_f32_16x16x32_bf16 v[44:47], v[92:95], a[84:87], v[44:47]
  v_and_b32 v199, 0xffff0000, v155
  ds_read_b64_tr_b16 v[126:127], v11 offset:28672
g2_s59:
  s_waitcnt vmcnt(16) lgkmcnt(4)
  v_mfma_f32_16x16x32_bf16 v[16:19], v[112:115], a[88:91], v[16:19]
  v_lshlrev_b32 v200, 16, v156
  s_barrier
  ds_read_b64_tr_b16 v[80:81], v8 offset:32768
  v_mfma_f32_16x16x32_bf16 v[20:23], v[112:115], a[92:95], v[20:23]
  v_and_b32 v201, 0xffff0000, v156
  ds_read_b64_tr_b16 v[82:83], v8 offset:36864
  v_mfma_f32_16x16x32_bf16 v[24:27], v[116:119], a[88:91], v[24:27]
  buffer_load_dwordx4 a[12:15], v1, s[4:7], s23 offen offset:256 sc1
  v_lshlrev_b32 v202, 16, v157
  ds_read_b64_tr_b16 v[84:85], v9 offset:32768
  v_mfma_f32_16x16x32_bf16 v[28:31], v[116:119], a[92:95], v[28:31]
  s_add_u32 s23, s63, 14417920
  v_and_b32 v203, 0xffff0000, v157
  s_waitcnt lgkmcnt(3)
  v_mfma_f32_16x16x32_bf16 v[32:35], v[120:123], a[88:91], v[32:35]
  ds_read_b64_tr_b16 v[86:87], v9 offset:36864
  buffer_load_dwordx4 a[16:19], v1, s[4:7], s23 offen offset:0 sc1
  v_lshlrev_b32 v204, 16, v158
  v_mfma_f32_16x16x32_bf16 v[36:39], v[120:123], a[92:95], v[36:39]
  ds_read_b64_tr_b16 v[88:89], v10 offset:32768
  v_and_b32 v205, 0xffff0000, v158
  v_mfma_f32_16x16x32_bf16 v[40:43], v[124:127], a[88:91], v[40:43]
  ds_read_b64_tr_b16 v[90:91], v10 offset:36864
  v_lshlrev_b32 v206, 16, v159
  ds_read_b64_tr_b16 v[92:93], v11 offset:32768
  v_mfma_f32_16x16x32_bf16 v[44:47], v[124:127], a[92:95], v[44:47]
  v_and_b32 v207, 0xffff0000, v159
  ds_read_b64_tr_b16 v[94:95], v11 offset:36864
g2_s60:
  s_waitcnt vmcnt(16) lgkmcnt(4)
  v_mfma_f32_16x16x32_bf16 v[16:19], v[80:83], a[96:99], v[16:19]
  ds_read_b64_tr_b16 v[112:113], v8 offset:40960
  ds_read_b64_tr_b16 v[114:115], v8 offset:45056
  v_mfma_f32_16x16x32_bf16 v[20:23], v[80:83], a[100:103], v[20:23]
  buffer_load_dwordx4 a[20:23], v1, s[4:7], s23 offen offset:256 sc1
  v_mfma_f32_16x16x32_bf16 v[24:27], v[84:87], a[96:99], v[24:27]
  ds_read_b64_tr_b16 v[116:117], v9 offset:40960
  s_add_u32 s23, s63, 14548992
  v_mfma_f32_16x16x32_bf16 v[28:31], v[84:87], a[100:103], v[28:31]
  ds_read_b64_tr_b16 v[118:119], v9 offset:45056
  s_waitcnt lgkmcnt(4)
  v_mfma_f32_16x16x32_bf16 v[32:35], v[88:91], a[96:99], v[32:35]
  buffer_load_dwordx4 a[24:27], v1, s[4:7], s23 offen offset:0 sc1
  v_mfma_f32_16x16x32_bf16 v[36:39], v[88:91], a[100:103], v[36:39]
  ds_read_b64_tr_b16 v[120:121], v10 offset:40960
  ds_read_b64_tr_b16 v[122:123], v10 offset:45056
  v_mfma_f32_16x16x32_bf16 v[40:43], v[92:95], a[96:99], v[40:43]
  ds_read_b64_tr_b16 v[124:125], v11 offset:40960
  v_mfma_f32_16x16x32_bf16 v[44:47], v[92:95], a[100:103], v[44:47]
  ds_read_b64_tr_b16 v[126:127], v11 offset:45056
g2_s61:
  s_waitcnt vmcnt(15) lgkmcnt(4)
  v_mfma_f32_16x16x32_bf16 v[16:19], v[112:115], a[104:107], v[16:19]
  ds_read_b64_tr_b16 v[80:81], v8 offset:49152
  ds_read_b64_tr_b16 v[82:83], v8 offset:53248
  v_mfma_f32_16x16x32_bf16 v[20:23], v[112:115], a[108:111], v[20:23]
  buffer_load_dwordx4 a[28:31], v1, s[4:7], s23 offen offset:256 sc1
  v_mfma_f32_16x16x32_bf16 v[24:27], v[116:119], a[104:107], v[24:27]
  ds_read_b64_tr_b16 v[84:85], v9 offset:49152
  v_mfma_f32_16x16x32_bf16 v[28:31], v[116:119], a[108:111], v[28:31]
  ds_read_b64_tr_b16 v[86:87], v9 offset:53248
  s_waitcnt lgkmcnt(4)
  v_mfma_f32_16x16x32_bf16 v[32:35], v[120:123], a[104:107], v[32:35]
  ds_read_b64_tr_b16 v[88:89], v10 offset:49152
  v_mfma_f32_16x16x32_bf16 v[36:39], v[120:123], a[108:111], v[36:39]
  ds_read_b64_tr_b16 v[90:91], v10 offset:53248
  v_mfma_f32_16x16x32_bf16 v[40:43], v[124:127], a[104:107], v[40:43]
  ds_read_b64_tr_b16 v[92:93], v11 offset:49152
  v_mfma_f32_16x16x32_bf16 v[44:47], v[124:127], a[108:111], v[44:47]
  ds_read_b64_tr_b16 v[94:95], v11 offset:53248
g2_s62:
  s_waitcnt vmcnt(13) lgkmcnt(4)
  v_mfma_f32_16x16x32_bf16 v[16:19], v[80:83], a[112:115], v[16:19]
  s_waitcnt vmcnt(7)
  s_mov_b32 s36, 0
g2_spin:
  v_readfirstlane_b32 s37, v14
  s_cmp_eq_u32 s37, 1
  s_cbranch_scc1 g2_got
  buffer_load_dword v14, v13, s[40:43], s47 offen sc0 sc1
  s_add_u32 s36, s36, 1
  s_cmp_lt_u32 s36, 0x40000
  s_waitcnt vmcnt(0)
  s_cbranch_scc1 g2_spin
g2_got:
  v_mfma_f32_16x16x32_bf16 v[20:23], v[80:83], a[116:119], v[20:23]
  ds_read_b64_tr_b16 v[112:113], v8 offset:57344
  buffer_load_dwordx4 v[48:51], v2, s[40:43], s45 offen offset:0 sc0 sc1
  v_mfma_f32_16x16x32_bf16 v[24:27], v[84:87], a[112:115], v[24:27]
  ds_read_b64_tr_b16 v[114:115], v8 offset:61440
  ds_read_b64_tr_b16 v[116:117], v9 offset:57344
  v_mfma_f32_16x16x32_bf16 v[28:31], v[84:87], a[116:119], v[28:31]
  buffer_load_dwordx4 v[52:55], v2, s[40:43], s45 offen offset:1024 sc0 sc1
  ds_read_b64_tr_b16 v[118:119], v9 offset:61440
  s_waitcnt lgkmcnt(4)
  v_mfma_f32_16x16x32_bf16 v[32:35], v[88:91], a[112:115], v[32:35]
  ds_read_b64_tr_b16 v[120:121], v10 offset:57344
  buffer_load_dwordx4 v[56:59], v2, s[40:43], s45 offen offset:2048 sc0 sc1
  v_mfma_f32_16x16x32_bf16 v[36:39], v[88:91], a[116:119], v[36:39]
  ds_read_b64_tr_b16 v[122:123], v10 offset:61440
  ds_read_b64_tr_b16 v[124:125], v11 offset:57344
  v_mfma_f32_16x16x32_bf16 v[40:43], v[92:95], a[112:115], v[40:43]
  buffer_load_dwordx4 v[60:63], v2, s[40:43], s45 offen offset:3072 sc0 sc1
  s_add_u32 s45, s45, 4096
  v_mfma_f32_16x16x32_bf16 v[44:47], v[92:95], a[116:119], v[44:47]
  ds_read_b64_tr_b16 v[126:127], v11 offset:61440
g2_s63:
  s_waitcnt vmcnt(13) lgkmcnt(4)
  v_mfma_f32_16x16x32_bf16 v[16:19], v[112:115], a[120:123], v[16:19]
  s_barrier
  ds_read_b64_tr_b16 v[80:81], v4 offset:0
  v_mfma_f32_16x16x32_bf16 v[20:23], v[112:115], a[124:127], v[20:23]
  ds_read_b64_tr_b16 v[82:83], v4 offset:4096
  v_mfma_f32_16x16x32_bf16 v[24:27], v[116:119], a[120:123], v[24:27]
  ds_read_b64_tr_b16 v[84:85], v5 offset:0
  v_mfma_f32_16x16x32_bf16 v[28:31], v[116:119], a[124:127], v[28:31]
  ds_read_b64_tr_b16 v[86:87], v5 offset:4096
  s_waitcnt lgkmcnt(4)
  v_mfma_f32_16x16x32_bf16 v[32:35], v[120:123], a[120:123], v[32:35]
  ds_read_b64_tr_b16 v[88:89], v6 offset:0
  v_mfma_f32_16x16x32_bf16 v[36:39], v[120:123], a[124:127], v[36:39]
  ds_read_b64_tr_b16 v[90:91], v6 offset:4096
  v_mfma_f32_16x16x32_bf16 v[40:43], v[124:127], a[120:123], v[40:43]
  ds_read_b64_tr_b16 v[92:93], v7 offset:0
  v_mfma_f32_16x16x32_bf16 v[44:47], v[124:127], a[124:127], v[44:47]
  ds_read_b64_tr_b16 v[94:95], v7 offset:4096
g2_s64:
  s_waitcnt vmcnt(10) lgkmcnt(4)
  v_mfma_f32_16x16x32_bf16 v[16:19], v[80:83], a[0:3], v[16:19]
  ds_read_b64_tr_b16 v[112:113], v4 offset:8192
  v_mfma_f32_16x16x32_bf16 v[20:23], v[80:83], a[4:7], v[20:23]
  ds_read_b64_tr_b16 v[114:115], v4 offset:12288
  v_mfma_f32_16x16x32_bf16 v[24:27], v[84:87], a[0:3], v[24:27]
  ds_read_b64_tr_b16 v[116:117], v5 offset:8192
  v_mfma_f32_16x16x32_bf16 v[28:31], v[84:87], a[4:7], v[28:31]
  ds_read_b64_tr_b16 v[118:119], v5 offset:12288
  s_waitcnt lgkmcnt(4)
  v_mfma_f32_16x16x32_bf16 v[32:35], v[88:91], a[0:3], v[32:35]
  ds_read_b64_tr_b16 v[120:121], v6 offset:8192
  v_mfma_f32_16x16x32_bf16 v[36:39], v[88:91], a[4:7], v[36:39]
  ds_read_b64_tr_b16 v[122:123], v6 offset:12288
  v_mfma_f32_16x16x32_bf16 v[40:43], v[92:95], a[0:3], v[40:43]
  ds_read_b64_tr_b16 v[124:125], v7 offset:8192
  v_mfma_f32_16x16x32_bf16 v[44:47], v[92:95], a[4:7], v[44:47]
  ds_read_b64_tr_b16 v[126:127], v7 offset:12288
g2_s65:
  s_waitcnt vmcnt(8) lgkmcnt(4)
  v_mfma_f32_16x16x32_bf16 v[16:19], v[112:115], a[8:11], v[16:19]
  ds_read_b64_tr_b16 v[80:81], v4 offset:16384
  v_mfma_f32_16x16x32_bf16 v[20:23], v[112:115], a[12:15], v[20:23]
  ds_read_b64_tr_b16 v[82:83], v4 offset:20480
  v_mfma_f32_16x16x32_bf16 v[24:27], v[116:119], a[8:11], v[24:27]
  ds_read_b64_tr_b16 v[84:85], v5 offset:16384
  v_mfma_f32_16x16x32_bf16 v[28:31], v[116:119], a[12:15], v[28:31]
  ds_read_b64_tr_b16 v[86:87], v5 offset:20480
  s_waitcnt lgkmcnt(4)
  v_mfma_f32_16x16x32_bf16 v[32:35], v[120:123], a[8:11], v[32:35]
  ds_read_b64_tr_b16 v[88:89], v6 offset:16384
  v_mfma_f32_16x16x32_bf16 v[36:39], v[120:123], a[12:15], v[36:39]
  ds_read_b64_tr_b16 v[90:91], v6 offset:20480
  v_mfma_f32_16x16x32_bf16 v[40:43], v[124:127], a[8:11], v[40:43]
  ds_read_b64_tr_b16 v[92:93], v7 offset:16384
  v_mfma_f32_16x16x32_bf16 v[44:47], v[124:127], a[12:15], v[44:47]
  ds_read_b64_tr_b16 v[94:95], v7 offset:20480
g2_s66:
  s_waitcnt vmcnt(6) lgkmcnt(4)
  v_mfma_f32_16x16x32_bf16 v[16:19], v[80:83], a[16:19], v[16:19]
  v_and_b32 v13, 15, v15
  ds_read_b64_tr_b16 v[112:113], v4 offset:24576
  v_lshlrev_b32 v12, 11, v13
  v_mfma_f32_16x16x32_bf16 v[20:23], v[80:83], a[20:23], v[20:23]
  ds_read_b64_tr_b16 v[114:115], v4 offset:28672
  v_bfe_u32 v13, v15, 4, 1
  v_mfma_f32_16x16x32_bf16 v[24:27], v[84:87], a[16:19], v[24:27]
  ds_read_b64_tr_b16 v[116:117], v5 offset:24576
  v_lshl_add_u32 v12, v13, 5, v12
  v_mfma_f32_16x16x32_bf16 v[28:31], v[84:87], a[20:23], v[28:31]
  ds_read_b64_tr_b16 v[118:119], v5 offset:28672
  v_lshrrev_b32 v13, 5, v15
  s_waitcnt lgkmcnt(4)
  v_mfma_f32_16x16x32_bf16 v[32:35], v[88:91], a[16:19], v[32:35]
  ds_read_b64_tr_b16 v[120:121], v6 offset:24576
  v_lshl_add_u32 v12, v13, 4, v12
  ds_read_b64_tr_b16 v[122:123], v6 offset:28672
  v_mfma_f32_16x16x32_bf16 v[36:39], v[88:91], a[20:23], v[36:39]
  s_lshl_b32 s36, s34, 7
  ds_read_b64_tr_b16 v[124:125], v7 offset:24576
  v_mfma_f32_16x16x32_bf16 v[40:43], v[92:95], a[16:19], v[40:43]
  s_lshl_b32 s27, s22, 7
  s_add_u32 s36, s36, s27
  v_mfma_f32_16x16x32_bf16 v[44:47], v[92:95], a[20:23], v[44:47]
  s_add_u32 s37, s36, 0x8000
  ds_read_b64_tr_b16 v[126:127], v7 offset:28672
g2_s67:
  s_waitcnt vmcnt(4) lgkmcnt(4)
  v_mfma_f32_16x16x32_bf16 v[16:19], v[112:115], a[24:27], v[16:19]
  v_mfma_f32_16x16x32_bf16 v[20:23], v[112:115], a[28:31], v[20:23]
  v_mfma_f32_16x16x32_bf16 v[24:27], v[116:119], a[24:27], v[24:27]
  v_mfma_f32_16x16x32_bf16 v[28:31], v[116:119], a[28:31], v[28:31]
  s_waitcnt lgkmcnt(0)
  v_mfma_f32_16x16x32_bf16 v[32:35], v[120:123], a[24:27], v[32:35]
  v_mfma_f32_16x16x32_bf16 v[36:39], v[120:123], a[28:31], v[36:39]
  v_mfma_f32_16x16x32_bf16 v[40:43], v[124:127], a[24:27], v[40:43]
  v_mfma_f32_16x16x32_bf16 v[44:47], v[124:127], a[28:31], v[44:47]
  s_waitcnt vmcnt(0)
  v_lshlrev_b32 v64, 16, v48
  v_and_b32 v65, 0xffff0000, v48
  v_lshlrev_b32 v66, 16, v49
  v_and_b32 v67, 0xffff0000, v49
  v_pk_add_f32 v[16:17], v[16:17], v[64:65]
  v_pk_add_f32 v[18:19], v[18:19], v[66:67]
  v_pk_add_f32 v[16:17], v[16:17], v[176:177]
  v_pk_add_f32 v[18:19], v[18:19], v[178:179]
  v_cvt_pk_bf16_f32 v80, v16, v17
  v_cvt_pk_bf16_f32 v81, v18, v19
  v_lshlrev_b32 v64, 16, v52
  v_and_b32 v65, 0xffff0000, v52
  v_lshlrev_b32 v66, 16, v53
  v_and_b32 v67, 0xffff0000, v53
  v_pk_add_f32 v[24:25], v[24:25], v[64:65]
  v_pk_add_f32 v[26:27], v[26:27], v[66:67]
  v_pk_add_f32 v[24:25], v[24:25], v[184:185]
  v_pk_add_f32 v[26:27], v[26:27], v[186:187]
  v_cvt_pk_bf16_f32 v82, v24, v25
  v_cvt_pk_bf16_f32 v83, v26, v27
  s_nop 0
  v_permlane16_swap_b32 v80, v82
  v_permlane16_swap_b32 v81, v83
  buffer_store_dwordx4 v[80:83], v12, s[56:59], s36 offen offset:0 sc1
  v_lshlrev_b32 v64, 16, v56
  v_and_b32 v65, 0xffff0000, v56
  v_lshlrev_b32 v66, 16, v57
  v_and_b32 v67, 0xffff0000, v57
  v_pk_add_f32 v[32:33], v[32:33], v[64:65]
  v_pk_add_f32 v[34:35], v[34:35], v[66:67]
  v_pk_add_f32 v[32:33], v[32:33], v[192:193]
  v_pk_add_f32 v[34:35], v[34:35], v[194:195]
  v_cvt_pk_bf16_f32 v84, v32, v33
  v_cvt_pk_bf16_f32 v85, v34, v35
  v_lshlrev_b32 v64, 16, v60
  v_and_b32 v65, 0xffff0000, v60
  v_lshlrev_b32 v66, 16, v61
  v_and_b32 v67, 0xffff0000, v61
  v_pk_add_f32 v[40:41], v[40:41], v[64:65]
  v_pk_add_f32 v[42:43], v[42:43], v[66:67]
  v_pk_add_f32 v[40:41], v[40:41], v[200:201]
  v_pk_add_f32 v[42:43], v[42:43], v[202:203]
  v_cvt_pk_bf16_f32 v86, v40, v41
  v_cvt_pk_bf16_f32 v87, v42, v43
  s_nop 0
  v_permlane16_swap_b32 v84, v86
  v_permlane16_swap_b32 v85, v87
  buffer_store_dwordx4 v[84:87], v12, s[56:59], s36 offen offset:64 sc1
  v_lshlrev_b32 v64, 16, v50
  v_and_b32 v65, 0xffff0000, v50
  v_lshlrev_b32 v66, 16, v51
  v_and_b32 v67, 0xffff0000, v51
  v_pk_add_f32 v[20:21], v[20:21], v[64:65]
  v_pk_add_f32 v[22:23], v[22:23], v[66:67]
  v_pk_add_f32 v[20:21], v[20:21], v[180:181]
  v_pk_add_f32 v[22:23], v[22:23], v[182:183]
  v_cvt_pk_bf16_f32 v88, v20, v21
  v_cvt_pk_bf16_f32 v89, v22, v23
  v_lshlrev_b32 v64, 16, v54
  v_and_b32 v65, 0xffff0000, v54
  v_lshlrev_b32 v66, 16, v55
  v_and_b32 v67, 0xffff0000, v55
  v_pk_add_f32 v[28:29], v[28:29], v[64:65]
  v_pk_add_f32 v[30:31], v[30:31], v[66:67]
  v_pk_add_f32 v[28:29], v[28:29], v[188:189]
  v_pk_add_f32 v[30:31], v[30:31], v[190:191]
  v_cvt_pk_bf16_f32 v90, v28, v29
  v_cvt_pk_bf16_f32 v91, v30, v31
  s_nop 0
  v_permlane16_swap_b32 v88, v90
  v_permlane16_swap_b32 v89, v91
  buffer_store_dwordx4 v[88:91], v12, s[56:59], s37 offen offset:0 sc1
  v_lshlrev_b32 v64, 16, v58
  v_and_b32 v65, 0xffff0000, v58
  v_lshlrev_b32 v66, 16, v59
  v_and_b32 v67, 0xffff0000, v59
  v_pk_add_f32 v[36:37], v[36:37], v[64:65]
  v_pk_add_f32 v[38:39], v[38:39], v[66:67]
  v_pk_add_f32 v[36:37], v[36:37], v[196:197]
  v_pk_add_f32 v[38:39], v[38:39], v[198:199]
  v_cvt_pk_bf16_f32 v92, v36, v37
  v_cvt_pk_bf16_f32 v93, v38, v39
  v_lshlrev_b32 v64, 16, v62
  v_and_b32 v65, 0xffff0000, v62
  v_lshlrev_b32 v66, 16, v63
  v_and_b32 v67, 0xffff0000, v63
  v_pk_add_f32 v[44:45], v[44:45], v[64:65]
  v_pk_add_f32 v[46:47], v[46:47], v[66:67]
  v_pk_add_f32 v[44:45], v[44:45], v[204:205]
  v_pk_add_f32 v[46:47], v[46:47], v[206:207]
  v_cvt_pk_bf16_f32 v94, v44, v45
  v_cvt_pk_bf16_f32 v95, v46, v47
  s_nop 0
  v_permlane16_swap_b32 v92, v94
  v_permlane16_swap_b32 v93, v95
  buffer_store_dwordx4 v[92:95], v12, s[56:59], s37 offen offset:64 sc1
g1_end:
  s_endpgm
code_end:
  s_endpgm
.section .rodata,"a"
.p2align 6
.amdhsa_kernel conv_kernel
  .amdhsa_next_free_vgpr 452
  .amdhsa_next_free_sgpr 100
  .amdhsa_accum_offset 256
  .amdhsa_group_segment_fixed_size 0
  .amdhsa_kernarg_size 128
  .amdhsa_user_sgpr_count 2
  .amdhsa_user_sgpr_kernarg_segment_ptr 1
  .amdhsa_system_sgpr_workgroup_id_x 1
.end_amdhsa_kernel
.p2align 6
.amdhsa_kernel ffn_kernel
  .amdhsa_next_free_vgpr 472
  .amdhsa_next_free_sgpr 96
  .amdhsa_accum_offset 256
  .amdhsa_group_segment_fixed_size 0
  .amdhsa_kernarg_size 128
  .amdhsa_user_sgpr_count 2
  .amdhsa_user_sgpr_kernarg_segment_ptr 1
  .amdhsa_system_sgpr_workgroup_id_x 1
.end_amdhsa_kernel
```
